```python
import torch

def _softmax(x, axis=-1):
    return torch.softmax(x, dim=axis)

def _gelu(x):
    return torch.nn.functional.gelu(x, approximate='tanh')

def _silu(x):
    return torch.nn.functional.silu(x)

def _sigmoid(x):
    return torch.sigmoid(x)

def _layernorm(x, axis=-1, eps=1e-05):
    m = x.mean(dim=axis, keepdim=True)
    v = x.var(dim=axis, keepdim=True, unbiased=False)
    return (x - m) / torch.sqrt(v + eps)

def _scatter_add(tgt, idx, src, axis=0):
    return tgt.clone().index_add_(axis, idx, src)

def _segment_sum(src, seg, n):
    out = torch.zeros((n,) + src.shape[1:], dtype=src.dtype)
    return out.index_add_(0, seg, src)

def _pad(x, pw):
    flat = tuple((v for pair in reversed(pw) for v in pair))
    return torch.nn.functional.pad(x, flat)
kernel_name = 'adaLN_cond__gqa_block_cached__glu_gated_glu__prompt'

def setup_inputs():

    _w = lambda a: (lambda t: t.to(torch.bfloat16) if t.is_floating_point() else t)(torch.as_tensor(a))

    def _A_setup():
        B, Sq, D = (1, 2048, 1024)
        Hq, Hkv, Sk, Dh = (32, 4, 2048, 128)
        assert Hq % Hkv == 0, (Hq, Hkv)
        return {'x': _w((lambda *s: torch.randn(*s, dtype=torch.bfloat16) * 0.05)(B, Sq, D)), 'k_cache': _w((lambda *s: torch.randn(*s, dtype=torch.bfloat16) * 3.2)(B, Hkv, Sk, Dh)), 'v_cache': _w((lambda *s: torch.randn(*s, dtype=torch.bfloat16) * 0.4)(B, Hkv, Sk, Dh)), 'wq': _w((lambda *s: torch.randn(*s, dtype=torch.bfloat16) * 3.2)(D, Hq * Dh) * D ** (-0.5)), 'wo': _w((lambda *s: torch.randn(*s, dtype=torch.bfloat16) * 0.4)(Hq * Dh, D) * (Hq * Dh) ** (-0.5))}
    _A_in = _A_setup()

    def _B_setup():
        B, S, D, F = (1, 2048, 1024, 3584)
        return {'x': _w((lambda *s: torch.randn(*s, dtype=torch.bfloat16) * 0.05)(B, S, D)), 'w_gate': _w((lambda *s: torch.randn(*s, dtype=torch.bfloat16) * 0.05)(D, F)), 'w_up': _w((lambda *s: torch.randn(*s, dtype=torch.bfloat16) * 0.05)(D, F)), 'w_down': _w((lambda *s: torch.randn(*s, dtype=torch.bfloat16) * 0.05)(F, D))}
    _B_in = _B_setup()
    return {'A_x': _A_in['x'], 'A_k_cache': _A_in['k_cache'], 'A_v_cache': _A_in['v_cache'], 'A_wq': _A_in['wq'], 'A_wo': _A_in['wo'], 'B_x': _B_in['x'], 'B_w_gate': _B_in['w_gate'], 'B_w_up': _B_in['w_up'], 'B_w_down': _B_in['w_down'], 'c': _w((lambda *s: torch.randn(*s, dtype=torch.bfloat16) * 0.1)(1, 1024) * 8.0), 'w_mod': _w((lambda *s: torch.randn(*s, dtype=torch.bfloat16) * 0.1)(1024, 6 * 1024) * 1024 ** (-0.5) * 8.0)}

def reference(A_x, A_k_cache, A_v_cache, A_wq, A_wo, B_x, B_w_gate, B_w_up, B_w_down, c, w_mod):

    def _A_ref(x, k_cache, v_cache, wq, wo):
        B, Sq, D = x.shape
        Hq, Dh = (32, 128)
        Hkv = k_cache.shape[1]
        rep = Hq // Hkv
        q = (lambda x, *d: x.permute(*d))((x @ wq).reshape(B, Sq, Hq, Dh), 0, 2, 1, 3)
        k = (lambda x, n, axis: torch.repeat_interleave(x, n, dim=axis))(k_cache, rep, axis=1)
        v = (lambda x, n, axis: torch.repeat_interleave(x, n, dim=axis))(v_cache, rep, axis=1)
        scores = torch.einsum('bhqd,bhkd->bhqk', q, k) * Dh ** (-0.5)
        p = _softmax(scores, axis=-1)
        o = torch.einsum('bhqk,bhkd->bhqd', p, v)
        return (lambda x, *d: x.permute(*d))(o, 0, 2, 1, 3).reshape(B, Sq, Hq * Dh) @ wo

    def _B_ref(x, w_gate, w_up, w_down):
        g = torch.einsum('bsd,df->bsf', x, w_gate)
        u = torch.einsum('bsd,df->bsf', x, w_up)
        h = _sigmoid(g) * u
        return torch.einsum('bsf,fd->bsd', h, w_down)
    x = A_x
    mod = (_silu(c) @ w_mod).reshape(c.shape[0], 6, 1, -1)
    sa, ca, ga, sb, cb, gb = (mod[:, 0].clone(), mod[:, 1].clone(), mod[:, 2].clone(), mod[:, 3].clone(), mod[:, 4].clone(), mod[:, 5].clone())
    h = _layernorm(x, axis=-1) * (1 + ca) + sa
    x = x + ga * _A_ref(h, A_k_cache, A_v_cache, A_wq, A_wo)
    h = _layernorm(x, axis=-1) * (1 + cb) + sb
    x = x + gb * _B_ref(h, B_w_gate, B_w_up, B_w_down)
    return x
```

```asm
; @launch kernel=prep_kernel grid=(192,1,1) block=(512,1,1) lds=16384
; @launch kernel=mega_kernel grid=(256,1,1) block=(256,1,1) lds=143616
.amdgcn_target "amdgcn-amd-amdhsa--gfx950"
.text
.globl prep_kernel
.p2align 8
.type prep_kernel,@function
prep_kernel:
    s_cmp_ge_u32 s2, 192
    s_cbranch_scc1 L_prep_kernel_end
    s_load_dwordx2 s[4:5], s[0:1], 104
    s_load_dwordx2 s[6:7], s[0:1], 72
    s_load_dwordx2 s[8:9], s[0:1], 80
    v_lshrrev_b32 v4, 6, v0
    v_and_b32 v1, 63, v0
    v_readfirstlane_b32 s24, v4
    s_mul_hi_u32 s26, s2, 0x5555556
    s_mul_i32 s27, s26, 48
    s_sub_u32 s25, s2, s27
    s_waitcnt lgkmcnt(0)
    s_mov_b32 s12, s6
    s_mov_b32 s13, s7
    s_mov_b32 s14, 0x800
    s_mov_b32 s15, 0x20000
    s_mov_b32 s16, s8
    s_mov_b32 s17, s9
    s_mov_b32 s18, 0xc00000
    s_mov_b32 s19, 0x20000
    s_mov_b32 s20, s4
    s_mov_b32 s21, s5
    s_mov_b32 s22, 0x18000
    s_mov_b32 s23, 0x20000
    s_lshl_b32 s27, s26, 8
    s_lshl_b32 s28, s24, 5
    s_add_u32 s27, s27, s28
    v_lshrrev_b32 v2, 4, v1
    v_lshl_add_u32 v3, v2, 3, s27
    v_lshlrev_b32 v4, 1, v3
    buffer_load_dwordx4 v[8:11], v4, s[12:15], 0 offen
    s_mov_b32 s28, 12288
    v_mul_lo_u32 v5, v3, s28
    v_and_b32 v6, 15, v1
    v_lshl_add_u32 v5, v6, 4, v5
    s_lshl_b32 s28, s25, 8
    v_add_u32 v5, s28, v5
    buffer_load_dwordx4 v[32:35], v5, s[16:19], 0 offen
    v_add_u32 v5, 12288, v5
    buffer_load_dwordx4 v[36:39], v5, s[16:19], 0 offen
    v_add_u32 v5, 12288, v5
    buffer_load_dwordx4 v[40:43], v5, s[16:19], 0 offen
    v_add_u32 v5, 12288, v5
    buffer_load_dwordx4 v[44:47], v5, s[16:19], 0 offen
    v_add_u32 v5, 12288, v5
    buffer_load_dwordx4 v[48:51], v5, s[16:19], 0 offen
    v_add_u32 v5, 12288, v5
    buffer_load_dwordx4 v[52:55], v5, s[16:19], 0 offen
    v_add_u32 v5, 12288, v5
    buffer_load_dwordx4 v[56:59], v5, s[16:19], 0 offen
    v_add_u32 v5, 12288, v5
    buffer_load_dwordx4 v[60:63], v5, s[16:19], 0 offen
    s_add_u32 s36, s4, 0x5800000
    s_addc_u32 s37, s5, 0
    s_mov_b32 s38, 0xa800
    s_mov_b32 s39, 0x20000
    s_mul_i32 s40, s2, 256
    v_lshlrev_b32 v106, 2, v0
    v_mov_b32 v107, 0
    v_cmp_gt_u32 vcc, 64, v0
    s_and_saveexec_b64 s[42:43], vcc
    buffer_store_dword v107, v106, s[36:39], s40 offen
    s_mov_b64 exec, s[42:43]
    s_cmp_ge_u32 s2, 16
    s_cbranch_scc1 L_prep_kernel_nocode
    s_cmp_lg_u32 s24, 7
    s_cbranch_scc1 L_prep_kernel_nocode
    s_mov_b32 s48, s2
    s_getpc_b64 s[44:45]
L_prep_kernel_pc:
    s_add_u32 s44, s44, mega_kernel - L_prep_kernel_pc
    s_addc_u32 s45, s45, 0
    s_mov_b32 s46, mega_kernel_codeend - mega_kernel
    s_mov_b32 s47, 0x20000
    s_lshl_b32 s48, s48, 13
    v_lshlrev_b32 v104, 7, v1
    buffer_load_dword v105, v104, s[44:47], s48 offen
L_prep_kernel_nocode:
    s_waitcnt vmcnt(8)
    v_lshlrev_b32 v12, 16, v8
    v_and_b32 v13, 0xffff0000, v8
    v_lshlrev_b32 v14, 16, v9
    v_and_b32 v15, 0xffff0000, v9
    v_lshlrev_b32 v16, 16, v10
    v_and_b32 v17, 0xffff0000, v10
    v_lshlrev_b32 v18, 16, v11
    v_and_b32 v19, 0xffff0000, v11
    s_mov_b32 s28, 0xbfb8aa3b
    v_mul_f32 v20, s28, v12
    v_mul_f32 v21, s28, v13
    v_mul_f32 v22, s28, v14
    v_mul_f32 v23, s28, v15
    v_mul_f32 v24, s28, v16
    v_mul_f32 v25, s28, v17
    v_mul_f32 v26, s28, v18
    v_mul_f32 v27, s28, v19
    v_exp_f32 v20, v20
    v_exp_f32 v21, v21
    v_exp_f32 v22, v22
    v_exp_f32 v23, v23
    v_exp_f32 v24, v24
    v_exp_f32 v25, v25
    v_exp_f32 v26, v26
    v_exp_f32 v27, v27
    v_add_f32 v20, 1.0, v20
    v_add_f32 v21, 1.0, v21
    v_add_f32 v22, 1.0, v22
    v_add_f32 v23, 1.0, v23
    v_add_f32 v24, 1.0, v24
    v_add_f32 v25, 1.0, v25
    v_add_f32 v26, 1.0, v26
    v_add_f32 v27, 1.0, v27
    v_rcp_f32 v20, v20
    v_rcp_f32 v21, v21
    v_rcp_f32 v22, v22
    v_rcp_f32 v23, v23
    v_rcp_f32 v24, v24
    v_rcp_f32 v25, v25
    v_rcp_f32 v26, v26
    v_rcp_f32 v27, v27
    v_mul_f32 v12, v12, v20
    v_mul_f32 v13, v13, v21
    v_mul_f32 v14, v14, v22
    v_mul_f32 v15, v15, v23
    v_mul_f32 v16, v16, v24
    v_mul_f32 v17, v17, v25
    v_mul_f32 v18, v18, v26
    v_mul_f32 v19, v19, v27
    v_cvt_pk_bf16_f32 v20, v12, v13
    v_cvt_pk_bf16_f32 v21, v14, v15
    v_cvt_pk_bf16_f32 v22, v16, v17
    v_cvt_pk_bf16_f32 v23, v18, v19
    v_lshlrev_b32 v12, 16, v20
    v_and_b32 v13, 0xffff0000, v20
    v_lshlrev_b32 v14, 16, v21
    v_and_b32 v15, 0xffff0000, v21
    v_lshlrev_b32 v16, 16, v22
    v_and_b32 v17, 0xffff0000, v22
    v_lshlrev_b32 v18, 16, v23
    v_and_b32 v19, 0xffff0000, v23
    v_mov_b32 v64, 0
    v_mov_b32 v65, 0
    v_mov_b32 v66, 0
    v_mov_b32 v67, 0
    v_mov_b32 v68, 0
    v_mov_b32 v69, 0
    v_mov_b32 v70, 0
    v_mov_b32 v71, 0
    s_waitcnt vmcnt(7)
    v_lshlrev_b32 v28, 16, v32
    v_and_b32 v29, 0xffff0000, v32
    v_fmac_f32 v64, v28, v12
    v_fmac_f32 v65, v29, v12
    v_lshlrev_b32 v28, 16, v33
    v_and_b32 v29, 0xffff0000, v33
    v_fmac_f32 v66, v28, v12
    v_fmac_f32 v67, v29, v12
    v_lshlrev_b32 v28, 16, v34
    v_and_b32 v29, 0xffff0000, v34
    v_fmac_f32 v68, v28, v12
    v_fmac_f32 v69, v29, v12
    v_lshlrev_b32 v28, 16, v35
    v_and_b32 v29, 0xffff0000, v35
    v_fmac_f32 v70, v28, v12
    v_fmac_f32 v71, v29, v12
    s_waitcnt vmcnt(6)
    v_lshlrev_b32 v28, 16, v36
    v_and_b32 v29, 0xffff0000, v36
    v_fmac_f32 v64, v28, v13
    v_fmac_f32 v65, v29, v13
    v_lshlrev_b32 v28, 16, v37
    v_and_b32 v29, 0xffff0000, v37
    v_fmac_f32 v66, v28, v13
    v_fmac_f32 v67, v29, v13
    v_lshlrev_b32 v28, 16, v38
    v_and_b32 v29, 0xffff0000, v38
    v_fmac_f32 v68, v28, v13
    v_fmac_f32 v69, v29, v13
    v_lshlrev_b32 v28, 16, v39
    v_and_b32 v29, 0xffff0000, v39
    v_fmac_f32 v70, v28, v13
    v_fmac_f32 v71, v29, v13
    s_waitcnt vmcnt(5)
    v_lshlrev_b32 v28, 16, v40
    v_and_b32 v29, 0xffff0000, v40
    v_fmac_f32 v64, v28, v14
    v_fmac_f32 v65, v29, v14
    v_lshlrev_b32 v28, 16, v41
    v_and_b32 v29, 0xffff0000, v41
    v_fmac_f32 v66, v28, v14
    v_fmac_f32 v67, v29, v14
    v_lshlrev_b32 v28, 16, v42
    v_and_b32 v29, 0xffff0000, v42
    v_fmac_f32 v68, v28, v14
    v_fmac_f32 v69, v29, v14
    v_lshlrev_b32 v28, 16, v43
    v_and_b32 v29, 0xffff0000, v43
    v_fmac_f32 v70, v28, v14
    v_fmac_f32 v71, v29, v14
    s_waitcnt vmcnt(4)
    v_lshlrev_b32 v28, 16, v44
    v_and_b32 v29, 0xffff0000, v44
    v_fmac_f32 v64, v28, v15
    v_fmac_f32 v65, v29, v15
    v_lshlrev_b32 v28, 16, v45
    v_and_b32 v29, 0xffff0000, v45
    v_fmac_f32 v66, v28, v15
    v_fmac_f32 v67, v29, v15
    v_lshlrev_b32 v28, 16, v46
    v_and_b32 v29, 0xffff0000, v46
    v_fmac_f32 v68, v28, v15
    v_fmac_f32 v69, v29, v15
    v_lshlrev_b32 v28, 16, v47
    v_and_b32 v29, 0xffff0000, v47
    v_fmac_f32 v70, v28, v15
    v_fmac_f32 v71, v29, v15
    s_waitcnt vmcnt(3)
    v_lshlrev_b32 v28, 16, v48
    v_and_b32 v29, 0xffff0000, v48
    v_fmac_f32 v64, v28, v16
    v_fmac_f32 v65, v29, v16
    v_lshlrev_b32 v28, 16, v49
    v_and_b32 v29, 0xffff0000, v49
    v_fmac_f32 v66, v28, v16
    v_fmac_f32 v67, v29, v16
    v_lshlrev_b32 v28, 16, v50
    v_and_b32 v29, 0xffff0000, v50
    v_fmac_f32 v68, v28, v16
    v_fmac_f32 v69, v29, v16
    v_lshlrev_b32 v28, 16, v51
    v_and_b32 v29, 0xffff0000, v51
    v_fmac_f32 v70, v28, v16
    v_fmac_f32 v71, v29, v16
    s_waitcnt vmcnt(2)
    v_lshlrev_b32 v28, 16, v52
    v_and_b32 v29, 0xffff0000, v52
    v_fmac_f32 v64, v28, v17
    v_fmac_f32 v65, v29, v17
    v_lshlrev_b32 v28, 16, v53
    v_and_b32 v29, 0xffff0000, v53
    v_fmac_f32 v66, v28, v17
    v_fmac_f32 v67, v29, v17
    v_lshlrev_b32 v28, 16, v54
    v_and_b32 v29, 0xffff0000, v54
    v_fmac_f32 v68, v28, v17
    v_fmac_f32 v69, v29, v17
    v_lshlrev_b32 v28, 16, v55
    v_and_b32 v29, 0xffff0000, v55
    v_fmac_f32 v70, v28, v17
    v_fmac_f32 v71, v29, v17
    s_waitcnt vmcnt(1)
    v_lshlrev_b32 v28, 16, v56
    v_and_b32 v29, 0xffff0000, v56
    v_fmac_f32 v64, v28, v18
    v_fmac_f32 v65, v29, v18
    v_lshlrev_b32 v28, 16, v57
    v_and_b32 v29, 0xffff0000, v57
    v_fmac_f32 v66, v28, v18
    v_fmac_f32 v67, v29, v18
    v_lshlrev_b32 v28, 16, v58
    v_and_b32 v29, 0xffff0000, v58
    v_fmac_f32 v68, v28, v18
    v_fmac_f32 v69, v29, v18
    v_lshlrev_b32 v28, 16, v59
    v_and_b32 v29, 0xffff0000, v59
    v_fmac_f32 v70, v28, v18
    v_fmac_f32 v71, v29, v18
    s_waitcnt vmcnt(0)
    v_lshlrev_b32 v28, 16, v60
    v_and_b32 v29, 0xffff0000, v60
    v_fmac_f32 v64, v28, v19
    v_fmac_f32 v65, v29, v19
    v_lshlrev_b32 v28, 16, v61
    v_and_b32 v29, 0xffff0000, v61
    v_fmac_f32 v66, v28, v19
    v_fmac_f32 v67, v29, v19
    v_lshlrev_b32 v28, 16, v62
    v_and_b32 v29, 0xffff0000, v62
    v_fmac_f32 v68, v28, v19
    v_fmac_f32 v69, v29, v19
    v_lshlrev_b32 v28, 16, v63
    v_and_b32 v29, 0xffff0000, v63
    v_fmac_f32 v70, v28, v19
    v_fmac_f32 v71, v29, v19
    s_lshl_b32 s28, s24, 2
    v_add_u32 v2, s28, v2
    v_lshlrev_b32 v2, 9, v2
    v_lshl_add_u32 v2, v6, 5, v2
    ds_write_b128 v2, v[64:67]
    ds_write_b128 v2, v[68:71] offset:16
    s_waitcnt lgkmcnt(0)
    s_barrier
    v_cmp_gt_u32 vcc, 128, v0
    s_and_saveexec_b64 s[30:31], vcc
    s_cbranch_execz L_prep_kernel_end
    v_lshlrev_b32 v2, 2, v0
    ds_read_b32 v32, v2 offset:0
    ds_read_b32 v33, v2 offset:512
    ds_read_b32 v34, v2 offset:1024
    ds_read_b32 v35, v2 offset:1536
    ds_read_b32 v36, v2 offset:2048
    ds_read_b32 v37, v2 offset:2560
    ds_read_b32 v38, v2 offset:3072
    ds_read_b32 v39, v2 offset:3584
    ds_read_b32 v40, v2 offset:4096
    ds_read_b32 v41, v2 offset:4608
    ds_read_b32 v42, v2 offset:5120
    ds_read_b32 v43, v2 offset:5632
    ds_read_b32 v44, v2 offset:6144
    ds_read_b32 v45, v2 offset:6656
    ds_read_b32 v46, v2 offset:7168
    ds_read_b32 v47, v2 offset:7680
    ds_read_b32 v48, v2 offset:8192
    ds_read_b32 v49, v2 offset:8704
    ds_read_b32 v50, v2 offset:9216
    ds_read_b32 v51, v2 offset:9728
    ds_read_b32 v52, v2 offset:10240
    ds_read_b32 v53, v2 offset:10752
    ds_read_b32 v54, v2 offset:11264
    ds_read_b32 v55, v2 offset:11776
    ds_read_b32 v56, v2 offset:12288
    ds_read_b32 v57, v2 offset:12800
    ds_read_b32 v58, v2 offset:13312
    ds_read_b32 v59, v2 offset:13824
    ds_read_b32 v60, v2 offset:14336
    ds_read_b32 v61, v2 offset:14848
    ds_read_b32 v62, v2 offset:15360
    ds_read_b32 v63, v2 offset:15872
    s_waitcnt lgkmcnt(0)
    v_add_f32 v32, v32, v48
    v_add_f32 v33, v33, v49
    v_add_f32 v34, v34, v50
    v_add_f32 v35, v35, v51
    v_add_f32 v36, v36, v52
    v_add_f32 v37, v37, v53
    v_add_f32 v38, v38, v54
    v_add_f32 v39, v39, v55
    v_add_f32 v40, v40, v56
    v_add_f32 v41, v41, v57
    v_add_f32 v42, v42, v58
    v_add_f32 v43, v43, v59
    v_add_f32 v44, v44, v60
    v_add_f32 v45, v45, v61
    v_add_f32 v46, v46, v62
    v_add_f32 v47, v47, v63
    v_add_f32 v32, v32, v40
    v_add_f32 v33, v33, v41
    v_add_f32 v34, v34, v42
    v_add_f32 v35, v35, v43
    v_add_f32 v36, v36, v44
    v_add_f32 v37, v37, v45
    v_add_f32 v38, v38, v46
    v_add_f32 v39, v39, v47
    v_add_f32 v32, v32, v36
    v_add_f32 v33, v33, v37
    v_add_f32 v34, v34, v38
    v_add_f32 v35, v35, v39
    v_add_f32 v32, v32, v34
    v_add_f32 v33, v33, v35
    v_add_f32 v32, v32, v33
    s_mul_i32 s28, s26, 24576
    s_lshl_b32 s29, s25, 9
    s_add_u32 s28, s28, s29
    buffer_store_dword v32, v2, s[20:23], s28 offen
    s_endpgm
L_prep_kernel_end:
    s_endpgm
prep_kernel_codeend:
.globl mega_kernel
.p2align 8
.type mega_kernel,@function
mega_kernel:
    s_cmp_ge_u32 s2, 256
    s_cbranch_scc1 L_mega_kernel_end
    s_load_dwordx2 s[4:5], s[0:1], 104
    s_load_dwordx2 s[6:7], s[0:1], 24
    s_load_dwordx2 s[74:75], s[0:1], 32
    s_load_dwordx2 s[76:77], s[0:1], 48
    s_load_dwordx2 s[78:79], s[0:1], 56
    s_load_dwordx2 s[80:81], s[0:1], 64
    s_load_dwordx2 s[82:83], s[0:1], 0
    s_load_dwordx2 s[84:85], s[0:1], 88
    v_lshrrev_b32 v4, 6, v0
    v_and_b32 v0, 63, v0
    v_readfirstlane_b32 s24, v4
    s_waitcnt lgkmcnt(0)
    s_add_u32 s92, s4, 0x5800000
    s_addc_u32 s93, s5, 0
    s_mov_b32 s94, 0xa800
    s_mov_b32 s95, 0x20000
    s_mov_b32 s100, s24
    s_lshr_b32 s48, s2, 3
    s_getpc_b64 s[44:45]
L_mega_kernel_pc:
    s_sub_u32 s44, s44, L_mega_kernel_pc - mega_kernel
    s_subb_u32 s45, s45, 0
    s_mov_b32 s46, mega_kernel_codeend - mega_kernel
    s_mov_b32 s47, 0x20000
    s_lshl_b32 s48, s48, 12
    v_lshlrev_b32 v249, 6, v0
    buffer_load_dword v255, v249, s[44:47], s48 offen
    s_load_dwordx2 s[44:45], s[0:1], 8
    s_load_dwordx2 s[46:47], s[0:1], 16
    s_mov_b32 s52, s6
    s_mov_b32 s53, s7
    s_mov_b32 s54, 0x800000
    s_mov_b32 s55, 0x20000
    s_mov_b64 s[6:7], s[82:83]
    s_mov_b32 s24, s100
    v_mov_b32 v1, v0
    s_mov_b32 s8, s6
    s_mov_b32 s9, s7
    s_mov_b32 s10, 0x400000
    s_mov_b32 s11, 0x20000
    s_add_u32 s12, s4, 0x100000
    s_addc_u32 s13, s5, 0
    s_mov_b32 s14, 0x400000
    s_mov_b32 s15, 0x20000
    s_mov_b32 s16, s4
    s_mov_b32 s17, s5
    s_mov_b32 s18, 0x18000
    s_mov_b32 s19, 0x20000
    s_add_u32 s20, s4, 0x20000
    s_addc_u32 s21, s5, 0
    s_mov_b32 s22, 0x6000
    s_mov_b32 s23, 0x20000
    s_and_b32 s40, s2, 7
    s_lshr_b32 s41, s2, 3
    s_and_b32 s42, s40, 1
    s_lshl_b32 s42, s42, 2
    s_lshr_b32 s43, s41, 3
    s_add_u32 s42, s42, s43
    s_lshr_b32 s40, s40, 1
    s_lshl_b32 s40, s40, 3
    s_and_b32 s41, s41, 7
    s_add_u32 s41, s41, s40
    s_lshl_b32 s25, s42, 8
    s_lshl_b32 s41, s41, 3
    s_add_u32 s25, s25, s41
    v_and_b32 v2, 7, v1
    v_add_u32 v2, s25, v2
    v_lshrrev_b32 v3, 3, v1
    v_lshlrev_b32 v5, 11, v2
    v_lshl_add_u32 v5, v3, 4, v5
    s_lshl_b32 s26, s24, 9
    v_add_u32 v5, s26, v5
    buffer_load_dwordx4 v[32:35], v5, s[8:11], 0 offen offset:0
    buffer_load_dwordx4 v[36:39], v5, s[8:11], 0 offen offset:128
    buffer_load_dwordx4 v[40:43], v5, s[8:11], 0 offen offset:256
    buffer_load_dwordx4 v[44:47], v5, s[8:11], 0 offen offset:384
    s_lshl_b32 s26, s24, 10
    v_lshlrev_b32 v6, 4, v0
    v_add_u32 v6, s26, v6
    s_mov_b32 s26, 0
    s_mov_b32 s27, 4096
    buffer_load_dwordx4 v[64:67], v6, s[16:19], s26 offen
    buffer_load_dwordx4 v[68:71], v6, s[16:19], s27 offen
    s_mov_b32 s26, 24576
    s_mov_b32 s27, 28672
    buffer_load_dwordx4 v[72:75], v6, s[16:19], s26 offen
    buffer_load_dwordx4 v[76:79], v6, s[16:19], s27 offen
    s_mov_b32 s26, 49152
    s_mov_b32 s27, 53248
    buffer_load_dwordx4 v[80:83], v6, s[16:19], s26 offen
    buffer_load_dwordx4 v[84:87], v6, s[16:19], s27 offen
    s_mov_b32 s26, 73728
    s_mov_b32 s27, 77824
    buffer_load_dwordx4 v[88:91], v6, s[16:19], s26 offen
    buffer_load_dwordx4 v[92:95], v6, s[16:19], s27 offen
    s_and_b32 s38, s2, 7
    s_lshr_b32 s39, s2, 3
    s_lshr_b32 s57, s38, 1
    s_lshl_b32 s57, s57, 3
    s_and_b32 s58, s39, 7
    s_add_u32 s57, s57, s58
    s_and_b32 s58, s38, 1
    s_lshl_b32 s58, s58, 2
    s_lshr_b32 s59, s39, 3
    s_add_u32 s58, s58, s59
    v_lshrrev_b32 v241, 4, v0
    s_and_b32 s38, s24, 1
    s_lshl_b32 s38, s38, 2
    v_or_b32 v242, s38, v241
    v_bfe_u32 v243, v0, 1, 3
    v_xor_b32 v242, v242, v243
    v_lshlrev_b32 v242, 5, v242
    v_and_b32 v243, 1, v0
    v_lshlrev_b32 v243, 4, v243
    v_lshl_add_u32 v242, v241, 13, v242
    v_add_u32 v242, v242, v243
    s_lshl_b32 s38, s57, 8
    v_add_u32 v240, s38, v242
    s_lshl_b32 s56, s24, 16
    s_lshl_b32 s59, s24, 11
    s_add_u32 s59, s59, 0x10000
    s_add_u32 m0, s59, 0
    s_add_u32 s38, s56, 32768
    buffer_load_dwordx4 v240, s[52:55], s56 offen lds
    s_add_u32 m0, s59, 1024
    s_add_u32 s56, s56, 262144
    buffer_load_dwordx4 v240, s[52:55], s38 offen lds
    s_add_u32 m0, s59, 8192
    s_add_u32 s38, s56, 32768
    buffer_load_dwordx4 v240, s[52:55], s56 offen lds
    s_add_u32 m0, s59, 9216
    s_add_u32 s56, s56, 262144
    buffer_load_dwordx4 v240, s[52:55], s38 offen lds
    s_add_u32 m0, s59, 16384
    s_add_u32 s38, s56, 32768
    buffer_load_dwordx4 v240, s[52:55], s56 offen lds
    s_add_u32 m0, s59, 17408
    s_add_u32 s56, s56, 262144
    buffer_load_dwordx4 v240, s[52:55], s38 offen lds
    s_add_u32 m0, s59, 24576
    s_add_u32 s38, s56, 32768
    buffer_load_dwordx4 v240, s[52:55], s56 offen lds
    s_add_u32 m0, s59, 25600
    s_add_u32 s56, s56, 262144
    buffer_load_dwordx4 v240, s[52:55], s38 offen lds
    s_add_u32 m0, s59, 32768
    s_add_u32 s38, s56, 32768
    buffer_load_dwordx4 v240, s[52:55], s56 offen lds
    s_add_u32 m0, s59, 33792
    s_add_u32 s56, s56, 262144
    buffer_load_dwordx4 v240, s[52:55], s38 offen lds
    s_add_u32 m0, s59, 40960
    s_add_u32 s38, s56, 32768
    buffer_load_dwordx4 v240, s[52:55], s56 offen lds
    s_add_u32 m0, s59, 41984
    s_add_u32 s56, s56, 262144
    buffer_load_dwordx4 v240, s[52:55], s38 offen lds
    v_lshlrev_b32 v13, 5, v3
    s_lshl_b32 s26, s24, 10
    v_add_u32 v13, s26, v13
    v_add_u32 v13, 131072, v13
    v_and_b32 v14, 7, v1
    v_lshlrev_b32 v14, 2, v14
    v_add_u32 v14, 143360, v14
    s_lshl_b32 s26, s24, 5
    v_add_u32 v20, s26, v14
    v_lshrrev_b32 v12, 4, v2
    v_lshlrev_b32 v12, 15, v12
    s_lshl_b32 s26, s24, 13
    v_add_u32 v12, s26, v12
    v_lshrrev_b32 v16, 2, v3
    v_lshl_add_u32 v12, v16, 10, v12
    v_and_b32 v16, 3, v3
    v_lshl_add_u32 v12, v16, 8, v12
    v_and_b32 v16, 15, v2
    v_lshl_add_u32 v12, v16, 4, v12
    s_waitcnt vmcnt(12)
    s_waitcnt lgkmcnt(0)
    s_cmp_eq_u32 s100, 2
    s_cselect_b64 s[48:49], s[46:47], s[44:45]
    s_mov_b32 s50, 0x200000
    s_mov_b32 s51, 0x20000
    s_lshl_b32 s44, s2, 13
    s_sub_u32 s45, s100, 1
    s_cmp_ge_u32 s45, 2
    s_cselect_b32 s44, 0x400000, s44
    s_lshl_b32 s45, s100, 13
    v_lshlrev_b32 v248, 4, v0
    s_add_u32 m0, s45, 0
    s_nop 0
    buffer_load_dwordx4 v248, s[48:51], s44 offen offset:0 lds
    buffer_load_dwordx4 v248, s[48:51], s44 offen offset:1024 lds
    buffer_load_dwordx4 v248, s[48:51], s44 offen offset:2048 lds
    buffer_load_dwordx4 v248, s[48:51], s44 offen offset:3072 lds
    s_add_u32 s44, s44, 4096
    s_add_u32 m0, s45, 4096
    s_nop 0
    buffer_load_dwordx4 v248, s[48:51], s44 offen offset:0 lds
    buffer_load_dwordx4 v248, s[48:51], s44 offen offset:1024 lds
    buffer_load_dwordx4 v248, s[48:51], s44 offen offset:2048 lds
    buffer_load_dwordx4 v248, s[48:51], s44 offen offset:3072 lds
    v_add_f32 v64, v64, v72
    v_add_f32 v80, v80, v88
    v_add_f32 v64, v64, v80
    v_add_f32 v65, v65, v73
    v_add_f32 v81, v81, v89
    v_add_f32 v65, v65, v81
    v_add_f32 v66, v66, v74
    v_add_f32 v82, v82, v90
    v_add_f32 v66, v66, v82
    v_add_f32 v67, v67, v75
    v_add_f32 v83, v83, v91
    v_add_f32 v67, v67, v83
    v_add_f32 v68, v68, v76
    v_add_f32 v84, v84, v92
    v_add_f32 v68, v68, v84
    v_add_f32 v69, v69, v77
    v_add_f32 v85, v85, v93
    v_add_f32 v69, v69, v85
    v_add_f32 v70, v70, v78
    v_add_f32 v86, v86, v94
    v_add_f32 v70, v70, v86
    v_add_f32 v71, v71, v79
    v_add_f32 v87, v87, v95
    v_add_f32 v71, v71, v87
    v_cvt_pk_bf16_f32 v72, v64, v65
    v_cvt_pk_bf16_f32 v73, v66, v67
    v_cvt_pk_bf16_f32 v74, v68, v69
    v_cvt_pk_bf16_f32 v75, v70, v71
    v_lshlrev_b32 v64, 16, v72
    v_and_b32 v65, 0xffff0000, v72
    v_lshlrev_b32 v66, 16, v73
    v_and_b32 v67, 0xffff0000, v73
    v_lshlrev_b32 v68, 16, v74
    v_and_b32 v69, 0xffff0000, v74
    v_lshlrev_b32 v70, 16, v75
    v_and_b32 v71, 0xffff0000, v75
    v_add_f32 v68, 1.0, v68
    v_add_f32 v69, 1.0, v69
    v_add_f32 v70, 1.0, v70
    v_add_f32 v71, 1.0, v71
    v_cvt_pk_bf16_f32 v72, v68, v69
    v_cvt_pk_bf16_f32 v73, v70, v71
    v_lshlrev_b32 v68, 16, v72
    v_and_b32 v69, 0xffff0000, v72
    v_lshlrev_b32 v70, 16, v73
    v_and_b32 v71, 0xffff0000, v73
    s_mov_b32 s26, 0x3e0293ee
    v_mul_f32 v64, s26, v64
    v_mul_f32 v65, s26, v65
    v_mul_f32 v66, s26, v66
    v_mul_f32 v67, s26, v67
    v_mul_f32 v68, s26, v68
    v_mul_f32 v69, s26, v69
    v_mul_f32 v70, s26, v70
    v_mul_f32 v71, s26, v71
    v_add_u32 v6, 131072, v6
    ds_write_b128 v6, v[64:67]
    ds_write_b128 v6, v[68:71] offset:4096
    v_lshlrev_b32 v100, 16, v32
    v_and_b32 v101, 0xffff0000, v32
    v_lshlrev_b32 v102, 16, v33
    v_and_b32 v103, 0xffff0000, v33
    v_lshlrev_b32 v104, 16, v34
    v_and_b32 v105, 0xffff0000, v34
    v_lshlrev_b32 v106, 16, v35
    v_and_b32 v107, 0xffff0000, v35
    v_lshlrev_b32 v108, 16, v36
    v_and_b32 v109, 0xffff0000, v36
    v_lshlrev_b32 v110, 16, v37
    v_and_b32 v111, 0xffff0000, v37
    v_lshlrev_b32 v112, 16, v38
    v_and_b32 v113, 0xffff0000, v38
    v_lshlrev_b32 v114, 16, v39
    v_and_b32 v115, 0xffff0000, v39
    v_lshlrev_b32 v116, 16, v40
    v_and_b32 v117, 0xffff0000, v40
    v_lshlrev_b32 v118, 16, v41
    v_and_b32 v119, 0xffff0000, v41
    v_lshlrev_b32 v120, 16, v42
    v_and_b32 v121, 0xffff0000, v42
    v_lshlrev_b32 v122, 16, v43
    v_and_b32 v123, 0xffff0000, v43
    v_lshlrev_b32 v124, 16, v44
    v_and_b32 v125, 0xffff0000, v44
    v_lshlrev_b32 v126, 16, v45
    v_and_b32 v127, 0xffff0000, v45
    v_lshlrev_b32 v128, 16, v46
    v_and_b32 v129, 0xffff0000, v46
    v_lshlrev_b32 v130, 16, v47
    v_and_b32 v131, 0xffff0000, v47
    v_pk_add_f32 v[8:9], v[100:101], v[102:103]
    v_pk_add_f32 v[10:11], v[104:105], v[106:107]
    v_pk_add_f32 v[8:9], v[8:9], v[108:109]
    v_pk_add_f32 v[10:11], v[10:11], v[110:111]
    v_pk_add_f32 v[8:9], v[8:9], v[112:113]
    v_pk_add_f32 v[10:11], v[10:11], v[114:115]
    v_pk_add_f32 v[8:9], v[8:9], v[116:117]
    v_pk_add_f32 v[10:11], v[10:11], v[118:119]
    v_pk_add_f32 v[8:9], v[8:9], v[120:121]
    v_pk_add_f32 v[10:11], v[10:11], v[122:123]
    v_pk_add_f32 v[8:9], v[8:9], v[124:125]
    v_pk_add_f32 v[10:11], v[10:11], v[126:127]
    v_pk_add_f32 v[8:9], v[8:9], v[128:129]
    v_pk_add_f32 v[10:11], v[10:11], v[130:131]
    v_pk_add_f32 v[8:9], v[8:9], v[10:11]
    v_add_f32 v8, v8, v9
    s_nop 1
    v_add_f32_dpp v8, v8, v8 row_ror:8 row_mask:0xf bank_mask:0xf
    v_mov_b32 v9, v8
    s_nop 1
    v_permlane16_swap_b32 v8, v9
    v_add_f32 v8, v8, v9
    v_mov_b32 v9, v8
    s_nop 1
    v_permlane32_swap_b32 v8, v9
    v_add_f32 v8, v8, v9
    ds_write_b32 v20, v8 offset:0
    s_waitcnt lgkmcnt(0)
    s_barrier
    ds_read_b32 v22, v14 offset:0
    ds_read_b32 v23, v14 offset:32
    ds_read_b32 v24, v14 offset:64
    ds_read_b32 v25, v14 offset:96
    s_waitcnt lgkmcnt(0)
    v_add_f32 v22, v22, v23
    v_add_f32 v24, v24, v25
    v_add_f32 v8, v22, v24
    v_mul_f32 v8, 0xba800000, v8
    v_mov_b32 v9, v8
    v_pk_add_f32 v[100:101], v[100:101], v[8:9]
    v_pk_add_f32 v[102:103], v[102:103], v[8:9]
    v_pk_add_f32 v[104:105], v[104:105], v[8:9]
    v_pk_add_f32 v[106:107], v[106:107], v[8:9]
    v_pk_add_f32 v[108:109], v[108:109], v[8:9]
    v_pk_add_f32 v[110:111], v[110:111], v[8:9]
    v_pk_add_f32 v[112:113], v[112:113], v[8:9]
    v_pk_add_f32 v[114:115], v[114:115], v[8:9]
    v_pk_add_f32 v[116:117], v[116:117], v[8:9]
    v_pk_add_f32 v[118:119], v[118:119], v[8:9]
    v_pk_add_f32 v[120:121], v[120:121], v[8:9]
    v_pk_add_f32 v[122:123], v[122:123], v[8:9]
    v_pk_add_f32 v[124:125], v[124:125], v[8:9]
    v_pk_add_f32 v[126:127], v[126:127], v[8:9]
    v_pk_add_f32 v[128:129], v[128:129], v[8:9]
    v_pk_add_f32 v[130:131], v[130:131], v[8:9]
    v_pk_mul_f32 v[26:27], v[100:101], v[100:101]
    v_pk_mul_f32 v[28:29], v[102:103], v[102:103]
    v_pk_fma_f32 v[26:27], v[104:105], v[104:105], v[26:27]
    v_pk_fma_f32 v[28:29], v[106:107], v[106:107], v[28:29]
    v_pk_fma_f32 v[26:27], v[108:109], v[108:109], v[26:27]
    v_pk_fma_f32 v[28:29], v[110:111], v[110:111], v[28:29]
    v_pk_fma_f32 v[26:27], v[112:113], v[112:113], v[26:27]
    v_pk_fma_f32 v[28:29], v[114:115], v[114:115], v[28:29]
    v_pk_fma_f32 v[26:27], v[116:117], v[116:117], v[26:27]
    v_pk_fma_f32 v[28:29], v[118:119], v[118:119], v[28:29]
    v_pk_fma_f32 v[26:27], v[120:121], v[120:121], v[26:27]
    v_pk_fma_f32 v[28:29], v[122:123], v[122:123], v[28:29]
    v_pk_fma_f32 v[26:27], v[124:125], v[124:125], v[26:27]
    v_pk_fma_f32 v[28:29], v[126:127], v[126:127], v[28:29]
    v_pk_fma_f32 v[26:27], v[128:129], v[128:129], v[26:27]
    v_pk_fma_f32 v[28:29], v[130:131], v[130:131], v[28:29]
    v_pk_add_f32 v[26:27], v[26:27], v[28:29]
    v_add_f32 v10, v26, v27
    ds_read_b128 v[132:135], v13 offset:0
    ds_read_b128 v[136:139], v13 offset:16
    ds_read_b128 v[140:143], v13 offset:4096
    ds_read_b128 v[144:147], v13 offset:4112
    ds_read_b128 v[148:151], v13 offset:256
    ds_read_b128 v[152:155], v13 offset:272
    ds_read_b128 v[156:159], v13 offset:4352
    ds_read_b128 v[160:163], v13 offset:4368
    s_waitcnt lgkmcnt(0)
    ds_read_b128 v[164:167], v13 offset:512
    ds_read_b128 v[168:171], v13 offset:528
    ds_read_b128 v[172:175], v13 offset:4608
    ds_read_b128 v[176:179], v13 offset:4624
    ds_read_b128 v[180:183], v13 offset:768
    ds_read_b128 v[184:187], v13 offset:784
    ds_read_b128 v[188:191], v13 offset:4864
    ds_read_b128 v[192:195], v13 offset:4880
    s_waitcnt lgkmcnt(0)
    s_nop 1
    v_add_f32_dpp v10, v10, v10 row_ror:8 row_mask:0xf bank_mask:0xf
    v_mov_b32 v9, v10
    s_nop 1
    v_permlane16_swap_b32 v10, v9
    v_add_f32 v10, v10, v9
    v_mov_b32 v9, v10
    s_nop 1
    v_permlane32_swap_b32 v10, v9
    v_add_f32 v10, v10, v9
    ds_write_b32 v20, v10 offset:128
    s_waitcnt lgkmcnt(0)
    s_barrier
    ds_read_b32 v22, v14 offset:128
    ds_read_b32 v23, v14 offset:160
    ds_read_b32 v24, v14 offset:192
    ds_read_b32 v25, v14 offset:224
    s_waitcnt lgkmcnt(0)
    v_add_f32 v22, v22, v23
    v_add_f32 v24, v24, v25
    v_add_f32 v10, v22, v24
    v_mov_b32 v16, 0x3727c5ac
    v_fmac_f32 v16, 0x3a800000, v10
    v_rsq_f32 v16, v16
    s_nop 0
    v_mov_b32 v17, v16
    v_pk_mul_f32 v[100:101], v[100:101], v[16:17]
    v_pk_mul_f32 v[102:103], v[102:103], v[16:17]
    v_pk_mul_f32 v[104:105], v[104:105], v[16:17]
    v_pk_mul_f32 v[106:107], v[106:107], v[16:17]
    v_pk_fma_f32 v[100:101], v[100:101], v[140:141], v[132:133]
    v_pk_fma_f32 v[102:103], v[102:103], v[142:143], v[134:135]
    v_pk_fma_f32 v[104:105], v[104:105], v[144:145], v[136:137]
    v_pk_fma_f32 v[106:107], v[106:107], v[146:147], v[138:139]
    v_cvt_pk_bf16_f32 v80, v100, v101
    v_cvt_pk_bf16_f32 v81, v102, v103
    v_cvt_pk_bf16_f32 v82, v104, v105
    v_cvt_pk_bf16_f32 v83, v106, v107
    s_mov_b32 s26, 0
    buffer_store_dwordx4 v[80:83], v12, s[12:15], s26 offen sc1
    v_pk_mul_f32 v[108:109], v[108:109], v[16:17]
    v_pk_mul_f32 v[110:111], v[110:111], v[16:17]
    v_pk_mul_f32 v[112:113], v[112:113], v[16:17]
    v_pk_mul_f32 v[114:115], v[114:115], v[16:17]
    v_pk_fma_f32 v[108:109], v[108:109], v[156:157], v[148:149]
    v_pk_fma_f32 v[110:111], v[110:111], v[158:159], v[150:151]
    v_pk_fma_f32 v[112:113], v[112:113], v[160:161], v[152:153]
    v_pk_fma_f32 v[114:115], v[114:115], v[162:163], v[154:155]
    v_cvt_pk_bf16_f32 v84, v108, v109
    v_cvt_pk_bf16_f32 v85, v110, v111
    v_cvt_pk_bf16_f32 v86, v112, v113
    v_cvt_pk_bf16_f32 v87, v114, v115
    s_mov_b32 s26, 2048
    buffer_store_dwordx4 v[84:87], v12, s[12:15], s26 offen sc1
    v_pk_mul_f32 v[116:117], v[116:117], v[16:17]
    v_pk_mul_f32 v[118:119], v[118:119], v[16:17]
    v_pk_mul_f32 v[120:121], v[120:121], v[16:17]
    v_pk_mul_f32 v[122:123], v[122:123], v[16:17]
    v_pk_fma_f32 v[116:117], v[116:117], v[172:173], v[164:165]
    v_pk_fma_f32 v[118:119], v[118:119], v[174:175], v[166:167]
    v_pk_fma_f32 v[120:121], v[120:121], v[176:177], v[168:169]
    v_pk_fma_f32 v[122:123], v[122:123], v[178:179], v[170:171]
    v_cvt_pk_bf16_f32 v88, v116, v117
    v_cvt_pk_bf16_f32 v89, v118, v119
    v_cvt_pk_bf16_f32 v90, v120, v121
    v_cvt_pk_bf16_f32 v91, v122, v123
    s_mov_b32 s26, 4096
    buffer_store_dwordx4 v[88:91], v12, s[12:15], s26 offen sc1
    v_pk_mul_f32 v[124:125], v[124:125], v[16:17]
    v_pk_mul_f32 v[126:127], v[126:127], v[16:17]
    v_pk_mul_f32 v[128:129], v[128:129], v[16:17]
    v_pk_mul_f32 v[130:131], v[130:131], v[16:17]
    v_pk_fma_f32 v[124:125], v[124:125], v[188:189], v[180:181]
    v_pk_fma_f32 v[126:127], v[126:127], v[190:191], v[182:183]
    v_pk_fma_f32 v[128:129], v[128:129], v[192:193], v[184:185]
    v_pk_fma_f32 v[130:131], v[130:131], v[194:195], v[186:187]
    v_cvt_pk_bf16_f32 v92, v124, v125
    v_cvt_pk_bf16_f32 v93, v126, v127
    v_cvt_pk_bf16_f32 v94, v128, v129
    v_cvt_pk_bf16_f32 v95, v130, v131
    s_mov_b32 s26, 6144
    buffer_store_dwordx4 v[92:95], v12, s[12:15], s26 offen sc1
    s_add_u32 s43, s42, 312
    s_lshl_b32 s91, s43, 7
    s_lshr_b32 s41, s41, 1
    s_add_u32 s90, s91, s41
    s_waitcnt vmcnt(0)
    s_barrier
    s_cmp_lg_u32 s100, 0
    s_cbranch_scc1 L_fz_s1
    s_mov_b64 s[88:89], exec
    s_mov_b64 exec, 1
    v_mov_b32 v250, 1
    v_mov_b32 v251, s90
    buffer_store_dword v250, v251, s[92:95], 0 offen sc1
    s_mov_b64 exec, s[88:89]
L_fz_s1:
    s_sub_u32 s50, s100, 1
    s_cmp_ge_u32 s50, 2
    s_cbranch_scc1 L_kvf2
    s_add_u32 s44, s4, 0x500000
    s_addc_u32 s45, s5, 0
    s_mov_b32 s46, 0x400000
    s_mov_b32 s47, 0x20000
    s_lshl_b32 s48, s2, 13
    s_lshl_b32 s49, s50, 21
    s_add_u32 s48, s48, s49
    s_lshl_b32 s49, s100, 13
    v_lshlrev_b32 v248, 4, v0
    s_cmp_eq_u32 s100, 2
    s_cbranch_scc1 L_kvv2
    v_and_b32 v4, 15, v0
    v_lshlrev_b32 v4, 8, v4
    v_lshrrev_b32 v5, 4, v0
    v_lshl_add_u32 v4, v5, 3, v4
    v_add_u32 v4, s49, v4
    ds_read_b64 v[196:197], v4 offset:0
    ds_read_b64 v[198:199], v4 offset:32
    ds_read_b64 v[200:201], v4 offset:64
    ds_read_b64 v[202:203], v4 offset:96
    ds_read_b64 v[204:205], v4 offset:128
    ds_read_b64 v[206:207], v4 offset:160
    ds_read_b64 v[208:209], v4 offset:192
    ds_read_b64 v[210:211], v4 offset:224
    s_waitcnt lgkmcnt(0)
    ds_read_b64 v[212:213], v4 offset:4096
    ds_read_b64 v[214:215], v4 offset:4128
    ds_read_b64 v[216:217], v4 offset:4160
    ds_read_b64 v[218:219], v4 offset:4192
    ds_read_b64 v[220:221], v4 offset:4224
    ds_read_b64 v[222:223], v4 offset:4256
    ds_read_b64 v[224:225], v4 offset:4288
    ds_read_b64 v[226:227], v4 offset:4320
    s_waitcnt lgkmcnt(0)
    s_branch L_kvs2
L_kvv2:
    v_lshrrev_b32 v4, 4, v0
    v_bfe_u32 v5, v0, 2, 2
    v_lshl_add_u32 v4, v4, 2, v5
    v_lshlrev_b32 v4, 8, v4
    v_and_b32 v5, 3, v0
    v_lshl_add_u32 v4, v5, 3, v4
    v_add_u32 v4, s49, v4
    ds_read_b64_tr_b16 v[196:197], v4 offset:0
    ds_read_b64_tr_b16 v[198:199], v4 offset:4096
    ds_read_b64_tr_b16 v[200:201], v4 offset:32
    ds_read_b64_tr_b16 v[202:203], v4 offset:4128
    ds_read_b64_tr_b16 v[204:205], v4 offset:64
    ds_read_b64_tr_b16 v[206:207], v4 offset:4160
    ds_read_b64_tr_b16 v[208:209], v4 offset:96
    ds_read_b64_tr_b16 v[210:211], v4 offset:4192
    s_waitcnt lgkmcnt(0)
    ds_read_b64_tr_b16 v[212:213], v4 offset:128
    ds_read_b64_tr_b16 v[214:215], v4 offset:4224
    ds_read_b64_tr_b16 v[216:217], v4 offset:160
    ds_read_b64_tr_b16 v[218:219], v4 offset:4256
    ds_read_b64_tr_b16 v[220:221], v4 offset:192
    ds_read_b64_tr_b16 v[222:223], v4 offset:4288
    ds_read_b64_tr_b16 v[224:225], v4 offset:224
    ds_read_b64_tr_b16 v[226:227], v4 offset:4320
    s_waitcnt lgkmcnt(0)
L_kvs2:
    buffer_store_dwordx4 v[196:199], v248, s[44:47], s48 offen offset:0 sc1
    buffer_store_dwordx4 v[200:203], v248, s[44:47], s48 offen offset:1024 sc1
    buffer_store_dwordx4 v[204:207], v248, s[44:47], s48 offen offset:2048 sc1
    buffer_store_dwordx4 v[208:211], v248, s[44:47], s48 offen offset:3072 sc1
    s_add_u32 s48, s48, 4096
    buffer_store_dwordx4 v[212:215], v248, s[44:47], s48 offen offset:0 sc1
    buffer_store_dwordx4 v[216:219], v248, s[44:47], s48 offen offset:1024 sc1
    buffer_store_dwordx4 v[220:223], v248, s[44:47], s48 offen offset:2048 sc1
    buffer_store_dwordx4 v[224:227], v248, s[44:47], s48 offen offset:3072 sc1
L_kvf2:
    s_lshr_b32 s38, s2, 6
    s_lshl_b32 s38, s38, 8
    s_and_b32 s39, s2, 63
    s_lshl_b32 s39, s39, 2
    s_add_u32 s38, s38, s39
    s_add_u32 s61, s38, 40960
    s_mov_b32 s101, s61
    s_mov_b32 s24, s100
    s_load_dwordx2 s[6:7], s[0:1], 24
    s_and_b32 s38, s2, 7
    s_lshr_b32 s39, s2, 3
    s_lshr_b32 s27, s38, 1
    s_and_b32 s38, s38, 1
    s_lshl_b32 s38, s38, 2
    s_lshr_b32 s26, s39, 3
    s_add_u32 s26, s26, s38
    s_and_b32 s39, s39, 7
    s_lshl_b32 s25, s27, 3
    s_add_u32 s25, s25, s39
    s_waitcnt lgkmcnt(0)
    s_mov_b32 s8, s6
    s_mov_b32 s9, s7
    s_mov_b32 s10, 0x800000
    s_mov_b32 s11, 0x20000
    s_add_u32 s12, s4, 0x100000
    s_addc_u32 s13, s5, 0
    s_mov_b32 s14, 0x400000
    s_mov_b32 s15, 0x20000
    s_add_u32 s16, s4, 0x500000
    s_addc_u32 s17, s5, 0
    s_mov_b32 s18, 0x400000
    s_mov_b32 s19, 0x20000
    s_add_u32 s20, s4, 0x1000000
    s_addc_u32 s21, s5, 0
    s_mov_b32 s22, 0x1000000
    s_mov_b32 s23, 0x20000
    v_lshlrev_b32 v1, 4, v0
    v_mov_b32 v2, v1
    v_add_u32 v3, 0x10000, v1
    v_lshrrev_b32 v9, 4, v0
    s_and_b32 s38, s24, 1
    s_lshl_b32 s38, s38, 2
    v_or_b32 v10, s38, v9
    v_bfe_u32 v11, v0, 1, 3
    v_xor_b32 v10, v10, v11
    v_lshlrev_b32 v10, 5, v10
    v_and_b32 v11, 1, v0
    v_lshlrev_b32 v11, 4, v11
    v_lshl_add_u32 v10, v9, 13, v10
    v_add_u32 v10, v10, v11
    s_lshl_b32 s38, s25, 8
    v_add_u32 v4, s38, v10
    s_lshl_b32 s38, s26, 4
    s_lshl_b32 s39, s24, 2
    s_add_u32 s38, s38, s39
    s_lshl_b32 s38, s38, 15
    v_add_u32 v5, s38, v1
    v_add_u32 v6, 0x8000, v5
    v_add_u32 v7, 0x8000, v6
    v_add_u32 v8, 0x8000, v7
    v_lshrrev_b32 v17, 4, v0
    v_bfe_u32 v18, v0, 2, 2
    v_lshl_add_u32 v19, v17, 3, v18
    v_lshlrev_b32 v19, 8, v19
    v_and_b32 v20, 3, v0
    v_lshl_add_u32 v19, v20, 3, v19
    v_add_u32 v19, 0x10000, v19
    v_and_b32 v17, 1, v17
    v_lshl_or_b32 v18, v17, 2, v18
    v_xor_b32 v20, 0, v18
    v_lshl_add_u32 v9, v20, 5, v19
    v_xor_b32 v20, 1, v18
    v_lshl_add_u32 v10, v20, 5, v19
    v_xor_b32 v20, 2, v18
    v_lshl_add_u32 v11, v20, 5, v19
    v_xor_b32 v20, 3, v18
    v_lshl_add_u32 v12, v20, 5, v19
    v_xor_b32 v20, 4, v18
    v_lshl_add_u32 v13, v20, 5, v19
    v_xor_b32 v20, 5, v18
    v_lshl_add_u32 v14, v20, 5, v19
    v_xor_b32 v20, 6, v18
    v_lshl_add_u32 v15, v20, 5, v19
    v_xor_b32 v20, 7, v18
    v_lshl_add_u32 v16, v20, 5, v19
    s_lshl_b32 s28, s24, 16
    s_lshl_b32 s30, s24, 11
    s_add_u32 s30, s30, 0x10000
    s_mov_b32 s31, 0
    s_lshl_b32 s38, s27, 19
    s_lshl_b32 s39, s24, 13
    s_add_u32 s33, s38, s39
    s_add_u32 s34, s33, 0x1fe000
    s_mov_b32 s36, s39
    s_add_u32 s35, s39, 0x10000
    s_mov_b32 s37, 0x5d800000
    s_lshl_b32 s38, s2, 2
    s_add_u32 s38, s38, s24
    s_lshl_b32 s42, s38, 9
    s_mul_i32 s43, s38, 448
    s_mov_b64 s[44:45], s[74:75]
    s_mov_b64 s[48:49], s[76:77]
    s_mov_b64 s[52:53], s[78:79]
    s_mov_b64 s[56:57], s[80:81]
    s_mov_b32 s46, 8388608
    s_mov_b32 s47, 0x20000
    s_mov_b32 s50, 7340032
    s_mov_b32 s51, 0x20000
    s_mov_b32 s54, 7340032
    s_mov_b32 s55, 0x20000
    s_mov_b32 s58, 7340032
    s_mov_b32 s59, 0x20000
    s_add_u32 s28, s28, 1572864
    s_lshl_b32 s38, s27, 8
    s_add_u32 s61, s38, 40960
    s_cmp_lg_u32 s100, 0
    s_cbranch_scc1 L_fz_w3
    s_mov_b64 s[88:89], exec
    s_mov_b64 exec, 0xffffffff
    v_lshlrev_b32 v252, 2, v0
    v_add_u32 v252, s91, v252
    s_mov_b32 s87, 262144
L_fz_p3:
    buffer_load_dword v253, v252, s[92:95], 0 offen sc1
    s_waitcnt vmcnt(0)
    v_cmp_ne_u32 vcc, 1, v253
    s_cbranch_vccz L_fz_g3
    s_sub_u32 s87, s87, 1
    s_cmp_lg_u32 s87, 0
    s_cbranch_scc1 L_fz_p3
L_fz_g3:
    s_mov_b64 exec, s[88:89]
L_fz_w3:
    s_barrier
    buffer_load_dwordx4 a[128:131], v5, s[12:15], s31 offen sc1
    buffer_load_dwordx4 a[132:135], v6, s[12:15], s31 offen sc1
    buffer_load_dwordx4 a[136:139], v7, s[12:15], s31 offen sc1
    buffer_load_dwordx4 a[140:143], v8, s[12:15], s31 offen sc1
    s_add_u32 s31, s31, 1024
    buffer_load_dwordx4 a[144:147], v5, s[12:15], s31 offen sc1
    buffer_load_dwordx4 a[148:151], v6, s[12:15], s31 offen sc1
    buffer_load_dwordx4 a[152:155], v7, s[12:15], s31 offen sc1
    buffer_load_dwordx4 a[156:159], v8, s[12:15], s31 offen sc1
    s_add_u32 s31, s31, 1024
    buffer_load_dwordx4 a[160:163], v5, s[12:15], s31 offen sc1
    buffer_load_dwordx4 a[164:167], v6, s[12:15], s31 offen sc1
    buffer_load_dwordx4 a[168:171], v7, s[12:15], s31 offen sc1
    buffer_load_dwordx4 a[172:175], v8, s[12:15], s31 offen sc1
    s_add_u32 s31, s31, 1024
    s_and_b32 s38, s26, 3
    s_lshl_b32 s38, s38, 2
    s_add_u32 s38, s38, s24
    s_lshl_b32 s38, s38, 19
    s_lshl_b32 s39, s25, 8
    s_add_u32 s38, s38, s39
    v_lshrrev_b32 v18, 1, v0
    v_lshlrev_b32 v18, 13, v18
    v_and_b32 v19, 1, v0
    v_lshl_add_u32 v18, v19, 7, v18
    buffer_load_dword v212, v18, s[8:11], s38 offen
    s_add_u32 s38, s38, 262144
    buffer_load_dword v213, v18, s[8:11], s38 offen
    v_accvgpr_write_b32 a0, 0
    v_accvgpr_write_b32 a1, 0
    v_accvgpr_write_b32 a2, 0
    v_accvgpr_write_b32 a3, 0
    v_accvgpr_write_b32 a4, 0
    v_accvgpr_write_b32 a5, 0
    v_accvgpr_write_b32 a6, 0
    v_accvgpr_write_b32 a7, 0
    v_accvgpr_write_b32 a8, 0
    v_accvgpr_write_b32 a9, 0
    v_accvgpr_write_b32 a10, 0
    v_accvgpr_write_b32 a11, 0
    v_accvgpr_write_b32 a12, 0
    v_accvgpr_write_b32 a13, 0
    v_accvgpr_write_b32 a14, 0
    v_accvgpr_write_b32 a15, 0
    v_accvgpr_write_b32 a16, 0
    v_accvgpr_write_b32 a17, 0
    v_accvgpr_write_b32 a18, 0
    v_accvgpr_write_b32 a19, 0
    v_accvgpr_write_b32 a20, 0
    v_accvgpr_write_b32 a21, 0
    v_accvgpr_write_b32 a22, 0
    v_accvgpr_write_b32 a23, 0
    v_accvgpr_write_b32 a24, 0
    v_accvgpr_write_b32 a25, 0
    v_accvgpr_write_b32 a26, 0
    v_accvgpr_write_b32 a27, 0
    v_accvgpr_write_b32 a28, 0
    v_accvgpr_write_b32 a29, 0
    v_accvgpr_write_b32 a30, 0
    v_accvgpr_write_b32 a31, 0
    v_accvgpr_write_b32 a32, 0
    v_accvgpr_write_b32 a33, 0
    v_accvgpr_write_b32 a34, 0
    v_accvgpr_write_b32 a35, 0
    v_accvgpr_write_b32 a36, 0
    v_accvgpr_write_b32 a37, 0
    v_accvgpr_write_b32 a38, 0
    v_accvgpr_write_b32 a39, 0
    v_accvgpr_write_b32 a40, 0
    v_accvgpr_write_b32 a41, 0
    v_accvgpr_write_b32 a42, 0
    v_accvgpr_write_b32 a43, 0
    v_accvgpr_write_b32 a44, 0
    v_accvgpr_write_b32 a45, 0
    v_accvgpr_write_b32 a46, 0
    v_accvgpr_write_b32 a47, 0
    v_accvgpr_write_b32 a48, 0
    v_accvgpr_write_b32 a49, 0
    v_accvgpr_write_b32 a50, 0
    v_accvgpr_write_b32 a51, 0
    v_accvgpr_write_b32 a52, 0
    v_accvgpr_write_b32 a53, 0
    v_accvgpr_write_b32 a54, 0
    v_accvgpr_write_b32 a55, 0
    v_accvgpr_write_b32 a56, 0
    v_accvgpr_write_b32 a57, 0
    v_accvgpr_write_b32 a58, 0
    v_accvgpr_write_b32 a59, 0
    v_accvgpr_write_b32 a60, 0
    v_accvgpr_write_b32 a61, 0
    v_accvgpr_write_b32 a62, 0
    v_accvgpr_write_b32 a63, 0
    v_accvgpr_write_b32 a64, 0
    v_accvgpr_write_b32 a65, 0
    v_accvgpr_write_b32 a66, 0
    v_accvgpr_write_b32 a67, 0
    v_accvgpr_write_b32 a68, 0
    v_accvgpr_write_b32 a69, 0
    v_accvgpr_write_b32 a70, 0
    v_accvgpr_write_b32 a71, 0
    v_accvgpr_write_b32 a72, 0
    v_accvgpr_write_b32 a73, 0
    v_accvgpr_write_b32 a74, 0
    v_accvgpr_write_b32 a75, 0
    v_accvgpr_write_b32 a76, 0
    v_accvgpr_write_b32 a77, 0
    v_accvgpr_write_b32 a78, 0
    v_accvgpr_write_b32 a79, 0
    v_accvgpr_write_b32 a80, 0
    v_accvgpr_write_b32 a81, 0
    v_accvgpr_write_b32 a82, 0
    v_accvgpr_write_b32 a83, 0
    v_accvgpr_write_b32 a84, 0
    v_accvgpr_write_b32 a85, 0
    v_accvgpr_write_b32 a86, 0
    v_accvgpr_write_b32 a87, 0
    v_accvgpr_write_b32 a88, 0
    v_accvgpr_write_b32 a89, 0
    v_accvgpr_write_b32 a90, 0
    v_accvgpr_write_b32 a91, 0
    v_accvgpr_write_b32 a92, 0
    v_accvgpr_write_b32 a93, 0
    v_accvgpr_write_b32 a94, 0
    v_accvgpr_write_b32 a95, 0
    v_accvgpr_write_b32 a96, 0
    v_accvgpr_write_b32 a97, 0
    v_accvgpr_write_b32 a98, 0
    v_accvgpr_write_b32 a99, 0
    v_accvgpr_write_b32 a100, 0
    v_accvgpr_write_b32 a101, 0
    v_accvgpr_write_b32 a102, 0
    v_accvgpr_write_b32 a103, 0
    v_accvgpr_write_b32 a104, 0
    v_accvgpr_write_b32 a105, 0
    v_accvgpr_write_b32 a106, 0
    v_accvgpr_write_b32 a107, 0
    v_accvgpr_write_b32 a108, 0
    v_accvgpr_write_b32 a109, 0
    v_accvgpr_write_b32 a110, 0
    v_accvgpr_write_b32 a111, 0
    v_accvgpr_write_b32 a112, 0
    v_accvgpr_write_b32 a113, 0
    v_accvgpr_write_b32 a114, 0
    v_accvgpr_write_b32 a115, 0
    v_accvgpr_write_b32 a116, 0
    v_accvgpr_write_b32 a117, 0
    v_accvgpr_write_b32 a118, 0
    v_accvgpr_write_b32 a119, 0
    v_accvgpr_write_b32 a120, 0
    v_accvgpr_write_b32 a121, 0
    v_accvgpr_write_b32 a122, 0
    v_accvgpr_write_b32 a123, 0
    v_accvgpr_write_b32 a124, 0
    v_accvgpr_write_b32 a125, 0
    v_accvgpr_write_b32 a126, 0
    v_accvgpr_write_b32 a127, 0
    ds_read_b64_tr_b16 a[192:193], v9 offset:0
    ds_read_b64_tr_b16 a[194:195], v9 offset:1024
    ds_read_b64_tr_b16 a[196:197], v10 offset:0
    ds_read_b64_tr_b16 a[198:199], v10 offset:1024
    ds_read_b64_tr_b16 a[200:201], v11 offset:0
    ds_read_b64_tr_b16 a[202:203], v11 offset:1024
    ds_read_b64_tr_b16 a[204:205], v12 offset:0
    ds_read_b64_tr_b16 a[206:207], v12 offset:1024
    ds_read_b64_tr_b16 a[208:209], v13 offset:0
    ds_read_b64_tr_b16 a[210:211], v13 offset:1024
    ds_read_b64_tr_b16 a[212:213], v14 offset:0
    ds_read_b64_tr_b16 a[214:215], v14 offset:1024
    ds_read_b64_tr_b16 a[216:217], v15 offset:0
    ds_read_b64_tr_b16 a[218:219], v15 offset:1024
    s_waitcnt vmcnt(10)
    s_barrier
    s_cmp_lg_u32 s100, 0
    s_cbranch_scc1 L_fz_s4
    s_mov_b64 s[88:89], exec
    s_mov_b64 exec, 1
    v_mov_b32 v250, 1
    v_mov_b32 v251, s101
    buffer_store_dword v250, v251, s[92:95], 0 offen sc1
    s_mov_b64 exec, s[88:89]
L_fz_s4:
    s_waitcnt lgkmcnt(12)
    v_mfma_f32_16x16x32_bf16 v[84:87], a[192:195], a[128:131], 0
    ds_read_b64_tr_b16 a[220:221], v16 offset:0
    v_mfma_f32_16x16x32_bf16 v[88:91], a[192:195], a[132:135], 0
    ds_read_b64_tr_b16 a[222:223], v16 offset:1024
    s_add_u32 m0, s30, 49152
    v_mfma_f32_16x16x32_bf16 v[92:95], a[192:195], a[136:139], 0
    buffer_load_dwordx4 v4, s[8:11], s28 offen lds
    v_mfma_f32_16x16x32_bf16 v[96:99], a[192:195], a[140:143], 0
    s_add_u32 s29, s28, 32768
    s_waitcnt lgkmcnt(12)
    v_mfma_f32_16x16x32_bf16 v[100:103], a[196:199], a[128:131], 0
    ds_read_b64_tr_b16 a[192:193], v9 offset:8192
    v_mfma_f32_16x16x32_bf16 v[104:107], a[196:199], a[132:135], 0
    ds_read_b64_tr_b16 a[194:195], v9 offset:9216
    v_mfma_f32_16x16x32_bf16 v[108:111], a[196:199], a[136:139], 0
    s_add_u32 m0, s30, 50176
    v_mfma_f32_16x16x32_bf16 v[112:115], a[196:199], a[140:143], 0
    buffer_load_dwordx4 v4, s[8:11], s29 offen lds
    s_waitcnt lgkmcnt(12)
    v_mfma_f32_16x16x32_bf16 v[116:119], a[200:203], a[128:131], 0
    ds_read_b64_tr_b16 a[196:197], v10 offset:8192
    s_add_u32 s28, s28, 262144
    v_mfma_f32_16x16x32_bf16 v[120:123], a[200:203], a[132:135], 0
    ds_read_b64_tr_b16 a[198:199], v10 offset:9216
    v_mfma_f32_16x16x32_bf16 v[124:127], a[200:203], a[136:139], 0
    v_mfma_f32_16x16x32_bf16 v[128:131], a[200:203], a[140:143], 0
    s_waitcnt lgkmcnt(12)
    v_mfma_f32_16x16x32_bf16 v[132:135], a[204:207], a[128:131], 0
    ds_read_b64_tr_b16 a[200:201], v11 offset:8192
    v_mfma_f32_16x16x32_bf16 v[136:139], a[204:207], a[132:135], 0
    ds_read_b64_tr_b16 a[202:203], v11 offset:9216
    v_mfma_f32_16x16x32_bf16 v[140:143], a[204:207], a[136:139], 0
    buffer_load_dwordx4 a[176:179], v5, s[12:15], s31 offen sc1
    v_mfma_f32_16x16x32_bf16 v[144:147], a[204:207], a[140:143], 0
    s_waitcnt lgkmcnt(12)
    v_mfma_f32_16x16x32_bf16 v[148:151], a[208:211], a[128:131], 0
    ds_read_b64_tr_b16 a[204:205], v12 offset:8192
    v_mfma_f32_16x16x32_bf16 v[152:155], a[208:211], a[132:135], 0
    ds_read_b64_tr_b16 a[206:207], v12 offset:9216
    v_mfma_f32_16x16x32_bf16 v[156:159], a[208:211], a[136:139], 0
    v_mfma_f32_16x16x32_bf16 v[160:163], a[208:211], a[140:143], 0
    buffer_load_dwordx4 a[180:183], v6, s[12:15], s31 offen sc1
    s_waitcnt lgkmcnt(12)
    v_mfma_f32_16x16x32_bf16 v[164:167], a[212:215], a[128:131], 0
    ds_read_b64_tr_b16 a[208:209], v13 offset:8192
    v_mfma_f32_16x16x32_bf16 v[168:171], a[212:215], a[132:135], 0
    ds_read_b64_tr_b16 a[210:211], v13 offset:9216
    v_mfma_f32_16x16x32_bf16 v[172:175], a[212:215], a[136:139], 0
    v_mfma_f32_16x16x32_bf16 v[176:179], a[212:215], a[140:143], 0
    buffer_load_dwordx4 a[184:187], v7, s[12:15], s31 offen sc1
    s_waitcnt lgkmcnt(12)
    v_mfma_f32_16x16x32_bf16 v[180:183], a[216:219], a[128:131], 0
    ds_read_b64_tr_b16 a[212:213], v14 offset:8192
    v_mfma_f32_16x16x32_bf16 v[184:187], a[216:219], a[132:135], 0
    ds_read_b64_tr_b16 a[214:215], v14 offset:9216
    v_mfma_f32_16x16x32_bf16 v[188:191], a[216:219], a[136:139], 0
    v_mfma_f32_16x16x32_bf16 v[192:195], a[216:219], a[140:143], 0
    s_waitcnt lgkmcnt(12)
    v_mfma_f32_16x16x32_bf16 v[196:199], a[220:223], a[128:131], 0
    ds_read_b64_tr_b16 a[216:217], v15 offset:8192
    v_mfma_f32_16x16x32_bf16 v[200:203], a[220:223], a[132:135], 0
    ds_read_b64_tr_b16 a[218:219], v15 offset:9216
    v_mfma_f32_16x16x32_bf16 v[204:207], a[220:223], a[136:139], 0
    buffer_load_dwordx4 a[188:191], v8, s[12:15], s31 offen sc1
    v_mfma_f32_16x16x32_bf16 v[208:211], a[220:223], a[140:143], 0
    s_add_u32 s31, s31, 1024
    s_waitcnt vmcnt(12)
    s_barrier
    s_waitcnt lgkmcnt(12)
    v_mfma_f32_16x16x32_bf16 v[84:87], a[192:195], a[144:147], v[84:87]
    ds_read_b64_tr_b16 a[220:221], v16 offset:8192
    v_mfma_f32_16x16x32_bf16 v[88:91], a[192:195], a[148:151], v[88:91]
    ds_read_b64_tr_b16 a[222:223], v16 offset:9216
    s_add_u32 m0, s30, 57344
    v_mfma_f32_16x16x32_bf16 v[92:95], a[192:195], a[152:155], v[92:95]
    buffer_load_dwordx4 v4, s[8:11], s28 offen lds
    v_mfma_f32_16x16x32_bf16 v[96:99], a[192:195], a[156:159], v[96:99]
    s_add_u32 s29, s28, 32768
    s_waitcnt lgkmcnt(12)
    v_mfma_f32_16x16x32_bf16 v[100:103], a[196:199], a[144:147], v[100:103]
    ds_read_b64_tr_b16 a[192:193], v9 offset:16384
    v_mfma_f32_16x16x32_bf16 v[104:107], a[196:199], a[148:151], v[104:107]
    ds_read_b64_tr_b16 a[194:195], v9 offset:17408
    v_mfma_f32_16x16x32_bf16 v[108:111], a[196:199], a[152:155], v[108:111]
    s_add_u32 m0, s30, 58368
    v_mfma_f32_16x16x32_bf16 v[112:115], a[196:199], a[156:159], v[112:115]
    buffer_load_dwordx4 v4, s[8:11], s29 offen lds
    s_waitcnt lgkmcnt(12)
    v_mfma_f32_16x16x32_bf16 v[116:119], a[200:203], a[144:147], v[116:119]
    ds_read_b64_tr_b16 a[196:197], v10 offset:16384
    s_add_u32 s28, s28, 262144
    v_mfma_f32_16x16x32_bf16 v[120:123], a[200:203], a[148:151], v[120:123]
    ds_read_b64_tr_b16 a[198:199], v10 offset:17408
    v_mfma_f32_16x16x32_bf16 v[124:127], a[200:203], a[152:155], v[124:127]
    v_mfma_f32_16x16x32_bf16 v[128:131], a[200:203], a[156:159], v[128:131]
    s_waitcnt lgkmcnt(12)
    v_mfma_f32_16x16x32_bf16 v[132:135], a[204:207], a[144:147], v[132:135]
    ds_read_b64_tr_b16 a[200:201], v11 offset:16384
    v_mfma_f32_16x16x32_bf16 v[136:139], a[204:207], a[148:151], v[136:139]
    ds_read_b64_tr_b16 a[202:203], v11 offset:17408
    v_mfma_f32_16x16x32_bf16 v[140:143], a[204:207], a[152:155], v[140:143]
    buffer_load_dwordx4 a[128:131], v5, s[12:15], s31 offen sc1
    v_mfma_f32_16x16x32_bf16 v[144:147], a[204:207], a[156:159], v[144:147]
    s_waitcnt lgkmcnt(12)
    v_mfma_f32_16x16x32_bf16 v[148:151], a[208:211], a[144:147], v[148:151]
    ds_read_b64_tr_b16 a[204:205], v12 offset:16384
    v_mfma_f32_16x16x32_bf16 v[152:155], a[208:211], a[148:151], v[152:155]
    ds_read_b64_tr_b16 a[206:207], v12 offset:17408
    v_mfma_f32_16x16x32_bf16 v[156:159], a[208:211], a[152:155], v[156:159]
    v_mfma_f32_16x16x32_bf16 v[160:163], a[208:211], a[156:159], v[160:163]
    buffer_load_dwordx4 a[132:135], v6, s[12:15], s31 offen sc1
    s_waitcnt lgkmcnt(12)
    v_mfma_f32_16x16x32_bf16 v[164:167], a[212:215], a[144:147], v[164:167]
    ds_read_b64_tr_b16 a[208:209], v13 offset:16384
    v_mfma_f32_16x16x32_bf16 v[168:171], a[212:215], a[148:151], v[168:171]
    ds_read_b64_tr_b16 a[210:211], v13 offset:17408
    v_mfma_f32_16x16x32_bf16 v[172:175], a[212:215], a[152:155], v[172:175]
    v_mfma_f32_16x16x32_bf16 v[176:179], a[212:215], a[156:159], v[176:179]
    buffer_load_dwordx4 a[136:139], v7, s[12:15], s31 offen sc1
    s_waitcnt lgkmcnt(12)
    v_mfma_f32_16x16x32_bf16 v[180:183], a[216:219], a[144:147], v[180:183]
    ds_read_b64_tr_b16 a[212:213], v14 offset:16384
    v_mfma_f32_16x16x32_bf16 v[184:187], a[216:219], a[148:151], v[184:187]
    ds_read_b64_tr_b16 a[214:215], v14 offset:17408
    v_mfma_f32_16x16x32_bf16 v[188:191], a[216:219], a[152:155], v[188:191]
    v_mfma_f32_16x16x32_bf16 v[192:195], a[216:219], a[156:159], v[192:195]
    s_waitcnt lgkmcnt(12)
    v_mfma_f32_16x16x32_bf16 v[196:199], a[220:223], a[144:147], v[196:199]
    ds_read_b64_tr_b16 a[216:217], v15 offset:16384
    v_mfma_f32_16x16x32_bf16 v[200:203], a[220:223], a[148:151], v[200:203]
    ds_read_b64_tr_b16 a[218:219], v15 offset:17408
    v_mfma_f32_16x16x32_bf16 v[204:207], a[220:223], a[152:155], v[204:207]
    buffer_load_dwordx4 a[140:143], v8, s[12:15], s31 offen sc1
    v_mfma_f32_16x16x32_bf16 v[208:211], a[220:223], a[156:159], v[208:211]
    s_add_u32 s31, s31, 1024
    s_waitcnt vmcnt(14)
    s_waitcnt lgkmcnt(12)
    v_mfma_f32_16x16x32_bf16 v[84:87], a[192:195], a[160:163], v[84:87]
    ds_read_b64_tr_b16 a[220:221], v16 offset:16384
    v_mfma_f32_16x16x32_bf16 v[88:91], a[192:195], a[164:167], v[88:91]
    ds_read_b64_tr_b16 a[222:223], v16 offset:17408
    s_add_u32 m0, s30, 0
    v_mfma_f32_16x16x32_bf16 v[92:95], a[192:195], a[168:171], v[92:95]
    buffer_load_dwordx4 v4, s[8:11], s28 offen lds
    v_mfma_f32_16x16x32_bf16 v[96:99], a[192:195], a[172:175], v[96:99]
    s_add_u32 s29, s28, 32768
    s_waitcnt lgkmcnt(12)
    v_mfma_f32_16x16x32_bf16 v[100:103], a[196:199], a[160:163], v[100:103]
    ds_read_b64_tr_b16 a[192:193], v9 offset:24576
    v_mfma_f32_16x16x32_bf16 v[104:107], a[196:199], a[164:167], v[104:107]
    ds_read_b64_tr_b16 a[194:195], v9 offset:25600
    v_mfma_f32_16x16x32_bf16 v[108:111], a[196:199], a[168:171], v[108:111]
    s_add_u32 m0, s30, 1024
    v_mfma_f32_16x16x32_bf16 v[112:115], a[196:199], a[172:175], v[112:115]
    buffer_load_dwordx4 v4, s[8:11], s29 offen lds
    s_waitcnt lgkmcnt(12)
    v_mfma_f32_16x16x32_bf16 v[116:119], a[200:203], a[160:163], v[116:119]
    ds_read_b64_tr_b16 a[196:197], v10 offset:24576
    s_add_u32 s28, s28, 262144
    v_mfma_f32_16x16x32_bf16 v[120:123], a[200:203], a[164:167], v[120:123]
    ds_read_b64_tr_b16 a[198:199], v10 offset:25600
    v_mfma_f32_16x16x32_bf16 v[124:127], a[200:203], a[168:171], v[124:127]
    v_mfma_f32_16x16x32_bf16 v[128:131], a[200:203], a[172:175], v[128:131]
    s_waitcnt lgkmcnt(12)
    v_mfma_f32_16x16x32_bf16 v[132:135], a[204:207], a[160:163], v[132:135]
    ds_read_b64_tr_b16 a[200:201], v11 offset:24576
    v_mfma_f32_16x16x32_bf16 v[136:139], a[204:207], a[164:167], v[136:139]
    ds_read_b64_tr_b16 a[202:203], v11 offset:25600
    v_mfma_f32_16x16x32_bf16 v[140:143], a[204:207], a[168:171], v[140:143]
    buffer_load_dwordx4 a[144:147], v5, s[12:15], s31 offen sc1
    v_mfma_f32_16x16x32_bf16 v[144:147], a[204:207], a[172:175], v[144:147]
    s_waitcnt lgkmcnt(12)
    v_mfma_f32_16x16x32_bf16 v[148:151], a[208:211], a[160:163], v[148:151]
    ds_read_b64_tr_b16 a[204:205], v12 offset:24576
    v_mfma_f32_16x16x32_bf16 v[152:155], a[208:211], a[164:167], v[152:155]
    ds_read_b64_tr_b16 a[206:207], v12 offset:25600
    v_mfma_f32_16x16x32_bf16 v[156:159], a[208:211], a[168:171], v[156:159]
    v_mfma_f32_16x16x32_bf16 v[160:163], a[208:211], a[172:175], v[160:163]
    buffer_load_dwordx4 a[148:151], v6, s[12:15], s31 offen sc1
    s_waitcnt lgkmcnt(12)
    v_mfma_f32_16x16x32_bf16 v[164:167], a[212:215], a[160:163], v[164:167]
    ds_read_b64_tr_b16 a[208:209], v13 offset:24576
    v_mfma_f32_16x16x32_bf16 v[168:171], a[212:215], a[164:167], v[168:171]
    ds_read_b64_tr_b16 a[210:211], v13 offset:25600
    v_mfma_f32_16x16x32_bf16 v[172:175], a[212:215], a[168:171], v[172:175]
    v_mfma_f32_16x16x32_bf16 v[176:179], a[212:215], a[172:175], v[176:179]
    buffer_load_dwordx4 a[152:155], v7, s[12:15], s31 offen sc1
    s_waitcnt lgkmcnt(12)
    v_mfma_f32_16x16x32_bf16 v[180:183], a[216:219], a[160:163], v[180:183]
    ds_read_b64_tr_b16 a[212:213], v14 offset:24576
    v_mfma_f32_16x16x32_bf16 v[184:187], a[216:219], a[164:167], v[184:187]
    ds_read_b64_tr_b16 a[214:215], v14 offset:25600
    v_mfma_f32_16x16x32_bf16 v[188:191], a[216:219], a[168:171], v[188:191]
    v_mfma_f32_16x16x32_bf16 v[192:195], a[216:219], a[172:175], v[192:195]
    s_waitcnt lgkmcnt(12)
    v_mfma_f32_16x16x32_bf16 v[196:199], a[220:223], a[160:163], v[196:199]
    ds_read_b64_tr_b16 a[216:217], v15 offset:24576
    v_mfma_f32_16x16x32_bf16 v[200:203], a[220:223], a[164:167], v[200:203]
    ds_read_b64_tr_b16 a[218:219], v15 offset:25600
    v_mfma_f32_16x16x32_bf16 v[204:207], a[220:223], a[168:171], v[204:207]
    buffer_load_dwordx4 a[156:159], v8, s[12:15], s31 offen sc1
    v_mfma_f32_16x16x32_bf16 v[208:211], a[220:223], a[172:175], v[208:211]
    s_add_u32 s31, s31, 1024
    s_waitcnt vmcnt(12)
    s_barrier
    s_waitcnt lgkmcnt(12)
    v_mfma_f32_16x16x32_bf16 v[84:87], a[192:195], a[176:179], v[84:87]
    ds_read_b64_tr_b16 a[220:221], v16 offset:24576
    v_mfma_f32_16x16x32_bf16 v[88:91], a[192:195], a[180:183], v[88:91]
    ds_read_b64_tr_b16 a[222:223], v16 offset:25600
    s_add_u32 m0, s30, 8192
    v_mfma_f32_16x16x32_bf16 v[92:95], a[192:195], a[184:187], v[92:95]
    buffer_load_dwordx4 v4, s[8:11], s28 offen lds
    v_mfma_f32_16x16x32_bf16 v[96:99], a[192:195], a[188:191], v[96:99]
    s_add_u32 s29, s28, 32768
    s_waitcnt lgkmcnt(12)
    v_mfma_f32_16x16x32_bf16 v[100:103], a[196:199], a[176:179], v[100:103]
    ds_read_b64_tr_b16 a[192:193], v9 offset:32768
    v_mfma_f32_16x16x32_bf16 v[104:107], a[196:199], a[180:183], v[104:107]
    ds_read_b64_tr_b16 a[194:195], v9 offset:33792
    v_mfma_f32_16x16x32_bf16 v[108:111], a[196:199], a[184:187], v[108:111]
    s_add_u32 m0, s30, 9216
    v_mfma_f32_16x16x32_bf16 v[112:115], a[196:199], a[188:191], v[112:115]
    buffer_load_dwordx4 v4, s[8:11], s29 offen lds
    s_waitcnt lgkmcnt(12)
    v_mfma_f32_16x16x32_bf16 v[116:119], a[200:203], a[176:179], v[116:119]
    ds_read_b64_tr_b16 a[196:197], v10 offset:32768
    s_add_u32 s28, s28, 262144
    v_mfma_f32_16x16x32_bf16 v[120:123], a[200:203], a[180:183], v[120:123]
    ds_read_b64_tr_b16 a[198:199], v10 offset:33792
    v_mfma_f32_16x16x32_bf16 v[124:127], a[200:203], a[184:187], v[124:127]
    v_mfma_f32_16x16x32_bf16 v[128:131], a[200:203], a[188:191], v[128:131]
    s_waitcnt lgkmcnt(12)
    v_mfma_f32_16x16x32_bf16 v[132:135], a[204:207], a[176:179], v[132:135]
    ds_read_b64_tr_b16 a[200:201], v11 offset:32768
    v_mfma_f32_16x16x32_bf16 v[136:139], a[204:207], a[180:183], v[136:139]
    ds_read_b64_tr_b16 a[202:203], v11 offset:33792
    v_mfma_f32_16x16x32_bf16 v[140:143], a[204:207], a[184:187], v[140:143]
    buffer_load_dwordx4 a[160:163], v5, s[12:15], s31 offen sc1
    v_mfma_f32_16x16x32_bf16 v[144:147], a[204:207], a[188:191], v[144:147]
    s_waitcnt lgkmcnt(12)
    v_mfma_f32_16x16x32_bf16 v[148:151], a[208:211], a[176:179], v[148:151]
    ds_read_b64_tr_b16 a[204:205], v12 offset:32768
    v_mfma_f32_16x16x32_bf16 v[152:155], a[208:211], a[180:183], v[152:155]
    ds_read_b64_tr_b16 a[206:207], v12 offset:33792
    v_mfma_f32_16x16x32_bf16 v[156:159], a[208:211], a[184:187], v[156:159]
    v_mfma_f32_16x16x32_bf16 v[160:163], a[208:211], a[188:191], v[160:163]
    buffer_load_dwordx4 a[164:167], v6, s[12:15], s31 offen sc1
    s_waitcnt lgkmcnt(12)
    v_mfma_f32_16x16x32_bf16 v[164:167], a[212:215], a[176:179], v[164:167]
    ds_read_b64_tr_b16 a[208:209], v13 offset:32768
    v_mfma_f32_16x16x32_bf16 v[168:171], a[212:215], a[180:183], v[168:171]
    ds_read_b64_tr_b16 a[210:211], v13 offset:33792
    v_mfma_f32_16x16x32_bf16 v[172:175], a[212:215], a[184:187], v[172:175]
    v_mfma_f32_16x16x32_bf16 v[176:179], a[212:215], a[188:191], v[176:179]
    buffer_load_dwordx4 a[168:171], v7, s[12:15], s31 offen sc1
    s_waitcnt lgkmcnt(12)
    v_mfma_f32_16x16x32_bf16 v[180:183], a[216:219], a[176:179], v[180:183]
    ds_read_b64_tr_b16 a[212:213], v14 offset:32768
    v_mfma_f32_16x16x32_bf16 v[184:187], a[216:219], a[180:183], v[184:187]
    ds_read_b64_tr_b16 a[214:215], v14 offset:33792
    v_mfma_f32_16x16x32_bf16 v[188:191], a[216:219], a[184:187], v[188:191]
    v_mfma_f32_16x16x32_bf16 v[192:195], a[216:219], a[188:191], v[192:195]
    s_waitcnt lgkmcnt(12)
    v_mfma_f32_16x16x32_bf16 v[196:199], a[220:223], a[176:179], v[196:199]
    ds_read_b64_tr_b16 a[216:217], v15 offset:32768
    v_mfma_f32_16x16x32_bf16 v[200:203], a[220:223], a[180:183], v[200:203]
    ds_read_b64_tr_b16 a[218:219], v15 offset:33792
    v_mfma_f32_16x16x32_bf16 v[204:207], a[220:223], a[184:187], v[204:207]
    buffer_load_dwordx4 a[172:175], v8, s[12:15], s31 offen sc1
    v_mfma_f32_16x16x32_bf16 v[208:211], a[220:223], a[188:191], v[208:211]
    s_add_u32 s31, s31, 1024
    s_waitcnt vmcnt(12)
    s_waitcnt lgkmcnt(12)
    v_mfma_f32_16x16x32_bf16 v[84:87], a[192:195], a[128:131], v[84:87]
    ds_read_b64_tr_b16 a[220:221], v16 offset:32768
    v_mfma_f32_16x16x32_bf16 v[88:91], a[192:195], a[132:135], v[88:91]
    ds_read_b64_tr_b16 a[222:223], v16 offset:33792
    s_add_u32 m0, s30, 16384
    v_mfma_f32_16x16x32_bf16 v[92:95], a[192:195], a[136:139], v[92:95]
    buffer_load_dwordx4 v4, s[8:11], s28 offen lds
    v_mfma_f32_16x16x32_bf16 v[96:99], a[192:195], a[140:143], v[96:99]
    s_add_u32 s29, s28, 32768
    s_waitcnt lgkmcnt(12)
    v_mfma_f32_16x16x32_bf16 v[100:103], a[196:199], a[128:131], v[100:103]
    ds_read_b64_tr_b16 a[192:193], v9 offset:40960
    v_mfma_f32_16x16x32_bf16 v[104:107], a[196:199], a[132:135], v[104:107]
    ds_read_b64_tr_b16 a[194:195], v9 offset:41984
    v_mfma_f32_16x16x32_bf16 v[108:111], a[196:199], a[136:139], v[108:111]
    s_add_u32 m0, s30, 17408
    v_mfma_f32_16x16x32_bf16 v[112:115], a[196:199], a[140:143], v[112:115]
    buffer_load_dwordx4 v4, s[8:11], s29 offen lds
    s_waitcnt lgkmcnt(12)
    v_mfma_f32_16x16x32_bf16 v[116:119], a[200:203], a[128:131], v[116:119]
    ds_read_b64_tr_b16 a[196:197], v10 offset:40960
    s_add_u32 s28, s28, 262144
    v_mfma_f32_16x16x32_bf16 v[120:123], a[200:203], a[132:135], v[120:123]
    ds_read_b64_tr_b16 a[198:199], v10 offset:41984
    v_mfma_f32_16x16x32_bf16 v[124:127], a[200:203], a[136:139], v[124:127]
    v_mfma_f32_16x16x32_bf16 v[128:131], a[200:203], a[140:143], v[128:131]
    s_waitcnt lgkmcnt(12)
    v_mfma_f32_16x16x32_bf16 v[132:135], a[204:207], a[128:131], v[132:135]
    ds_read_b64_tr_b16 a[200:201], v11 offset:40960
    v_mfma_f32_16x16x32_bf16 v[136:139], a[204:207], a[132:135], v[136:139]
    ds_read_b64_tr_b16 a[202:203], v11 offset:41984
    v_mfma_f32_16x16x32_bf16 v[140:143], a[204:207], a[136:139], v[140:143]
    buffer_load_dwordx4 a[176:179], v5, s[12:15], s31 offen sc1
    v_mfma_f32_16x16x32_bf16 v[144:147], a[204:207], a[140:143], v[144:147]
    s_waitcnt lgkmcnt(12)
    v_mfma_f32_16x16x32_bf16 v[148:151], a[208:211], a[128:131], v[148:151]
    ds_read_b64_tr_b16 a[204:205], v12 offset:40960
    v_mfma_f32_16x16x32_bf16 v[152:155], a[208:211], a[132:135], v[152:155]
    ds_read_b64_tr_b16 a[206:207], v12 offset:41984
    v_mfma_f32_16x16x32_bf16 v[156:159], a[208:211], a[136:139], v[156:159]
    v_mfma_f32_16x16x32_bf16 v[160:163], a[208:211], a[140:143], v[160:163]
    buffer_load_dwordx4 a[180:183], v6, s[12:15], s31 offen sc1
    s_waitcnt lgkmcnt(12)
    v_mfma_f32_16x16x32_bf16 v[164:167], a[212:215], a[128:131], v[164:167]
    ds_read_b64_tr_b16 a[208:209], v13 offset:40960
    v_mfma_f32_16x16x32_bf16 v[168:171], a[212:215], a[132:135], v[168:171]
    ds_read_b64_tr_b16 a[210:211], v13 offset:41984
    v_mfma_f32_16x16x32_bf16 v[172:175], a[212:215], a[136:139], v[172:175]
    v_mfma_f32_16x16x32_bf16 v[176:179], a[212:215], a[140:143], v[176:179]
    buffer_load_dwordx4 a[184:187], v7, s[12:15], s31 offen sc1
    s_waitcnt lgkmcnt(12)
    v_mfma_f32_16x16x32_bf16 v[180:183], a[216:219], a[128:131], v[180:183]
    ds_read_b64_tr_b16 a[212:213], v14 offset:40960
    v_mfma_f32_16x16x32_bf16 v[184:187], a[216:219], a[132:135], v[184:187]
    ds_read_b64_tr_b16 a[214:215], v14 offset:41984
    v_mfma_f32_16x16x32_bf16 v[188:191], a[216:219], a[136:139], v[188:191]
    v_mfma_f32_16x16x32_bf16 v[192:195], a[216:219], a[140:143], v[192:195]
    s_waitcnt lgkmcnt(12)
    v_mfma_f32_16x16x32_bf16 v[196:199], a[220:223], a[128:131], v[196:199]
    ds_read_b64_tr_b16 a[216:217], v15 offset:40960
    v_mfma_f32_16x16x32_bf16 v[200:203], a[220:223], a[132:135], v[200:203]
    ds_read_b64_tr_b16 a[218:219], v15 offset:41984
    v_mfma_f32_16x16x32_bf16 v[204:207], a[220:223], a[136:139], v[204:207]
    buffer_load_dwordx4 a[188:191], v8, s[12:15], s31 offen sc1
    v_mfma_f32_16x16x32_bf16 v[208:211], a[220:223], a[140:143], v[208:211]
    s_add_u32 s31, s31, 1024
    s_waitcnt vmcnt(12)
    s_barrier
    s_waitcnt lgkmcnt(12)
    v_mfma_f32_16x16x32_bf16 v[84:87], a[192:195], a[144:147], v[84:87]
    ds_read_b64_tr_b16 a[220:221], v16 offset:40960
    v_mfma_f32_16x16x32_bf16 v[88:91], a[192:195], a[148:151], v[88:91]
    ds_read_b64_tr_b16 a[222:223], v16 offset:41984
    s_add_u32 m0, s30, 24576
    v_mfma_f32_16x16x32_bf16 v[92:95], a[192:195], a[152:155], v[92:95]
    buffer_load_dwordx4 v4, s[8:11], s28 offen lds
    v_mfma_f32_16x16x32_bf16 v[96:99], a[192:195], a[156:159], v[96:99]
    s_add_u32 s29, s28, 32768
    s_waitcnt lgkmcnt(12)
    v_mfma_f32_16x16x32_bf16 v[100:103], a[196:199], a[144:147], v[100:103]
    ds_read_b64_tr_b16 a[192:193], v9 offset:49152
    v_mfma_f32_16x16x32_bf16 v[104:107], a[196:199], a[148:151], v[104:107]
    ds_read_b64_tr_b16 a[194:195], v9 offset:50176
    v_mfma_f32_16x16x32_bf16 v[108:111], a[196:199], a[152:155], v[108:111]
    s_add_u32 m0, s30, 25600
    v_mfma_f32_16x16x32_bf16 v[112:115], a[196:199], a[156:159], v[112:115]
    buffer_load_dwordx4 v4, s[8:11], s29 offen lds
    s_waitcnt lgkmcnt(12)
    v_mfma_f32_16x16x32_bf16 v[116:119], a[200:203], a[144:147], v[116:119]
    ds_read_b64_tr_b16 a[196:197], v10 offset:49152
    s_add_u32 s28, s28, 262144
    v_mfma_f32_16x16x32_bf16 v[120:123], a[200:203], a[148:151], v[120:123]
    ds_read_b64_tr_b16 a[198:199], v10 offset:50176
    v_mfma_f32_16x16x32_bf16 v[124:127], a[200:203], a[152:155], v[124:127]
    v_mfma_f32_16x16x32_bf16 v[128:131], a[200:203], a[156:159], v[128:131]
    s_waitcnt lgkmcnt(12)
    v_mfma_f32_16x16x32_bf16 v[132:135], a[204:207], a[144:147], v[132:135]
    ds_read_b64_tr_b16 a[200:201], v11 offset:49152
    v_mfma_f32_16x16x32_bf16 v[136:139], a[204:207], a[148:151], v[136:139]
    ds_read_b64_tr_b16 a[202:203], v11 offset:50176
    v_mfma_f32_16x16x32_bf16 v[140:143], a[204:207], a[152:155], v[140:143]
    buffer_load_dwordx4 a[128:131], v5, s[12:15], s31 offen sc1
    v_mfma_f32_16x16x32_bf16 v[144:147], a[204:207], a[156:159], v[144:147]
    s_waitcnt lgkmcnt(12)
    v_mfma_f32_16x16x32_bf16 v[148:151], a[208:211], a[144:147], v[148:151]
    ds_read_b64_tr_b16 a[204:205], v12 offset:49152
    v_mfma_f32_16x16x32_bf16 v[152:155], a[208:211], a[148:151], v[152:155]
    ds_read_b64_tr_b16 a[206:207], v12 offset:50176
    v_mfma_f32_16x16x32_bf16 v[156:159], a[208:211], a[152:155], v[156:159]
    v_mfma_f32_16x16x32_bf16 v[160:163], a[208:211], a[156:159], v[160:163]
    buffer_load_dwordx4 a[132:135], v6, s[12:15], s31 offen sc1
    s_waitcnt lgkmcnt(12)
    v_mfma_f32_16x16x32_bf16 v[164:167], a[212:215], a[144:147], v[164:167]
    ds_read_b64_tr_b16 a[208:209], v13 offset:49152
    v_mfma_f32_16x16x32_bf16 v[168:171], a[212:215], a[148:151], v[168:171]
    ds_read_b64_tr_b16 a[210:211], v13 offset:50176
    v_mfma_f32_16x16x32_bf16 v[172:175], a[212:215], a[152:155], v[172:175]
    v_mfma_f32_16x16x32_bf16 v[176:179], a[212:215], a[156:159], v[176:179]
    buffer_load_dwordx4 a[136:139], v7, s[12:15], s31 offen sc1
    s_waitcnt lgkmcnt(12)
    v_mfma_f32_16x16x32_bf16 v[180:183], a[216:219], a[144:147], v[180:183]
    ds_read_b64_tr_b16 a[212:213], v14 offset:49152
    v_mfma_f32_16x16x32_bf16 v[184:187], a[216:219], a[148:151], v[184:187]
    ds_read_b64_tr_b16 a[214:215], v14 offset:50176
    v_mfma_f32_16x16x32_bf16 v[188:191], a[216:219], a[152:155], v[188:191]
    v_mfma_f32_16x16x32_bf16 v[192:195], a[216:219], a[156:159], v[192:195]
    s_waitcnt lgkmcnt(12)
    v_mfma_f32_16x16x32_bf16 v[196:199], a[220:223], a[144:147], v[196:199]
    ds_read_b64_tr_b16 a[216:217], v15 offset:49152
    v_mfma_f32_16x16x32_bf16 v[200:203], a[220:223], a[148:151], v[200:203]
    ds_read_b64_tr_b16 a[218:219], v15 offset:50176
    v_mfma_f32_16x16x32_bf16 v[204:207], a[220:223], a[152:155], v[204:207]
    buffer_load_dwordx4 a[140:143], v8, s[12:15], s31 offen sc1
    v_mfma_f32_16x16x32_bf16 v[208:211], a[220:223], a[156:159], v[208:211]
    s_add_u32 s31, s31, 1024
    s_waitcnt vmcnt(12)
    s_waitcnt lgkmcnt(12)
    v_mfma_f32_16x16x32_bf16 v[84:87], a[192:195], a[160:163], v[84:87]
    ds_read_b64_tr_b16 a[220:221], v16 offset:49152
    v_mfma_f32_16x16x32_bf16 v[88:91], a[192:195], a[164:167], v[88:91]
    ds_read_b64_tr_b16 a[222:223], v16 offset:50176
    s_add_u32 m0, s30, 32768
    v_mfma_f32_16x16x32_bf16 v[92:95], a[192:195], a[168:171], v[92:95]
    buffer_load_dwordx4 v4, s[8:11], s28 offen lds
    v_mfma_f32_16x16x32_bf16 v[96:99], a[192:195], a[172:175], v[96:99]
    s_add_u32 s29, s28, 32768
    s_waitcnt lgkmcnt(12)
    v_mfma_f32_16x16x32_bf16 v[100:103], a[196:199], a[160:163], v[100:103]
    ds_read_b64_tr_b16 a[192:193], v9 offset:57344
    v_mfma_f32_16x16x32_bf16 v[104:107], a[196:199], a[164:167], v[104:107]
    ds_read_b64_tr_b16 a[194:195], v9 offset:58368
    v_mfma_f32_16x16x32_bf16 v[108:111], a[196:199], a[168:171], v[108:111]
    s_add_u32 m0, s30, 33792
    v_mfma_f32_16x16x32_bf16 v[112:115], a[196:199], a[172:175], v[112:115]
    buffer_load_dwordx4 v4, s[8:11], s29 offen lds
    s_waitcnt lgkmcnt(12)
    v_mfma_f32_16x16x32_bf16 v[116:119], a[200:203], a[160:163], v[116:119]
    ds_read_b64_tr_b16 a[196:197], v10 offset:57344
    s_add_u32 s28, s28, 262144
    v_mfma_f32_16x16x32_bf16 v[120:123], a[200:203], a[164:167], v[120:123]
    ds_read_b64_tr_b16 a[198:199], v10 offset:58368
    v_mfma_f32_16x16x32_bf16 v[124:127], a[200:203], a[168:171], v[124:127]
    v_mfma_f32_16x16x32_bf16 v[128:131], a[200:203], a[172:175], v[128:131]
    s_waitcnt lgkmcnt(12)
    v_mfma_f32_16x16x32_bf16 v[132:135], a[204:207], a[160:163], v[132:135]
    ds_read_b64_tr_b16 a[200:201], v11 offset:57344
    v_mfma_f32_16x16x32_bf16 v[136:139], a[204:207], a[164:167], v[136:139]
    ds_read_b64_tr_b16 a[202:203], v11 offset:58368
    v_mfma_f32_16x16x32_bf16 v[140:143], a[204:207], a[168:171], v[140:143]
    buffer_load_dwordx4 a[144:147], v5, s[12:15], s31 offen sc1
    v_mfma_f32_16x16x32_bf16 v[144:147], a[204:207], a[172:175], v[144:147]
    s_waitcnt lgkmcnt(12)
    v_mfma_f32_16x16x32_bf16 v[148:151], a[208:211], a[160:163], v[148:151]
    ds_read_b64_tr_b16 a[204:205], v12 offset:57344
    v_mfma_f32_16x16x32_bf16 v[152:155], a[208:211], a[164:167], v[152:155]
    ds_read_b64_tr_b16 a[206:207], v12 offset:58368
    v_mfma_f32_16x16x32_bf16 v[156:159], a[208:211], a[168:171], v[156:159]
    v_mfma_f32_16x16x32_bf16 v[160:163], a[208:211], a[172:175], v[160:163]
    buffer_load_dwordx4 a[148:151], v6, s[12:15], s31 offen sc1
    s_waitcnt lgkmcnt(12)
    v_mfma_f32_16x16x32_bf16 v[164:167], a[212:215], a[160:163], v[164:167]
    ds_read_b64_tr_b16 a[208:209], v13 offset:57344
    v_mfma_f32_16x16x32_bf16 v[168:171], a[212:215], a[164:167], v[168:171]
    ds_read_b64_tr_b16 a[210:211], v13 offset:58368
    v_mfma_f32_16x16x32_bf16 v[172:175], a[212:215], a[168:171], v[172:175]
    v_mfma_f32_16x16x32_bf16 v[176:179], a[212:215], a[172:175], v[176:179]
    buffer_load_dwordx4 a[152:155], v7, s[12:15], s31 offen sc1
    s_waitcnt lgkmcnt(12)
    v_mfma_f32_16x16x32_bf16 v[180:183], a[216:219], a[160:163], v[180:183]
    ds_read_b64_tr_b16 a[212:213], v14 offset:57344
    v_mfma_f32_16x16x32_bf16 v[184:187], a[216:219], a[164:167], v[184:187]
    ds_read_b64_tr_b16 a[214:215], v14 offset:58368
    v_mfma_f32_16x16x32_bf16 v[188:191], a[216:219], a[168:171], v[188:191]
    v_mfma_f32_16x16x32_bf16 v[192:195], a[216:219], a[172:175], v[192:195]
    s_waitcnt lgkmcnt(12)
    v_mfma_f32_16x16x32_bf16 v[196:199], a[220:223], a[160:163], v[196:199]
    ds_read_b64_tr_b16 a[216:217], v15 offset:57344
    v_mfma_f32_16x16x32_bf16 v[200:203], a[220:223], a[164:167], v[200:203]
    ds_read_b64_tr_b16 a[218:219], v15 offset:58368
    v_mfma_f32_16x16x32_bf16 v[204:207], a[220:223], a[168:171], v[204:207]
    buffer_load_dwordx4 a[156:159], v8, s[12:15], s31 offen sc1
    v_mfma_f32_16x16x32_bf16 v[208:211], a[220:223], a[172:175], v[208:211]
    s_add_u32 s31, s31, 1024
    s_waitcnt vmcnt(12)
    s_barrier
    s_waitcnt lgkmcnt(12)
    v_mfma_f32_16x16x32_bf16 v[84:87], a[192:195], a[176:179], v[84:87]
    ds_read_b64_tr_b16 a[220:221], v16 offset:57344
    v_mfma_f32_16x16x32_bf16 v[88:91], a[192:195], a[180:183], v[88:91]
    ds_read_b64_tr_b16 a[222:223], v16 offset:58368
    s_add_u32 m0, s30, 40960
    v_mfma_f32_16x16x32_bf16 v[92:95], a[192:195], a[184:187], v[92:95]
    buffer_load_dwordx4 v4, s[8:11], s28 offen lds
    v_mfma_f32_16x16x32_bf16 v[96:99], a[192:195], a[188:191], v[96:99]
    s_add_u32 s29, s28, 32768
    s_waitcnt lgkmcnt(12)
    v_mfma_f32_16x16x32_bf16 v[100:103], a[196:199], a[176:179], v[100:103]
    ds_read_b64_tr_b16 a[192:193], v9 offset:0
    v_mfma_f32_16x16x32_bf16 v[104:107], a[196:199], a[180:183], v[104:107]
    ds_read_b64_tr_b16 a[194:195], v9 offset:1024
    v_mfma_f32_16x16x32_bf16 v[108:111], a[196:199], a[184:187], v[108:111]
    s_add_u32 m0, s30, 41984
    v_mfma_f32_16x16x32_bf16 v[112:115], a[196:199], a[188:191], v[112:115]
    buffer_load_dwordx4 v4, s[8:11], s29 offen lds
    s_waitcnt lgkmcnt(12)
    v_mfma_f32_16x16x32_bf16 v[116:119], a[200:203], a[176:179], v[116:119]
    ds_read_b64_tr_b16 a[196:197], v10 offset:0
    s_add_u32 s28, s28, 262144
    v_mfma_f32_16x16x32_bf16 v[120:123], a[200:203], a[180:183], v[120:123]
    ds_read_b64_tr_b16 a[198:199], v10 offset:1024
    v_mfma_f32_16x16x32_bf16 v[124:127], a[200:203], a[184:187], v[124:127]
    v_mfma_f32_16x16x32_bf16 v[128:131], a[200:203], a[188:191], v[128:131]
    s_waitcnt lgkmcnt(12)
    v_mfma_f32_16x16x32_bf16 v[132:135], a[204:207], a[176:179], v[132:135]
    ds_read_b64_tr_b16 a[200:201], v11 offset:0
    v_mfma_f32_16x16x32_bf16 v[136:139], a[204:207], a[180:183], v[136:139]
    ds_read_b64_tr_b16 a[202:203], v11 offset:1024
    v_mfma_f32_16x16x32_bf16 v[140:143], a[204:207], a[184:187], v[140:143]
    buffer_load_dwordx4 a[160:163], v5, s[12:15], s31 offen sc1
    v_mfma_f32_16x16x32_bf16 v[144:147], a[204:207], a[188:191], v[144:147]
    s_waitcnt lgkmcnt(12)
    v_mfma_f32_16x16x32_bf16 v[148:151], a[208:211], a[176:179], v[148:151]
    ds_read_b64_tr_b16 a[204:205], v12 offset:0
    v_mfma_f32_16x16x32_bf16 v[152:155], a[208:211], a[180:183], v[152:155]
    ds_read_b64_tr_b16 a[206:207], v12 offset:1024
    v_mfma_f32_16x16x32_bf16 v[156:159], a[208:211], a[184:187], v[156:159]
    v_mfma_f32_16x16x32_bf16 v[160:163], a[208:211], a[188:191], v[160:163]
    buffer_load_dwordx4 a[164:167], v6, s[12:15], s31 offen sc1
    s_waitcnt lgkmcnt(12)
    v_mfma_f32_16x16x32_bf16 v[164:167], a[212:215], a[176:179], v[164:167]
    ds_read_b64_tr_b16 a[208:209], v13 offset:0
    v_mfma_f32_16x16x32_bf16 v[168:171], a[212:215], a[180:183], v[168:171]
    ds_read_b64_tr_b16 a[210:211], v13 offset:1024
    v_mfma_f32_16x16x32_bf16 v[172:175], a[212:215], a[184:187], v[172:175]
    v_mfma_f32_16x16x32_bf16 v[176:179], a[212:215], a[188:191], v[176:179]
    buffer_load_dwordx4 a[168:171], v7, s[12:15], s31 offen sc1
    s_waitcnt lgkmcnt(12)
    v_mfma_f32_16x16x32_bf16 v[180:183], a[216:219], a[176:179], v[180:183]
    ds_read_b64_tr_b16 a[212:213], v14 offset:0
    v_mfma_f32_16x16x32_bf16 v[184:187], a[216:219], a[180:183], v[184:187]
    ds_read_b64_tr_b16 a[214:215], v14 offset:1024
    v_mfma_f32_16x16x32_bf16 v[188:191], a[216:219], a[184:187], v[188:191]
    v_mfma_f32_16x16x32_bf16 v[192:195], a[216:219], a[188:191], v[192:195]
    s_waitcnt lgkmcnt(12)
    v_mfma_f32_16x16x32_bf16 v[196:199], a[220:223], a[176:179], v[196:199]
    ds_read_b64_tr_b16 a[216:217], v15 offset:0
    v_mfma_f32_16x16x32_bf16 v[200:203], a[220:223], a[180:183], v[200:203]
    ds_read_b64_tr_b16 a[218:219], v15 offset:1024
    v_mfma_f32_16x16x32_bf16 v[204:207], a[220:223], a[184:187], v[204:207]
    buffer_load_dwordx4 a[172:175], v8, s[12:15], s31 offen sc1
    v_mfma_f32_16x16x32_bf16 v[208:211], a[220:223], a[188:191], v[208:211]
    s_add_u32 s31, s31, 1024
    s_mov_b32 s32, 2
.p2align 6
L_mega_kernel_q:
    s_waitcnt vmcnt(12)
    s_waitcnt lgkmcnt(12)
    v_mfma_f32_16x16x32_bf16 v[84:87], a[192:195], a[128:131], v[84:87]
    ds_read_b64_tr_b16 a[220:221], v16 offset:0
    v_mfma_f32_16x16x32_bf16 v[88:91], a[192:195], a[132:135], v[88:91]
    ds_read_b64_tr_b16 a[222:223], v16 offset:1024
    s_add_u32 m0, s30, 49152
    v_mfma_f32_16x16x32_bf16 v[92:95], a[192:195], a[136:139], v[92:95]
    buffer_load_dwordx4 v4, s[8:11], s28 offen lds
    v_mfma_f32_16x16x32_bf16 v[96:99], a[192:195], a[140:143], v[96:99]
    s_add_u32 s29, s28, 32768
    s_waitcnt lgkmcnt(12)
    v_mfma_f32_16x16x32_bf16 v[100:103], a[196:199], a[128:131], v[100:103]
    ds_read_b64_tr_b16 a[192:193], v9 offset:8192
    v_mfma_f32_16x16x32_bf16 v[104:107], a[196:199], a[132:135], v[104:107]
    ds_read_b64_tr_b16 a[194:195], v9 offset:9216
    v_mfma_f32_16x16x32_bf16 v[108:111], a[196:199], a[136:139], v[108:111]
    s_add_u32 m0, s30, 50176
    v_mfma_f32_16x16x32_bf16 v[112:115], a[196:199], a[140:143], v[112:115]
    buffer_load_dwordx4 v4, s[8:11], s29 offen lds
    s_waitcnt lgkmcnt(12)
    v_mfma_f32_16x16x32_bf16 v[116:119], a[200:203], a[128:131], v[116:119]
    ds_read_b64_tr_b16 a[196:197], v10 offset:8192
    s_add_u32 s28, s28, 262144
    v_mfma_f32_16x16x32_bf16 v[120:123], a[200:203], a[132:135], v[120:123]
    ds_read_b64_tr_b16 a[198:199], v10 offset:9216
    v_mfma_f32_16x16x32_bf16 v[124:127], a[200:203], a[136:139], v[124:127]
    v_mfma_f32_16x16x32_bf16 v[128:131], a[200:203], a[140:143], v[128:131]
    s_waitcnt lgkmcnt(12)
    v_mfma_f32_16x16x32_bf16 v[132:135], a[204:207], a[128:131], v[132:135]
    ds_read_b64_tr_b16 a[200:201], v11 offset:8192
    v_mfma_f32_16x16x32_bf16 v[136:139], a[204:207], a[132:135], v[136:139]
    ds_read_b64_tr_b16 a[202:203], v11 offset:9216
    v_mfma_f32_16x16x32_bf16 v[140:143], a[204:207], a[136:139], v[140:143]
    buffer_load_dwordx4 a[176:179], v5, s[12:15], s31 offen sc1
    v_mfma_f32_16x16x32_bf16 v[144:147], a[204:207], a[140:143], v[144:147]
    s_waitcnt lgkmcnt(12)
    v_mfma_f32_16x16x32_bf16 v[148:151], a[208:211], a[128:131], v[148:151]
    ds_read_b64_tr_b16 a[204:205], v12 offset:8192
    v_mfma_f32_16x16x32_bf16 v[152:155], a[208:211], a[132:135], v[152:155]
    ds_read_b64_tr_b16 a[206:207], v12 offset:9216
    v_mfma_f32_16x16x32_bf16 v[156:159], a[208:211], a[136:139], v[156:159]
    v_mfma_f32_16x16x32_bf16 v[160:163], a[208:211], a[140:143], v[160:163]
    buffer_load_dwordx4 a[180:183], v6, s[12:15], s31 offen sc1
    s_waitcnt lgkmcnt(12)
    v_mfma_f32_16x16x32_bf16 v[164:167], a[212:215], a[128:131], v[164:167]
    ds_read_b64_tr_b16 a[208:209], v13 offset:8192
    v_mfma_f32_16x16x32_bf16 v[168:171], a[212:215], a[132:135], v[168:171]
    ds_read_b64_tr_b16 a[210:211], v13 offset:9216
    v_mfma_f32_16x16x32_bf16 v[172:175], a[212:215], a[136:139], v[172:175]
    v_mfma_f32_16x16x32_bf16 v[176:179], a[212:215], a[140:143], v[176:179]
    buffer_load_dwordx4 a[184:187], v7, s[12:15], s31 offen sc1
    s_waitcnt lgkmcnt(12)
    v_mfma_f32_16x16x32_bf16 v[180:183], a[216:219], a[128:131], v[180:183]
    ds_read_b64_tr_b16 a[212:213], v14 offset:8192
    v_mfma_f32_16x16x32_bf16 v[184:187], a[216:219], a[132:135], v[184:187]
    ds_read_b64_tr_b16 a[214:215], v14 offset:9216
    v_mfma_f32_16x16x32_bf16 v[188:191], a[216:219], a[136:139], v[188:191]
    v_mfma_f32_16x16x32_bf16 v[192:195], a[216:219], a[140:143], v[192:195]
    s_waitcnt lgkmcnt(12)
    v_mfma_f32_16x16x32_bf16 v[196:199], a[220:223], a[128:131], v[196:199]
    ds_read_b64_tr_b16 a[216:217], v15 offset:8192
    v_mfma_f32_16x16x32_bf16 v[200:203], a[220:223], a[132:135], v[200:203]
    ds_read_b64_tr_b16 a[218:219], v15 offset:9216
    v_mfma_f32_16x16x32_bf16 v[204:207], a[220:223], a[136:139], v[204:207]
    buffer_load_dwordx4 a[188:191], v8, s[12:15], s31 offen sc1
    v_mfma_f32_16x16x32_bf16 v[208:211], a[220:223], a[140:143], v[208:211]
    s_add_u32 s31, s31, 1024
    s_waitcnt vmcnt(12)
    s_barrier
    s_waitcnt lgkmcnt(12)
    v_mfma_f32_16x16x32_bf16 v[84:87], a[192:195], a[144:147], v[84:87]
    ds_read_b64_tr_b16 a[220:221], v16 offset:8192
    v_mfma_f32_16x16x32_bf16 v[88:91], a[192:195], a[148:151], v[88:91]
    ds_read_b64_tr_b16 a[222:223], v16 offset:9216
    s_add_u32 m0, s30, 57344
    v_mfma_f32_16x16x32_bf16 v[92:95], a[192:195], a[152:155], v[92:95]
    buffer_load_dwordx4 v4, s[8:11], s28 offen lds
    v_mfma_f32_16x16x32_bf16 v[96:99], a[192:195], a[156:159], v[96:99]
    s_add_u32 s29, s28, 32768
    s_waitcnt lgkmcnt(12)
    v_mfma_f32_16x16x32_bf16 v[100:103], a[196:199], a[144:147], v[100:103]
    ds_read_b64_tr_b16 a[192:193], v9 offset:16384
    v_mfma_f32_16x16x32_bf16 v[104:107], a[196:199], a[148:151], v[104:107]
    ds_read_b64_tr_b16 a[194:195], v9 offset:17408
    v_mfma_f32_16x16x32_bf16 v[108:111], a[196:199], a[152:155], v[108:111]
    s_add_u32 m0, s30, 58368
    v_mfma_f32_16x16x32_bf16 v[112:115], a[196:199], a[156:159], v[112:115]
    buffer_load_dwordx4 v4, s[8:11], s29 offen lds
    s_waitcnt lgkmcnt(12)
    v_mfma_f32_16x16x32_bf16 v[116:119], a[200:203], a[144:147], v[116:119]
    ds_read_b64_tr_b16 a[196:197], v10 offset:16384
    s_add_u32 s28, s28, 262144
    v_mfma_f32_16x16x32_bf16 v[120:123], a[200:203], a[148:151], v[120:123]
    ds_read_b64_tr_b16 a[198:199], v10 offset:17408
    v_mfma_f32_16x16x32_bf16 v[124:127], a[200:203], a[152:155], v[124:127]
    v_mfma_f32_16x16x32_bf16 v[128:131], a[200:203], a[156:159], v[128:131]
    s_waitcnt lgkmcnt(12)
    v_mfma_f32_16x16x32_bf16 v[132:135], a[204:207], a[144:147], v[132:135]
    ds_read_b64_tr_b16 a[200:201], v11 offset:16384
    v_mfma_f32_16x16x32_bf16 v[136:139], a[204:207], a[148:151], v[136:139]
    ds_read_b64_tr_b16 a[202:203], v11 offset:17408
    v_mfma_f32_16x16x32_bf16 v[140:143], a[204:207], a[152:155], v[140:143]
    buffer_load_dwordx4 a[128:131], v5, s[12:15], s31 offen sc1
    v_mfma_f32_16x16x32_bf16 v[144:147], a[204:207], a[156:159], v[144:147]
    s_waitcnt lgkmcnt(12)
    v_mfma_f32_16x16x32_bf16 v[148:151], a[208:211], a[144:147], v[148:151]
    ds_read_b64_tr_b16 a[204:205], v12 offset:16384
    v_mfma_f32_16x16x32_bf16 v[152:155], a[208:211], a[148:151], v[152:155]
    ds_read_b64_tr_b16 a[206:207], v12 offset:17408
    v_mfma_f32_16x16x32_bf16 v[156:159], a[208:211], a[152:155], v[156:159]
    v_mfma_f32_16x16x32_bf16 v[160:163], a[208:211], a[156:159], v[160:163]
    buffer_load_dwordx4 a[132:135], v6, s[12:15], s31 offen sc1
    s_waitcnt lgkmcnt(12)
    v_mfma_f32_16x16x32_bf16 v[164:167], a[212:215], a[144:147], v[164:167]
    ds_read_b64_tr_b16 a[208:209], v13 offset:16384
    v_mfma_f32_16x16x32_bf16 v[168:171], a[212:215], a[148:151], v[168:171]
    ds_read_b64_tr_b16 a[210:211], v13 offset:17408
    v_mfma_f32_16x16x32_bf16 v[172:175], a[212:215], a[152:155], v[172:175]
    v_mfma_f32_16x16x32_bf16 v[176:179], a[212:215], a[156:159], v[176:179]
    buffer_load_dwordx4 a[136:139], v7, s[12:15], s31 offen sc1
    s_waitcnt lgkmcnt(12)
    v_mfma_f32_16x16x32_bf16 v[180:183], a[216:219], a[144:147], v[180:183]
    ds_read_b64_tr_b16 a[212:213], v14 offset:16384
    v_mfma_f32_16x16x32_bf16 v[184:187], a[216:219], a[148:151], v[184:187]
    ds_read_b64_tr_b16 a[214:215], v14 offset:17408
    v_mfma_f32_16x16x32_bf16 v[188:191], a[216:219], a[152:155], v[188:191]
    v_mfma_f32_16x16x32_bf16 v[192:195], a[216:219], a[156:159], v[192:195]
    s_waitcnt lgkmcnt(12)
    v_mfma_f32_16x16x32_bf16 v[196:199], a[220:223], a[144:147], v[196:199]
    ds_read_b64_tr_b16 a[216:217], v15 offset:16384
    v_mfma_f32_16x16x32_bf16 v[200:203], a[220:223], a[148:151], v[200:203]
    ds_read_b64_tr_b16 a[218:219], v15 offset:17408
    v_mfma_f32_16x16x32_bf16 v[204:207], a[220:223], a[152:155], v[204:207]
    buffer_load_dwordx4 a[140:143], v8, s[12:15], s31 offen sc1
    v_mfma_f32_16x16x32_bf16 v[208:211], a[220:223], a[156:159], v[208:211]
    s_add_u32 s31, s31, 1024
    s_waitcnt vmcnt(12)
    s_waitcnt lgkmcnt(12)
    v_mfma_f32_16x16x32_bf16 v[84:87], a[192:195], a[160:163], v[84:87]
    ds_read_b64_tr_b16 a[220:221], v16 offset:16384
    v_mfma_f32_16x16x32_bf16 v[88:91], a[192:195], a[164:167], v[88:91]
    ds_read_b64_tr_b16 a[222:223], v16 offset:17408
    s_add_u32 m0, s30, 0
    v_mfma_f32_16x16x32_bf16 v[92:95], a[192:195], a[168:171], v[92:95]
    buffer_load_dwordx4 v4, s[8:11], s28 offen lds
    v_mfma_f32_16x16x32_bf16 v[96:99], a[192:195], a[172:175], v[96:99]
    s_add_u32 s29, s28, 32768
    s_waitcnt lgkmcnt(12)
    v_mfma_f32_16x16x32_bf16 v[100:103], a[196:199], a[160:163], v[100:103]
    ds_read_b64_tr_b16 a[192:193], v9 offset:24576
    v_mfma_f32_16x16x32_bf16 v[104:107], a[196:199], a[164:167], v[104:107]
    ds_read_b64_tr_b16 a[194:195], v9 offset:25600
    v_mfma_f32_16x16x32_bf16 v[108:111], a[196:199], a[168:171], v[108:111]
    s_add_u32 m0, s30, 1024
    v_mfma_f32_16x16x32_bf16 v[112:115], a[196:199], a[172:175], v[112:115]
    buffer_load_dwordx4 v4, s[8:11], s29 offen lds
    s_waitcnt lgkmcnt(12)
    v_mfma_f32_16x16x32_bf16 v[116:119], a[200:203], a[160:163], v[116:119]
    ds_read_b64_tr_b16 a[196:197], v10 offset:24576
    s_add_u32 s28, s28, 262144
    v_mfma_f32_16x16x32_bf16 v[120:123], a[200:203], a[164:167], v[120:123]
    ds_read_b64_tr_b16 a[198:199], v10 offset:25600
    v_mfma_f32_16x16x32_bf16 v[124:127], a[200:203], a[168:171], v[124:127]
    v_mfma_f32_16x16x32_bf16 v[128:131], a[200:203], a[172:175], v[128:131]
    s_waitcnt lgkmcnt(12)
    v_mfma_f32_16x16x32_bf16 v[132:135], a[204:207], a[160:163], v[132:135]
    ds_read_b64_tr_b16 a[200:201], v11 offset:24576
    v_mfma_f32_16x16x32_bf16 v[136:139], a[204:207], a[164:167], v[136:139]
    ds_read_b64_tr_b16 a[202:203], v11 offset:25600
    v_mfma_f32_16x16x32_bf16 v[140:143], a[204:207], a[168:171], v[140:143]
    buffer_load_dwordx4 a[144:147], v5, s[12:15], s31 offen sc1
    v_mfma_f32_16x16x32_bf16 v[144:147], a[204:207], a[172:175], v[144:147]
    s_waitcnt lgkmcnt(12)
    v_mfma_f32_16x16x32_bf16 v[148:151], a[208:211], a[160:163], v[148:151]
    ds_read_b64_tr_b16 a[204:205], v12 offset:24576
    v_mfma_f32_16x16x32_bf16 v[152:155], a[208:211], a[164:167], v[152:155]
    ds_read_b64_tr_b16 a[206:207], v12 offset:25600
    v_mfma_f32_16x16x32_bf16 v[156:159], a[208:211], a[168:171], v[156:159]
    v_mfma_f32_16x16x32_bf16 v[160:163], a[208:211], a[172:175], v[160:163]
    buffer_load_dwordx4 a[148:151], v6, s[12:15], s31 offen sc1
    s_waitcnt lgkmcnt(12)
    v_mfma_f32_16x16x32_bf16 v[164:167], a[212:215], a[160:163], v[164:167]
    ds_read_b64_tr_b16 a[208:209], v13 offset:24576
    v_mfma_f32_16x16x32_bf16 v[168:171], a[212:215], a[164:167], v[168:171]
    ds_read_b64_tr_b16 a[210:211], v13 offset:25600
    v_mfma_f32_16x16x32_bf16 v[172:175], a[212:215], a[168:171], v[172:175]
    v_mfma_f32_16x16x32_bf16 v[176:179], a[212:215], a[172:175], v[176:179]
    buffer_load_dwordx4 a[152:155], v7, s[12:15], s31 offen sc1
    s_waitcnt lgkmcnt(12)
    v_mfma_f32_16x16x32_bf16 v[180:183], a[216:219], a[160:163], v[180:183]
    ds_read_b64_tr_b16 a[212:213], v14 offset:24576
    v_mfma_f32_16x16x32_bf16 v[184:187], a[216:219], a[164:167], v[184:187]
    ds_read_b64_tr_b16 a[214:215], v14 offset:25600
    v_mfma_f32_16x16x32_bf16 v[188:191], a[216:219], a[168:171], v[188:191]
    v_mfma_f32_16x16x32_bf16 v[192:195], a[216:219], a[172:175], v[192:195]
    s_waitcnt lgkmcnt(12)
    v_mfma_f32_16x16x32_bf16 v[196:199], a[220:223], a[160:163], v[196:199]
    ds_read_b64_tr_b16 a[216:217], v15 offset:24576
    v_mfma_f32_16x16x32_bf16 v[200:203], a[220:223], a[164:167], v[200:203]
    ds_read_b64_tr_b16 a[218:219], v15 offset:25600
    v_mfma_f32_16x16x32_bf16 v[204:207], a[220:223], a[168:171], v[204:207]
    buffer_load_dwordx4 a[156:159], v8, s[12:15], s31 offen sc1
    v_mfma_f32_16x16x32_bf16 v[208:211], a[220:223], a[172:175], v[208:211]
    s_add_u32 s31, s31, 1024
    s_waitcnt vmcnt(12)
    s_barrier
    s_waitcnt lgkmcnt(12)
    v_mfma_f32_16x16x32_bf16 v[84:87], a[192:195], a[176:179], v[84:87]
    ds_read_b64_tr_b16 a[220:221], v16 offset:24576
    v_mfma_f32_16x16x32_bf16 v[88:91], a[192:195], a[180:183], v[88:91]
    ds_read_b64_tr_b16 a[222:223], v16 offset:25600
    s_add_u32 m0, s30, 8192
    v_mfma_f32_16x16x32_bf16 v[92:95], a[192:195], a[184:187], v[92:95]
    buffer_load_dwordx4 v4, s[8:11], s28 offen lds
    v_mfma_f32_16x16x32_bf16 v[96:99], a[192:195], a[188:191], v[96:99]
    s_add_u32 s29, s28, 32768
    s_waitcnt lgkmcnt(12)
    v_mfma_f32_16x16x32_bf16 v[100:103], a[196:199], a[176:179], v[100:103]
    ds_read_b64_tr_b16 a[192:193], v9 offset:32768
    v_mfma_f32_16x16x32_bf16 v[104:107], a[196:199], a[180:183], v[104:107]
    ds_read_b64_tr_b16 a[194:195], v9 offset:33792
    v_mfma_f32_16x16x32_bf16 v[108:111], a[196:199], a[184:187], v[108:111]
    s_add_u32 m0, s30, 9216
    v_mfma_f32_16x16x32_bf16 v[112:115], a[196:199], a[188:191], v[112:115]
    buffer_load_dwordx4 v4, s[8:11], s29 offen lds
    s_waitcnt lgkmcnt(12)
    v_mfma_f32_16x16x32_bf16 v[116:119], a[200:203], a[176:179], v[116:119]
    ds_read_b64_tr_b16 a[196:197], v10 offset:32768
    s_add_u32 s28, s28, 262144
    v_mfma_f32_16x16x32_bf16 v[120:123], a[200:203], a[180:183], v[120:123]
    ds_read_b64_tr_b16 a[198:199], v10 offset:33792
    v_mfma_f32_16x16x32_bf16 v[124:127], a[200:203], a[184:187], v[124:127]
    v_mfma_f32_16x16x32_bf16 v[128:131], a[200:203], a[188:191], v[128:131]
    s_waitcnt lgkmcnt(12)
    v_mfma_f32_16x16x32_bf16 v[132:135], a[204:207], a[176:179], v[132:135]
    ds_read_b64_tr_b16 a[200:201], v11 offset:32768
    v_mfma_f32_16x16x32_bf16 v[136:139], a[204:207], a[180:183], v[136:139]
    ds_read_b64_tr_b16 a[202:203], v11 offset:33792
    v_mfma_f32_16x16x32_bf16 v[140:143], a[204:207], a[184:187], v[140:143]
    buffer_load_dwordx4 a[160:163], v5, s[12:15], s31 offen sc1
    v_mfma_f32_16x16x32_bf16 v[144:147], a[204:207], a[188:191], v[144:147]
    s_waitcnt lgkmcnt(12)
    v_mfma_f32_16x16x32_bf16 v[148:151], a[208:211], a[176:179], v[148:151]
    ds_read_b64_tr_b16 a[204:205], v12 offset:32768
    v_mfma_f32_16x16x32_bf16 v[152:155], a[208:211], a[180:183], v[152:155]
    ds_read_b64_tr_b16 a[206:207], v12 offset:33792
    v_mfma_f32_16x16x32_bf16 v[156:159], a[208:211], a[184:187], v[156:159]
    v_mfma_f32_16x16x32_bf16 v[160:163], a[208:211], a[188:191], v[160:163]
    buffer_load_dwordx4 a[164:167], v6, s[12:15], s31 offen sc1
    s_waitcnt lgkmcnt(12)
    v_mfma_f32_16x16x32_bf16 v[164:167], a[212:215], a[176:179], v[164:167]
    ds_read_b64_tr_b16 a[208:209], v13 offset:32768
    v_mfma_f32_16x16x32_bf16 v[168:171], a[212:215], a[180:183], v[168:171]
    ds_read_b64_tr_b16 a[210:211], v13 offset:33792
    v_mfma_f32_16x16x32_bf16 v[172:175], a[212:215], a[184:187], v[172:175]
    v_mfma_f32_16x16x32_bf16 v[176:179], a[212:215], a[188:191], v[176:179]
    buffer_load_dwordx4 a[168:171], v7, s[12:15], s31 offen sc1
    s_waitcnt lgkmcnt(12)
    v_mfma_f32_16x16x32_bf16 v[180:183], a[216:219], a[176:179], v[180:183]
    ds_read_b64_tr_b16 a[212:213], v14 offset:32768
    v_mfma_f32_16x16x32_bf16 v[184:187], a[216:219], a[180:183], v[184:187]
    ds_read_b64_tr_b16 a[214:215], v14 offset:33792
    v_mfma_f32_16x16x32_bf16 v[188:191], a[216:219], a[184:187], v[188:191]
    v_mfma_f32_16x16x32_bf16 v[192:195], a[216:219], a[188:191], v[192:195]
    s_waitcnt lgkmcnt(12)
    v_mfma_f32_16x16x32_bf16 v[196:199], a[220:223], a[176:179], v[196:199]
    ds_read_b64_tr_b16 a[216:217], v15 offset:32768
    v_mfma_f32_16x16x32_bf16 v[200:203], a[220:223], a[180:183], v[200:203]
    ds_read_b64_tr_b16 a[218:219], v15 offset:33792
    v_mfma_f32_16x16x32_bf16 v[204:207], a[220:223], a[184:187], v[204:207]
    buffer_load_dwordx4 a[172:175], v8, s[12:15], s31 offen sc1
    v_mfma_f32_16x16x32_bf16 v[208:211], a[220:223], a[188:191], v[208:211]
    s_add_u32 s31, s31, 1024
    s_waitcnt vmcnt(12)
    s_waitcnt lgkmcnt(12)
    v_mfma_f32_16x16x32_bf16 v[84:87], a[192:195], a[128:131], v[84:87]
    ds_read_b64_tr_b16 a[220:221], v16 offset:32768
    v_mfma_f32_16x16x32_bf16 v[88:91], a[192:195], a[132:135], v[88:91]
    ds_read_b64_tr_b16 a[222:223], v16 offset:33792
    s_add_u32 m0, s30, 16384
    v_mfma_f32_16x16x32_bf16 v[92:95], a[192:195], a[136:139], v[92:95]
    buffer_load_dwordx4 v4, s[8:11], s28 offen lds
    v_mfma_f32_16x16x32_bf16 v[96:99], a[192:195], a[140:143], v[96:99]
    s_add_u32 s29, s28, 32768
    s_waitcnt lgkmcnt(12)
    v_mfma_f32_16x16x32_bf16 v[100:103], a[196:199], a[128:131], v[100:103]
    ds_read_b64_tr_b16 a[192:193], v9 offset:40960
    v_mfma_f32_16x16x32_bf16 v[104:107], a[196:199], a[132:135], v[104:107]
    ds_read_b64_tr_b16 a[194:195], v9 offset:41984
    v_mfma_f32_16x16x32_bf16 v[108:111], a[196:199], a[136:139], v[108:111]
    s_add_u32 m0, s30, 17408
    v_mfma_f32_16x16x32_bf16 v[112:115], a[196:199], a[140:143], v[112:115]
    buffer_load_dwordx4 v4, s[8:11], s29 offen lds
    s_waitcnt lgkmcnt(12)
    v_mfma_f32_16x16x32_bf16 v[116:119], a[200:203], a[128:131], v[116:119]
    ds_read_b64_tr_b16 a[196:197], v10 offset:40960
    s_add_u32 s28, s28, 262144
    v_mfma_f32_16x16x32_bf16 v[120:123], a[200:203], a[132:135], v[120:123]
    ds_read_b64_tr_b16 a[198:199], v10 offset:41984
    v_mfma_f32_16x16x32_bf16 v[124:127], a[200:203], a[136:139], v[124:127]
    v_mfma_f32_16x16x32_bf16 v[128:131], a[200:203], a[140:143], v[128:131]
    s_waitcnt lgkmcnt(12)
    v_mfma_f32_16x16x32_bf16 v[132:135], a[204:207], a[128:131], v[132:135]
    ds_read_b64_tr_b16 a[200:201], v11 offset:40960
    v_mfma_f32_16x16x32_bf16 v[136:139], a[204:207], a[132:135], v[136:139]
    ds_read_b64_tr_b16 a[202:203], v11 offset:41984
    v_mfma_f32_16x16x32_bf16 v[140:143], a[204:207], a[136:139], v[140:143]
    buffer_load_dwordx4 a[176:179], v5, s[12:15], s31 offen sc1
    v_mfma_f32_16x16x32_bf16 v[144:147], a[204:207], a[140:143], v[144:147]
    s_waitcnt lgkmcnt(12)
    v_mfma_f32_16x16x32_bf16 v[148:151], a[208:211], a[128:131], v[148:151]
    ds_read_b64_tr_b16 a[204:205], v12 offset:40960
    v_mfma_f32_16x16x32_bf16 v[152:155], a[208:211], a[132:135], v[152:155]
    ds_read_b64_tr_b16 a[206:207], v12 offset:41984
    v_mfma_f32_16x16x32_bf16 v[156:159], a[208:211], a[136:139], v[156:159]
    v_mfma_f32_16x16x32_bf16 v[160:163], a[208:211], a[140:143], v[160:163]
    buffer_load_dwordx4 a[180:183], v6, s[12:15], s31 offen sc1
    s_waitcnt lgkmcnt(12)
    v_mfma_f32_16x16x32_bf16 v[164:167], a[212:215], a[128:131], v[164:167]
    ds_read_b64_tr_b16 a[208:209], v13 offset:40960
    v_mfma_f32_16x16x32_bf16 v[168:171], a[212:215], a[132:135], v[168:171]
    ds_read_b64_tr_b16 a[210:211], v13 offset:41984
    v_mfma_f32_16x16x32_bf16 v[172:175], a[212:215], a[136:139], v[172:175]
    v_mfma_f32_16x16x32_bf16 v[176:179], a[212:215], a[140:143], v[176:179]
    buffer_load_dwordx4 a[184:187], v7, s[12:15], s31 offen sc1
    s_waitcnt lgkmcnt(12)
    v_mfma_f32_16x16x32_bf16 v[180:183], a[216:219], a[128:131], v[180:183]
    ds_read_b64_tr_b16 a[212:213], v14 offset:40960
    v_mfma_f32_16x16x32_bf16 v[184:187], a[216:219], a[132:135], v[184:187]
    ds_read_b64_tr_b16 a[214:215], v14 offset:41984
    v_mfma_f32_16x16x32_bf16 v[188:191], a[216:219], a[136:139], v[188:191]
    v_mfma_f32_16x16x32_bf16 v[192:195], a[216:219], a[140:143], v[192:195]
    s_waitcnt lgkmcnt(12)
    v_mfma_f32_16x16x32_bf16 v[196:199], a[220:223], a[128:131], v[196:199]
    ds_read_b64_tr_b16 a[216:217], v15 offset:40960
    v_mfma_f32_16x16x32_bf16 v[200:203], a[220:223], a[132:135], v[200:203]
    ds_read_b64_tr_b16 a[218:219], v15 offset:41984
    v_mfma_f32_16x16x32_bf16 v[204:207], a[220:223], a[136:139], v[204:207]
    buffer_load_dwordx4 a[188:191], v8, s[12:15], s31 offen sc1
    v_mfma_f32_16x16x32_bf16 v[208:211], a[220:223], a[140:143], v[208:211]
    s_add_u32 s31, s31, 1024
    s_waitcnt vmcnt(12)
    s_barrier
    s_waitcnt lgkmcnt(12)
    v_mfma_f32_16x16x32_bf16 v[84:87], a[192:195], a[144:147], v[84:87]
    ds_read_b64_tr_b16 a[220:221], v16 offset:40960
    v_mfma_f32_16x16x32_bf16 v[88:91], a[192:195], a[148:151], v[88:91]
    ds_read_b64_tr_b16 a[222:223], v16 offset:41984
    s_add_u32 m0, s30, 24576
    v_mfma_f32_16x16x32_bf16 v[92:95], a[192:195], a[152:155], v[92:95]
    buffer_load_dwordx4 v4, s[8:11], s28 offen lds
    v_mfma_f32_16x16x32_bf16 v[96:99], a[192:195], a[156:159], v[96:99]
    s_add_u32 s29, s28, 32768
    s_waitcnt lgkmcnt(12)
    v_mfma_f32_16x16x32_bf16 v[100:103], a[196:199], a[144:147], v[100:103]
    ds_read_b64_tr_b16 a[192:193], v9 offset:49152
    v_mfma_f32_16x16x32_bf16 v[104:107], a[196:199], a[148:151], v[104:107]
    ds_read_b64_tr_b16 a[194:195], v9 offset:50176
    v_mfma_f32_16x16x32_bf16 v[108:111], a[196:199], a[152:155], v[108:111]
    s_add_u32 m0, s30, 25600
    v_mfma_f32_16x16x32_bf16 v[112:115], a[196:199], a[156:159], v[112:115]
    buffer_load_dwordx4 v4, s[8:11], s29 offen lds
    s_waitcnt lgkmcnt(12)
    v_mfma_f32_16x16x32_bf16 v[116:119], a[200:203], a[144:147], v[116:119]
    ds_read_b64_tr_b16 a[196:197], v10 offset:49152
    s_add_u32 s28, s28, 262144
    v_mfma_f32_16x16x32_bf16 v[120:123], a[200:203], a[148:151], v[120:123]
    ds_read_b64_tr_b16 a[198:199], v10 offset:50176
    v_mfma_f32_16x16x32_bf16 v[124:127], a[200:203], a[152:155], v[124:127]
    v_mfma_f32_16x16x32_bf16 v[128:131], a[200:203], a[156:159], v[128:131]
    s_waitcnt lgkmcnt(12)
    v_mfma_f32_16x16x32_bf16 v[132:135], a[204:207], a[144:147], v[132:135]
    ds_read_b64_tr_b16 a[200:201], v11 offset:49152
    v_mfma_f32_16x16x32_bf16 v[136:139], a[204:207], a[148:151], v[136:139]
    ds_read_b64_tr_b16 a[202:203], v11 offset:50176
    v_mfma_f32_16x16x32_bf16 v[140:143], a[204:207], a[152:155], v[140:143]
    buffer_load_dwordx4 a[128:131], v5, s[12:15], s31 offen sc1
    v_mfma_f32_16x16x32_bf16 v[144:147], a[204:207], a[156:159], v[144:147]
    s_waitcnt lgkmcnt(12)
    v_mfma_f32_16x16x32_bf16 v[148:151], a[208:211], a[144:147], v[148:151]
    ds_read_b64_tr_b16 a[204:205], v12 offset:49152
    v_mfma_f32_16x16x32_bf16 v[152:155], a[208:211], a[148:151], v[152:155]
    ds_read_b64_tr_b16 a[206:207], v12 offset:50176
    v_mfma_f32_16x16x32_bf16 v[156:159], a[208:211], a[152:155], v[156:159]
    v_mfma_f32_16x16x32_bf16 v[160:163], a[208:211], a[156:159], v[160:163]
    buffer_load_dwordx4 a[132:135], v6, s[12:15], s31 offen sc1
    s_waitcnt lgkmcnt(12)
    v_mfma_f32_16x16x32_bf16 v[164:167], a[212:215], a[144:147], v[164:167]
    ds_read_b64_tr_b16 a[208:209], v13 offset:49152
    v_mfma_f32_16x16x32_bf16 v[168:171], a[212:215], a[148:151], v[168:171]
    ds_read_b64_tr_b16 a[210:211], v13 offset:50176
    v_mfma_f32_16x16x32_bf16 v[172:175], a[212:215], a[152:155], v[172:175]
    v_mfma_f32_16x16x32_bf16 v[176:179], a[212:215], a[156:159], v[176:179]
    buffer_load_dwordx4 a[136:139], v7, s[12:15], s31 offen sc1
    s_waitcnt lgkmcnt(12)
    v_mfma_f32_16x16x32_bf16 v[180:183], a[216:219], a[144:147], v[180:183]
    ds_read_b64_tr_b16 a[212:213], v14 offset:49152
    v_mfma_f32_16x16x32_bf16 v[184:187], a[216:219], a[148:151], v[184:187]
    ds_read_b64_tr_b16 a[214:215], v14 offset:50176
    v_mfma_f32_16x16x32_bf16 v[188:191], a[216:219], a[152:155], v[188:191]
    v_mfma_f32_16x16x32_bf16 v[192:195], a[216:219], a[156:159], v[192:195]
    s_waitcnt lgkmcnt(12)
    v_mfma_f32_16x16x32_bf16 v[196:199], a[220:223], a[144:147], v[196:199]
    ds_read_b64_tr_b16 a[216:217], v15 offset:49152
    v_mfma_f32_16x16x32_bf16 v[200:203], a[220:223], a[148:151], v[200:203]
    ds_read_b64_tr_b16 a[218:219], v15 offset:50176
    v_mfma_f32_16x16x32_bf16 v[204:207], a[220:223], a[152:155], v[204:207]
    buffer_load_dwordx4 a[140:143], v8, s[12:15], s31 offen sc1
    v_mfma_f32_16x16x32_bf16 v[208:211], a[220:223], a[156:159], v[208:211]
    s_add_u32 s31, s31, 1024
    s_waitcnt vmcnt(12)
    s_waitcnt lgkmcnt(12)
    v_mfma_f32_16x16x32_bf16 v[84:87], a[192:195], a[160:163], v[84:87]
    ds_read_b64_tr_b16 a[220:221], v16 offset:49152
    v_mfma_f32_16x16x32_bf16 v[88:91], a[192:195], a[164:167], v[88:91]
    ds_read_b64_tr_b16 a[222:223], v16 offset:50176
    s_add_u32 m0, s30, 32768
    v_mfma_f32_16x16x32_bf16 v[92:95], a[192:195], a[168:171], v[92:95]
    buffer_load_dwordx4 v4, s[8:11], s28 offen lds
    v_mfma_f32_16x16x32_bf16 v[96:99], a[192:195], a[172:175], v[96:99]
    s_add_u32 s29, s28, 32768
    s_waitcnt lgkmcnt(12)
    v_mfma_f32_16x16x32_bf16 v[100:103], a[196:199], a[160:163], v[100:103]
    ds_read_b64_tr_b16 a[192:193], v9 offset:57344
    v_mfma_f32_16x16x32_bf16 v[104:107], a[196:199], a[164:167], v[104:107]
    ds_read_b64_tr_b16 a[194:195], v9 offset:58368
    v_mfma_f32_16x16x32_bf16 v[108:111], a[196:199], a[168:171], v[108:111]
    s_add_u32 m0, s30, 33792
    v_mfma_f32_16x16x32_bf16 v[112:115], a[196:199], a[172:175], v[112:115]
    buffer_load_dwordx4 v4, s[8:11], s29 offen lds
    s_waitcnt lgkmcnt(12)
    v_mfma_f32_16x16x32_bf16 v[116:119], a[200:203], a[160:163], v[116:119]
    ds_read_b64_tr_b16 a[196:197], v10 offset:57344
    s_add_u32 s28, s28, 262144
    v_mfma_f32_16x16x32_bf16 v[120:123], a[200:203], a[164:167], v[120:123]
    ds_read_b64_tr_b16 a[198:199], v10 offset:58368
    v_mfma_f32_16x16x32_bf16 v[124:127], a[200:203], a[168:171], v[124:127]
    v_mfma_f32_16x16x32_bf16 v[128:131], a[200:203], a[172:175], v[128:131]
    s_waitcnt lgkmcnt(12)
    v_mfma_f32_16x16x32_bf16 v[132:135], a[204:207], a[160:163], v[132:135]
    ds_read_b64_tr_b16 a[200:201], v11 offset:57344
    v_mfma_f32_16x16x32_bf16 v[136:139], a[204:207], a[164:167], v[136:139]
    ds_read_b64_tr_b16 a[202:203], v11 offset:58368
    v_mfma_f32_16x16x32_bf16 v[140:143], a[204:207], a[168:171], v[140:143]
    buffer_load_dwordx4 a[144:147], v5, s[12:15], s31 offen sc1
    v_mfma_f32_16x16x32_bf16 v[144:147], a[204:207], a[172:175], v[144:147]
    s_waitcnt lgkmcnt(12)
    v_mfma_f32_16x16x32_bf16 v[148:151], a[208:211], a[160:163], v[148:151]
    ds_read_b64_tr_b16 a[204:205], v12 offset:57344
    v_mfma_f32_16x16x32_bf16 v[152:155], a[208:211], a[164:167], v[152:155]
    ds_read_b64_tr_b16 a[206:207], v12 offset:58368
    v_mfma_f32_16x16x32_bf16 v[156:159], a[208:211], a[168:171], v[156:159]
    v_mfma_f32_16x16x32_bf16 v[160:163], a[208:211], a[172:175], v[160:163]
    buffer_load_dwordx4 a[148:151], v6, s[12:15], s31 offen sc1
    s_waitcnt lgkmcnt(12)
    v_mfma_f32_16x16x32_bf16 v[164:167], a[212:215], a[160:163], v[164:167]
    ds_read_b64_tr_b16 a[208:209], v13 offset:57344
    v_mfma_f32_16x16x32_bf16 v[168:171], a[212:215], a[164:167], v[168:171]
    ds_read_b64_tr_b16 a[210:211], v13 offset:58368
    v_mfma_f32_16x16x32_bf16 v[172:175], a[212:215], a[168:171], v[172:175]
    v_mfma_f32_16x16x32_bf16 v[176:179], a[212:215], a[172:175], v[176:179]
    buffer_load_dwordx4 a[152:155], v7, s[12:15], s31 offen sc1
    s_waitcnt lgkmcnt(12)
    v_mfma_f32_16x16x32_bf16 v[180:183], a[216:219], a[160:163], v[180:183]
    ds_read_b64_tr_b16 a[212:213], v14 offset:57344
    v_mfma_f32_16x16x32_bf16 v[184:187], a[216:219], a[164:167], v[184:187]
    ds_read_b64_tr_b16 a[214:215], v14 offset:58368
    v_mfma_f32_16x16x32_bf16 v[188:191], a[216:219], a[168:171], v[188:191]
    v_mfma_f32_16x16x32_bf16 v[192:195], a[216:219], a[172:175], v[192:195]
    s_waitcnt lgkmcnt(12)
    v_mfma_f32_16x16x32_bf16 v[196:199], a[220:223], a[160:163], v[196:199]
    ds_read_b64_tr_b16 a[216:217], v15 offset:57344
    v_mfma_f32_16x16x32_bf16 v[200:203], a[220:223], a[164:167], v[200:203]
    ds_read_b64_tr_b16 a[218:219], v15 offset:58368
    v_mfma_f32_16x16x32_bf16 v[204:207], a[220:223], a[168:171], v[204:207]
    buffer_load_dwordx4 a[156:159], v8, s[12:15], s31 offen sc1
    v_mfma_f32_16x16x32_bf16 v[208:211], a[220:223], a[172:175], v[208:211]
    s_add_u32 s31, s31, 1024
    s_waitcnt vmcnt(12)
    s_barrier
    s_waitcnt lgkmcnt(12)
    v_mfma_f32_16x16x32_bf16 v[84:87], a[192:195], a[176:179], v[84:87]
    ds_read_b64_tr_b16 a[220:221], v16 offset:57344
    v_mfma_f32_16x16x32_bf16 v[88:91], a[192:195], a[180:183], v[88:91]
    ds_read_b64_tr_b16 a[222:223], v16 offset:58368
    s_add_u32 m0, s30, 40960
    v_mfma_f32_16x16x32_bf16 v[92:95], a[192:195], a[184:187], v[92:95]
    buffer_load_dwordx4 v4, s[8:11], s28 offen lds
    v_mfma_f32_16x16x32_bf16 v[96:99], a[192:195], a[188:191], v[96:99]
    s_add_u32 s29, s28, 32768
    s_waitcnt lgkmcnt(12)
    v_mfma_f32_16x16x32_bf16 v[100:103], a[196:199], a[176:179], v[100:103]
    ds_read_b64_tr_b16 a[192:193], v9 offset:0
    v_mfma_f32_16x16x32_bf16 v[104:107], a[196:199], a[180:183], v[104:107]
    ds_read_b64_tr_b16 a[194:195], v9 offset:1024
    v_mfma_f32_16x16x32_bf16 v[108:111], a[196:199], a[184:187], v[108:111]
    s_add_u32 m0, s30, 41984
    v_mfma_f32_16x16x32_bf16 v[112:115], a[196:199], a[188:191], v[112:115]
    buffer_load_dwordx4 v4, s[8:11], s29 offen lds
    s_waitcnt lgkmcnt(12)
    v_mfma_f32_16x16x32_bf16 v[116:119], a[200:203], a[176:179], v[116:119]
    ds_read_b64_tr_b16 a[196:197], v10 offset:0
    s_add_u32 s28, s28, 262144
    v_mfma_f32_16x16x32_bf16 v[120:123], a[200:203], a[180:183], v[120:123]
    ds_read_b64_tr_b16 a[198:199], v10 offset:1024
    v_mfma_f32_16x16x32_bf16 v[124:127], a[200:203], a[184:187], v[124:127]
    v_mfma_f32_16x16x32_bf16 v[128:131], a[200:203], a[188:191], v[128:131]
    s_waitcnt lgkmcnt(12)
    v_mfma_f32_16x16x32_bf16 v[132:135], a[204:207], a[176:179], v[132:135]
    ds_read_b64_tr_b16 a[200:201], v11 offset:0
    v_mfma_f32_16x16x32_bf16 v[136:139], a[204:207], a[180:183], v[136:139]
    ds_read_b64_tr_b16 a[202:203], v11 offset:1024
    v_mfma_f32_16x16x32_bf16 v[140:143], a[204:207], a[184:187], v[140:143]
    buffer_load_dwordx4 a[160:163], v5, s[12:15], s31 offen sc1
    v_mfma_f32_16x16x32_bf16 v[144:147], a[204:207], a[188:191], v[144:147]
    s_waitcnt lgkmcnt(12)
    v_mfma_f32_16x16x32_bf16 v[148:151], a[208:211], a[176:179], v[148:151]
    ds_read_b64_tr_b16 a[204:205], v12 offset:0
    v_mfma_f32_16x16x32_bf16 v[152:155], a[208:211], a[180:183], v[152:155]
    ds_read_b64_tr_b16 a[206:207], v12 offset:1024
    v_mfma_f32_16x16x32_bf16 v[156:159], a[208:211], a[184:187], v[156:159]
    v_mfma_f32_16x16x32_bf16 v[160:163], a[208:211], a[188:191], v[160:163]
    buffer_load_dwordx4 a[164:167], v6, s[12:15], s31 offen sc1
    s_waitcnt lgkmcnt(12)
    v_mfma_f32_16x16x32_bf16 v[164:167], a[212:215], a[176:179], v[164:167]
    ds_read_b64_tr_b16 a[208:209], v13 offset:0
    v_mfma_f32_16x16x32_bf16 v[168:171], a[212:215], a[180:183], v[168:171]
    ds_read_b64_tr_b16 a[210:211], v13 offset:1024
    v_mfma_f32_16x16x32_bf16 v[172:175], a[212:215], a[184:187], v[172:175]
    v_mfma_f32_16x16x32_bf16 v[176:179], a[212:215], a[188:191], v[176:179]
    buffer_load_dwordx4 a[168:171], v7, s[12:15], s31 offen sc1
    s_waitcnt lgkmcnt(12)
    v_mfma_f32_16x16x32_bf16 v[180:183], a[216:219], a[176:179], v[180:183]
    ds_read_b64_tr_b16 a[212:213], v14 offset:0
    v_mfma_f32_16x16x32_bf16 v[184:187], a[216:219], a[180:183], v[184:187]
    ds_read_b64_tr_b16 a[214:215], v14 offset:1024
    v_mfma_f32_16x16x32_bf16 v[188:191], a[216:219], a[184:187], v[188:191]
    v_mfma_f32_16x16x32_bf16 v[192:195], a[216:219], a[188:191], v[192:195]
    s_waitcnt lgkmcnt(12)
    v_mfma_f32_16x16x32_bf16 v[196:199], a[220:223], a[176:179], v[196:199]
    ds_read_b64_tr_b16 a[216:217], v15 offset:0
    v_mfma_f32_16x16x32_bf16 v[200:203], a[220:223], a[180:183], v[200:203]
    ds_read_b64_tr_b16 a[218:219], v15 offset:1024
    v_mfma_f32_16x16x32_bf16 v[204:207], a[220:223], a[184:187], v[204:207]
    buffer_load_dwordx4 a[172:175], v8, s[12:15], s31 offen sc1
    v_mfma_f32_16x16x32_bf16 v[208:211], a[220:223], a[188:191], v[208:211]
    s_add_u32 s31, s31, 1024
    s_sub_u32 s32, s32, 1
    s_cmp_lg_u32 s32, 0
    s_cbranch_scc1 L_mega_kernel_q
    s_waitcnt vmcnt(12)
    s_waitcnt lgkmcnt(12)
    v_mfma_f32_16x16x32_bf16 v[84:87], a[192:195], a[128:131], v[84:87]
    ds_read_b64_tr_b16 a[220:221], v16 offset:0
    v_mfma_f32_16x16x32_bf16 v[88:91], a[192:195], a[132:135], v[88:91]
    ds_read_b64_tr_b16 a[222:223], v16 offset:1024
    s_add_u32 m0, s30, 49152
    v_mfma_f32_16x16x32_bf16 v[92:95], a[192:195], a[136:139], v[92:95]
    buffer_load_dwordx4 v4, s[8:11], s28 offen lds
    v_mfma_f32_16x16x32_bf16 v[96:99], a[192:195], a[140:143], v[96:99]
    s_add_u32 s29, s28, 32768
    s_waitcnt lgkmcnt(12)
    v_mfma_f32_16x16x32_bf16 v[100:103], a[196:199], a[128:131], v[100:103]
    ds_read_b64_tr_b16 a[192:193], v9 offset:8192
    v_lshlrev_b32 v214, 2, v0
    v_mfma_f32_16x16x32_bf16 v[104:107], a[196:199], a[132:135], v[104:107]
    ds_read_b64_tr_b16 a[194:195], v9 offset:9216
    v_mfma_f32_16x16x32_bf16 v[108:111], a[196:199], a[136:139], v[108:111]
    s_add_u32 m0, s30, 50176
    v_add_u32 v214, s61, v214
    v_mfma_f32_16x16x32_bf16 v[112:115], a[196:199], a[140:143], v[112:115]
    buffer_load_dwordx4 v4, s[8:11], s29 offen lds
    s_waitcnt lgkmcnt(12)
    v_mfma_f32_16x16x32_bf16 v[116:119], a[200:203], a[128:131], v[116:119]
    ds_read_b64_tr_b16 a[196:197], v10 offset:8192
    s_add_u32 s28, s28, 262144
    buffer_load_dword v215, v214, s[92:95], 0 offen sc1
    v_mfma_f32_16x16x32_bf16 v[120:123], a[200:203], a[132:135], v[120:123]
    ds_read_b64_tr_b16 a[198:199], v10 offset:9216
    v_mfma_f32_16x16x32_bf16 v[124:127], a[200:203], a[136:139], v[124:127]
    v_mfma_f32_16x16x32_bf16 v[128:131], a[200:203], a[140:143], v[128:131]
    s_waitcnt lgkmcnt(12)
    v_mfma_f32_16x16x32_bf16 v[132:135], a[204:207], a[128:131], v[132:135]
    ds_read_b64_tr_b16 a[200:201], v11 offset:8192
    v_mfma_f32_16x16x32_bf16 v[136:139], a[204:207], a[132:135], v[136:139]
    ds_read_b64_tr_b16 a[202:203], v11 offset:9216
    v_mfma_f32_16x16x32_bf16 v[140:143], a[204:207], a[136:139], v[140:143]
    buffer_load_dwordx4 a[176:179], v5, s[12:15], s31 offen sc1
    v_mfma_f32_16x16x32_bf16 v[144:147], a[204:207], a[140:143], v[144:147]
    s_waitcnt lgkmcnt(12)
    v_mfma_f32_16x16x32_bf16 v[148:151], a[208:211], a[128:131], v[148:151]
    ds_read_b64_tr_b16 a[204:205], v12 offset:8192
    v_mfma_f32_16x16x32_bf16 v[152:155], a[208:211], a[132:135], v[152:155]
    ds_read_b64_tr_b16 a[206:207], v12 offset:9216
    v_mfma_f32_16x16x32_bf16 v[156:159], a[208:211], a[136:139], v[156:159]
    v_mfma_f32_16x16x32_bf16 v[160:163], a[208:211], a[140:143], v[160:163]
    buffer_load_dwordx4 a[180:183], v6, s[12:15], s31 offen sc1
    s_waitcnt lgkmcnt(12)
    v_mfma_f32_16x16x32_bf16 v[164:167], a[212:215], a[128:131], v[164:167]
    ds_read_b64_tr_b16 a[208:209], v13 offset:8192
    v_mfma_f32_16x16x32_bf16 v[168:171], a[212:215], a[132:135], v[168:171]
    ds_read_b64_tr_b16 a[210:211], v13 offset:9216
    v_mfma_f32_16x16x32_bf16 v[172:175], a[212:215], a[136:139], v[172:175]
    v_mfma_f32_16x16x32_bf16 v[176:179], a[212:215], a[140:143], v[176:179]
    buffer_load_dwordx4 a[184:187], v7, s[12:15], s31 offen sc1
    s_waitcnt lgkmcnt(12)
    v_mfma_f32_16x16x32_bf16 v[180:183], a[216:219], a[128:131], v[180:183]
    ds_read_b64_tr_b16 a[212:213], v14 offset:8192
    v_mfma_f32_16x16x32_bf16 v[184:187], a[216:219], a[132:135], v[184:187]
    ds_read_b64_tr_b16 a[214:215], v14 offset:9216
    v_mfma_f32_16x16x32_bf16 v[188:191], a[216:219], a[136:139], v[188:191]
    v_mfma_f32_16x16x32_bf16 v[192:195], a[216:219], a[140:143], v[192:195]
    s_waitcnt lgkmcnt(12)
    v_mfma_f32_16x16x32_bf16 v[196:199], a[220:223], a[128:131], v[196:199]
    ds_read_b64_tr_b16 a[216:217], v15 offset:8192
    v_mfma_f32_16x16x32_bf16 v[200:203], a[220:223], a[132:135], v[200:203]
    ds_read_b64_tr_b16 a[218:219], v15 offset:9216
    v_mfma_f32_16x16x32_bf16 v[204:207], a[220:223], a[136:139], v[204:207]
    buffer_load_dwordx4 a[188:191], v8, s[12:15], s31 offen sc1
    v_mfma_f32_16x16x32_bf16 v[208:211], a[220:223], a[140:143], v[208:211]
    s_add_u32 s31, s31, 1024
    s_waitcnt vmcnt(13)
    s_barrier
    s_waitcnt lgkmcnt(12)
    v_mfma_f32_16x16x32_bf16 v[84:87], a[192:195], a[144:147], v[84:87]
    ds_read_b64_tr_b16 a[220:221], v16 offset:8192
    v_mfma_f32_16x16x32_bf16 v[88:91], a[192:195], a[148:151], v[88:91]
    ds_read_b64_tr_b16 a[222:223], v16 offset:9216
    s_add_u32 m0, s30, 57344
    v_mfma_f32_16x16x32_bf16 v[92:95], a[192:195], a[152:155], v[92:95]
    buffer_load_dwordx4 v4, s[8:11], s28 offen lds
    v_mfma_f32_16x16x32_bf16 v[96:99], a[192:195], a[156:159], v[96:99]
    s_add_u32 s29, s28, 32768
    s_waitcnt lgkmcnt(12)
    v_mfma_f32_16x16x32_bf16 v[100:103], a[196:199], a[144:147], v[100:103]
    ds_read_b64_tr_b16 a[192:193], v9 offset:16384
    v_mfma_f32_16x16x32_bf16 v[104:107], a[196:199], a[148:151], v[104:107]
    ds_read_b64_tr_b16 a[194:195], v9 offset:17408
    v_mfma_f32_16x16x32_bf16 v[108:111], a[196:199], a[152:155], v[108:111]
    s_add_u32 m0, s30, 58368
    v_mfma_f32_16x16x32_bf16 v[112:115], a[196:199], a[156:159], v[112:115]
    buffer_load_dwordx4 v4, s[8:11], s29 offen lds
    s_waitcnt lgkmcnt(12)
    v_mfma_f32_16x16x32_bf16 v[116:119], a[200:203], a[144:147], v[116:119]
    ds_read_b64_tr_b16 a[196:197], v10 offset:16384
    s_add_u32 s28, s28, 262144
    v_mfma_f32_16x16x32_bf16 v[120:123], a[200:203], a[148:151], v[120:123]
    ds_read_b64_tr_b16 a[198:199], v10 offset:17408
    v_mfma_f32_16x16x32_bf16 v[124:127], a[200:203], a[152:155], v[124:127]
    v_mfma_f32_16x16x32_bf16 v[128:131], a[200:203], a[156:159], v[128:131]
    s_waitcnt lgkmcnt(12)
    v_mfma_f32_16x16x32_bf16 v[132:135], a[204:207], a[144:147], v[132:135]
    ds_read_b64_tr_b16 a[200:201], v11 offset:16384
    v_mfma_f32_16x16x32_bf16 v[136:139], a[204:207], a[148:151], v[136:139]
    ds_read_b64_tr_b16 a[202:203], v11 offset:17408
    v_mfma_f32_16x16x32_bf16 v[140:143], a[204:207], a[152:155], v[140:143]
    buffer_load_dwordx4 a[128:131], v5, s[12:15], s31 offen sc1
    v_mfma_f32_16x16x32_bf16 v[144:147], a[204:207], a[156:159], v[144:147]
    s_waitcnt lgkmcnt(12)
    v_mfma_f32_16x16x32_bf16 v[148:151], a[208:211], a[144:147], v[148:151]
    ds_read_b64_tr_b16 a[204:205], v12 offset:16384
    v_mfma_f32_16x16x32_bf16 v[152:155], a[208:211], a[148:151], v[152:155]
    ds_read_b64_tr_b16 a[206:207], v12 offset:17408
    v_mfma_f32_16x16x32_bf16 v[156:159], a[208:211], a[152:155], v[156:159]
    v_mfma_f32_16x16x32_bf16 v[160:163], a[208:211], a[156:159], v[160:163]
    buffer_load_dwordx4 a[132:135], v6, s[12:15], s31 offen sc1
    s_waitcnt lgkmcnt(12)
    v_mfma_f32_16x16x32_bf16 v[164:167], a[212:215], a[144:147], v[164:167]
    ds_read_b64_tr_b16 a[208:209], v13 offset:16384
    v_mfma_f32_16x16x32_bf16 v[168:171], a[212:215], a[148:151], v[168:171]
    ds_read_b64_tr_b16 a[210:211], v13 offset:17408
    v_mfma_f32_16x16x32_bf16 v[172:175], a[212:215], a[152:155], v[172:175]
    v_mfma_f32_16x16x32_bf16 v[176:179], a[212:215], a[156:159], v[176:179]
    buffer_load_dwordx4 a[136:139], v7, s[12:15], s31 offen sc1
    s_waitcnt lgkmcnt(12)
    v_mfma_f32_16x16x32_bf16 v[180:183], a[216:219], a[144:147], v[180:183]
    ds_read_b64_tr_b16 a[212:213], v14 offset:16384
    v_mfma_f32_16x16x32_bf16 v[184:187], a[216:219], a[148:151], v[184:187]
    ds_read_b64_tr_b16 a[214:215], v14 offset:17408
    v_mfma_f32_16x16x32_bf16 v[188:191], a[216:219], a[152:155], v[188:191]
    v_mfma_f32_16x16x32_bf16 v[192:195], a[216:219], a[156:159], v[192:195]
    s_waitcnt lgkmcnt(12)
    v_mfma_f32_16x16x32_bf16 v[196:199], a[220:223], a[144:147], v[196:199]
    ds_read_b64_tr_b16 a[216:217], v15 offset:16384
    v_mfma_f32_16x16x32_bf16 v[200:203], a[220:223], a[148:151], v[200:203]
    ds_read_b64_tr_b16 a[218:219], v15 offset:17408
    v_mfma_f32_16x16x32_bf16 v[204:207], a[220:223], a[152:155], v[204:207]
    buffer_load_dwordx4 a[140:143], v8, s[12:15], s31 offen sc1
    v_mfma_f32_16x16x32_bf16 v[208:211], a[220:223], a[156:159], v[208:211]
    s_add_u32 s31, s31, 1024
    s_waitcnt vmcnt(10)
    v_cmp_ne_u32 vcc, 1, v215
    s_cbranch_vccnz L_mega_kernel_kvspin
L_mega_kernel_kvok:
    s_waitcnt vmcnt(63)
    s_waitcnt lgkmcnt(12)
    v_mfma_f32_16x16x32_bf16 v[84:87], a[192:195], a[160:163], v[84:87]
    ds_read_b64_tr_b16 a[220:221], v16 offset:16384
    v_mfma_f32_16x16x32_bf16 v[88:91], a[192:195], a[164:167], v[88:91]
    ds_read_b64_tr_b16 a[222:223], v16 offset:17408
    v_mfma_f32_16x16x32_bf16 v[92:95], a[192:195], a[168:171], v[92:95]
    s_add_u32 m0, s36, 0
    v_mfma_f32_16x16x32_bf16 v[96:99], a[192:195], a[172:175], v[96:99]
    buffer_load_dwordx4 v1, s[16:19], s33 offen offset:0 sc1 lds
    s_waitcnt lgkmcnt(12)
    v_mfma_f32_16x16x32_bf16 v[100:103], a[196:199], a[160:163], v[100:103]
    ds_read_b64_tr_b16 a[192:193], v9 offset:24576
    v_mfma_f32_16x16x32_bf16 v[104:107], a[196:199], a[164:167], v[104:107]
    ds_read_b64_tr_b16 a[194:195], v9 offset:25600
    v_mfma_f32_16x16x32_bf16 v[108:111], a[196:199], a[168:171], v[108:111]
    v_mfma_f32_16x16x32_bf16 v[112:115], a[196:199], a[172:175], v[112:115]
    buffer_load_dwordx4 v1, s[16:19], s33 offen offset:1024 sc1 lds
    s_waitcnt lgkmcnt(12)
    v_mfma_f32_16x16x32_bf16 v[116:119], a[200:203], a[160:163], v[116:119]
    ds_read_b64_tr_b16 a[196:197], v10 offset:24576
    v_mfma_f32_16x16x32_bf16 v[120:123], a[200:203], a[164:167], v[120:123]
    ds_read_b64_tr_b16 a[198:199], v10 offset:25600
    v_mfma_f32_16x16x32_bf16 v[124:127], a[200:203], a[168:171], v[124:127]
    v_mfma_f32_16x16x32_bf16 v[128:131], a[200:203], a[172:175], v[128:131]
    buffer_load_dwordx4 v1, s[16:19], s33 offen offset:2048 sc1 lds
    s_waitcnt lgkmcnt(12)
    v_mfma_f32_16x16x32_bf16 v[132:135], a[204:207], a[160:163], v[132:135]
    ds_read_b64_tr_b16 a[200:201], v11 offset:24576
    v_mfma_f32_16x16x32_bf16 v[136:139], a[204:207], a[164:167], v[136:139]
    ds_read_b64_tr_b16 a[202:203], v11 offset:25600
    v_mfma_f32_16x16x32_bf16 v[140:143], a[204:207], a[168:171], v[140:143]
    buffer_load_dwordx4 a[144:147], v5, s[12:15], s31 offen sc1
    buffer_load_dwordx4 v1, s[16:19], s33 offen offset:3072 sc1 lds
    v_mfma_f32_16x16x32_bf16 v[144:147], a[204:207], a[172:175], v[144:147]
    s_waitcnt lgkmcnt(12)
    v_mfma_f32_16x16x32_bf16 v[148:151], a[208:211], a[160:163], v[148:151]
    ds_read_b64_tr_b16 a[204:205], v12 offset:24576
    v_mfma_f32_16x16x32_bf16 v[152:155], a[208:211], a[164:167], v[152:155]
    ds_read_b64_tr_b16 a[206:207], v12 offset:25600
    v_mfma_f32_16x16x32_bf16 v[156:159], a[208:211], a[168:171], v[156:159]
    v_mfma_f32_16x16x32_bf16 v[160:163], a[208:211], a[172:175], v[160:163]
    buffer_load_dwordx4 a[148:151], v6, s[12:15], s31 offen sc1
    s_waitcnt lgkmcnt(12)
    v_mfma_f32_16x16x32_bf16 v[164:167], a[212:215], a[160:163], v[164:167]
    ds_read_b64_tr_b16 a[208:209], v13 offset:24576
    v_mfma_f32_16x16x32_bf16 v[168:171], a[212:215], a[164:167], v[168:171]
    ds_read_b64_tr_b16 a[210:211], v13 offset:25600
    v_mfma_f32_16x16x32_bf16 v[172:175], a[212:215], a[168:171], v[172:175]
    v_mfma_f32_16x16x32_bf16 v[176:179], a[212:215], a[172:175], v[176:179]
    buffer_load_dwordx4 a[152:155], v7, s[12:15], s31 offen sc1
    s_waitcnt lgkmcnt(12)
    v_mfma_f32_16x16x32_bf16 v[180:183], a[216:219], a[160:163], v[180:183]
    ds_read_b64_tr_b16 a[212:213], v14 offset:24576
    v_mfma_f32_16x16x32_bf16 v[184:187], a[216:219], a[164:167], v[184:187]
    ds_read_b64_tr_b16 a[214:215], v14 offset:25600
    v_mfma_f32_16x16x32_bf16 v[188:191], a[216:219], a[168:171], v[188:191]
    v_mfma_f32_16x16x32_bf16 v[192:195], a[216:219], a[172:175], v[192:195]
    s_waitcnt lgkmcnt(12)
    v_mfma_f32_16x16x32_bf16 v[196:199], a[220:223], a[160:163], v[196:199]
    ds_read_b64_tr_b16 a[216:217], v15 offset:24576
    v_mfma_f32_16x16x32_bf16 v[200:203], a[220:223], a[164:167], v[200:203]
    ds_read_b64_tr_b16 a[218:219], v15 offset:25600
    v_mfma_f32_16x16x32_bf16 v[204:207], a[220:223], a[168:171], v[204:207]
    buffer_load_dwordx4 a[156:159], v8, s[12:15], s31 offen sc1
    v_mfma_f32_16x16x32_bf16 v[208:211], a[220:223], a[172:175], v[208:211]
    s_add_u32 s31, s31, 1024
    s_waitcnt vmcnt(14)
    s_barrier
    s_waitcnt lgkmcnt(12)
    v_mfma_f32_16x16x32_bf16 v[84:87], a[192:195], a[176:179], v[84:87]
    ds_read_b64_tr_b16 a[220:221], v16 offset:24576
    v_mfma_f32_16x16x32_bf16 v[88:91], a[192:195], a[180:183], v[88:91]
    ds_read_b64_tr_b16 a[222:223], v16 offset:25600
    v_mfma_f32_16x16x32_bf16 v[92:95], a[192:195], a[184:187], v[92:95]
    s_add_u32 m0, s36, 4096
    s_add_u32 s38, s33, 4096
    v_mfma_f32_16x16x32_bf16 v[96:99], a[192:195], a[188:191], v[96:99]
    buffer_load_dwordx4 v1, s[16:19], s38 offen offset:0 sc1 lds
    s_waitcnt lgkmcnt(12)
    v_mfma_f32_16x16x32_bf16 v[100:103], a[196:199], a[176:179], v[100:103]
    ds_read_b64_tr_b16 a[192:193], v9 offset:32768
    v_mfma_f32_16x16x32_bf16 v[104:107], a[196:199], a[180:183], v[104:107]
    ds_read_b64_tr_b16 a[194:195], v9 offset:33792
    v_mfma_f32_16x16x32_bf16 v[108:111], a[196:199], a[184:187], v[108:111]
    v_mfma_f32_16x16x32_bf16 v[112:115], a[196:199], a[188:191], v[112:115]
    buffer_load_dwordx4 v1, s[16:19], s38 offen offset:1024 sc1 lds
    s_waitcnt lgkmcnt(12)
    v_mfma_f32_16x16x32_bf16 v[116:119], a[200:203], a[176:179], v[116:119]
    ds_read_b64_tr_b16 a[196:197], v10 offset:32768
    v_mfma_f32_16x16x32_bf16 v[120:123], a[200:203], a[180:183], v[120:123]
    ds_read_b64_tr_b16 a[198:199], v10 offset:33792
    v_mfma_f32_16x16x32_bf16 v[124:127], a[200:203], a[184:187], v[124:127]
    v_mfma_f32_16x16x32_bf16 v[128:131], a[200:203], a[188:191], v[128:131]
    buffer_load_dwordx4 v1, s[16:19], s38 offen offset:2048 sc1 lds
    s_waitcnt lgkmcnt(12)
    v_mfma_f32_16x16x32_bf16 v[132:135], a[204:207], a[176:179], v[132:135]
    ds_read_b64_tr_b16 a[200:201], v11 offset:32768
    v_mfma_f32_16x16x32_bf16 v[136:139], a[204:207], a[180:183], v[136:139]
    ds_read_b64_tr_b16 a[202:203], v11 offset:33792
    v_mfma_f32_16x16x32_bf16 v[140:143], a[204:207], a[184:187], v[140:143]
    buffer_load_dwordx4 a[160:163], v5, s[12:15], s31 offen sc1
    buffer_load_dwordx4 v1, s[16:19], s38 offen offset:3072 sc1 lds
    v_mfma_f32_16x16x32_bf16 v[144:147], a[204:207], a[188:191], v[144:147]
    s_waitcnt lgkmcnt(12)
    v_mfma_f32_16x16x32_bf16 v[148:151], a[208:211], a[176:179], v[148:151]
    ds_read_b64_tr_b16 a[204:205], v12 offset:32768
    v_mfma_f32_16x16x32_bf16 v[152:155], a[208:211], a[180:183], v[152:155]
    ds_read_b64_tr_b16 a[206:207], v12 offset:33792
    v_mfma_f32_16x16x32_bf16 v[156:159], a[208:211], a[184:187], v[156:159]
    s_add_u32 s33, s33, 32768
    v_mfma_f32_16x16x32_bf16 v[160:163], a[208:211], a[188:191], v[160:163]
    buffer_load_dwordx4 a[164:167], v6, s[12:15], s31 offen sc1
    s_waitcnt lgkmcnt(12)
    v_mfma_f32_16x16x32_bf16 v[164:167], a[212:215], a[176:179], v[164:167]
    ds_read_b64_tr_b16 a[208:209], v13 offset:32768
    v_mfma_f32_16x16x32_bf16 v[168:171], a[212:215], a[180:183], v[168:171]
    ds_read_b64_tr_b16 a[210:211], v13 offset:33792
    v_mfma_f32_16x16x32_bf16 v[172:175], a[212:215], a[184:187], v[172:175]
    v_mfma_f32_16x16x32_bf16 v[176:179], a[212:215], a[188:191], v[176:179]
    buffer_load_dwordx4 a[168:171], v7, s[12:15], s31 offen sc1
    s_waitcnt lgkmcnt(12)
    v_mfma_f32_16x16x32_bf16 v[180:183], a[216:219], a[176:179], v[180:183]
    ds_read_b64_tr_b16 a[212:213], v14 offset:32768
    v_mfma_f32_16x16x32_bf16 v[184:187], a[216:219], a[180:183], v[184:187]
    ds_read_b64_tr_b16 a[214:215], v14 offset:33792
    v_mfma_f32_16x16x32_bf16 v[188:191], a[216:219], a[184:187], v[188:191]
    v_mfma_f32_16x16x32_bf16 v[192:195], a[216:219], a[188:191], v[192:195]
    s_waitcnt lgkmcnt(12)
    v_mfma_f32_16x16x32_bf16 v[196:199], a[220:223], a[176:179], v[196:199]
    ds_read_b64_tr_b16 a[216:217], v15 offset:32768
    v_mfma_f32_16x16x32_bf16 v[200:203], a[220:223], a[180:183], v[200:203]
    ds_read_b64_tr_b16 a[218:219], v15 offset:33792
    v_mfma_f32_16x16x32_bf16 v[204:207], a[220:223], a[184:187], v[204:207]
    buffer_load_dwordx4 a[172:175], v8, s[12:15], s31 offen sc1
    v_mfma_f32_16x16x32_bf16 v[208:211], a[220:223], a[188:191], v[208:211]
    s_add_u32 s31, s31, 1024
    s_waitcnt vmcnt(16)
    s_waitcnt lgkmcnt(12)
    v_mfma_f32_16x16x32_bf16 v[84:87], a[192:195], a[128:131], v[84:87]
    ds_read_b64_tr_b16 a[220:221], v16 offset:32768
    v_mfma_f32_16x16x32_bf16 v[88:91], a[192:195], a[132:135], v[88:91]
    ds_read_b64_tr_b16 a[222:223], v16 offset:33792
    v_mfma_f32_16x16x32_bf16 v[92:95], a[192:195], a[136:139], v[92:95]
    s_add_u32 m0, s36, 32768
    v_mfma_f32_16x16x32_bf16 v[96:99], a[192:195], a[140:143], v[96:99]
    buffer_load_dwordx4 v1, s[16:19], s34 offen offset:0 sc1 lds
    s_waitcnt lgkmcnt(12)
    v_mfma_f32_16x16x32_bf16 v[100:103], a[196:199], a[128:131], v[100:103]
    ds_read_b64_tr_b16 a[192:193], v9 offset:40960
    v_mfma_f32_16x16x32_bf16 v[104:107], a[196:199], a[132:135], v[104:107]
    ds_read_b64_tr_b16 a[194:195], v9 offset:41984
    v_mfma_f32_16x16x32_bf16 v[108:111], a[196:199], a[136:139], v[108:111]
    v_mfma_f32_16x16x32_bf16 v[112:115], a[196:199], a[140:143], v[112:115]
    buffer_load_dwordx4 v1, s[16:19], s34 offen offset:1024 sc1 lds
    s_waitcnt lgkmcnt(12)
    v_mfma_f32_16x16x32_bf16 v[116:119], a[200:203], a[128:131], v[116:119]
    ds_read_b64_tr_b16 a[196:197], v10 offset:40960
    v_mfma_f32_16x16x32_bf16 v[120:123], a[200:203], a[132:135], v[120:123]
    ds_read_b64_tr_b16 a[198:199], v10 offset:41984
    v_mfma_f32_16x16x32_bf16 v[124:127], a[200:203], a[136:139], v[124:127]
    v_mfma_f32_16x16x32_bf16 v[128:131], a[200:203], a[140:143], v[128:131]
    buffer_load_dwordx4 v1, s[16:19], s34 offen offset:2048 sc1 lds
    s_waitcnt lgkmcnt(12)
    v_mfma_f32_16x16x32_bf16 v[132:135], a[204:207], a[128:131], v[132:135]
    ds_read_b64_tr_b16 a[200:201], v11 offset:40960
    v_mfma_f32_16x16x32_bf16 v[136:139], a[204:207], a[132:135], v[136:139]
    ds_read_b64_tr_b16 a[202:203], v11 offset:41984
    v_mfma_f32_16x16x32_bf16 v[140:143], a[204:207], a[136:139], v[140:143]
    buffer_load_dwordx4 a[176:179], v5, s[12:15], s31 offen sc1
    buffer_load_dwordx4 v1, s[16:19], s34 offen offset:3072 sc1 lds
    v_mfma_f32_16x16x32_bf16 v[144:147], a[204:207], a[140:143], v[144:147]
    s_waitcnt lgkmcnt(12)
    v_mfma_f32_16x16x32_bf16 v[148:151], a[208:211], a[128:131], v[148:151]
    ds_read_b64_tr_b16 a[204:205], v12 offset:40960
    v_mfma_f32_16x16x32_bf16 v[152:155], a[208:211], a[132:135], v[152:155]
    ds_read_b64_tr_b16 a[206:207], v12 offset:41984
    v_mfma_f32_16x16x32_bf16 v[156:159], a[208:211], a[136:139], v[156:159]
    v_mfma_f32_16x16x32_bf16 v[160:163], a[208:211], a[140:143], v[160:163]
    buffer_load_dwordx4 a[180:183], v6, s[12:15], s31 offen sc1
    s_waitcnt lgkmcnt(12)
    v_mfma_f32_16x16x32_bf16 v[164:167], a[212:215], a[128:131], v[164:167]
    ds_read_b64_tr_b16 a[208:209], v13 offset:40960
    v_mfma_f32_16x16x32_bf16 v[168:171], a[212:215], a[132:135], v[168:171]
    ds_read_b64_tr_b16 a[210:211], v13 offset:41984
    v_mfma_f32_16x16x32_bf16 v[172:175], a[212:215], a[136:139], v[172:175]
    v_mfma_f32_16x16x32_bf16 v[176:179], a[212:215], a[140:143], v[176:179]
    buffer_load_dwordx4 a[184:187], v7, s[12:15], s31 offen sc1
    s_waitcnt lgkmcnt(12)
    v_mfma_f32_16x16x32_bf16 v[180:183], a[216:219], a[128:131], v[180:183]
    ds_read_b64_tr_b16 a[212:213], v14 offset:40960
    v_mfma_f32_16x16x32_bf16 v[184:187], a[216:219], a[132:135], v[184:187]
    ds_read_b64_tr_b16 a[214:215], v14 offset:41984
    v_mfma_f32_16x16x32_bf16 v[188:191], a[216:219], a[136:139], v[188:191]
    v_mfma_f32_16x16x32_bf16 v[192:195], a[216:219], a[140:143], v[192:195]
    s_waitcnt lgkmcnt(12)
    v_mfma_f32_16x16x32_bf16 v[196:199], a[220:223], a[128:131], v[196:199]
    ds_read_b64_tr_b16 a[216:217], v15 offset:40960
    v_mfma_f32_16x16x32_bf16 v[200:203], a[220:223], a[132:135], v[200:203]
    ds_read_b64_tr_b16 a[218:219], v15 offset:41984
    v_mfma_f32_16x16x32_bf16 v[204:207], a[220:223], a[136:139], v[204:207]
    buffer_load_dwordx4 a[188:191], v8, s[12:15], s31 offen sc1
    v_mfma_f32_16x16x32_bf16 v[208:211], a[220:223], a[140:143], v[208:211]
    s_add_u32 s31, s31, 1024
    s_waitcnt vmcnt(16)
    s_barrier
    s_waitcnt lgkmcnt(12)
    v_mfma_f32_16x16x32_bf16 v[84:87], a[192:195], a[144:147], v[84:87]
    ds_read_b64_tr_b16 a[220:221], v16 offset:40960
    v_mfma_f32_16x16x32_bf16 v[88:91], a[192:195], a[148:151], v[88:91]
    ds_read_b64_tr_b16 a[222:223], v16 offset:41984
    v_mfma_f32_16x16x32_bf16 v[92:95], a[192:195], a[152:155], v[92:95]
    s_add_u32 m0, s36, 36864
    s_add_u32 s38, s34, 4096
    v_mfma_f32_16x16x32_bf16 v[96:99], a[192:195], a[156:159], v[96:99]
    buffer_load_dwordx4 v1, s[16:19], s38 offen offset:0 sc1 lds
    s_waitcnt lgkmcnt(12)
    v_mfma_f32_16x16x32_bf16 v[100:103], a[196:199], a[144:147], v[100:103]
    ds_read_b64_tr_b16 a[192:193], v9 offset:49152
    v_mfma_f32_16x16x32_bf16 v[104:107], a[196:199], a[148:151], v[104:107]
    ds_read_b64_tr_b16 a[194:195], v9 offset:50176
    v_mfma_f32_16x16x32_bf16 v[108:111], a[196:199], a[152:155], v[108:111]
    v_mfma_f32_16x16x32_bf16 v[112:115], a[196:199], a[156:159], v[112:115]
    buffer_load_dwordx4 v1, s[16:19], s38 offen offset:1024 sc1 lds
    s_waitcnt lgkmcnt(12)
    v_mfma_f32_16x16x32_bf16 v[116:119], a[200:203], a[144:147], v[116:119]
    ds_read_b64_tr_b16 a[196:197], v10 offset:49152
    v_mfma_f32_16x16x32_bf16 v[120:123], a[200:203], a[148:151], v[120:123]
    ds_read_b64_tr_b16 a[198:199], v10 offset:50176
    v_mfma_f32_16x16x32_bf16 v[124:127], a[200:203], a[152:155], v[124:127]
    v_mfma_f32_16x16x32_bf16 v[128:131], a[200:203], a[156:159], v[128:131]
    buffer_load_dwordx4 v1, s[16:19], s38 offen offset:2048 sc1 lds
    s_waitcnt lgkmcnt(12)
    v_mfma_f32_16x16x32_bf16 v[132:135], a[204:207], a[144:147], v[132:135]
    ds_read_b64_tr_b16 a[200:201], v11 offset:49152
    v_mfma_f32_16x16x32_bf16 v[136:139], a[204:207], a[148:151], v[136:139]
    ds_read_b64_tr_b16 a[202:203], v11 offset:50176
    v_mfma_f32_16x16x32_bf16 v[140:143], a[204:207], a[152:155], v[140:143]
    buffer_load_dwordx4 v1, s[16:19], s38 offen offset:3072 sc1 lds
    v_mfma_f32_16x16x32_bf16 v[144:147], a[204:207], a[156:159], v[144:147]
    s_waitcnt lgkmcnt(12)
    v_mfma_f32_16x16x32_bf16 v[148:151], a[208:211], a[144:147], v[148:151]
    ds_read_b64_tr_b16 a[204:205], v12 offset:49152
    v_mfma_f32_16x16x32_bf16 v[152:155], a[208:211], a[148:151], v[152:155]
    ds_read_b64_tr_b16 a[206:207], v12 offset:50176
    v_mfma_f32_16x16x32_bf16 v[156:159], a[208:211], a[152:155], v[156:159]
    s_add_u32 s34, s34, 32768
    v_mfma_f32_16x16x32_bf16 v[160:163], a[208:211], a[156:159], v[160:163]
    s_waitcnt lgkmcnt(12)
    v_mfma_f32_16x16x32_bf16 v[164:167], a[212:215], a[144:147], v[164:167]
    ds_read_b64_tr_b16 a[208:209], v13 offset:49152
    v_mfma_f32_16x16x32_bf16 v[168:171], a[212:215], a[148:151], v[168:171]
    ds_read_b64_tr_b16 a[210:211], v13 offset:50176
    v_mfma_f32_16x16x32_bf16 v[172:175], a[212:215], a[152:155], v[172:175]
    v_mfma_f32_16x16x32_bf16 v[176:179], a[212:215], a[156:159], v[176:179]
    s_waitcnt lgkmcnt(12)
    v_mfma_f32_16x16x32_bf16 v[180:183], a[216:219], a[144:147], v[180:183]
    ds_read_b64_tr_b16 a[212:213], v14 offset:49152
    v_mfma_f32_16x16x32_bf16 v[184:187], a[216:219], a[148:151], v[184:187]
    ds_read_b64_tr_b16 a[214:215], v14 offset:50176
    v_mfma_f32_16x16x32_bf16 v[188:191], a[216:219], a[152:155], v[188:191]
    v_mfma_f32_16x16x32_bf16 v[192:195], a[216:219], a[156:159], v[192:195]
    s_waitcnt lgkmcnt(12)
    v_mfma_f32_16x16x32_bf16 v[196:199], a[220:223], a[144:147], v[196:199]
    ds_read_b64_tr_b16 a[216:217], v15 offset:49152
    v_mfma_f32_16x16x32_bf16 v[200:203], a[220:223], a[148:151], v[200:203]
    ds_read_b64_tr_b16 a[218:219], v15 offset:50176
    v_mfma_f32_16x16x32_bf16 v[204:207], a[220:223], a[152:155], v[204:207]
    v_mfma_f32_16x16x32_bf16 v[208:211], a[220:223], a[156:159], v[208:211]
    s_waitcnt vmcnt(12)
    s_waitcnt lgkmcnt(12)
    v_mfma_f32_16x16x32_bf16 v[84:87], a[192:195], a[160:163], v[84:87]
    ds_read_b64_tr_b16 a[220:221], v16 offset:49152
    v_mfma_f32_16x16x32_bf16 v[88:91], a[192:195], a[164:167], v[88:91]
    ds_read_b64_tr_b16 a[222:223], v16 offset:50176
    v_mfma_f32_16x16x32_bf16 v[92:95], a[192:195], a[168:171], v[92:95]
    v_mfma_f32_16x16x32_bf16 v[96:99], a[192:195], a[172:175], v[96:99]
    s_waitcnt lgkmcnt(12)
    v_mfma_f32_16x16x32_bf16 v[100:103], a[196:199], a[160:163], v[100:103]
    ds_read_b64_tr_b16 a[192:193], v9 offset:57344
    v_mfma_f32_16x16x32_bf16 v[104:107], a[196:199], a[164:167], v[104:107]
    ds_read_b64_tr_b16 a[194:195], v9 offset:58368
    v_mfma_f32_16x16x32_bf16 v[108:111], a[196:199], a[168:171], v[108:111]
    v_mfma_f32_16x16x32_bf16 v[112:115], a[196:199], a[172:175], v[112:115]
    s_waitcnt lgkmcnt(12)
    v_mfma_f32_16x16x32_bf16 v[116:119], a[200:203], a[160:163], v[116:119]
    ds_read_b64_tr_b16 a[196:197], v10 offset:57344
    v_mfma_f32_16x16x32_bf16 v[120:123], a[200:203], a[164:167], v[120:123]
    ds_read_b64_tr_b16 a[198:199], v10 offset:58368
    v_mfma_f32_16x16x32_bf16 v[124:127], a[200:203], a[168:171], v[124:127]
    v_mfma_f32_16x16x32_bf16 v[128:131], a[200:203], a[172:175], v[128:131]
    s_waitcnt lgkmcnt(12)
    v_mfma_f32_16x16x32_bf16 v[132:135], a[204:207], a[160:163], v[132:135]
    ds_read_b64_tr_b16 a[200:201], v11 offset:57344
    v_mfma_f32_16x16x32_bf16 v[136:139], a[204:207], a[164:167], v[136:139]
    ds_read_b64_tr_b16 a[202:203], v11 offset:58368
    v_mfma_f32_16x16x32_bf16 v[140:143], a[204:207], a[168:171], v[140:143]
    v_mfma_f32_16x16x32_bf16 v[144:147], a[204:207], a[172:175], v[144:147]
    s_waitcnt lgkmcnt(12)
    v_mfma_f32_16x16x32_bf16 v[148:151], a[208:211], a[160:163], v[148:151]
    ds_read_b64_tr_b16 a[204:205], v12 offset:57344
    v_mfma_f32_16x16x32_bf16 v[152:155], a[208:211], a[164:167], v[152:155]
    ds_read_b64_tr_b16 a[206:207], v12 offset:58368
    v_mfma_f32_16x16x32_bf16 v[156:159], a[208:211], a[168:171], v[156:159]
    v_mfma_f32_16x16x32_bf16 v[160:163], a[208:211], a[172:175], v[160:163]
    s_waitcnt lgkmcnt(12)
    v_mfma_f32_16x16x32_bf16 v[164:167], a[212:215], a[160:163], v[164:167]
    ds_read_b64_tr_b16 a[208:209], v13 offset:57344
    v_mfma_f32_16x16x32_bf16 v[168:171], a[212:215], a[164:167], v[168:171]
    ds_read_b64_tr_b16 a[210:211], v13 offset:58368
    v_mfma_f32_16x16x32_bf16 v[172:175], a[212:215], a[168:171], v[172:175]
    v_mfma_f32_16x16x32_bf16 v[176:179], a[212:215], a[172:175], v[176:179]
    s_waitcnt lgkmcnt(12)
    v_mfma_f32_16x16x32_bf16 v[180:183], a[216:219], a[160:163], v[180:183]
    ds_read_b64_tr_b16 a[212:213], v14 offset:57344
    v_mfma_f32_16x16x32_bf16 v[184:187], a[216:219], a[164:167], v[184:187]
    ds_read_b64_tr_b16 a[214:215], v14 offset:58368
    v_mfma_f32_16x16x32_bf16 v[188:191], a[216:219], a[168:171], v[188:191]
    v_mfma_f32_16x16x32_bf16 v[192:195], a[216:219], a[172:175], v[192:195]
    s_waitcnt lgkmcnt(12)
    v_mfma_f32_16x16x32_bf16 v[196:199], a[220:223], a[160:163], v[196:199]
    ds_read_b64_tr_b16 a[216:217], v15 offset:57344
    v_mfma_f32_16x16x32_bf16 v[200:203], a[220:223], a[164:167], v[200:203]
    ds_read_b64_tr_b16 a[218:219], v15 offset:58368
    v_mfma_f32_16x16x32_bf16 v[204:207], a[220:223], a[168:171], v[204:207]
    v_mfma_f32_16x16x32_bf16 v[208:211], a[220:223], a[172:175], v[208:211]
    s_waitcnt vmcnt(4)
    s_barrier
    s_waitcnt lgkmcnt(12)
    v_mfma_f32_16x16x32_bf16 v[84:87], a[192:195], a[176:179], v[84:87]
    ds_read_b64_tr_b16 a[220:221], v16 offset:57344
    v_mfma_f32_16x16x32_bf16 v[88:91], a[192:195], a[180:183], v[88:91]
    ds_read_b64_tr_b16 a[222:223], v16 offset:58368
    v_mfma_f32_16x16x32_bf16 v[92:95], a[192:195], a[184:187], v[92:95]
    v_mfma_f32_16x16x32_bf16 v[96:99], a[192:195], a[188:191], v[96:99]
    s_waitcnt lgkmcnt(12)
    v_mfma_f32_16x16x32_bf16 v[100:103], a[196:199], a[176:179], v[100:103]
    v_mfma_f32_16x16x32_bf16 v[104:107], a[196:199], a[180:183], v[104:107]
    v_mfma_f32_16x16x32_bf16 v[108:111], a[196:199], a[184:187], v[108:111]
    v_mfma_f32_16x16x32_bf16 v[112:115], a[196:199], a[188:191], v[112:115]
    s_waitcnt lgkmcnt(10)
    v_mfma_f32_16x16x32_bf16 v[116:119], a[200:203], a[176:179], v[116:119]
    v_mfma_f32_16x16x32_bf16 v[120:123], a[200:203], a[180:183], v[120:123]
    v_mfma_f32_16x16x32_bf16 v[124:127], a[200:203], a[184:187], v[124:127]
    v_mfma_f32_16x16x32_bf16 v[128:131], a[200:203], a[188:191], v[128:131]
    s_waitcnt lgkmcnt(8)
    v_mfma_f32_16x16x32_bf16 v[132:135], a[204:207], a[176:179], v[132:135]
    v_mfma_f32_16x16x32_bf16 v[136:139], a[204:207], a[180:183], v[136:139]
    v_mfma_f32_16x16x32_bf16 v[140:143], a[204:207], a[184:187], v[140:143]
    v_mfma_f32_16x16x32_bf16 v[144:147], a[204:207], a[188:191], v[144:147]
    s_waitcnt lgkmcnt(6)
    v_mfma_f32_16x16x32_bf16 v[148:151], a[208:211], a[176:179], v[148:151]
    v_mfma_f32_16x16x32_bf16 v[152:155], a[208:211], a[180:183], v[152:155]
    v_mfma_f32_16x16x32_bf16 v[156:159], a[208:211], a[184:187], v[156:159]
    v_mfma_f32_16x16x32_bf16 v[160:163], a[208:211], a[188:191], v[160:163]
    s_waitcnt lgkmcnt(4)
    v_mfma_f32_16x16x32_bf16 v[164:167], a[212:215], a[176:179], v[164:167]
    v_mfma_f32_16x16x32_bf16 v[168:171], a[212:215], a[180:183], v[168:171]
    v_mfma_f32_16x16x32_bf16 v[172:175], a[212:215], a[184:187], v[172:175]
    v_mfma_f32_16x16x32_bf16 v[176:179], a[212:215], a[188:191], v[176:179]
    s_waitcnt lgkmcnt(2)
    v_mfma_f32_16x16x32_bf16 v[180:183], a[216:219], a[176:179], v[180:183]
    v_mfma_f32_16x16x32_bf16 v[184:187], a[216:219], a[180:183], v[184:187]
    v_mfma_f32_16x16x32_bf16 v[188:191], a[216:219], a[184:187], v[188:191]
    v_mfma_f32_16x16x32_bf16 v[192:195], a[216:219], a[188:191], v[192:195]
    s_waitcnt lgkmcnt(0)
    v_mfma_f32_16x16x32_bf16 v[196:199], a[220:223], a[176:179], v[196:199]
    v_mfma_f32_16x16x32_bf16 v[200:203], a[220:223], a[180:183], v[200:203]
    v_mfma_f32_16x16x32_bf16 v[204:207], a[220:223], a[184:187], v[204:207]
    v_mfma_f32_16x16x32_bf16 v[208:211], a[220:223], a[188:191], v[208:211]
    s_nop 7
    v_cvt_pk_bf16_f32 v20, v84, v85
    v_cvt_pk_bf16_f32 v21, v86, v87
    v_cvt_pk_bf16_f32 v22, v100, v101
    v_cvt_pk_bf16_f32 v23, v102, v103
    v_cvt_pk_bf16_f32 v24, v116, v117
    v_cvt_pk_bf16_f32 v25, v118, v119
    v_cvt_pk_bf16_f32 v26, v132, v133
    v_cvt_pk_bf16_f32 v27, v134, v135
    v_cvt_pk_bf16_f32 v28, v148, v149
    v_cvt_pk_bf16_f32 v29, v150, v151
    v_cvt_pk_bf16_f32 v30, v164, v165
    v_cvt_pk_bf16_f32 v31, v166, v167
    v_cvt_pk_bf16_f32 v32, v180, v181
    v_cvt_pk_bf16_f32 v33, v182, v183
    v_cvt_pk_bf16_f32 v34, v196, v197
    v_cvt_pk_bf16_f32 v35, v198, v199
    v_cvt_pk_bf16_f32 v36, v88, v89
    v_cvt_pk_bf16_f32 v37, v90, v91
    v_cvt_pk_bf16_f32 v38, v104, v105
    v_cvt_pk_bf16_f32 v39, v106, v107
    v_cvt_pk_bf16_f32 v40, v120, v121
    v_cvt_pk_bf16_f32 v41, v122, v123
    v_cvt_pk_bf16_f32 v42, v136, v137
    v_cvt_pk_bf16_f32 v43, v138, v139
    v_cvt_pk_bf16_f32 v44, v152, v153
    v_cvt_pk_bf16_f32 v45, v154, v155
    v_cvt_pk_bf16_f32 v46, v168, v169
    v_cvt_pk_bf16_f32 v47, v170, v171
    v_cvt_pk_bf16_f32 v48, v184, v185
    v_cvt_pk_bf16_f32 v49, v186, v187
    v_cvt_pk_bf16_f32 v50, v200, v201
    v_cvt_pk_bf16_f32 v51, v202, v203
    v_cvt_pk_bf16_f32 v52, v92, v93
    v_cvt_pk_bf16_f32 v53, v94, v95
    v_cvt_pk_bf16_f32 v54, v108, v109
    v_cvt_pk_bf16_f32 v55, v110, v111
    v_cvt_pk_bf16_f32 v56, v124, v125
    v_cvt_pk_bf16_f32 v57, v126, v127
    v_cvt_pk_bf16_f32 v58, v140, v141
    v_cvt_pk_bf16_f32 v59, v142, v143
    v_cvt_pk_bf16_f32 v60, v156, v157
    v_cvt_pk_bf16_f32 v61, v158, v159
    v_cvt_pk_bf16_f32 v62, v172, v173
    v_cvt_pk_bf16_f32 v63, v174, v175
    v_cvt_pk_bf16_f32 v64, v188, v189
    v_cvt_pk_bf16_f32 v65, v190, v191
    v_cvt_pk_bf16_f32 v66, v204, v205
    v_cvt_pk_bf16_f32 v67, v206, v207
    v_cvt_pk_bf16_f32 v68, v96, v97
    v_cvt_pk_bf16_f32 v69, v98, v99
    v_cvt_pk_bf16_f32 v70, v112, v113
    v_cvt_pk_bf16_f32 v71, v114, v115
    v_cvt_pk_bf16_f32 v72, v128, v129
    v_cvt_pk_bf16_f32 v73, v130, v131
    v_cvt_pk_bf16_f32 v74, v144, v145
    v_cvt_pk_bf16_f32 v75, v146, v147
    v_cvt_pk_bf16_f32 v76, v160, v161
    v_cvt_pk_bf16_f32 v77, v162, v163
    v_cvt_pk_bf16_f32 v78, v176, v177
    v_cvt_pk_bf16_f32 v79, v178, v179
    v_cvt_pk_bf16_f32 v80, v192, v193
    v_cvt_pk_bf16_f32 v81, v194, v195
    v_cvt_pk_bf16_f32 v82, v208, v209
    v_cvt_pk_bf16_f32 v83, v210, v211
    v_lshlrev_b32 v17, 3, v0
    s_mov_b32 s3, 0
L_mega_kernel_restart:
    s_waitcnt vmcnt(0)
    s_barrier
    s_add_u32 m0, s35, 0
    s_nop 0
    buffer_load_dwordx4 v1, s[16:19], s33 offen offset:0 sc1 lds
    buffer_load_dwordx4 v1, s[16:19], s33 offen offset:1024 sc1 lds
    buffer_load_dwordx4 v1, s[16:19], s33 offen offset:2048 sc1 lds
    buffer_load_dwordx4 v1, s[16:19], s33 offen offset:3072 sc1 lds
    s_add_u32 m0, s35, 4096
    s_add_u32 s38, s33, 4096
    s_nop 0
    buffer_load_dwordx4 v1, s[16:19], s38 offen offset:0 sc1 lds
    buffer_load_dwordx4 v1, s[16:19], s38 offen offset:1024 sc1 lds
    buffer_load_dwordx4 v1, s[16:19], s38 offen offset:2048 sc1 lds
    buffer_load_dwordx4 v1, s[16:19], s38 offen offset:3072 sc1 lds
    s_add_u32 s33, s33, 32768
    s_cmp_lg_u32 s3, 0
    s_cbranch_scc1 L_mega_kernel_pf00
    buffer_load_dword v224, v17, s[44:47], s42 offen
    buffer_load_dword v225, v17, s[48:51], s43 offen
    buffer_load_dword v226, v17, s[52:55], s43 offen
    buffer_load_dword v227, v17, s[56:59], s43 offen
    s_add_u32 s42, s42, 524288
    s_add_u32 s43, s43, 458752
L_mega_kernel_pf00:
    ds_read_b128 a[192:195], v2 offset:0
    ds_read_b128 a[196:199], v2 offset:1024
    ds_read_b128 a[200:203], v2 offset:2048
    ds_read_b128 a[204:207], v2 offset:3072
    ds_read_b128 a[208:211], v2 offset:4096
    ds_read_b128 a[212:215], v2 offset:5120
    ds_read_b128 a[216:219], v2 offset:6144
    ds_read_b128 a[220:223], v2 offset:7168
    s_waitcnt lgkmcnt(0)
    v_mfma_f32_16x16x32_bf16 v[84:87], a[192:195], v[20:23], 0
    v_mfma_f32_16x16x32_bf16 v[84:87], a[196:199], v[24:27], v[84:87]
    v_mfma_f32_16x16x32_bf16 v[84:87], a[200:203], v[28:31], v[84:87]
    v_mfma_f32_16x16x32_bf16 v[84:87], a[204:207], v[32:35], v[84:87]
    v_mfma_f32_16x16x32_bf16 v[88:91], a[208:211], v[20:23], 0
    v_mfma_f32_16x16x32_bf16 v[88:91], a[212:215], v[24:27], v[88:91]
    v_mfma_f32_16x16x32_bf16 v[88:91], a[216:219], v[28:31], v[88:91]
    v_mfma_f32_16x16x32_bf16 v[88:91], a[220:223], v[32:35], v[88:91]
    v_mfma_f32_16x16x32_bf16 v[92:95], a[192:195], v[36:39], 0
    v_mfma_f32_16x16x32_bf16 v[92:95], a[196:199], v[40:43], v[92:95]
    v_mfma_f32_16x16x32_bf16 v[92:95], a[200:203], v[44:47], v[92:95]
    v_mfma_f32_16x16x32_bf16 v[92:95], a[204:207], v[48:51], v[92:95]
    v_mfma_f32_16x16x32_bf16 v[96:99], a[208:211], v[36:39], 0
    v_mfma_f32_16x16x32_bf16 v[96:99], a[212:215], v[40:43], v[96:99]
    v_mfma_f32_16x16x32_bf16 v[96:99], a[216:219], v[44:47], v[96:99]
    v_mfma_f32_16x16x32_bf16 v[96:99], a[220:223], v[48:51], v[96:99]
    v_mfma_f32_16x16x32_bf16 v[100:103], a[192:195], v[52:55], 0
    v_mfma_f32_16x16x32_bf16 v[100:103], a[196:199], v[56:59], v[100:103]
    v_mfma_f32_16x16x32_bf16 v[100:103], a[200:203], v[60:63], v[100:103]
    v_mfma_f32_16x16x32_bf16 v[100:103], a[204:207], v[64:67], v[100:103]
    v_mfma_f32_16x16x32_bf16 v[104:107], a[208:211], v[52:55], 0
    v_mfma_f32_16x16x32_bf16 v[104:107], a[212:215], v[56:59], v[104:107]
    v_mfma_f32_16x16x32_bf16 v[104:107], a[216:219], v[60:63], v[104:107]
    v_mfma_f32_16x16x32_bf16 v[104:107], a[220:223], v[64:67], v[104:107]
    v_mfma_f32_16x16x32_bf16 v[108:111], a[192:195], v[68:71], 0
    v_mfma_f32_16x16x32_bf16 v[108:111], a[196:199], v[72:75], v[108:111]
    v_mfma_f32_16x16x32_bf16 v[108:111], a[200:203], v[76:79], v[108:111]
    v_mfma_f32_16x16x32_bf16 v[108:111], a[204:207], v[80:83], v[108:111]
    v_mfma_f32_16x16x32_bf16 v[112:115], a[208:211], v[68:71], 0
    v_mfma_f32_16x16x32_bf16 v[112:115], a[212:215], v[72:75], v[112:115]
    v_mfma_f32_16x16x32_bf16 v[112:115], a[216:219], v[76:79], v[112:115]
    v_mfma_f32_16x16x32_bf16 v[112:115], a[220:223], v[80:83], v[112:115]
    ds_read_b128 a[192:195], v2 offset:8192
    ds_read_b128 a[196:199], v2 offset:9216
    ds_read_b128 a[200:203], v2 offset:10240
    ds_read_b128 a[204:207], v2 offset:11264
    ds_read_b128 a[208:211], v2 offset:12288
    ds_read_b128 a[212:215], v2 offset:13312
    ds_read_b128 a[216:219], v2 offset:14336
    ds_read_b128 a[220:223], v2 offset:15360
    s_nop 7
    v_max3_f32 v180, v84, v85, v86
    v_max3_f32 v183, v92, v93, v94
    v_max3_f32 v186, v100, v101, v102
    v_max3_f32 v189, v108, v109, v110
    v_max3_f32 v180, v180, v87, v88
    v_max3_f32 v183, v183, v95, v96
    v_max3_f32 v186, v186, v103, v104
    v_max3_f32 v189, v189, v111, v112
    v_max3_f32 v180, v180, v89, v90
    v_max3_f32 v183, v183, v97, v98
    v_max3_f32 v186, v186, v105, v106
    v_max3_f32 v189, v189, v113, v114
    v_max_f32 v180, v180, v91
    v_max_f32 v183, v183, v99
    v_max_f32 v186, v186, v107
    v_max_f32 v189, v189, v115
    v_mov_b32 v181, v180
    v_mov_b32 v184, v183
    v_mov_b32 v187, v186
    v_mov_b32 v190, v189
    v_permlane16_swap_b32 v180, v181
    v_permlane16_swap_b32 v183, v184
    v_permlane16_swap_b32 v186, v187
    v_permlane16_swap_b32 v189, v190
    v_max_f32 v180, v180, v181
    v_max_f32 v183, v183, v184
    v_max_f32 v186, v186, v187
    v_max_f32 v189, v189, v190
    v_mov_b32 v181, v180
    v_mov_b32 v184, v183
    v_mov_b32 v187, v186
    v_mov_b32 v190, v189
    v_permlane32_swap_b32 v180, v181
    v_permlane32_swap_b32 v183, v184
    v_permlane32_swap_b32 v186, v187
    v_permlane32_swap_b32 v189, v190
    v_max_f32 v180, v180, v181
    v_max_f32 v183, v183, v184
    v_max_f32 v186, v186, v187
    v_max_f32 v189, v189, v190
    v_ceil_f32 v182, v180
    v_ceil_f32 v185, v183
    v_ceil_f32 v188, v186
    v_ceil_f32 v191, v189
    v_add_f32 v182, 0x41c00000, v182
    v_add_f32 v185, 0x41c00000, v185
    v_add_f32 v188, 0x41c00000, v188
    v_add_f32 v191, 0x41c00000, v191
    v_sub_f32 v84, v84, v182
    v_sub_f32 v85, v85, v182
    v_sub_f32 v86, v86, v182
    v_sub_f32 v87, v87, v182
    v_sub_f32 v88, v88, v182
    v_sub_f32 v89, v89, v182
    v_sub_f32 v90, v90, v182
    v_sub_f32 v91, v91, v182
    v_sub_f32 v156, 0, v182
    v_sub_f32 v157, 0, v182
    v_sub_f32 v158, 0, v182
    v_sub_f32 v159, 0, v182
    v_mov_b32 v176, 0
    v_sub_f32 v92, v92, v185
    v_sub_f32 v93, v93, v185
    v_sub_f32 v94, v94, v185
    v_sub_f32 v95, v95, v185
    v_sub_f32 v96, v96, v185
    v_sub_f32 v97, v97, v185
    v_sub_f32 v98, v98, v185
    v_sub_f32 v99, v99, v185
    v_sub_f32 v160, 0, v185
    v_sub_f32 v161, 0, v185
    v_sub_f32 v162, 0, v185
    v_sub_f32 v163, 0, v185
    v_mov_b32 v177, 0
    v_sub_f32 v100, v100, v188
    v_sub_f32 v101, v101, v188
    v_sub_f32 v102, v102, v188
    v_sub_f32 v103, v103, v188
    v_sub_f32 v104, v104, v188
    v_sub_f32 v105, v105, v188
    v_sub_f32 v106, v106, v188
    v_sub_f32 v107, v107, v188
    v_sub_f32 v164, 0, v188
    v_sub_f32 v165, 0, v188
    v_sub_f32 v166, 0, v188
    v_sub_f32 v167, 0, v188
    v_mov_b32 v178, 0
    v_sub_f32 v108, v108, v191
    v_sub_f32 v109, v109, v191
    v_sub_f32 v110, v110, v191
    v_sub_f32 v111, v111, v191
    v_sub_f32 v112, v112, v191
    v_sub_f32 v113, v113, v191
    v_sub_f32 v114, v114, v191
    v_sub_f32 v115, v115, v191
    v_sub_f32 v168, 0, v191
    v_sub_f32 v169, 0, v191
    v_sub_f32 v170, 0, v191
    v_sub_f32 v171, 0, v191
    v_mov_b32 v179, 0
    v_exp_f32 v148, v84
    v_exp_f32 v149, v85
    v_exp_f32 v150, v86
    v_exp_f32 v151, v87
    v_exp_f32 v152, v88
    v_exp_f32 v153, v89
    v_exp_f32 v154, v90
    v_exp_f32 v155, v91
    s_nop 0
    v_add_f32 v172, v148, v149
    v_cvt_pk_bf16_f32 v116, v148, v149
    v_add_f32 v172, v172, v150
    v_add_f32 v172, v172, v151
    v_cvt_pk_bf16_f32 v117, v150, v151
    v_add_f32 v172, v172, v152
    v_add_f32 v172, v172, v153
    v_cvt_pk_bf16_f32 v118, v152, v153
    v_add_f32 v172, v172, v154
    v_add_f32 v172, v172, v155
    v_cvt_pk_bf16_f32 v119, v154, v155
    v_add_f32 v176, v176, v172
    v_exp_f32 v148, v92
    v_exp_f32 v149, v93
    v_exp_f32 v150, v94
    v_exp_f32 v151, v95
    v_exp_f32 v152, v96
    v_exp_f32 v153, v97
    v_exp_f32 v154, v98
    v_exp_f32 v155, v99
    s_nop 0
    v_add_f32 v173, v148, v149
    v_cvt_pk_bf16_f32 v120, v148, v149
    v_add_f32 v173, v173, v150
    v_add_f32 v173, v173, v151
    v_cvt_pk_bf16_f32 v121, v150, v151
    v_add_f32 v173, v173, v152
    v_add_f32 v173, v173, v153
    v_cvt_pk_bf16_f32 v122, v152, v153
    v_add_f32 v173, v173, v154
    v_add_f32 v173, v173, v155
    v_cvt_pk_bf16_f32 v123, v154, v155
    v_add_f32 v177, v177, v173
    v_exp_f32 v148, v100
    v_exp_f32 v149, v101
    v_exp_f32 v150, v102
    v_exp_f32 v151, v103
    v_exp_f32 v152, v104
    s_nop 0
    v_add_f32 v174, v148, v149
    v_cvt_pk_bf16_f32 v124, v148, v149
    v_add_f32 v174, v174, v150
    v_add_f32 v174, v174, v151
    v_cvt_pk_bf16_f32 v125, v150, v151
    v_add_f32 v174, v174, v152
    s_waitcnt lgkmcnt(0)
    s_cmp_lg_u32 s3, 0
    s_cbranch_scc1 L_mega_kernel_checked
    s_mov_b32 s32, 15
.p2align 6
L_mega_kernel_main:
    v_mfma_f32_16x16x32_bf16 v[84:87], a[192:195], v[20:23], v[156:159]
    v_exp_f32 v153, v105
    v_mfma_f32_16x16x32_bf16 v[84:87], a[196:199], v[24:27], v[84:87]
    v_add_f32 v174, v174, v153
    v_cvt_pk_bf16_f32 v126, v152, v153
    v_mfma_f32_16x16x32_bf16 v[84:87], a[200:203], v[28:31], v[84:87]
    v_exp_f32 v154, v106
    v_mfma_f32_16x16x32_bf16 v[84:87], a[204:207], v[32:35], v[84:87]
    ds_read_b128 a[224:227], v2 offset:40960
    v_add_f32 v174, v174, v154
    v_mfma_f32_16x16x32_bf16 v[88:91], a[208:211], v[20:23], v[156:159]
    v_exp_f32 v155, v107
    v_mfma_f32_16x16x32_bf16 v[88:91], a[212:215], v[24:27], v[88:91]
    ds_read_b128 a[228:231], v2 offset:41984
    v_add_f32 v174, v174, v155
    v_mfma_f32_16x16x32_bf16 v[88:91], a[216:219], v[28:31], v[88:91]
    s_waitcnt lgkmcnt(2)
    v_exp_f32 v148, v108
    v_mfma_f32_16x16x32_bf16 v[88:91], a[220:223], v[32:35], v[88:91]
    s_add_u32 m0, s35, 32768
    v_cvt_pk_bf16_f32 v127, v154, v155
    v_add_f32 v178, v178, v174
    v_mfma_f32_16x16x32_bf16 v[92:95], a[192:195], v[36:39], v[160:163]
    buffer_load_dwordx4 v1, s[16:19], s34 offen offset:0 sc1 lds
    v_exp_f32 v149, v109
    v_mfma_f32_16x16x32_bf16 v[92:95], a[196:199], v[40:43], v[92:95]
    v_add_f32 v175, v148, v149
    v_cvt_pk_bf16_f32 v128, v148, v149
    v_mfma_f32_16x16x32_bf16 v[92:95], a[200:203], v[44:47], v[92:95]
    v_exp_f32 v150, v110
    v_mfma_f32_16x16x32_bf16 v[92:95], a[204:207], v[48:51], v[92:95]
    ds_read_b128 a[232:235], v2 offset:43008
    v_add_f32 v175, v175, v150
    v_mfma_f32_16x16x32_bf16 v[96:99], a[208:211], v[36:39], v[160:163]
    buffer_load_dword v214, v17, s[52:55], s43 offen
    v_exp_f32 v151, v111
    v_mfma_f32_16x16x32_bf16 v[96:99], a[212:215], v[40:43], v[96:99]
    v_add_f32 v175, v175, v151
    v_cvt_pk_bf16_f32 v129, v150, v151
    v_mfma_f32_16x16x32_bf16 v[96:99], a[216:219], v[44:47], v[96:99]
    v_exp_f32 v152, v112
    v_mfma_f32_16x16x32_bf16 v[96:99], a[220:223], v[48:51], v[96:99]
    ds_read_b128 a[236:239], v2 offset:44032
    v_add_f32 v175, v175, v152
    v_mfma_f32_16x16x32_bf16 v[100:103], a[192:195], v[52:55], v[164:167]
    v_exp_f32 v153, v113
    v_mfma_f32_16x16x32_bf16 v[100:103], a[196:199], v[56:59], v[100:103]
    v_add_f32 v175, v175, v153
    v_cvt_pk_bf16_f32 v130, v152, v153
    v_mfma_f32_16x16x32_bf16 v[100:103], a[200:203], v[60:63], v[100:103]
    v_exp_f32 v154, v114
    v_mfma_f32_16x16x32_bf16 v[100:103], a[204:207], v[64:67], v[100:103]
    ds_read_b128 a[240:243], v2 offset:45056
    v_add_f32 v175, v175, v154
    v_mfma_f32_16x16x32_bf16 v[104:107], a[208:211], v[52:55], v[164:167]
    v_exp_f32 v155, v115
    v_mfma_f32_16x16x32_bf16 v[104:107], a[212:215], v[56:59], v[104:107]
    ds_read_b128 a[244:247], v2 offset:46080
    v_add_f32 v175, v175, v155
    v_mfma_f32_16x16x32_bf16 v[104:107], a[216:219], v[60:63], v[104:107]
    v_exp_f32 v148, v84
    v_mfma_f32_16x16x32_bf16 v[104:107], a[220:223], v[64:67], v[104:107]
    v_cvt_pk_bf16_f32 v131, v154, v155
    v_add_f32 v179, v179, v175
    v_mfma_f32_16x16x32_bf16 v[108:111], a[192:195], v[68:71], v[168:171]
    buffer_load_dwordx4 v1, s[16:19], s34 offen offset:1024 sc1 lds
    v_exp_f32 v149, v85
    v_mfma_f32_16x16x32_bf16 v[108:111], a[196:199], v[72:75], v[108:111]
    v_add_f32 v172, v148, v149
    v_cvt_pk_bf16_f32 v132, v148, v149
    v_mfma_f32_16x16x32_bf16 v[108:111], a[200:203], v[76:79], v[108:111]
    v_exp_f32 v150, v86
    v_mfma_f32_16x16x32_bf16 v[108:111], a[204:207], v[80:83], v[108:111]
    ds_read_b128 a[248:251], v2 offset:47104
    v_add_f32 v172, v172, v150
    v_mfma_f32_16x16x32_bf16 v[112:115], a[208:211], v[68:71], v[168:171]
    v_exp_f32 v151, v87
    v_mfma_f32_16x16x32_bf16 v[112:115], a[212:215], v[72:75], v[112:115]
    v_add_f32 v172, v172, v151
    v_cvt_pk_bf16_f32 v133, v150, v151
    v_mfma_f32_16x16x32_bf16 v[112:115], a[216:219], v[76:79], v[112:115]
    v_exp_f32 v152, v88
    v_mfma_f32_16x16x32_bf16 v[112:115], a[220:223], v[80:83], v[112:115]
    s_waitcnt lgkmcnt(0)
    ds_read_b128 a[252:255], v2 offset:48128
    v_add_f32 v172, v172, v152
    v_mfma_f32_16x16x32_bf16 a[0:3], a[224:227], v[116:119], a[0:3]
    v_exp_f32 v153, v89
    v_mfma_f32_16x16x32_bf16 a[4:7], a[228:231], v[116:119], a[4:7]
    v_add_f32 v172, v172, v153
    v_cvt_pk_bf16_f32 v134, v152, v153
    v_mfma_f32_16x16x32_bf16 a[8:11], a[232:235], v[116:119], a[8:11]
    v_exp_f32 v154, v90
    v_mfma_f32_16x16x32_bf16 a[12:15], a[236:239], v[116:119], a[12:15]
    ds_read_b128 a[192:195], v2 offset:16384
    v_add_f32 v172, v172, v154
    v_mfma_f32_16x16x32_bf16 a[16:19], a[240:243], v[116:119], a[16:19]
    v_exp_f32 v155, v91
    v_mfma_f32_16x16x32_bf16 a[20:23], a[244:247], v[116:119], a[20:23]
    ds_read_b128 a[196:199], v2 offset:17408
    v_add_f32 v172, v172, v155
    v_mfma_f32_16x16x32_bf16 a[24:27], a[248:251], v[116:119], a[24:27]
    s_waitcnt lgkmcnt(2)
    v_exp_f32 v148, v92
    v_mfma_f32_16x16x32_bf16 a[28:31], a[252:255], v[116:119], a[28:31]
    v_cvt_pk_bf16_f32 v135, v154, v155
    v_add_f32 v176, v176, v172
    v_mfma_f32_16x16x32_bf16 a[32:35], a[224:227], v[120:123], a[32:35]
    buffer_load_dwordx4 v1, s[16:19], s34 offen offset:2048 sc1 lds
    v_exp_f32 v149, v93
    v_mfma_f32_16x16x32_bf16 a[36:39], a[228:231], v[120:123], a[36:39]
    v_add_f32 v173, v148, v149
    v_cvt_pk_bf16_f32 v136, v148, v149
    v_mfma_f32_16x16x32_bf16 a[40:43], a[232:235], v[120:123], a[40:43]
    v_exp_f32 v150, v94
    v_mfma_f32_16x16x32_bf16 a[44:47], a[236:239], v[120:123], a[44:47]
    ds_read_b128 a[200:203], v2 offset:18432
    v_add_f32 v173, v173, v150
    v_mfma_f32_16x16x32_bf16 a[48:51], a[240:243], v[120:123], a[48:51]
    buffer_load_dword v215, v17, s[56:59], s43 offen
    v_exp_f32 v151, v95
    v_mfma_f32_16x16x32_bf16 a[52:55], a[244:247], v[120:123], a[52:55]
    s_add_u32 s43, s43, 458752
    v_add_f32 v173, v173, v151
    v_cvt_pk_bf16_f32 v137, v150, v151
    v_mfma_f32_16x16x32_bf16 a[56:59], a[248:251], v[120:123], a[56:59]
    v_exp_f32 v152, v96
    v_mfma_f32_16x16x32_bf16 a[60:63], a[252:255], v[120:123], a[60:63]
    ds_read_b128 a[204:207], v2 offset:19456
    v_add_f32 v173, v173, v152
    v_mfma_f32_16x16x32_bf16 a[64:67], a[224:227], v[124:127], a[64:67]
    v_exp_f32 v153, v97
    v_mfma_f32_16x16x32_bf16 a[68:71], a[228:231], v[124:127], a[68:71]
    v_add_f32 v173, v173, v153
    v_cvt_pk_bf16_f32 v138, v152, v153
    v_mfma_f32_16x16x32_bf16 a[72:75], a[232:235], v[124:127], a[72:75]
    v_exp_f32 v154, v98
    v_mfma_f32_16x16x32_bf16 a[76:79], a[236:239], v[124:127], a[76:79]
    ds_read_b128 a[208:211], v2 offset:20480
    v_add_f32 v173, v173, v154
    v_mfma_f32_16x16x32_bf16 a[80:83], a[240:243], v[124:127], a[80:83]
    v_exp_f32 v155, v99
    v_mfma_f32_16x16x32_bf16 a[84:87], a[244:247], v[124:127], a[84:87]
    ds_read_b128 a[212:215], v2 offset:21504
    v_add_f32 v173, v173, v155
    v_mfma_f32_16x16x32_bf16 a[88:91], a[248:251], v[124:127], a[88:91]
    v_exp_f32 v148, v100
    v_mfma_f32_16x16x32_bf16 a[92:95], a[252:255], v[124:127], a[92:95]
    v_cvt_pk_bf16_f32 v139, v154, v155
    v_add_f32 v177, v177, v173
    v_mfma_f32_16x16x32_bf16 a[96:99], a[224:227], v[128:131], a[96:99]
    buffer_load_dwordx4 v1, s[16:19], s34 offen offset:3072 sc1 lds
    v_exp_f32 v149, v101
    v_mfma_f32_16x16x32_bf16 a[100:103], a[228:231], v[128:131], a[100:103]
    v_add_f32 v174, v148, v149
    v_cvt_pk_bf16_f32 v140, v148, v149
    v_mfma_f32_16x16x32_bf16 a[104:107], a[232:235], v[128:131], a[104:107]
    v_exp_f32 v150, v102
    v_mfma_f32_16x16x32_bf16 a[108:111], a[236:239], v[128:131], a[108:111]
    ds_read_b128 a[216:219], v2 offset:22528
    v_add_f32 v174, v174, v150
    v_mfma_f32_16x16x32_bf16 a[112:115], a[240:243], v[128:131], a[112:115]
    v_exp_f32 v151, v103
    v_mfma_f32_16x16x32_bf16 a[116:119], a[244:247], v[128:131], a[116:119]
    v_add_f32 v174, v174, v151
    v_cvt_pk_bf16_f32 v141, v150, v151
    v_mfma_f32_16x16x32_bf16 a[120:123], a[248:251], v[128:131], a[120:123]
    v_exp_f32 v152, v104
    v_mfma_f32_16x16x32_bf16 a[124:127], a[252:255], v[128:131], a[124:127]
    s_waitcnt lgkmcnt(0)
    ds_read_b128 a[220:223], v2 offset:23552
    v_add_f32 v174, v174, v152
    v_mfma_f32_16x16x32_bf16 v[84:87], a[192:195], v[20:23], v[156:159]
    v_exp_f32 v153, v105
    v_mfma_f32_16x16x32_bf16 v[84:87], a[196:199], v[24:27], v[84:87]
    v_add_f32 v174, v174, v153
    v_cvt_pk_bf16_f32 v142, v152, v153
    v_mfma_f32_16x16x32_bf16 v[84:87], a[200:203], v[28:31], v[84:87]
    v_exp_f32 v154, v106
    v_mfma_f32_16x16x32_bf16 v[84:87], a[204:207], v[32:35], v[84:87]
    ds_read_b128 a[224:227], v2 offset:49152
    v_add_f32 v174, v174, v154
    v_mfma_f32_16x16x32_bf16 v[88:91], a[208:211], v[20:23], v[156:159]
    v_exp_f32 v155, v107
    v_mfma_f32_16x16x32_bf16 v[88:91], a[212:215], v[24:27], v[88:91]
    ds_read_b128 a[228:231], v2 offset:50176
    v_add_f32 v174, v174, v155
    v_mfma_f32_16x16x32_bf16 v[88:91], a[216:219], v[28:31], v[88:91]
    s_waitcnt lgkmcnt(2)
    v_exp_f32 v148, v108
    v_mfma_f32_16x16x32_bf16 v[88:91], a[220:223], v[32:35], v[88:91]
    s_add_u32 m0, s35, 36864
    s_add_u32 s38, s34, 4096
    v_cvt_pk_bf16_f32 v143, v154, v155
    v_add_f32 v178, v178, v174
    v_mfma_f32_16x16x32_bf16 v[92:95], a[192:195], v[36:39], v[160:163]
    buffer_load_dwordx4 v1, s[16:19], s38 offen offset:0 sc1 lds
    v_exp_f32 v149, v109
    v_mfma_f32_16x16x32_bf16 v[92:95], a[196:199], v[40:43], v[92:95]
    v_add_f32 v175, v148, v149
    v_cvt_pk_bf16_f32 v144, v148, v149
    v_mfma_f32_16x16x32_bf16 v[92:95], a[200:203], v[44:47], v[92:95]
    v_exp_f32 v150, v110
    v_mfma_f32_16x16x32_bf16 v[92:95], a[204:207], v[48:51], v[92:95]
    ds_read_b128 a[232:235], v2 offset:51200
    v_add_f32 v175, v175, v150
    v_mfma_f32_16x16x32_bf16 v[96:99], a[208:211], v[36:39], v[160:163]
    v_exp_f32 v151, v111
    v_mfma_f32_16x16x32_bf16 v[96:99], a[212:215], v[40:43], v[96:99]
    v_add_f32 v175, v175, v151
    v_cvt_pk_bf16_f32 v145, v150, v151
    v_mfma_f32_16x16x32_bf16 v[96:99], a[216:219], v[44:47], v[96:99]
    buffer_load_dwordx4 v1, s[16:19], s38 offen offset:1024 sc1 lds
    v_exp_f32 v152, v112
    v_mfma_f32_16x16x32_bf16 v[96:99], a[220:223], v[48:51], v[96:99]
    ds_read_b128 a[236:239], v2 offset:52224
    v_add_f32 v175, v175, v152
    v_mfma_f32_16x16x32_bf16 v[100:103], a[192:195], v[52:55], v[164:167]
    v_exp_f32 v153, v113
    v_mfma_f32_16x16x32_bf16 v[100:103], a[196:199], v[56:59], v[100:103]
    v_add_f32 v175, v175, v153
    v_cvt_pk_bf16_f32 v146, v152, v153
    v_mfma_f32_16x16x32_bf16 v[100:103], a[200:203], v[60:63], v[100:103]
    v_exp_f32 v154, v114
    v_mfma_f32_16x16x32_bf16 v[100:103], a[204:207], v[64:67], v[100:103]
    ds_read_b128 a[240:243], v2 offset:53248
    v_add_f32 v175, v175, v154
    v_mfma_f32_16x16x32_bf16 v[104:107], a[208:211], v[52:55], v[164:167]
    buffer_load_dwordx4 v1, s[16:19], s38 offen offset:2048 sc1 lds
    v_exp_f32 v155, v115
    v_mfma_f32_16x16x32_bf16 v[104:107], a[212:215], v[56:59], v[104:107]
    ds_read_b128 a[244:247], v2 offset:54272
    v_add_f32 v175, v175, v155
    v_mfma_f32_16x16x32_bf16 v[104:107], a[216:219], v[60:63], v[104:107]
    v_exp_f32 v148, v84
    v_mfma_f32_16x16x32_bf16 v[104:107], a[220:223], v[64:67], v[104:107]
    v_cvt_pk_bf16_f32 v147, v154, v155
    v_add_f32 v179, v179, v175
    v_mfma_f32_16x16x32_bf16 v[108:111], a[192:195], v[68:71], v[168:171]
    v_exp_f32 v149, v85
    v_mfma_f32_16x16x32_bf16 v[108:111], a[196:199], v[72:75], v[108:111]
    v_add_f32 v172, v148, v149
    v_cvt_pk_bf16_f32 v116, v148, v149
    v_mfma_f32_16x16x32_bf16 v[108:111], a[200:203], v[76:79], v[108:111]
    buffer_load_dwordx4 v1, s[16:19], s38 offen offset:3072 sc1 lds
    v_exp_f32 v150, v86
    v_mfma_f32_16x16x32_bf16 v[108:111], a[204:207], v[80:83], v[108:111]
    ds_read_b128 a[248:251], v2 offset:55296
    s_add_u32 s34, s34, 32768
    v_add_f32 v172, v172, v150
    v_mfma_f32_16x16x32_bf16 v[112:115], a[208:211], v[68:71], v[168:171]
    v_exp_f32 v151, v87
    v_mfma_f32_16x16x32_bf16 v[112:115], a[212:215], v[72:75], v[112:115]
    v_add_f32 v172, v172, v151
    v_cvt_pk_bf16_f32 v117, v150, v151
    v_mfma_f32_16x16x32_bf16 v[112:115], a[216:219], v[76:79], v[112:115]
    v_exp_f32 v152, v88
    v_mfma_f32_16x16x32_bf16 v[112:115], a[220:223], v[80:83], v[112:115]
    s_waitcnt lgkmcnt(0)
    ds_read_b128 a[252:255], v2 offset:56320
    v_add_f32 v172, v172, v152
    v_mfma_f32_16x16x32_bf16 a[0:3], a[224:227], v[132:135], a[0:3]
    v_exp_f32 v153, v89
    v_mfma_f32_16x16x32_bf16 a[4:7], a[228:231], v[132:135], a[4:7]
    v_add_f32 v172, v172, v153
    v_cvt_pk_bf16_f32 v118, v152, v153
    v_mfma_f32_16x16x32_bf16 a[8:11], a[232:235], v[132:135], a[8:11]
    v_exp_f32 v154, v90
    v_mfma_f32_16x16x32_bf16 a[12:15], a[236:239], v[132:135], a[12:15]
    ds_read_b128 a[192:195], v2 offset:24576
    v_add_f32 v172, v172, v154
    v_mfma_f32_16x16x32_bf16 a[16:19], a[240:243], v[132:135], a[16:19]
    v_exp_f32 v155, v91
    v_mfma_f32_16x16x32_bf16 a[20:23], a[244:247], v[132:135], a[20:23]
    ds_read_b128 a[196:199], v2 offset:25600
    v_add_f32 v172, v172, v155
    v_mfma_f32_16x16x32_bf16 a[24:27], a[248:251], v[132:135], a[24:27]
    s_waitcnt lgkmcnt(2)
    v_exp_f32 v148, v92
    v_mfma_f32_16x16x32_bf16 a[28:31], a[252:255], v[132:135], a[28:31]
    v_cvt_pk_bf16_f32 v119, v154, v155
    v_add_f32 v176, v176, v172
    v_mfma_f32_16x16x32_bf16 a[32:35], a[224:227], v[136:139], a[32:35]
    v_exp_f32 v149, v93
    v_mfma_f32_16x16x32_bf16 a[36:39], a[228:231], v[136:139], a[36:39]
    v_add_f32 v173, v148, v149
    v_cvt_pk_bf16_f32 v120, v148, v149
    v_mfma_f32_16x16x32_bf16 a[40:43], a[232:235], v[136:139], a[40:43]
    v_exp_f32 v150, v94
    v_mfma_f32_16x16x32_bf16 a[44:47], a[236:239], v[136:139], a[44:47]
    ds_read_b128 a[200:203], v2 offset:26624
    v_add_f32 v173, v173, v150
    v_mfma_f32_16x16x32_bf16 a[48:51], a[240:243], v[136:139], a[48:51]
    v_exp_f32 v151, v95
    v_mfma_f32_16x16x32_bf16 a[52:55], a[244:247], v[136:139], a[52:55]
    v_add_f32 v173, v173, v151
    v_cvt_pk_bf16_f32 v121, v150, v151
    v_mfma_f32_16x16x32_bf16 a[56:59], a[248:251], v[136:139], a[56:59]
    v_exp_f32 v152, v96
    v_mfma_f32_16x16x32_bf16 a[60:63], a[252:255], v[136:139], a[60:63]
    ds_read_b128 a[204:207], v2 offset:27648
    v_add_f32 v173, v173, v152
    v_mfma_f32_16x16x32_bf16 a[64:67], a[224:227], v[140:143], a[64:67]
    v_exp_f32 v153, v97
    v_mfma_f32_16x16x32_bf16 a[68:71], a[228:231], v[140:143], a[68:71]
    v_add_f32 v173, v173, v153
    v_cvt_pk_bf16_f32 v122, v152, v153
    v_mfma_f32_16x16x32_bf16 a[72:75], a[232:235], v[140:143], a[72:75]
    v_exp_f32 v154, v98
    v_mfma_f32_16x16x32_bf16 a[76:79], a[236:239], v[140:143], a[76:79]
    ds_read_b128 a[208:211], v2 offset:28672
    v_add_f32 v173, v173, v154
    v_mfma_f32_16x16x32_bf16 a[80:83], a[240:243], v[140:143], a[80:83]
    v_exp_f32 v155, v99
    v_mfma_f32_16x16x32_bf16 a[84:87], a[244:247], v[140:143], a[84:87]
    ds_read_b128 a[212:215], v2 offset:29696
    v_add_f32 v173, v173, v155
    v_mfma_f32_16x16x32_bf16 a[88:91], a[248:251], v[140:143], a[88:91]
    v_exp_f32 v148, v100
    v_mfma_f32_16x16x32_bf16 a[92:95], a[252:255], v[140:143], a[92:95]
    v_cvt_pk_bf16_f32 v123, v154, v155
    v_add_f32 v177, v177, v173
    v_mfma_f32_16x16x32_bf16 a[96:99], a[224:227], v[144:147], a[96:99]
    v_exp_f32 v149, v101
    v_mfma_f32_16x16x32_bf16 a[100:103], a[228:231], v[144:147], a[100:103]
    v_add_f32 v174, v148, v149
    v_cvt_pk_bf16_f32 v124, v148, v149
    v_mfma_f32_16x16x32_bf16 a[104:107], a[232:235], v[144:147], a[104:107]
    v_exp_f32 v150, v102
    v_mfma_f32_16x16x32_bf16 a[108:111], a[236:239], v[144:147], a[108:111]
    ds_read_b128 a[216:219], v2 offset:30720
    v_add_f32 v174, v174, v150
    v_mfma_f32_16x16x32_bf16 a[112:115], a[240:243], v[144:147], a[112:115]
    v_exp_f32 v151, v103
    v_mfma_f32_16x16x32_bf16 a[116:119], a[244:247], v[144:147], a[116:119]
    v_add_f32 v174, v174, v151
    v_cvt_pk_bf16_f32 v125, v150, v151
    v_mfma_f32_16x16x32_bf16 a[120:123], a[248:251], v[144:147], a[120:123]
    v_exp_f32 v152, v104
    v_mfma_f32_16x16x32_bf16 a[124:127], a[252:255], v[144:147], a[124:127]
    s_waitcnt lgkmcnt(0)
    ds_read_b128 a[220:223], v2 offset:31744
    v_add_f32 v174, v174, v152
    v_mfma_f32_16x16x32_bf16 v[84:87], a[192:195], v[20:23], v[156:159]
    v_exp_f32 v153, v105
    v_mfma_f32_16x16x32_bf16 v[84:87], a[196:199], v[24:27], v[84:87]
    v_add_f32 v174, v174, v153
    v_cvt_pk_bf16_f32 v126, v152, v153
    v_mfma_f32_16x16x32_bf16 v[84:87], a[200:203], v[28:31], v[84:87]
    v_exp_f32 v154, v106
    v_mfma_f32_16x16x32_bf16 v[84:87], a[204:207], v[32:35], v[84:87]
    ds_read_b128 a[224:227], v2 offset:57344
    v_add_f32 v174, v174, v154
    v_mfma_f32_16x16x32_bf16 v[88:91], a[208:211], v[20:23], v[156:159]
    v_exp_f32 v155, v107
    v_mfma_f32_16x16x32_bf16 v[88:91], a[212:215], v[24:27], v[88:91]
    ds_read_b128 a[228:231], v2 offset:58368
    v_add_f32 v174, v174, v155
    v_mfma_f32_16x16x32_bf16 v[88:91], a[216:219], v[28:31], v[88:91]
    s_waitcnt lgkmcnt(2)
    v_exp_f32 v148, v108
    v_mfma_f32_16x16x32_bf16 v[88:91], a[220:223], v[32:35], v[88:91]
    v_cvt_pk_bf16_f32 v127, v154, v155
    v_add_f32 v178, v178, v174
    v_mfma_f32_16x16x32_bf16 v[92:95], a[192:195], v[36:39], v[160:163]
    v_exp_f32 v149, v109
    v_mfma_f32_16x16x32_bf16 v[92:95], a[196:199], v[40:43], v[92:95]
    v_add_f32 v175, v148, v149
    v_cvt_pk_bf16_f32 v128, v148, v149
    v_mfma_f32_16x16x32_bf16 v[92:95], a[200:203], v[44:47], v[92:95]
    v_exp_f32 v150, v110
    v_mfma_f32_16x16x32_bf16 v[92:95], a[204:207], v[48:51], v[92:95]
    ds_read_b128 a[232:235], v2 offset:59392
    v_add_f32 v175, v175, v150
    v_mfma_f32_16x16x32_bf16 v[96:99], a[208:211], v[36:39], v[160:163]
    v_exp_f32 v151, v111
    v_mfma_f32_16x16x32_bf16 v[96:99], a[212:215], v[40:43], v[96:99]
    v_add_f32 v175, v175, v151
    v_cvt_pk_bf16_f32 v129, v150, v151
    v_mfma_f32_16x16x32_bf16 v[96:99], a[216:219], v[44:47], v[96:99]
    v_exp_f32 v152, v112
    v_mfma_f32_16x16x32_bf16 v[96:99], a[220:223], v[48:51], v[96:99]
    ds_read_b128 a[236:239], v2 offset:60416
    v_add_f32 v175, v175, v152
    v_mfma_f32_16x16x32_bf16 v[100:103], a[192:195], v[52:55], v[164:167]
    v_exp_f32 v153, v113
    v_mfma_f32_16x16x32_bf16 v[100:103], a[196:199], v[56:59], v[100:103]
    v_add_f32 v175, v175, v153
    v_cvt_pk_bf16_f32 v130, v152, v153
    v_mfma_f32_16x16x32_bf16 v[100:103], a[200:203], v[60:63], v[100:103]
    v_exp_f32 v154, v114
    v_mfma_f32_16x16x32_bf16 v[100:103], a[204:207], v[64:67], v[100:103]
    ds_read_b128 a[240:243], v2 offset:61440
    v_add_f32 v175, v175, v154
    v_mfma_f32_16x16x32_bf16 v[104:107], a[208:211], v[52:55], v[164:167]
    v_exp_f32 v155, v115
    v_mfma_f32_16x16x32_bf16 v[104:107], a[212:215], v[56:59], v[104:107]
    ds_read_b128 a[244:247], v2 offset:62464
    v_add_f32 v175, v175, v155
    v_mfma_f32_16x16x32_bf16 v[104:107], a[216:219], v[60:63], v[104:107]
    v_exp_f32 v148, v84
    v_mfma_f32_16x16x32_bf16 v[104:107], a[220:223], v[64:67], v[104:107]
    v_cvt_pk_bf16_f32 v131, v154, v155
    v_add_f32 v179, v179, v175
    v_mfma_f32_16x16x32_bf16 v[108:111], a[192:195], v[68:71], v[168:171]
    v_exp_f32 v149, v85
    v_mfma_f32_16x16x32_bf16 v[108:111], a[196:199], v[72:75], v[108:111]
    ds_read_b128 a[248:251], v2 offset:63488
    v_add_f32 v172, v148, v149
    v_cvt_pk_bf16_f32 v132, v148, v149
    v_mfma_f32_16x16x32_bf16 v[108:111], a[200:203], v[76:79], v[108:111]
    v_exp_f32 v150, v86
    v_mfma_f32_16x16x32_bf16 v[108:111], a[204:207], v[80:83], v[108:111]
    ds_read_b128 a[252:255], v2 offset:64512
    v_add_f32 v172, v172, v150
    v_mfma_f32_16x16x32_bf16 v[112:115], a[208:211], v[68:71], v[168:171]
    v_exp_f32 v151, v87
    v_mfma_f32_16x16x32_bf16 v[112:115], a[212:215], v[72:75], v[112:115]
    v_add_f32 v172, v172, v151
    v_cvt_pk_bf16_f32 v133, v150, v151
    v_mfma_f32_16x16x32_bf16 v[112:115], a[216:219], v[76:79], v[112:115]
    v_exp_f32 v152, v88
    v_mfma_f32_16x16x32_bf16 v[112:115], a[220:223], v[80:83], v[112:115]
    s_waitcnt lgkmcnt(0)
    v_add_f32 v172, v172, v152
    v_mfma_f32_16x16x32_bf16 a[0:3], a[224:227], v[116:119], a[0:3]
    v_exp_f32 v153, v89
    v_mfma_f32_16x16x32_bf16 a[4:7], a[228:231], v[116:119], a[4:7]
    s_waitcnt vmcnt(0) lgkmcnt(0)
    s_barrier
    v_add_f32 v172, v172, v153
    v_cvt_pk_bf16_f32 v134, v152, v153
    v_mfma_f32_16x16x32_bf16 a[8:11], a[232:235], v[116:119], a[8:11]
    v_exp_f32 v154, v90
    v_mfma_f32_16x16x32_bf16 a[12:15], a[236:239], v[116:119], a[12:15]
    ds_read_b128 a[192:195], v3 offset:0
    s_add_u32 m0, s36, 0
    v_add_f32 v172, v172, v154
    v_mfma_f32_16x16x32_bf16 a[16:19], a[240:243], v[116:119], a[16:19]
    buffer_load_dwordx4 v1, s[16:19], s33 offen offset:0 sc1 lds
    v_exp_f32 v155, v91
    v_mfma_f32_16x16x32_bf16 a[20:23], a[244:247], v[116:119], a[20:23]
    ds_read_b128 a[196:199], v3 offset:1024
    v_add_f32 v172, v172, v155
    v_mfma_f32_16x16x32_bf16 a[24:27], a[248:251], v[116:119], a[24:27]
    v_exp_f32 v148, v92
    v_mfma_f32_16x16x32_bf16 a[28:31], a[252:255], v[116:119], a[28:31]
    v_cvt_pk_bf16_f32 v135, v154, v155
    v_add_f32 v176, v176, v172
    v_mfma_f32_16x16x32_bf16 a[32:35], a[224:227], v[120:123], a[32:35]
    v_exp_f32 v149, v93
    v_mfma_f32_16x16x32_bf16 a[36:39], a[228:231], v[120:123], a[36:39]
    v_add_f32 v173, v148, v149
    v_cvt_pk_bf16_f32 v136, v148, v149
    v_mfma_f32_16x16x32_bf16 a[40:43], a[232:235], v[120:123], a[40:43]
    v_exp_f32 v150, v94
    v_mfma_f32_16x16x32_bf16 a[44:47], a[236:239], v[120:123], a[44:47]
    ds_read_b128 a[200:203], v3 offset:2048
    v_add_f32 v173, v173, v150
    v_mfma_f32_16x16x32_bf16 a[48:51], a[240:243], v[120:123], a[48:51]
    buffer_load_dwordx4 v1, s[16:19], s33 offen offset:1024 sc1 lds
    v_exp_f32 v151, v95
    v_mfma_f32_16x16x32_bf16 a[52:55], a[244:247], v[120:123], a[52:55]
    v_add_f32 v173, v173, v151
    v_cvt_pk_bf16_f32 v137, v150, v151
    v_mfma_f32_16x16x32_bf16 a[56:59], a[248:251], v[120:123], a[56:59]
    v_exp_f32 v152, v96
    v_mfma_f32_16x16x32_bf16 a[60:63], a[252:255], v[120:123], a[60:63]
    ds_read_b128 a[204:207], v3 offset:3072
    v_add_f32 v173, v173, v152
    v_mfma_f32_16x16x32_bf16 a[64:67], a[224:227], v[124:127], a[64:67]
    v_exp_f32 v153, v97
    v_mfma_f32_16x16x32_bf16 a[68:71], a[228:231], v[124:127], a[68:71]
    v_add_f32 v173, v173, v153
    v_cvt_pk_bf16_f32 v138, v152, v153
    v_mfma_f32_16x16x32_bf16 a[72:75], a[232:235], v[124:127], a[72:75]
    v_exp_f32 v154, v98
    v_mfma_f32_16x16x32_bf16 a[76:79], a[236:239], v[124:127], a[76:79]
    ds_read_b128 a[208:211], v3 offset:4096
    v_add_f32 v173, v173, v154
    v_mfma_f32_16x16x32_bf16 a[80:83], a[240:243], v[124:127], a[80:83]
    buffer_load_dwordx4 v1, s[16:19], s33 offen offset:2048 sc1 lds
    v_exp_f32 v155, v99
    v_mfma_f32_16x16x32_bf16 a[84:87], a[244:247], v[124:127], a[84:87]
    ds_read_b128 a[212:215], v3 offset:5120
    v_add_f32 v173, v173, v155
    v_mfma_f32_16x16x32_bf16 a[88:91], a[248:251], v[124:127], a[88:91]
    v_exp_f32 v148, v100
    v_mfma_f32_16x16x32_bf16 a[92:95], a[252:255], v[124:127], a[92:95]
    v_cvt_pk_bf16_f32 v139, v154, v155
    v_add_f32 v177, v177, v173
    v_mfma_f32_16x16x32_bf16 a[96:99], a[224:227], v[128:131], a[96:99]
    v_exp_f32 v149, v101
    v_mfma_f32_16x16x32_bf16 a[100:103], a[228:231], v[128:131], a[100:103]
    v_add_f32 v174, v148, v149
    v_cvt_pk_bf16_f32 v140, v148, v149
    v_mfma_f32_16x16x32_bf16 a[104:107], a[232:235], v[128:131], a[104:107]
    v_exp_f32 v150, v102
    v_mfma_f32_16x16x32_bf16 a[108:111], a[236:239], v[128:131], a[108:111]
    ds_read_b128 a[216:219], v3 offset:6144
    v_add_f32 v174, v174, v150
    v_mfma_f32_16x16x32_bf16 a[112:115], a[240:243], v[128:131], a[112:115]
    buffer_load_dwordx4 v1, s[16:19], s33 offen offset:3072 sc1 lds
    v_exp_f32 v151, v103
    v_mfma_f32_16x16x32_bf16 a[116:119], a[244:247], v[128:131], a[116:119]
    v_add_f32 v174, v174, v151
    v_cvt_pk_bf16_f32 v141, v150, v151
    v_mfma_f32_16x16x32_bf16 a[120:123], a[248:251], v[128:131], a[120:123]
    v_exp_f32 v152, v104
    v_mfma_f32_16x16x32_bf16 a[124:127], a[252:255], v[128:131], a[124:127]
    s_waitcnt lgkmcnt(0)
    ds_read_b128 a[220:223], v3 offset:7168
    v_add_f32 v174, v174, v152
    v_mfma_f32_16x16x32_bf16 v[84:87], a[192:195], v[20:23], v[156:159]
    v_exp_f32 v153, v105
    v_mfma_f32_16x16x32_bf16 v[84:87], a[196:199], v[24:27], v[84:87]
    v_add_f32 v174, v174, v153
    v_cvt_pk_bf16_f32 v142, v152, v153
    v_mfma_f32_16x16x32_bf16 v[84:87], a[200:203], v[28:31], v[84:87]
    v_exp_f32 v154, v106
    v_mfma_f32_16x16x32_bf16 v[84:87], a[204:207], v[32:35], v[84:87]
    ds_read_b128 a[224:227], v3 offset:32768
    v_add_f32 v174, v174, v154
    v_mfma_f32_16x16x32_bf16 v[88:91], a[208:211], v[20:23], v[156:159]
    v_exp_f32 v155, v107
    v_mfma_f32_16x16x32_bf16 v[88:91], a[212:215], v[24:27], v[88:91]
    ds_read_b128 a[228:231], v3 offset:33792
    v_add_f32 v174, v174, v155
    v_mfma_f32_16x16x32_bf16 v[88:91], a[216:219], v[28:31], v[88:91]
    s_waitcnt lgkmcnt(2)
    v_exp_f32 v148, v108
    v_mfma_f32_16x16x32_bf16 v[88:91], a[220:223], v[32:35], v[88:91]
    s_add_u32 m0, s36, 4096
    s_add_u32 s38, s33, 4096
    v_cvt_pk_bf16_f32 v143, v154, v155
    v_add_f32 v178, v178, v174
    v_mfma_f32_16x16x32_bf16 v[92:95], a[192:195], v[36:39], v[160:163]
    buffer_load_dwordx4 v1, s[16:19], s38 offen offset:0 sc1 lds
    v_exp_f32 v149, v109
    v_mfma_f32_16x16x32_bf16 v[92:95], a[196:199], v[40:43], v[92:95]
    v_add_f32 v175, v148, v149
    v_cvt_pk_bf16_f32 v144, v148, v149
    v_mfma_f32_16x16x32_bf16 v[92:95], a[200:203], v[44:47], v[92:95]
    v_exp_f32 v150, v110
    v_mfma_f32_16x16x32_bf16 v[92:95], a[204:207], v[48:51], v[92:95]
    ds_read_b128 a[232:235], v3 offset:34816
    v_add_f32 v175, v175, v150
    v_mfma_f32_16x16x32_bf16 v[96:99], a[208:211], v[36:39], v[160:163]
    buffer_load_dword v212, v17, s[44:47], s42 offen
    v_exp_f32 v151, v111
    v_mfma_f32_16x16x32_bf16 v[96:99], a[212:215], v[40:43], v[96:99]
    s_add_u32 s42, s42, 524288
    v_add_f32 v175, v175, v151
    v_cvt_pk_bf16_f32 v145, v150, v151
    v_mfma_f32_16x16x32_bf16 v[96:99], a[216:219], v[44:47], v[96:99]
    v_exp_f32 v152, v112
    v_mfma_f32_16x16x32_bf16 v[96:99], a[220:223], v[48:51], v[96:99]
    ds_read_b128 a[236:239], v3 offset:35840
    v_add_f32 v175, v175, v152
    v_mfma_f32_16x16x32_bf16 v[100:103], a[192:195], v[52:55], v[164:167]
    v_exp_f32 v153, v113
    v_mfma_f32_16x16x32_bf16 v[100:103], a[196:199], v[56:59], v[100:103]
    v_add_f32 v175, v175, v153
    v_cvt_pk_bf16_f32 v146, v152, v153
    v_mfma_f32_16x16x32_bf16 v[100:103], a[200:203], v[60:63], v[100:103]
    v_exp_f32 v154, v114
    v_mfma_f32_16x16x32_bf16 v[100:103], a[204:207], v[64:67], v[100:103]
    ds_read_b128 a[240:243], v3 offset:36864
    v_add_f32 v175, v175, v154
    v_mfma_f32_16x16x32_bf16 v[104:107], a[208:211], v[52:55], v[164:167]
    v_exp_f32 v155, v115
    v_mfma_f32_16x16x32_bf16 v[104:107], a[212:215], v[56:59], v[104:107]
    ds_read_b128 a[244:247], v3 offset:37888
    v_add_f32 v175, v175, v155
    v_mfma_f32_16x16x32_bf16 v[104:107], a[216:219], v[60:63], v[104:107]
    v_exp_f32 v148, v84
    v_mfma_f32_16x16x32_bf16 v[104:107], a[220:223], v[64:67], v[104:107]
    v_cvt_pk_bf16_f32 v147, v154, v155
    v_add_f32 v179, v179, v175
    v_mfma_f32_16x16x32_bf16 v[108:111], a[192:195], v[68:71], v[168:171]
    buffer_load_dwordx4 v1, s[16:19], s38 offen offset:1024 sc1 lds
    v_exp_f32 v149, v85
    v_mfma_f32_16x16x32_bf16 v[108:111], a[196:199], v[72:75], v[108:111]
    v_add_f32 v172, v148, v149
    v_cvt_pk_bf16_f32 v116, v148, v149
    v_mfma_f32_16x16x32_bf16 v[108:111], a[200:203], v[76:79], v[108:111]
    v_exp_f32 v150, v86
    v_mfma_f32_16x16x32_bf16 v[108:111], a[204:207], v[80:83], v[108:111]
    ds_read_b128 a[248:251], v3 offset:38912
    v_add_f32 v172, v172, v150
    v_mfma_f32_16x16x32_bf16 v[112:115], a[208:211], v[68:71], v[168:171]
    v_exp_f32 v151, v87
    v_mfma_f32_16x16x32_bf16 v[112:115], a[212:215], v[72:75], v[112:115]
    v_add_f32 v172, v172, v151
    v_cvt_pk_bf16_f32 v117, v150, v151
    v_mfma_f32_16x16x32_bf16 v[112:115], a[216:219], v[76:79], v[112:115]
    v_exp_f32 v152, v88
    v_mfma_f32_16x16x32_bf16 v[112:115], a[220:223], v[80:83], v[112:115]
    s_waitcnt lgkmcnt(0)
    ds_read_b128 a[252:255], v3 offset:39936
    v_add_f32 v172, v172, v152
    v_mfma_f32_16x16x32_bf16 a[0:3], a[224:227], v[132:135], a[0:3]
    v_exp_f32 v153, v89
    v_mfma_f32_16x16x32_bf16 a[4:7], a[228:231], v[132:135], a[4:7]
    v_add_f32 v172, v172, v153
    v_cvt_pk_bf16_f32 v118, v152, v153
    v_mfma_f32_16x16x32_bf16 a[8:11], a[232:235], v[132:135], a[8:11]
    v_exp_f32 v154, v90
    v_mfma_f32_16x16x32_bf16 a[12:15], a[236:239], v[132:135], a[12:15]
    ds_read_b128 a[192:195], v3 offset:8192
    v_add_f32 v172, v172, v154
    v_mfma_f32_16x16x32_bf16 a[16:19], a[240:243], v[132:135], a[16:19]
    v_exp_f32 v155, v91
    v_mfma_f32_16x16x32_bf16 a[20:23], a[244:247], v[132:135], a[20:23]
    ds_read_b128 a[196:199], v3 offset:9216
    v_add_f32 v172, v172, v155
    v_mfma_f32_16x16x32_bf16 a[24:27], a[248:251], v[132:135], a[24:27]
    s_waitcnt lgkmcnt(2)
    v_exp_f32 v148, v92
    v_mfma_f32_16x16x32_bf16 a[28:31], a[252:255], v[132:135], a[28:31]
    v_cvt_pk_bf16_f32 v119, v154, v155
    v_add_f32 v176, v176, v172
    v_mfma_f32_16x16x32_bf16 a[32:35], a[224:227], v[136:139], a[32:35]
    buffer_load_dwordx4 v1, s[16:19], s38 offen offset:2048 sc1 lds
    v_exp_f32 v149, v93
    v_mfma_f32_16x16x32_bf16 a[36:39], a[228:231], v[136:139], a[36:39]
    v_add_f32 v173, v148, v149
    v_cvt_pk_bf16_f32 v120, v148, v149
    v_mfma_f32_16x16x32_bf16 a[40:43], a[232:235], v[136:139], a[40:43]
    v_exp_f32 v150, v94
    v_mfma_f32_16x16x32_bf16 a[44:47], a[236:239], v[136:139], a[44:47]
    ds_read_b128 a[200:203], v3 offset:10240
    v_add_f32 v173, v173, v150
    v_mfma_f32_16x16x32_bf16 a[48:51], a[240:243], v[136:139], a[48:51]
    buffer_load_dword v213, v17, s[48:51], s43 offen
    v_exp_f32 v151, v95
    v_mfma_f32_16x16x32_bf16 a[52:55], a[244:247], v[136:139], a[52:55]
    v_add_f32 v173, v173, v151
    v_cvt_pk_bf16_f32 v121, v150, v151
    v_mfma_f32_16x16x32_bf16 a[56:59], a[248:251], v[136:139], a[56:59]
    v_exp_f32 v152, v96
    v_mfma_f32_16x16x32_bf16 a[60:63], a[252:255], v[136:139], a[60:63]
    ds_read_b128 a[204:207], v3 offset:11264
    v_add_f32 v173, v173, v152
    v_mfma_f32_16x16x32_bf16 a[64:67], a[224:227], v[140:143], a[64:67]
    v_exp_f32 v153, v97
    v_mfma_f32_16x16x32_bf16 a[68:71], a[228:231], v[140:143], a[68:71]
    v_add_f32 v173, v173, v153
    v_cvt_pk_bf16_f32 v122, v152, v153
    v_mfma_f32_16x16x32_bf16 a[72:75], a[232:235], v[140:143], a[72:75]
    v_exp_f32 v154, v98
    v_mfma_f32_16x16x32_bf16 a[76:79], a[236:239], v[140:143], a[76:79]
    ds_read_b128 a[208:211], v3 offset:12288
    v_add_f32 v173, v173, v154
    v_mfma_f32_16x16x32_bf16 a[80:83], a[240:243], v[140:143], a[80:83]
    v_exp_f32 v155, v99
    v_mfma_f32_16x16x32_bf16 a[84:87], a[244:247], v[140:143], a[84:87]
    ds_read_b128 a[212:215], v3 offset:13312
    v_add_f32 v173, v173, v155
    v_mfma_f32_16x16x32_bf16 a[88:91], a[248:251], v[140:143], a[88:91]
    v_exp_f32 v148, v100
    v_mfma_f32_16x16x32_bf16 a[92:95], a[252:255], v[140:143], a[92:95]
    v_cvt_pk_bf16_f32 v123, v154, v155
    v_add_f32 v177, v177, v173
    v_mfma_f32_16x16x32_bf16 a[96:99], a[224:227], v[144:147], a[96:99]
    buffer_load_dwordx4 v1, s[16:19], s38 offen offset:3072 sc1 lds
    v_exp_f32 v149, v101
    v_mfma_f32_16x16x32_bf16 a[100:103], a[228:231], v[144:147], a[100:103]
    s_add_u32 s33, s33, 32768
    v_add_f32 v174, v148, v149
    v_cvt_pk_bf16_f32 v124, v148, v149
    v_mfma_f32_16x16x32_bf16 a[104:107], a[232:235], v[144:147], a[104:107]
    v_exp_f32 v150, v102
    v_mfma_f32_16x16x32_bf16 a[108:111], a[236:239], v[144:147], a[108:111]
    ds_read_b128 a[216:219], v3 offset:14336
    v_add_f32 v174, v174, v150
    v_mfma_f32_16x16x32_bf16 a[112:115], a[240:243], v[144:147], a[112:115]
    v_exp_f32 v151, v103
    v_mfma_f32_16x16x32_bf16 a[116:119], a[244:247], v[144:147], a[116:119]
    v_add_f32 v174, v174, v151
    v_cvt_pk_bf16_f32 v125, v150, v151
    v_mfma_f32_16x16x32_bf16 a[120:123], a[248:251], v[144:147], a[120:123]
    v_exp_f32 v152, v104
    v_mfma_f32_16x16x32_bf16 a[124:127], a[252:255], v[144:147], a[124:127]
    s_waitcnt lgkmcnt(0)
    ds_read_b128 a[220:223], v3 offset:15360
    v_add_f32 v174, v174, v152
    v_xor_b32 v2, 0x10000, v2
    v_xor_b32 v3, 0x10000, v3
    s_xor_b32 s36, s36, 0x10000
    s_xor_b32 s35, s35, 0x10000
    s_sub_u32 s32, s32, 1
    s_cmp_lg_u32 s32, 0
    s_cbranch_scc1 L_mega_kernel_main
    v_mfma_f32_16x16x32_bf16 v[84:87], a[192:195], v[20:23], v[156:159]
    v_exp_f32 v153, v105
    v_mfma_f32_16x16x32_bf16 v[84:87], a[196:199], v[24:27], v[84:87]
    v_add_f32 v174, v174, v153
    v_cvt_pk_bf16_f32 v126, v152, v153
    v_mfma_f32_16x16x32_bf16 v[84:87], a[200:203], v[28:31], v[84:87]
    v_exp_f32 v154, v106
    v_mfma_f32_16x16x32_bf16 v[84:87], a[204:207], v[32:35], v[84:87]
    ds_read_b128 a[224:227], v2 offset:40960
    v_add_f32 v174, v174, v154
    v_mfma_f32_16x16x32_bf16 v[88:91], a[208:211], v[20:23], v[156:159]
    v_exp_f32 v155, v107
    v_mfma_f32_16x16x32_bf16 v[88:91], a[212:215], v[24:27], v[88:91]
    ds_read_b128 a[228:231], v2 offset:41984
    v_add_f32 v174, v174, v155
    v_mfma_f32_16x16x32_bf16 v[88:91], a[216:219], v[28:31], v[88:91]
    s_waitcnt lgkmcnt(2)
    v_exp_f32 v148, v108
    v_mfma_f32_16x16x32_bf16 v[88:91], a[220:223], v[32:35], v[88:91]
    s_add_u32 m0, s35, 32768
    v_cvt_pk_bf16_f32 v127, v154, v155
    v_add_f32 v178, v178, v174
    v_mfma_f32_16x16x32_bf16 v[92:95], a[192:195], v[36:39], v[160:163]
    buffer_load_dwordx4 v1, s[16:19], s34 offen offset:0 sc1 lds
    v_exp_f32 v149, v109
    v_mfma_f32_16x16x32_bf16 v[92:95], a[196:199], v[40:43], v[92:95]
    v_add_f32 v175, v148, v149
    v_cvt_pk_bf16_f32 v128, v148, v149
    v_mfma_f32_16x16x32_bf16 v[92:95], a[200:203], v[44:47], v[92:95]
    v_exp_f32 v150, v110
    v_mfma_f32_16x16x32_bf16 v[92:95], a[204:207], v[48:51], v[92:95]
    ds_read_b128 a[232:235], v2 offset:43008
    v_add_f32 v175, v175, v150
    v_mfma_f32_16x16x32_bf16 v[96:99], a[208:211], v[36:39], v[160:163]
    v_exp_f32 v151, v111
    v_mfma_f32_16x16x32_bf16 v[96:99], a[212:215], v[40:43], v[96:99]
    v_add_f32 v175, v175, v151
    v_cvt_pk_bf16_f32 v129, v150, v151
    v_mfma_f32_16x16x32_bf16 v[96:99], a[216:219], v[44:47], v[96:99]
    v_exp_f32 v152, v112
    v_mfma_f32_16x16x32_bf16 v[96:99], a[220:223], v[48:51], v[96:99]
    ds_read_b128 a[236:239], v2 offset:44032
    v_add_f32 v175, v175, v152
    v_mfma_f32_16x16x32_bf16 v[100:103], a[192:195], v[52:55], v[164:167]
    v_exp_f32 v153, v113
    v_mfma_f32_16x16x32_bf16 v[100:103], a[196:199], v[56:59], v[100:103]
    v_add_f32 v175, v175, v153
    v_cvt_pk_bf16_f32 v130, v152, v153
    v_mfma_f32_16x16x32_bf16 v[100:103], a[200:203], v[60:63], v[100:103]
    v_exp_f32 v154, v114
    v_mfma_f32_16x16x32_bf16 v[100:103], a[204:207], v[64:67], v[100:103]
    ds_read_b128 a[240:243], v2 offset:45056
    v_add_f32 v175, v175, v154
    v_mfma_f32_16x16x32_bf16 v[104:107], a[208:211], v[52:55], v[164:167]
    v_exp_f32 v155, v115
    v_mfma_f32_16x16x32_bf16 v[104:107], a[212:215], v[56:59], v[104:107]
    ds_read_b128 a[244:247], v2 offset:46080
    v_add_f32 v175, v175, v155
    v_mfma_f32_16x16x32_bf16 v[104:107], a[216:219], v[60:63], v[104:107]
    v_exp_f32 v148, v84
    v_mfma_f32_16x16x32_bf16 v[104:107], a[220:223], v[64:67], v[104:107]
    v_cvt_pk_bf16_f32 v131, v154, v155
    v_add_f32 v179, v179, v175
    v_mfma_f32_16x16x32_bf16 v[108:111], a[192:195], v[68:71], v[168:171]
    buffer_load_dwordx4 v1, s[16:19], s34 offen offset:1024 sc1 lds
    v_exp_f32 v149, v85
    v_mfma_f32_16x16x32_bf16 v[108:111], a[196:199], v[72:75], v[108:111]
    v_add_f32 v172, v148, v149
    v_cvt_pk_bf16_f32 v132, v148, v149
    v_mfma_f32_16x16x32_bf16 v[108:111], a[200:203], v[76:79], v[108:111]
    v_exp_f32 v150, v86
    v_mfma_f32_16x16x32_bf16 v[108:111], a[204:207], v[80:83], v[108:111]
    ds_read_b128 a[248:251], v2 offset:47104
    v_add_f32 v172, v172, v150
    v_mfma_f32_16x16x32_bf16 v[112:115], a[208:211], v[68:71], v[168:171]
    v_exp_f32 v151, v87
    v_mfma_f32_16x16x32_bf16 v[112:115], a[212:215], v[72:75], v[112:115]
    v_add_f32 v172, v172, v151
    v_cvt_pk_bf16_f32 v133, v150, v151
    v_mfma_f32_16x16x32_bf16 v[112:115], a[216:219], v[76:79], v[112:115]
    v_exp_f32 v152, v88
    v_mfma_f32_16x16x32_bf16 v[112:115], a[220:223], v[80:83], v[112:115]
    s_waitcnt lgkmcnt(0)
    ds_read_b128 a[252:255], v2 offset:48128
    v_add_f32 v172, v172, v152
    v_mfma_f32_16x16x32_bf16 a[0:3], a[224:227], v[116:119], a[0:3]
    v_exp_f32 v153, v89
    v_mfma_f32_16x16x32_bf16 a[4:7], a[228:231], v[116:119], a[4:7]
    v_add_f32 v172, v172, v153
    v_cvt_pk_bf16_f32 v134, v152, v153
    v_mfma_f32_16x16x32_bf16 a[8:11], a[232:235], v[116:119], a[8:11]
    v_exp_f32 v154, v90
    v_mfma_f32_16x16x32_bf16 a[12:15], a[236:239], v[116:119], a[12:15]
    ds_read_b128 a[192:195], v2 offset:16384
    v_add_f32 v172, v172, v154
    v_mfma_f32_16x16x32_bf16 a[16:19], a[240:243], v[116:119], a[16:19]
    v_exp_f32 v155, v91
    v_mfma_f32_16x16x32_bf16 a[20:23], a[244:247], v[116:119], a[20:23]
    ds_read_b128 a[196:199], v2 offset:17408
    v_add_f32 v172, v172, v155
    v_mfma_f32_16x16x32_bf16 a[24:27], a[248:251], v[116:119], a[24:27]
    s_waitcnt lgkmcnt(2)
    v_exp_f32 v148, v92
    v_mfma_f32_16x16x32_bf16 a[28:31], a[252:255], v[116:119], a[28:31]
    v_cvt_pk_bf16_f32 v135, v154, v155
    v_add_f32 v176, v176, v172
    v_mfma_f32_16x16x32_bf16 a[32:35], a[224:227], v[120:123], a[32:35]
    buffer_load_dwordx4 v1, s[16:19], s34 offen offset:2048 sc1 lds
    v_exp_f32 v149, v93
    v_mfma_f32_16x16x32_bf16 a[36:39], a[228:231], v[120:123], a[36:39]
    v_add_f32 v173, v148, v149
    v_cvt_pk_bf16_f32 v136, v148, v149
    v_mfma_f32_16x16x32_bf16 a[40:43], a[232:235], v[120:123], a[40:43]
    v_exp_f32 v150, v94
    v_mfma_f32_16x16x32_bf16 a[44:47], a[236:239], v[120:123], a[44:47]
    ds_read_b128 a[200:203], v2 offset:18432
    v_add_f32 v173, v173, v150
    v_mfma_f32_16x16x32_bf16 a[48:51], a[240:243], v[120:123], a[48:51]
    v_exp_f32 v151, v95
    v_mfma_f32_16x16x32_bf16 a[52:55], a[244:247], v[120:123], a[52:55]
    v_add_f32 v173, v173, v151
    v_cvt_pk_bf16_f32 v137, v150, v151
    v_mfma_f32_16x16x32_bf16 a[56:59], a[248:251], v[120:123], a[56:59]
    v_exp_f32 v152, v96
    v_mfma_f32_16x16x32_bf16 a[60:63], a[252:255], v[120:123], a[60:63]
    ds_read_b128 a[204:207], v2 offset:19456
    v_add_f32 v173, v173, v152
    v_mfma_f32_16x16x32_bf16 a[64:67], a[224:227], v[124:127], a[64:67]
    v_exp_f32 v153, v97
    v_mfma_f32_16x16x32_bf16 a[68:71], a[228:231], v[124:127], a[68:71]
    v_add_f32 v173, v173, v153
    v_cvt_pk_bf16_f32 v138, v152, v153
    v_mfma_f32_16x16x32_bf16 a[72:75], a[232:235], v[124:127], a[72:75]
    v_exp_f32 v154, v98
    v_mfma_f32_16x16x32_bf16 a[76:79], a[236:239], v[124:127], a[76:79]
    ds_read_b128 a[208:211], v2 offset:20480
    v_add_f32 v173, v173, v154
    v_mfma_f32_16x16x32_bf16 a[80:83], a[240:243], v[124:127], a[80:83]
    v_exp_f32 v155, v99
    v_mfma_f32_16x16x32_bf16 a[84:87], a[244:247], v[124:127], a[84:87]
    ds_read_b128 a[212:215], v2 offset:21504
    v_add_f32 v173, v173, v155
    v_mfma_f32_16x16x32_bf16 a[88:91], a[248:251], v[124:127], a[88:91]
    v_exp_f32 v148, v100
    v_mfma_f32_16x16x32_bf16 a[92:95], a[252:255], v[124:127], a[92:95]
    v_cvt_pk_bf16_f32 v139, v154, v155
    v_add_f32 v177, v177, v173
    v_mfma_f32_16x16x32_bf16 a[96:99], a[224:227], v[128:131], a[96:99]
    buffer_load_dwordx4 v1, s[16:19], s34 offen offset:3072 sc1 lds
    v_exp_f32 v149, v101
    v_mfma_f32_16x16x32_bf16 a[100:103], a[228:231], v[128:131], a[100:103]
    v_add_f32 v174, v148, v149
    v_cvt_pk_bf16_f32 v140, v148, v149
    v_mfma_f32_16x16x32_bf16 a[104:107], a[232:235], v[128:131], a[104:107]
    v_exp_f32 v150, v102
    v_mfma_f32_16x16x32_bf16 a[108:111], a[236:239], v[128:131], a[108:111]
    ds_read_b128 a[216:219], v2 offset:22528
    v_add_f32 v174, v174, v150
    v_mfma_f32_16x16x32_bf16 a[112:115], a[240:243], v[128:131], a[112:115]
    v_exp_f32 v151, v103
    v_mfma_f32_16x16x32_bf16 a[116:119], a[244:247], v[128:131], a[116:119]
    v_add_f32 v174, v174, v151
    v_cvt_pk_bf16_f32 v141, v150, v151
    v_mfma_f32_16x16x32_bf16 a[120:123], a[248:251], v[128:131], a[120:123]
    v_exp_f32 v152, v104
    v_mfma_f32_16x16x32_bf16 a[124:127], a[252:255], v[128:131], a[124:127]
    s_waitcnt lgkmcnt(0)
    ds_read_b128 a[220:223], v2 offset:23552
    v_add_f32 v174, v174, v152
    v_mfma_f32_16x16x32_bf16 v[84:87], a[192:195], v[20:23], v[156:159]
    v_exp_f32 v153, v105
    v_mfma_f32_16x16x32_bf16 v[84:87], a[196:199], v[24:27], v[84:87]
    v_add_f32 v174, v174, v153
    v_cvt_pk_bf16_f32 v142, v152, v153
    v_mfma_f32_16x16x32_bf16 v[84:87], a[200:203], v[28:31], v[84:87]
    v_exp_f32 v154, v106
    v_mfma_f32_16x16x32_bf16 v[84:87], a[204:207], v[32:35], v[84:87]
    ds_read_b128 a[224:227], v2 offset:49152
    v_add_f32 v174, v174, v154
    v_mfma_f32_16x16x32_bf16 v[88:91], a[208:211], v[20:23], v[156:159]
    v_exp_f32 v155, v107
    v_mfma_f32_16x16x32_bf16 v[88:91], a[212:215], v[24:27], v[88:91]
    ds_read_b128 a[228:231], v2 offset:50176
    v_add_f32 v174, v174, v155
    v_mfma_f32_16x16x32_bf16 v[88:91], a[216:219], v[28:31], v[88:91]
    s_waitcnt lgkmcnt(2)
    v_exp_f32 v148, v108
    v_mfma_f32_16x16x32_bf16 v[88:91], a[220:223], v[32:35], v[88:91]
    s_add_u32 m0, s35, 36864
    s_add_u32 s38, s34, 4096
    v_cvt_pk_bf16_f32 v143, v154, v155
    v_add_f32 v178, v178, v174
    v_mfma_f32_16x16x32_bf16 v[92:95], a[192:195], v[36:39], v[160:163]
    buffer_load_dwordx4 v1, s[16:19], s38 offen offset:0 sc1 lds
    v_exp_f32 v149, v109
    v_mfma_f32_16x16x32_bf16 v[92:95], a[196:199], v[40:43], v[92:95]
    v_add_f32 v175, v148, v149
    v_cvt_pk_bf16_f32 v144, v148, v149
    v_mfma_f32_16x16x32_bf16 v[92:95], a[200:203], v[44:47], v[92:95]
    v_exp_f32 v150, v110
    v_mfma_f32_16x16x32_bf16 v[92:95], a[204:207], v[48:51], v[92:95]
    ds_read_b128 a[232:235], v2 offset:51200
    v_add_f32 v175, v175, v150
    v_mfma_f32_16x16x32_bf16 v[96:99], a[208:211], v[36:39], v[160:163]
    v_exp_f32 v151, v111
    v_mfma_f32_16x16x32_bf16 v[96:99], a[212:215], v[40:43], v[96:99]
    v_add_f32 v175, v175, v151
    v_cvt_pk_bf16_f32 v145, v150, v151
    v_mfma_f32_16x16x32_bf16 v[96:99], a[216:219], v[44:47], v[96:99]
    buffer_load_dwordx4 v1, s[16:19], s38 offen offset:1024 sc1 lds
    v_exp_f32 v152, v112
    v_mfma_f32_16x16x32_bf16 v[96:99], a[220:223], v[48:51], v[96:99]
    ds_read_b128 a[236:239], v2 offset:52224
    v_add_f32 v175, v175, v152
    v_mfma_f32_16x16x32_bf16 v[100:103], a[192:195], v[52:55], v[164:167]
    v_exp_f32 v153, v113
    v_mfma_f32_16x16x32_bf16 v[100:103], a[196:199], v[56:59], v[100:103]
    v_add_f32 v175, v175, v153
    v_cvt_pk_bf16_f32 v146, v152, v153
    v_mfma_f32_16x16x32_bf16 v[100:103], a[200:203], v[60:63], v[100:103]
    v_exp_f32 v154, v114
    v_mfma_f32_16x16x32_bf16 v[100:103], a[204:207], v[64:67], v[100:103]
    ds_read_b128 a[240:243], v2 offset:53248
    v_add_f32 v175, v175, v154
    v_mfma_f32_16x16x32_bf16 v[104:107], a[208:211], v[52:55], v[164:167]
    buffer_load_dwordx4 v1, s[16:19], s38 offen offset:2048 sc1 lds
    v_exp_f32 v155, v115
    v_mfma_f32_16x16x32_bf16 v[104:107], a[212:215], v[56:59], v[104:107]
    ds_read_b128 a[244:247], v2 offset:54272
    v_add_f32 v175, v175, v155
    v_mfma_f32_16x16x32_bf16 v[104:107], a[216:219], v[60:63], v[104:107]
    v_exp_f32 v148, v84
    v_mfma_f32_16x16x32_bf16 v[104:107], a[220:223], v[64:67], v[104:107]
    v_cvt_pk_bf16_f32 v147, v154, v155
    v_add_f32 v179, v179, v175
    v_mfma_f32_16x16x32_bf16 v[108:111], a[192:195], v[68:71], v[168:171]
    v_exp_f32 v149, v85
    v_mfma_f32_16x16x32_bf16 v[108:111], a[196:199], v[72:75], v[108:111]
    v_add_f32 v172, v148, v149
    v_cvt_pk_bf16_f32 v116, v148, v149
    v_mfma_f32_16x16x32_bf16 v[108:111], a[200:203], v[76:79], v[108:111]
    buffer_load_dwordx4 v1, s[16:19], s38 offen offset:3072 sc1 lds
    v_exp_f32 v150, v86
    v_mfma_f32_16x16x32_bf16 v[108:111], a[204:207], v[80:83], v[108:111]
    ds_read_b128 a[248:251], v2 offset:55296
    s_add_u32 s34, s34, 32768
    v_add_f32 v172, v172, v150
    v_mfma_f32_16x16x32_bf16 v[112:115], a[208:211], v[68:71], v[168:171]
    v_exp_f32 v151, v87
    v_mfma_f32_16x16x32_bf16 v[112:115], a[212:215], v[72:75], v[112:115]
    v_add_f32 v172, v172, v151
    v_cvt_pk_bf16_f32 v117, v150, v151
    v_mfma_f32_16x16x32_bf16 v[112:115], a[216:219], v[76:79], v[112:115]
    v_exp_f32 v152, v88
    v_mfma_f32_16x16x32_bf16 v[112:115], a[220:223], v[80:83], v[112:115]
    s_waitcnt lgkmcnt(0)
    ds_read_b128 a[252:255], v2 offset:56320
    v_add_f32 v172, v172, v152
    v_mfma_f32_16x16x32_bf16 a[0:3], a[224:227], v[132:135], a[0:3]
    v_exp_f32 v153, v89
    v_mfma_f32_16x16x32_bf16 a[4:7], a[228:231], v[132:135], a[4:7]
    v_add_f32 v172, v172, v153
    v_cvt_pk_bf16_f32 v118, v152, v153
    v_mfma_f32_16x16x32_bf16 a[8:11], a[232:235], v[132:135], a[8:11]
    v_exp_f32 v154, v90
    v_mfma_f32_16x16x32_bf16 a[12:15], a[236:239], v[132:135], a[12:15]
    ds_read_b128 a[192:195], v2 offset:24576
    v_add_f32 v172, v172, v154
    v_mfma_f32_16x16x32_bf16 a[16:19], a[240:243], v[132:135], a[16:19]
    v_exp_f32 v155, v91
    v_mfma_f32_16x16x32_bf16 a[20:23], a[244:247], v[132:135], a[20:23]
    ds_read_b128 a[196:199], v2 offset:25600
    v_add_f32 v172, v172, v155
    v_mfma_f32_16x16x32_bf16 a[24:27], a[248:251], v[132:135], a[24:27]
    s_waitcnt lgkmcnt(2)
    v_exp_f32 v148, v92
    v_mfma_f32_16x16x32_bf16 a[28:31], a[252:255], v[132:135], a[28:31]
    v_cvt_pk_bf16_f32 v119, v154, v155
    v_add_f32 v176, v176, v172
    v_mfma_f32_16x16x32_bf16 a[32:35], a[224:227], v[136:139], a[32:35]
    v_exp_f32 v149, v93
    v_mfma_f32_16x16x32_bf16 a[36:39], a[228:231], v[136:139], a[36:39]
    v_add_f32 v173, v148, v149
    v_cvt_pk_bf16_f32 v120, v148, v149
    v_mfma_f32_16x16x32_bf16 a[40:43], a[232:235], v[136:139], a[40:43]
    v_exp_f32 v150, v94
    v_mfma_f32_16x16x32_bf16 a[44:47], a[236:239], v[136:139], a[44:47]
    ds_read_b128 a[200:203], v2 offset:26624
    v_add_f32 v173, v173, v150
    v_mfma_f32_16x16x32_bf16 a[48:51], a[240:243], v[136:139], a[48:51]
    v_exp_f32 v151, v95
    v_mfma_f32_16x16x32_bf16 a[52:55], a[244:247], v[136:139], a[52:55]
    v_add_f32 v173, v173, v151
    v_cvt_pk_bf16_f32 v121, v150, v151
    v_mfma_f32_16x16x32_bf16 a[56:59], a[248:251], v[136:139], a[56:59]
    v_exp_f32 v152, v96
    v_mfma_f32_16x16x32_bf16 a[60:63], a[252:255], v[136:139], a[60:63]
    ds_read_b128 a[204:207], v2 offset:27648
    v_add_f32 v173, v173, v152
    v_mfma_f32_16x16x32_bf16 a[64:67], a[224:227], v[140:143], a[64:67]
    v_exp_f32 v153, v97
    v_mfma_f32_16x16x32_bf16 a[68:71], a[228:231], v[140:143], a[68:71]
    v_add_f32 v173, v173, v153
    v_cvt_pk_bf16_f32 v122, v152, v153
    v_mfma_f32_16x16x32_bf16 a[72:75], a[232:235], v[140:143], a[72:75]
    v_exp_f32 v154, v98
    v_mfma_f32_16x16x32_bf16 a[76:79], a[236:239], v[140:143], a[76:79]
    ds_read_b128 a[208:211], v2 offset:28672
    v_add_f32 v173, v173, v154
    v_mfma_f32_16x16x32_bf16 a[80:83], a[240:243], v[140:143], a[80:83]
    v_exp_f32 v155, v99
    v_mfma_f32_16x16x32_bf16 a[84:87], a[244:247], v[140:143], a[84:87]
    ds_read_b128 a[212:215], v2 offset:29696
    v_add_f32 v173, v173, v155
    v_mfma_f32_16x16x32_bf16 a[88:91], a[248:251], v[140:143], a[88:91]
    v_exp_f32 v148, v100
    v_mfma_f32_16x16x32_bf16 a[92:95], a[252:255], v[140:143], a[92:95]
    v_cvt_pk_bf16_f32 v123, v154, v155
    v_add_f32 v177, v177, v173
    v_mfma_f32_16x16x32_bf16 a[96:99], a[224:227], v[144:147], a[96:99]
    v_exp_f32 v149, v101
    v_mfma_f32_16x16x32_bf16 a[100:103], a[228:231], v[144:147], a[100:103]
    v_add_f32 v174, v148, v149
    v_cvt_pk_bf16_f32 v124, v148, v149
    v_mfma_f32_16x16x32_bf16 a[104:107], a[232:235], v[144:147], a[104:107]
    v_exp_f32 v150, v102
    v_mfma_f32_16x16x32_bf16 a[108:111], a[236:239], v[144:147], a[108:111]
    ds_read_b128 a[216:219], v2 offset:30720
    v_add_f32 v174, v174, v150
    v_mfma_f32_16x16x32_bf16 a[112:115], a[240:243], v[144:147], a[112:115]
    v_exp_f32 v151, v103
    v_mfma_f32_16x16x32_bf16 a[116:119], a[244:247], v[144:147], a[116:119]
    v_add_f32 v174, v174, v151
    v_cvt_pk_bf16_f32 v125, v150, v151
    v_mfma_f32_16x16x32_bf16 a[120:123], a[248:251], v[144:147], a[120:123]
    v_exp_f32 v152, v104
    v_mfma_f32_16x16x32_bf16 a[124:127], a[252:255], v[144:147], a[124:127]
    s_waitcnt lgkmcnt(0)
    ds_read_b128 a[220:223], v2 offset:31744
    v_add_f32 v174, v174, v152
    v_mfma_f32_16x16x32_bf16 v[84:87], a[192:195], v[20:23], v[156:159]
    v_exp_f32 v153, v105
    v_mfma_f32_16x16x32_bf16 v[84:87], a[196:199], v[24:27], v[84:87]
    v_add_f32 v174, v174, v153
    v_cvt_pk_bf16_f32 v126, v152, v153
    v_mfma_f32_16x16x32_bf16 v[84:87], a[200:203], v[28:31], v[84:87]
    v_exp_f32 v154, v106
    v_mfma_f32_16x16x32_bf16 v[84:87], a[204:207], v[32:35], v[84:87]
    ds_read_b128 a[224:227], v2 offset:57344
    v_add_f32 v174, v174, v154
    v_mfma_f32_16x16x32_bf16 v[88:91], a[208:211], v[20:23], v[156:159]
    v_exp_f32 v155, v107
    v_mfma_f32_16x16x32_bf16 v[88:91], a[212:215], v[24:27], v[88:91]
    ds_read_b128 a[228:231], v2 offset:58368
    v_add_f32 v174, v174, v155
    v_mfma_f32_16x16x32_bf16 v[88:91], a[216:219], v[28:31], v[88:91]
    s_waitcnt lgkmcnt(2)
    v_exp_f32 v148, v108
    v_mfma_f32_16x16x32_bf16 v[88:91], a[220:223], v[32:35], v[88:91]
    v_cvt_pk_bf16_f32 v127, v154, v155
    v_add_f32 v178, v178, v174
    v_mfma_f32_16x16x32_bf16 v[92:95], a[192:195], v[36:39], v[160:163]
    v_exp_f32 v149, v109
    v_mfma_f32_16x16x32_bf16 v[92:95], a[196:199], v[40:43], v[92:95]
    v_add_f32 v175, v148, v149
    v_cvt_pk_bf16_f32 v128, v148, v149
    v_mfma_f32_16x16x32_bf16 v[92:95], a[200:203], v[44:47], v[92:95]
    v_exp_f32 v150, v110
    v_mfma_f32_16x16x32_bf16 v[92:95], a[204:207], v[48:51], v[92:95]
    ds_read_b128 a[232:235], v2 offset:59392
    v_add_f32 v175, v175, v150
    v_mfma_f32_16x16x32_bf16 v[96:99], a[208:211], v[36:39], v[160:163]
    v_exp_f32 v151, v111
    v_mfma_f32_16x16x32_bf16 v[96:99], a[212:215], v[40:43], v[96:99]
    v_add_f32 v175, v175, v151
    v_cvt_pk_bf16_f32 v129, v150, v151
    v_mfma_f32_16x16x32_bf16 v[96:99], a[216:219], v[44:47], v[96:99]
    v_exp_f32 v152, v112
    v_mfma_f32_16x16x32_bf16 v[96:99], a[220:223], v[48:51], v[96:99]
    ds_read_b128 a[236:239], v2 offset:60416
    v_add_f32 v175, v175, v152
    v_mfma_f32_16x16x32_bf16 v[100:103], a[192:195], v[52:55], v[164:167]
    v_exp_f32 v153, v113
    v_mfma_f32_16x16x32_bf16 v[100:103], a[196:199], v[56:59], v[100:103]
    v_add_f32 v175, v175, v153
    v_cvt_pk_bf16_f32 v130, v152, v153
    v_mfma_f32_16x16x32_bf16 v[100:103], a[200:203], v[60:63], v[100:103]
    v_exp_f32 v154, v114
    v_mfma_f32_16x16x32_bf16 v[100:103], a[204:207], v[64:67], v[100:103]
    ds_read_b128 a[240:243], v2 offset:61440
    v_add_f32 v175, v175, v154
    v_mfma_f32_16x16x32_bf16 v[104:107], a[208:211], v[52:55], v[164:167]
    v_exp_f32 v155, v115
    v_mfma_f32_16x16x32_bf16 v[104:107], a[212:215], v[56:59], v[104:107]
    ds_read_b128 a[244:247], v2 offset:62464
    v_add_f32 v175, v175, v155
    v_mfma_f32_16x16x32_bf16 v[104:107], a[216:219], v[60:63], v[104:107]
    v_exp_f32 v148, v84
    v_mfma_f32_16x16x32_bf16 v[104:107], a[220:223], v[64:67], v[104:107]
    v_cvt_pk_bf16_f32 v131, v154, v155
    v_add_f32 v179, v179, v175
    v_mfma_f32_16x16x32_bf16 v[108:111], a[192:195], v[68:71], v[168:171]
    v_exp_f32 v149, v85
    v_mfma_f32_16x16x32_bf16 v[108:111], a[196:199], v[72:75], v[108:111]
    ds_read_b128 a[248:251], v2 offset:63488
    v_add_f32 v172, v148, v149
    v_cvt_pk_bf16_f32 v132, v148, v149
    v_mfma_f32_16x16x32_bf16 v[108:111], a[200:203], v[76:79], v[108:111]
    v_exp_f32 v150, v86
    v_mfma_f32_16x16x32_bf16 v[108:111], a[204:207], v[80:83], v[108:111]
    ds_read_b128 a[252:255], v2 offset:64512
    v_add_f32 v172, v172, v150
    v_mfma_f32_16x16x32_bf16 v[112:115], a[208:211], v[68:71], v[168:171]
    v_exp_f32 v151, v87
    v_mfma_f32_16x16x32_bf16 v[112:115], a[212:215], v[72:75], v[112:115]
    v_add_f32 v172, v172, v151
    v_cvt_pk_bf16_f32 v133, v150, v151
    v_mfma_f32_16x16x32_bf16 v[112:115], a[216:219], v[76:79], v[112:115]
    v_exp_f32 v152, v88
    v_mfma_f32_16x16x32_bf16 v[112:115], a[220:223], v[80:83], v[112:115]
    s_waitcnt lgkmcnt(0)
    v_add_f32 v172, v172, v152
    v_mfma_f32_16x16x32_bf16 a[0:3], a[224:227], v[116:119], a[0:3]
    v_exp_f32 v153, v89
    v_mfma_f32_16x16x32_bf16 a[4:7], a[228:231], v[116:119], a[4:7]
    s_waitcnt vmcnt(0) lgkmcnt(0)
    s_barrier
    v_add_f32 v172, v172, v153
    v_cvt_pk_bf16_f32 v134, v152, v153
    v_mfma_f32_16x16x32_bf16 a[8:11], a[232:235], v[116:119], a[8:11]
    v_exp_f32 v154, v90
    v_mfma_f32_16x16x32_bf16 a[12:15], a[236:239], v[116:119], a[12:15]
    ds_read_b128 a[192:195], v3 offset:32768
    v_add_f32 v172, v172, v154
    v_mfma_f32_16x16x32_bf16 a[16:19], a[240:243], v[116:119], a[16:19]
    v_exp_f32 v155, v91
    v_mfma_f32_16x16x32_bf16 a[20:23], a[244:247], v[116:119], a[20:23]
    ds_read_b128 a[196:199], v3 offset:33792
    v_add_f32 v172, v172, v155
    v_mfma_f32_16x16x32_bf16 a[24:27], a[248:251], v[116:119], a[24:27]
    v_exp_f32 v148, v92
    v_mfma_f32_16x16x32_bf16 a[28:31], a[252:255], v[116:119], a[28:31]
    v_cvt_pk_bf16_f32 v135, v154, v155
    v_add_f32 v176, v176, v172
    v_mfma_f32_16x16x32_bf16 a[32:35], a[224:227], v[120:123], a[32:35]
    v_exp_f32 v149, v93
    v_mfma_f32_16x16x32_bf16 a[36:39], a[228:231], v[120:123], a[36:39]
    v_add_f32 v173, v148, v149
    v_cvt_pk_bf16_f32 v136, v148, v149
    v_mfma_f32_16x16x32_bf16 a[40:43], a[232:235], v[120:123], a[40:43]
    v_exp_f32 v150, v94
    v_mfma_f32_16x16x32_bf16 a[44:47], a[236:239], v[120:123], a[44:47]
    ds_read_b128 a[200:203], v3 offset:34816
    v_add_f32 v173, v173, v150
    v_mfma_f32_16x16x32_bf16 a[48:51], a[240:243], v[120:123], a[48:51]
    v_exp_f32 v151, v95
    v_mfma_f32_16x16x32_bf16 a[52:55], a[244:247], v[120:123], a[52:55]
    v_add_f32 v173, v173, v151
    v_cvt_pk_bf16_f32 v137, v150, v151
    v_mfma_f32_16x16x32_bf16 a[56:59], a[248:251], v[120:123], a[56:59]
    v_exp_f32 v152, v96
    v_mfma_f32_16x16x32_bf16 a[60:63], a[252:255], v[120:123], a[60:63]
    ds_read_b128 a[204:207], v3 offset:35840
    v_add_f32 v173, v173, v152
    v_mfma_f32_16x16x32_bf16 a[64:67], a[224:227], v[124:127], a[64:67]
    v_exp_f32 v153, v97
    v_mfma_f32_16x16x32_bf16 a[68:71], a[228:231], v[124:127], a[68:71]
    v_add_f32 v173, v173, v153
    v_cvt_pk_bf16_f32 v138, v152, v153
    v_mfma_f32_16x16x32_bf16 a[72:75], a[232:235], v[124:127], a[72:75]
    v_exp_f32 v154, v98
    v_mfma_f32_16x16x32_bf16 a[76:79], a[236:239], v[124:127], a[76:79]
    ds_read_b128 a[208:211], v3 offset:36864
    v_add_f32 v173, v173, v154
    v_mfma_f32_16x16x32_bf16 a[80:83], a[240:243], v[124:127], a[80:83]
    v_exp_f32 v155, v99
    v_mfma_f32_16x16x32_bf16 a[84:87], a[244:247], v[124:127], a[84:87]
    ds_read_b128 a[212:215], v3 offset:37888
    v_add_f32 v173, v173, v155
    v_mfma_f32_16x16x32_bf16 a[88:91], a[248:251], v[124:127], a[88:91]
    v_exp_f32 v148, v100
    v_mfma_f32_16x16x32_bf16 a[92:95], a[252:255], v[124:127], a[92:95]
    v_cvt_pk_bf16_f32 v139, v154, v155
    v_add_f32 v177, v177, v173
    v_mfma_f32_16x16x32_bf16 a[96:99], a[224:227], v[128:131], a[96:99]
    v_exp_f32 v149, v101
    v_mfma_f32_16x16x32_bf16 a[100:103], a[228:231], v[128:131], a[100:103]
    v_add_f32 v174, v148, v149
    v_cvt_pk_bf16_f32 v140, v148, v149
    v_mfma_f32_16x16x32_bf16 a[104:107], a[232:235], v[128:131], a[104:107]
    v_exp_f32 v150, v102
    v_mfma_f32_16x16x32_bf16 a[108:111], a[236:239], v[128:131], a[108:111]
    ds_read_b128 a[216:219], v3 offset:38912
    v_add_f32 v174, v174, v150
    v_mfma_f32_16x16x32_bf16 a[112:115], a[240:243], v[128:131], a[112:115]
    v_exp_f32 v151, v103
    v_mfma_f32_16x16x32_bf16 a[116:119], a[244:247], v[128:131], a[116:119]
    v_add_f32 v174, v174, v151
    v_cvt_pk_bf16_f32 v141, v150, v151
    v_mfma_f32_16x16x32_bf16 a[120:123], a[248:251], v[128:131], a[120:123]
    v_exp_f32 v152, v104
    v_mfma_f32_16x16x32_bf16 a[124:127], a[252:255], v[128:131], a[124:127]
    s_waitcnt lgkmcnt(0)
    ds_read_b128 a[220:223], v3 offset:39936
    v_add_f32 v174, v174, v152
    v_mfma_f32_16x16x32_bf16 a[0:3], a[192:195], v[132:135], a[0:3]
    v_exp_f32 v153, v105
    v_mfma_f32_16x16x32_bf16 a[4:7], a[196:199], v[132:135], a[4:7]
    v_add_f32 v174, v174, v153
    v_cvt_pk_bf16_f32 v142, v152, v153
    v_mfma_f32_16x16x32_bf16 a[8:11], a[200:203], v[132:135], a[8:11]
    v_exp_f32 v154, v106
    v_mfma_f32_16x16x32_bf16 a[12:15], a[204:207], v[132:135], a[12:15]
    v_add_f32 v174, v174, v154
    v_mfma_f32_16x16x32_bf16 a[16:19], a[208:211], v[132:135], a[16:19]
    v_exp_f32 v155, v107
    v_mfma_f32_16x16x32_bf16 a[20:23], a[212:215], v[132:135], a[20:23]
    v_add_f32 v174, v174, v155
    v_mfma_f32_16x16x32_bf16 a[24:27], a[216:219], v[132:135], a[24:27]
    s_waitcnt lgkmcnt(0)
    v_exp_f32 v148, v108
    v_mfma_f32_16x16x32_bf16 a[28:31], a[220:223], v[132:135], a[28:31]
    v_cvt_pk_bf16_f32 v143, v154, v155
    v_add_f32 v178, v178, v174
    v_mfma_f32_16x16x32_bf16 a[32:35], a[192:195], v[136:139], a[32:35]
    v_exp_f32 v149, v109
    v_mfma_f32_16x16x32_bf16 a[36:39], a[196:199], v[136:139], a[36:39]
    v_add_f32 v175, v148, v149
    v_cvt_pk_bf16_f32 v144, v148, v149
    v_mfma_f32_16x16x32_bf16 a[40:43], a[200:203], v[136:139], a[40:43]
    v_exp_f32 v150, v110
    v_mfma_f32_16x16x32_bf16 a[44:47], a[204:207], v[136:139], a[44:47]
    v_add_f32 v175, v175, v150
    v_mfma_f32_16x16x32_bf16 a[48:51], a[208:211], v[136:139], a[48:51]
    v_exp_f32 v151, v111
    v_mfma_f32_16x16x32_bf16 a[52:55], a[212:215], v[136:139], a[52:55]
    v_add_f32 v175, v175, v151
    v_cvt_pk_bf16_f32 v145, v150, v151
    v_mfma_f32_16x16x32_bf16 a[56:59], a[216:219], v[136:139], a[56:59]
    v_exp_f32 v152, v112
    v_mfma_f32_16x16x32_bf16 a[60:63], a[220:223], v[136:139], a[60:63]
    v_add_f32 v175, v175, v152
    v_mfma_f32_16x16x32_bf16 a[64:67], a[192:195], v[140:143], a[64:67]
    v_exp_f32 v153, v113
    v_mfma_f32_16x16x32_bf16 a[68:71], a[196:199], v[140:143], a[68:71]
    v_add_f32 v175, v175, v153
    v_cvt_pk_bf16_f32 v146, v152, v153
    v_mfma_f32_16x16x32_bf16 a[72:75], a[200:203], v[140:143], a[72:75]
    v_exp_f32 v154, v114
    v_mfma_f32_16x16x32_bf16 a[76:79], a[204:207], v[140:143], a[76:79]
    v_add_f32 v175, v175, v154
    v_mfma_f32_16x16x32_bf16 a[80:83], a[208:211], v[140:143], a[80:83]
    v_exp_f32 v155, v115
    v_mfma_f32_16x16x32_bf16 a[84:87], a[212:215], v[140:143], a[84:87]
    v_add_f32 v175, v175, v155
    v_mfma_f32_16x16x32_bf16 a[88:91], a[216:219], v[140:143], a[88:91]
    v_mfma_f32_16x16x32_bf16 a[92:95], a[220:223], v[140:143], a[92:95]
    v_cvt_pk_bf16_f32 v147, v154, v155
    v_add_f32 v179, v179, v175
    s_nop 0
    s_nop 0
    v_mfma_f32_16x16x32_bf16 a[96:99], a[192:195], v[144:147], a[96:99]
    v_mfma_f32_16x16x32_bf16 a[100:103], a[196:199], v[144:147], a[100:103]
    v_mfma_f32_16x16x32_bf16 a[104:107], a[200:203], v[144:147], a[104:107]
    v_mfma_f32_16x16x32_bf16 a[108:111], a[204:207], v[144:147], a[108:111]
    v_mfma_f32_16x16x32_bf16 a[112:115], a[208:211], v[144:147], a[112:115]
    v_mfma_f32_16x16x32_bf16 a[116:119], a[212:215], v[144:147], a[116:119]
    v_mfma_f32_16x16x32_bf16 a[120:123], a[216:219], v[144:147], a[120:123]
    v_mfma_f32_16x16x32_bf16 a[124:127], a[220:223], v[144:147], a[124:127]
L_mega_kernel_post:
    s_barrier
    s_nop 7
    s_lshl_b32 s38, s26, 4
    s_lshl_b32 s39, s24, 2
    s_add_u32 s38, s38, s39
    s_lshl_b32 s38, s38, 17
    s_lshl_b32 s39, s25, 12
    s_add_u32 s38, s38, s39
    v_mov_b32 v172, v176
    v_mov_b32 v173, v177
    v_mov_b32 v174, v178
    v_mov_b32 v175, v179
    v_mov_b32 v180, v172
    v_mov_b32 v181, v173
    v_mov_b32 v182, v174
    v_mov_b32 v183, v175
    s_nop 0
    v_permlane16_swap_b32 v172, v180
    v_permlane16_swap_b32 v173, v181
    v_permlane16_swap_b32 v174, v182
    v_permlane16_swap_b32 v175, v183
    v_add_f32 v172, v172, v180
    v_add_f32 v173, v173, v181
    v_add_f32 v174, v174, v182
    v_add_f32 v175, v175, v183
    v_mov_b32 v180, v172
    v_mov_b32 v181, v173
    v_mov_b32 v182, v174
    v_mov_b32 v183, v175
    s_nop 0
    v_permlane32_swap_b32 v172, v180
    v_permlane32_swap_b32 v173, v181
    v_permlane32_swap_b32 v174, v182
    v_permlane32_swap_b32 v175, v183
    v_add_f32 v172, v172, v180
    v_add_f32 v173, v173, v181
    v_add_f32 v174, v174, v182
    v_add_f32 v175, v175, v183
    v_rcp_f32 v216, v172
    v_rcp_f32 v218, v173
    v_rcp_f32 v220, v174
    v_rcp_f32 v222, v175
    v_mov_b32 v217, v216
    v_mov_b32 v219, v218
    v_mov_b32 v221, v220
    v_mov_b32 v223, v222
    s_mov_b32 s44, 0x5f800000
    v_max3_f32 v180, v172, v173, v174
    v_max_f32 v180, v180, v175
    v_add_f32 v181, v172, v173
    v_add_f32 v182, v174, v175
    v_add_f32 v181, v181, v182
    v_cmp_nlt_f32 vcc, v180, s44
    v_cmp_u_f32 s[40:41], v181, v181
    s_nop 1
    s_or_b64 vcc, vcc, s[40:41]
    s_cmp_lg_u64 vcc, 0
    s_cselect_b32 s44, 1, 0
    s_lshl_b32 s45, s24, 2
    s_add_u32 s45, s45, 0x10000
    v_mov_b32 v180, s45
    v_mov_b32 v181, s44
    ds_write_b32 v180, v181
    s_nop 0
    v_accvgpr_read_b32 v180, a0
    v_accvgpr_read_b32 v181, a1
    v_accvgpr_read_b32 v182, a2
    v_accvgpr_read_b32 v183, a3
    v_accvgpr_read_b32 v184, a4
    v_accvgpr_read_b32 v185, a5
    v_accvgpr_read_b32 v186, a6
    v_accvgpr_read_b32 v187, a7
    v_pk_mul_f32 v[180:181], v[180:181], v[216:217]
    v_pk_mul_f32 v[182:183], v[182:183], v[216:217]
    v_pk_mul_f32 v[184:185], v[184:185], v[216:217]
    v_pk_mul_f32 v[186:187], v[186:187], v[216:217]
    v_cvt_pk_bf16_f32 v196, v180, v181
    v_cvt_pk_bf16_f32 v197, v182, v183
    v_cvt_pk_bf16_f32 v198, v184, v185
    v_cvt_pk_bf16_f32 v199, v186, v187
    buffer_store_dwordx4 v[196:199], v1, s[20:23], s38 offen offset:0 sc1
    v_accvgpr_read_b32 v188, a8
    v_accvgpr_read_b32 v189, a9
    v_accvgpr_read_b32 v190, a10
    v_accvgpr_read_b32 v191, a11
    v_accvgpr_read_b32 v192, a12
    v_accvgpr_read_b32 v193, a13
    v_accvgpr_read_b32 v194, a14
    v_accvgpr_read_b32 v195, a15
    v_pk_mul_f32 v[188:189], v[188:189], v[216:217]
    v_pk_mul_f32 v[190:191], v[190:191], v[216:217]
    v_pk_mul_f32 v[192:193], v[192:193], v[216:217]
    v_pk_mul_f32 v[194:195], v[194:195], v[216:217]
    v_cvt_pk_bf16_f32 v200, v188, v189
    v_cvt_pk_bf16_f32 v201, v190, v191
    v_cvt_pk_bf16_f32 v202, v192, v193
    v_cvt_pk_bf16_f32 v203, v194, v195
    buffer_store_dwordx4 v[200:203], v1, s[20:23], s38 offen offset:1024 sc1
    v_accvgpr_read_b32 v180, a16
    v_accvgpr_read_b32 v181, a17
    v_accvgpr_read_b32 v182, a18
    v_accvgpr_read_b32 v183, a19
    v_accvgpr_read_b32 v184, a20
    v_accvgpr_read_b32 v185, a21
    v_accvgpr_read_b32 v186, a22
    v_accvgpr_read_b32 v187, a23
    v_pk_mul_f32 v[180:181], v[180:181], v[216:217]
    v_pk_mul_f32 v[182:183], v[182:183], v[216:217]
    v_pk_mul_f32 v[184:185], v[184:185], v[216:217]
    v_pk_mul_f32 v[186:187], v[186:187], v[216:217]
    v_cvt_pk_bf16_f32 v204, v180, v181
    v_cvt_pk_bf16_f32 v205, v182, v183
    v_cvt_pk_bf16_f32 v206, v184, v185
    v_cvt_pk_bf16_f32 v207, v186, v187
    buffer_store_dwordx4 v[204:207], v1, s[20:23], s38 offen offset:2048 sc1
    v_accvgpr_read_b32 v188, a24
    v_accvgpr_read_b32 v189, a25
    v_accvgpr_read_b32 v190, a26
    v_accvgpr_read_b32 v191, a27
    v_accvgpr_read_b32 v192, a28
    v_accvgpr_read_b32 v193, a29
    v_accvgpr_read_b32 v194, a30
    v_accvgpr_read_b32 v195, a31
    v_pk_mul_f32 v[188:189], v[188:189], v[216:217]
    v_pk_mul_f32 v[190:191], v[190:191], v[216:217]
    v_pk_mul_f32 v[192:193], v[192:193], v[216:217]
    v_pk_mul_f32 v[194:195], v[194:195], v[216:217]
    v_cvt_pk_bf16_f32 v208, v188, v189
    v_cvt_pk_bf16_f32 v209, v190, v191
    v_cvt_pk_bf16_f32 v210, v192, v193
    v_cvt_pk_bf16_f32 v211, v194, v195
    buffer_store_dwordx4 v[208:211], v1, s[20:23], s38 offen offset:3072 sc1
    s_add_u32 s38, s38, 0x20000
    v_accvgpr_read_b32 v180, a32
    v_accvgpr_read_b32 v181, a33
    v_accvgpr_read_b32 v182, a34
    v_accvgpr_read_b32 v183, a35
    v_accvgpr_read_b32 v184, a36
    v_accvgpr_read_b32 v185, a37
    v_accvgpr_read_b32 v186, a38
    v_accvgpr_read_b32 v187, a39
    v_pk_mul_f32 v[180:181], v[180:181], v[218:219]
    v_pk_mul_f32 v[182:183], v[182:183], v[218:219]
    v_pk_mul_f32 v[184:185], v[184:185], v[218:219]
    v_pk_mul_f32 v[186:187], v[186:187], v[218:219]
    v_cvt_pk_bf16_f32 v196, v180, v181
    v_cvt_pk_bf16_f32 v197, v182, v183
    v_cvt_pk_bf16_f32 v198, v184, v185
    v_cvt_pk_bf16_f32 v199, v186, v187
    buffer_store_dwordx4 v[196:199], v1, s[20:23], s38 offen offset:0 sc1
    v_accvgpr_read_b32 v188, a40
    v_accvgpr_read_b32 v189, a41
    v_accvgpr_read_b32 v190, a42
    v_accvgpr_read_b32 v191, a43
    v_accvgpr_read_b32 v192, a44
    v_accvgpr_read_b32 v193, a45
    v_accvgpr_read_b32 v194, a46
    v_accvgpr_read_b32 v195, a47
    v_pk_mul_f32 v[188:189], v[188:189], v[218:219]
    v_pk_mul_f32 v[190:191], v[190:191], v[218:219]
    v_pk_mul_f32 v[192:193], v[192:193], v[218:219]
    v_pk_mul_f32 v[194:195], v[194:195], v[218:219]
    v_cvt_pk_bf16_f32 v200, v188, v189
    v_cvt_pk_bf16_f32 v201, v190, v191
    v_cvt_pk_bf16_f32 v202, v192, v193
    v_cvt_pk_bf16_f32 v203, v194, v195
    buffer_store_dwordx4 v[200:203], v1, s[20:23], s38 offen offset:1024 sc1
    v_accvgpr_read_b32 v180, a48
    v_accvgpr_read_b32 v181, a49
    v_accvgpr_read_b32 v182, a50
    v_accvgpr_read_b32 v183, a51
    v_accvgpr_read_b32 v184, a52
    v_accvgpr_read_b32 v185, a53
    v_accvgpr_read_b32 v186, a54
    v_accvgpr_read_b32 v187, a55
    v_pk_mul_f32 v[180:181], v[180:181], v[218:219]
    v_pk_mul_f32 v[182:183], v[182:183], v[218:219]
    v_pk_mul_f32 v[184:185], v[184:185], v[218:219]
    v_pk_mul_f32 v[186:187], v[186:187], v[218:219]
    v_cvt_pk_bf16_f32 v204, v180, v181
    v_cvt_pk_bf16_f32 v205, v182, v183
    v_cvt_pk_bf16_f32 v206, v184, v185
    v_cvt_pk_bf16_f32 v207, v186, v187
    buffer_store_dwordx4 v[204:207], v1, s[20:23], s38 offen offset:2048 sc1
    v_accvgpr_read_b32 v188, a56
    v_accvgpr_read_b32 v189, a57
    v_accvgpr_read_b32 v190, a58
    v_accvgpr_read_b32 v191, a59
    v_accvgpr_read_b32 v192, a60
    v_accvgpr_read_b32 v193, a61
    v_accvgpr_read_b32 v194, a62
    v_accvgpr_read_b32 v195, a63
    v_pk_mul_f32 v[188:189], v[188:189], v[218:219]
    v_pk_mul_f32 v[190:191], v[190:191], v[218:219]
    v_pk_mul_f32 v[192:193], v[192:193], v[218:219]
    v_pk_mul_f32 v[194:195], v[194:195], v[218:219]
    v_cvt_pk_bf16_f32 v208, v188, v189
    v_cvt_pk_bf16_f32 v209, v190, v191
    v_cvt_pk_bf16_f32 v210, v192, v193
    v_cvt_pk_bf16_f32 v211, v194, v195
    buffer_store_dwordx4 v[208:211], v1, s[20:23], s38 offen offset:3072 sc1
    s_add_u32 s38, s38, 0x20000
    v_accvgpr_read_b32 v180, a64
    v_accvgpr_read_b32 v181, a65
    v_accvgpr_read_b32 v182, a66
    v_accvgpr_read_b32 v183, a67
    v_accvgpr_read_b32 v184, a68
    v_accvgpr_read_b32 v185, a69
    v_accvgpr_read_b32 v186, a70
    v_accvgpr_read_b32 v187, a71
    v_pk_mul_f32 v[180:181], v[180:181], v[220:221]
    v_pk_mul_f32 v[182:183], v[182:183], v[220:221]
    v_pk_mul_f32 v[184:185], v[184:185], v[220:221]
    v_pk_mul_f32 v[186:187], v[186:187], v[220:221]
    v_cvt_pk_bf16_f32 v196, v180, v181
    v_cvt_pk_bf16_f32 v197, v182, v183
    v_cvt_pk_bf16_f32 v198, v184, v185
    v_cvt_pk_bf16_f32 v199, v186, v187
    buffer_store_dwordx4 v[196:199], v1, s[20:23], s38 offen offset:0 sc1
    v_accvgpr_read_b32 v188, a72
    v_accvgpr_read_b32 v189, a73
    v_accvgpr_read_b32 v190, a74
    v_accvgpr_read_b32 v191, a75
    v_accvgpr_read_b32 v192, a76
    v_accvgpr_read_b32 v193, a77
    v_accvgpr_read_b32 v194, a78
    v_accvgpr_read_b32 v195, a79
    v_pk_mul_f32 v[188:189], v[188:189], v[220:221]
    v_pk_mul_f32 v[190:191], v[190:191], v[220:221]
    v_pk_mul_f32 v[192:193], v[192:193], v[220:221]
    v_pk_mul_f32 v[194:195], v[194:195], v[220:221]
    v_cvt_pk_bf16_f32 v200, v188, v189
    v_cvt_pk_bf16_f32 v201, v190, v191
    v_cvt_pk_bf16_f32 v202, v192, v193
    v_cvt_pk_bf16_f32 v203, v194, v195
    buffer_store_dwordx4 v[200:203], v1, s[20:23], s38 offen offset:1024 sc1
    v_accvgpr_read_b32 v180, a80
    v_accvgpr_read_b32 v181, a81
    v_accvgpr_read_b32 v182, a82
    v_accvgpr_read_b32 v183, a83
    v_accvgpr_read_b32 v184, a84
    v_accvgpr_read_b32 v185, a85
    v_accvgpr_read_b32 v186, a86
    v_accvgpr_read_b32 v187, a87
    v_pk_mul_f32 v[180:181], v[180:181], v[220:221]
    v_pk_mul_f32 v[182:183], v[182:183], v[220:221]
    v_pk_mul_f32 v[184:185], v[184:185], v[220:221]
    v_pk_mul_f32 v[186:187], v[186:187], v[220:221]
    v_cvt_pk_bf16_f32 v204, v180, v181
    v_cvt_pk_bf16_f32 v205, v182, v183
    v_cvt_pk_bf16_f32 v206, v184, v185
    v_cvt_pk_bf16_f32 v207, v186, v187
    buffer_store_dwordx4 v[204:207], v1, s[20:23], s38 offen offset:2048 sc1
    v_accvgpr_read_b32 v188, a88
    v_accvgpr_read_b32 v189, a89
    v_accvgpr_read_b32 v190, a90
    v_accvgpr_read_b32 v191, a91
    v_accvgpr_read_b32 v192, a92
    v_accvgpr_read_b32 v193, a93
    v_accvgpr_read_b32 v194, a94
    v_accvgpr_read_b32 v195, a95
    v_pk_mul_f32 v[188:189], v[188:189], v[220:221]
    v_pk_mul_f32 v[190:191], v[190:191], v[220:221]
    v_pk_mul_f32 v[192:193], v[192:193], v[220:221]
    v_pk_mul_f32 v[194:195], v[194:195], v[220:221]
    v_cvt_pk_bf16_f32 v208, v188, v189
    v_cvt_pk_bf16_f32 v209, v190, v191
    v_cvt_pk_bf16_f32 v210, v192, v193
    v_cvt_pk_bf16_f32 v211, v194, v195
    buffer_store_dwordx4 v[208:211], v1, s[20:23], s38 offen offset:3072 sc1
    s_add_u32 s38, s38, 0x20000
    v_accvgpr_read_b32 v180, a96
    v_accvgpr_read_b32 v181, a97
    v_accvgpr_read_b32 v182, a98
    v_accvgpr_read_b32 v183, a99
    v_accvgpr_read_b32 v184, a100
    v_accvgpr_read_b32 v185, a101
    v_accvgpr_read_b32 v186, a102
    v_accvgpr_read_b32 v187, a103
    v_pk_mul_f32 v[180:181], v[180:181], v[222:223]
    v_pk_mul_f32 v[182:183], v[182:183], v[222:223]
    v_pk_mul_f32 v[184:185], v[184:185], v[222:223]
    v_pk_mul_f32 v[186:187], v[186:187], v[222:223]
    v_cvt_pk_bf16_f32 v196, v180, v181
    v_cvt_pk_bf16_f32 v197, v182, v183
    v_cvt_pk_bf16_f32 v198, v184, v185
    v_cvt_pk_bf16_f32 v199, v186, v187
    buffer_store_dwordx4 v[196:199], v1, s[20:23], s38 offen offset:0 sc1
    v_accvgpr_read_b32 v188, a104
    v_accvgpr_read_b32 v189, a105
    v_accvgpr_read_b32 v190, a106
    v_accvgpr_read_b32 v191, a107
    v_accvgpr_read_b32 v192, a108
    v_accvgpr_read_b32 v193, a109
    v_accvgpr_read_b32 v194, a110
    v_accvgpr_read_b32 v195, a111
    v_pk_mul_f32 v[188:189], v[188:189], v[222:223]
    v_pk_mul_f32 v[190:191], v[190:191], v[222:223]
    v_pk_mul_f32 v[192:193], v[192:193], v[222:223]
    v_pk_mul_f32 v[194:195], v[194:195], v[222:223]
    v_cvt_pk_bf16_f32 v200, v188, v189
    v_cvt_pk_bf16_f32 v201, v190, v191
    v_cvt_pk_bf16_f32 v202, v192, v193
    v_cvt_pk_bf16_f32 v203, v194, v195
    buffer_store_dwordx4 v[200:203], v1, s[20:23], s38 offen offset:1024 sc1
    v_accvgpr_read_b32 v180, a112
    v_accvgpr_read_b32 v181, a113
    v_accvgpr_read_b32 v182, a114
    v_accvgpr_read_b32 v183, a115
    v_accvgpr_read_b32 v184, a116
    v_accvgpr_read_b32 v185, a117
    v_accvgpr_read_b32 v186, a118
    v_accvgpr_read_b32 v187, a119
    v_pk_mul_f32 v[180:181], v[180:181], v[222:223]
    v_pk_mul_f32 v[182:183], v[182:183], v[222:223]
    v_pk_mul_f32 v[184:185], v[184:185], v[222:223]
    v_pk_mul_f32 v[186:187], v[186:187], v[222:223]
    v_cvt_pk_bf16_f32 v204, v180, v181
    v_cvt_pk_bf16_f32 v205, v182, v183
    v_cvt_pk_bf16_f32 v206, v184, v185
    v_cvt_pk_bf16_f32 v207, v186, v187
    buffer_store_dwordx4 v[204:207], v1, s[20:23], s38 offen offset:2048 sc1
    v_accvgpr_read_b32 v188, a120
    v_accvgpr_read_b32 v189, a121
    v_accvgpr_read_b32 v190, a122
    v_accvgpr_read_b32 v191, a123
    v_accvgpr_read_b32 v192, a124
    v_accvgpr_read_b32 v193, a125
    v_accvgpr_read_b32 v194, a126
    v_accvgpr_read_b32 v195, a127
    v_pk_mul_f32 v[188:189], v[188:189], v[222:223]
    v_pk_mul_f32 v[190:191], v[190:191], v[222:223]
    v_pk_mul_f32 v[192:193], v[192:193], v[222:223]
    v_pk_mul_f32 v[194:195], v[194:195], v[222:223]
    v_cvt_pk_bf16_f32 v208, v188, v189
    v_cvt_pk_bf16_f32 v209, v190, v191
    v_cvt_pk_bf16_f32 v210, v192, v193
    v_cvt_pk_bf16_f32 v211, v194, v195
    buffer_store_dwordx4 v[208:211], v1, s[20:23], s38 offen offset:3072 sc1
    s_waitcnt lgkmcnt(0)
    s_barrier
    v_mov_b32 v180, 0x10000
    ds_read_b128 v[184:187], v180
    s_waitcnt lgkmcnt(0)
    v_or3_b32 v180, v184, v185, v186
    v_or_b32 v180, v180, v187
    s_nop 0
    v_readfirstlane_b32 s44, v180
    s_andn2_b32 s44, s44, s3
    s_cmp_lg_u32 s44, 0
    s_cbranch_scc1 L_mega_kernel_fallback
    s_add_u32 s38, s26, 256
    s_lshl_b32 s90, s38, 7
    s_lshl_b32 s38, s25, 2
    s_add_u32 s90, s90, s38
    s_branch L_mega_kernel_next
L_mega_kernel_end:
    s_endpgm
L_mega_kernel_checked:
    s_mov_b32 s32, 15
.p2align 6
L_mega_kernel_mainc:
    v_mfma_f32_16x16x32_bf16 v[84:87], a[192:195], v[20:23], v[156:159]
    v_exp_f32 v153, v105
    v_mfma_f32_16x16x32_bf16 v[84:87], a[196:199], v[24:27], v[84:87]
    v_add_f32 v174, v174, v153
    v_cvt_pk_bf16_f32 v126, v152, v153
    v_mfma_f32_16x16x32_bf16 v[84:87], a[200:203], v[28:31], v[84:87]
    v_exp_f32 v154, v106
    v_mfma_f32_16x16x32_bf16 v[84:87], a[204:207], v[32:35], v[84:87]
    ds_read_b128 a[224:227], v2 offset:40960
    v_add_f32 v174, v174, v154
    v_mfma_f32_16x16x32_bf16 v[88:91], a[208:211], v[20:23], v[156:159]
    v_exp_f32 v155, v107
    v_mfma_f32_16x16x32_bf16 v[88:91], a[212:215], v[24:27], v[88:91]
    ds_read_b128 a[228:231], v2 offset:41984
    v_add_f32 v174, v174, v155
    v_cmp_lt_f32 vcc, s37, v174
    v_mfma_f32_16x16x32_bf16 v[88:91], a[216:219], v[28:31], v[88:91]
    s_waitcnt lgkmcnt(2)
    v_exp_f32 v148, v108
    v_mfma_f32_16x16x32_bf16 v[88:91], a[220:223], v[32:35], v[88:91]
    s_cbranch_vccnz L_mega_kernel_cc_0_7_out
L_mega_kernel_cc_0_7:
    s_add_u32 m0, s35, 32768
    v_cvt_pk_bf16_f32 v127, v154, v155
    v_add_f32 v178, v178, v174
    v_mfma_f32_16x16x32_bf16 v[92:95], a[192:195], v[36:39], v[160:163]
    buffer_load_dwordx4 v1, s[16:19], s34 offen offset:0 sc1 lds
    v_exp_f32 v149, v109
    v_mfma_f32_16x16x32_bf16 v[92:95], a[196:199], v[40:43], v[92:95]
    v_add_f32 v175, v148, v149
    v_cvt_pk_bf16_f32 v128, v148, v149
    v_mfma_f32_16x16x32_bf16 v[92:95], a[200:203], v[44:47], v[92:95]
    v_exp_f32 v150, v110
    v_mfma_f32_16x16x32_bf16 v[92:95], a[204:207], v[48:51], v[92:95]
    ds_read_b128 a[232:235], v2 offset:43008
    v_add_f32 v175, v175, v150
    v_mfma_f32_16x16x32_bf16 v[96:99], a[208:211], v[36:39], v[160:163]
    v_exp_f32 v151, v111
    v_mfma_f32_16x16x32_bf16 v[96:99], a[212:215], v[40:43], v[96:99]
    v_add_f32 v175, v175, v151
    v_cvt_pk_bf16_f32 v129, v150, v151
    v_mfma_f32_16x16x32_bf16 v[96:99], a[216:219], v[44:47], v[96:99]
    v_exp_f32 v152, v112
    v_mfma_f32_16x16x32_bf16 v[96:99], a[220:223], v[48:51], v[96:99]
    ds_read_b128 a[236:239], v2 offset:44032
    v_add_f32 v175, v175, v152
    v_mfma_f32_16x16x32_bf16 v[100:103], a[192:195], v[52:55], v[164:167]
    v_exp_f32 v153, v113
    v_mfma_f32_16x16x32_bf16 v[100:103], a[196:199], v[56:59], v[100:103]
    v_add_f32 v175, v175, v153
    v_cvt_pk_bf16_f32 v130, v152, v153
    v_mfma_f32_16x16x32_bf16 v[100:103], a[200:203], v[60:63], v[100:103]
    v_exp_f32 v154, v114
    v_mfma_f32_16x16x32_bf16 v[100:103], a[204:207], v[64:67], v[100:103]
    ds_read_b128 a[240:243], v2 offset:45056
    v_add_f32 v175, v175, v154
    v_mfma_f32_16x16x32_bf16 v[104:107], a[208:211], v[52:55], v[164:167]
    v_exp_f32 v155, v115
    v_mfma_f32_16x16x32_bf16 v[104:107], a[212:215], v[56:59], v[104:107]
    ds_read_b128 a[244:247], v2 offset:46080
    v_add_f32 v175, v175, v155
    v_cmp_lt_f32 vcc, s37, v175
    v_mfma_f32_16x16x32_bf16 v[104:107], a[216:219], v[60:63], v[104:107]
    v_exp_f32 v148, v84
    v_mfma_f32_16x16x32_bf16 v[104:107], a[220:223], v[64:67], v[104:107]
    s_cbranch_vccnz L_mega_kernel_cc_0_23_out
L_mega_kernel_cc_0_23:
    v_cvt_pk_bf16_f32 v131, v154, v155
    v_add_f32 v179, v179, v175
    v_mfma_f32_16x16x32_bf16 v[108:111], a[192:195], v[68:71], v[168:171]
    buffer_load_dwordx4 v1, s[16:19], s34 offen offset:1024 sc1 lds
    v_exp_f32 v149, v85
    v_mfma_f32_16x16x32_bf16 v[108:111], a[196:199], v[72:75], v[108:111]
    v_add_f32 v172, v148, v149
    v_cvt_pk_bf16_f32 v132, v148, v149
    v_mfma_f32_16x16x32_bf16 v[108:111], a[200:203], v[76:79], v[108:111]
    v_exp_f32 v150, v86
    v_mfma_f32_16x16x32_bf16 v[108:111], a[204:207], v[80:83], v[108:111]
    ds_read_b128 a[248:251], v2 offset:47104
    v_add_f32 v172, v172, v150
    v_mfma_f32_16x16x32_bf16 v[112:115], a[208:211], v[68:71], v[168:171]
    v_exp_f32 v151, v87
    v_mfma_f32_16x16x32_bf16 v[112:115], a[212:215], v[72:75], v[112:115]
    v_add_f32 v172, v172, v151
    v_cvt_pk_bf16_f32 v133, v150, v151
    v_mfma_f32_16x16x32_bf16 v[112:115], a[216:219], v[76:79], v[112:115]
    v_exp_f32 v152, v88
    v_mfma_f32_16x16x32_bf16 v[112:115], a[220:223], v[80:83], v[112:115]
    s_waitcnt lgkmcnt(0)
    ds_read_b128 a[252:255], v2 offset:48128
    v_add_f32 v172, v172, v152
    v_mfma_f32_16x16x32_bf16 a[0:3], a[224:227], v[116:119], a[0:3]
    v_exp_f32 v153, v89
    v_mfma_f32_16x16x32_bf16 a[4:7], a[228:231], v[116:119], a[4:7]
    v_add_f32 v172, v172, v153
    v_cvt_pk_bf16_f32 v134, v152, v153
    v_mfma_f32_16x16x32_bf16 a[8:11], a[232:235], v[116:119], a[8:11]
    v_exp_f32 v154, v90
    v_mfma_f32_16x16x32_bf16 a[12:15], a[236:239], v[116:119], a[12:15]
    ds_read_b128 a[192:195], v2 offset:16384
    v_add_f32 v172, v172, v154
    v_mfma_f32_16x16x32_bf16 a[16:19], a[240:243], v[116:119], a[16:19]
    v_exp_f32 v155, v91
    v_mfma_f32_16x16x32_bf16 a[20:23], a[244:247], v[116:119], a[20:23]
    ds_read_b128 a[196:199], v2 offset:17408
    v_add_f32 v172, v172, v155
    v_cmp_lt_f32 vcc, s37, v172
    v_mfma_f32_16x16x32_bf16 a[24:27], a[248:251], v[116:119], a[24:27]
    s_waitcnt lgkmcnt(2)
    v_exp_f32 v148, v92
    v_mfma_f32_16x16x32_bf16 a[28:31], a[252:255], v[116:119], a[28:31]
    s_cbranch_vccnz L_mega_kernel_cc_0_39_out
L_mega_kernel_cc_0_39:
    v_cvt_pk_bf16_f32 v135, v154, v155
    v_add_f32 v176, v176, v172
    v_mfma_f32_16x16x32_bf16 a[32:35], a[224:227], v[120:123], a[32:35]
    buffer_load_dwordx4 v1, s[16:19], s34 offen offset:2048 sc1 lds
    v_exp_f32 v149, v93
    v_mfma_f32_16x16x32_bf16 a[36:39], a[228:231], v[120:123], a[36:39]
    v_add_f32 v173, v148, v149
    v_cvt_pk_bf16_f32 v136, v148, v149
    v_mfma_f32_16x16x32_bf16 a[40:43], a[232:235], v[120:123], a[40:43]
    v_exp_f32 v150, v94
    v_mfma_f32_16x16x32_bf16 a[44:47], a[236:239], v[120:123], a[44:47]
    ds_read_b128 a[200:203], v2 offset:18432
    v_add_f32 v173, v173, v150
    v_mfma_f32_16x16x32_bf16 a[48:51], a[240:243], v[120:123], a[48:51]
    v_exp_f32 v151, v95
    v_mfma_f32_16x16x32_bf16 a[52:55], a[244:247], v[120:123], a[52:55]
    v_add_f32 v173, v173, v151
    v_cvt_pk_bf16_f32 v137, v150, v151
    v_mfma_f32_16x16x32_bf16 a[56:59], a[248:251], v[120:123], a[56:59]
    v_exp_f32 v152, v96
    v_mfma_f32_16x16x32_bf16 a[60:63], a[252:255], v[120:123], a[60:63]
    ds_read_b128 a[204:207], v2 offset:19456
    v_add_f32 v173, v173, v152
    v_mfma_f32_16x16x32_bf16 a[64:67], a[224:227], v[124:127], a[64:67]
    v_exp_f32 v153, v97
    v_mfma_f32_16x16x32_bf16 a[68:71], a[228:231], v[124:127], a[68:71]
    v_add_f32 v173, v173, v153
    v_cvt_pk_bf16_f32 v138, v152, v153
    v_mfma_f32_16x16x32_bf16 a[72:75], a[232:235], v[124:127], a[72:75]
    v_exp_f32 v154, v98
    v_mfma_f32_16x16x32_bf16 a[76:79], a[236:239], v[124:127], a[76:79]
    ds_read_b128 a[208:211], v2 offset:20480
    v_add_f32 v173, v173, v154
    v_mfma_f32_16x16x32_bf16 a[80:83], a[240:243], v[124:127], a[80:83]
    v_exp_f32 v155, v99
    v_mfma_f32_16x16x32_bf16 a[84:87], a[244:247], v[124:127], a[84:87]
    ds_read_b128 a[212:215], v2 offset:21504
    v_add_f32 v173, v173, v155
    v_cmp_lt_f32 vcc, s37, v173
    v_mfma_f32_16x16x32_bf16 a[88:91], a[248:251], v[124:127], a[88:91]
    v_exp_f32 v148, v100
    v_mfma_f32_16x16x32_bf16 a[92:95], a[252:255], v[124:127], a[92:95]
    s_cbranch_vccnz L_mega_kernel_cc_0_55_out
L_mega_kernel_cc_0_55:
    v_cvt_pk_bf16_f32 v139, v154, v155
    v_add_f32 v177, v177, v173
    v_mfma_f32_16x16x32_bf16 a[96:99], a[224:227], v[128:131], a[96:99]
    buffer_load_dwordx4 v1, s[16:19], s34 offen offset:3072 sc1 lds
    v_exp_f32 v149, v101
    v_mfma_f32_16x16x32_bf16 a[100:103], a[228:231], v[128:131], a[100:103]
    v_add_f32 v174, v148, v149
    v_cvt_pk_bf16_f32 v140, v148, v149
    v_mfma_f32_16x16x32_bf16 a[104:107], a[232:235], v[128:131], a[104:107]
    v_exp_f32 v150, v102
    v_mfma_f32_16x16x32_bf16 a[108:111], a[236:239], v[128:131], a[108:111]
    ds_read_b128 a[216:219], v2 offset:22528
    v_add_f32 v174, v174, v150
    v_mfma_f32_16x16x32_bf16 a[112:115], a[240:243], v[128:131], a[112:115]
    v_exp_f32 v151, v103
    v_mfma_f32_16x16x32_bf16 a[116:119], a[244:247], v[128:131], a[116:119]
    v_add_f32 v174, v174, v151
    v_cvt_pk_bf16_f32 v141, v150, v151
    v_mfma_f32_16x16x32_bf16 a[120:123], a[248:251], v[128:131], a[120:123]
    v_exp_f32 v152, v104
    v_mfma_f32_16x16x32_bf16 a[124:127], a[252:255], v[128:131], a[124:127]
    s_waitcnt lgkmcnt(0)
    ds_read_b128 a[220:223], v2 offset:23552
    v_add_f32 v174, v174, v152
    v_mfma_f32_16x16x32_bf16 v[84:87], a[192:195], v[20:23], v[156:159]
    v_exp_f32 v153, v105
    v_mfma_f32_16x16x32_bf16 v[84:87], a[196:199], v[24:27], v[84:87]
    v_add_f32 v174, v174, v153
    v_cvt_pk_bf16_f32 v142, v152, v153
    v_mfma_f32_16x16x32_bf16 v[84:87], a[200:203], v[28:31], v[84:87]
    v_exp_f32 v154, v106
    v_mfma_f32_16x16x32_bf16 v[84:87], a[204:207], v[32:35], v[84:87]
    ds_read_b128 a[224:227], v2 offset:49152
    v_add_f32 v174, v174, v154
    v_mfma_f32_16x16x32_bf16 v[88:91], a[208:211], v[20:23], v[156:159]
    v_exp_f32 v155, v107
    v_mfma_f32_16x16x32_bf16 v[88:91], a[212:215], v[24:27], v[88:91]
    ds_read_b128 a[228:231], v2 offset:50176
    v_add_f32 v174, v174, v155
    v_cmp_lt_f32 vcc, s37, v174
    v_mfma_f32_16x16x32_bf16 v[88:91], a[216:219], v[28:31], v[88:91]
    s_waitcnt lgkmcnt(2)
    v_exp_f32 v148, v108
    v_mfma_f32_16x16x32_bf16 v[88:91], a[220:223], v[32:35], v[88:91]
    s_cbranch_vccnz L_mega_kernel_cc_1_7_out
L_mega_kernel_cc_1_7:
    s_add_u32 m0, s35, 36864
    s_add_u32 s38, s34, 4096
    v_cvt_pk_bf16_f32 v143, v154, v155
    v_add_f32 v178, v178, v174
    v_mfma_f32_16x16x32_bf16 v[92:95], a[192:195], v[36:39], v[160:163]
    buffer_load_dwordx4 v1, s[16:19], s38 offen offset:0 sc1 lds
    v_exp_f32 v149, v109
    v_mfma_f32_16x16x32_bf16 v[92:95], a[196:199], v[40:43], v[92:95]
    v_add_f32 v175, v148, v149
    v_cvt_pk_bf16_f32 v144, v148, v149
    v_mfma_f32_16x16x32_bf16 v[92:95], a[200:203], v[44:47], v[92:95]
    v_exp_f32 v150, v110
    v_mfma_f32_16x16x32_bf16 v[92:95], a[204:207], v[48:51], v[92:95]
    ds_read_b128 a[232:235], v2 offset:51200
    v_add_f32 v175, v175, v150
    v_mfma_f32_16x16x32_bf16 v[96:99], a[208:211], v[36:39], v[160:163]
    v_exp_f32 v151, v111
    v_mfma_f32_16x16x32_bf16 v[96:99], a[212:215], v[40:43], v[96:99]
    v_add_f32 v175, v175, v151
    v_cvt_pk_bf16_f32 v145, v150, v151
    v_mfma_f32_16x16x32_bf16 v[96:99], a[216:219], v[44:47], v[96:99]
    buffer_load_dwordx4 v1, s[16:19], s38 offen offset:1024 sc1 lds
    v_exp_f32 v152, v112
    v_mfma_f32_16x16x32_bf16 v[96:99], a[220:223], v[48:51], v[96:99]
    ds_read_b128 a[236:239], v2 offset:52224
    v_add_f32 v175, v175, v152
    v_mfma_f32_16x16x32_bf16 v[100:103], a[192:195], v[52:55], v[164:167]
    v_exp_f32 v153, v113
    v_mfma_f32_16x16x32_bf16 v[100:103], a[196:199], v[56:59], v[100:103]
    v_add_f32 v175, v175, v153
    v_cvt_pk_bf16_f32 v146, v152, v153
    v_mfma_f32_16x16x32_bf16 v[100:103], a[200:203], v[60:63], v[100:103]
    v_exp_f32 v154, v114
    v_mfma_f32_16x16x32_bf16 v[100:103], a[204:207], v[64:67], v[100:103]
    ds_read_b128 a[240:243], v2 offset:53248
    v_add_f32 v175, v175, v154
    v_mfma_f32_16x16x32_bf16 v[104:107], a[208:211], v[52:55], v[164:167]
    buffer_load_dwordx4 v1, s[16:19], s38 offen offset:2048 sc1 lds
    v_exp_f32 v155, v115
    v_mfma_f32_16x16x32_bf16 v[104:107], a[212:215], v[56:59], v[104:107]
    ds_read_b128 a[244:247], v2 offset:54272
    v_add_f32 v175, v175, v155
    v_cmp_lt_f32 vcc, s37, v175
    v_mfma_f32_16x16x32_bf16 v[104:107], a[216:219], v[60:63], v[104:107]
    v_exp_f32 v148, v84
    v_mfma_f32_16x16x32_bf16 v[104:107], a[220:223], v[64:67], v[104:107]
    s_cbranch_vccnz L_mega_kernel_cc_1_23_out
L_mega_kernel_cc_1_23:
    v_cvt_pk_bf16_f32 v147, v154, v155
    v_add_f32 v179, v179, v175
    v_mfma_f32_16x16x32_bf16 v[108:111], a[192:195], v[68:71], v[168:171]
    v_exp_f32 v149, v85
    v_mfma_f32_16x16x32_bf16 v[108:111], a[196:199], v[72:75], v[108:111]
    v_add_f32 v172, v148, v149
    v_cvt_pk_bf16_f32 v116, v148, v149
    v_mfma_f32_16x16x32_bf16 v[108:111], a[200:203], v[76:79], v[108:111]
    buffer_load_dwordx4 v1, s[16:19], s38 offen offset:3072 sc1 lds
    v_exp_f32 v150, v86
    v_mfma_f32_16x16x32_bf16 v[108:111], a[204:207], v[80:83], v[108:111]
    ds_read_b128 a[248:251], v2 offset:55296
    s_add_u32 s34, s34, 32768
    v_add_f32 v172, v172, v150
    v_mfma_f32_16x16x32_bf16 v[112:115], a[208:211], v[68:71], v[168:171]
    v_exp_f32 v151, v87
    v_mfma_f32_16x16x32_bf16 v[112:115], a[212:215], v[72:75], v[112:115]
    v_add_f32 v172, v172, v151
    v_cvt_pk_bf16_f32 v117, v150, v151
    v_mfma_f32_16x16x32_bf16 v[112:115], a[216:219], v[76:79], v[112:115]
    v_exp_f32 v152, v88
    v_mfma_f32_16x16x32_bf16 v[112:115], a[220:223], v[80:83], v[112:115]
    s_waitcnt lgkmcnt(0)
    ds_read_b128 a[252:255], v2 offset:56320
    v_add_f32 v172, v172, v152
    v_mfma_f32_16x16x32_bf16 a[0:3], a[224:227], v[132:135], a[0:3]
    v_exp_f32 v153, v89
    v_mfma_f32_16x16x32_bf16 a[4:7], a[228:231], v[132:135], a[4:7]
    v_add_f32 v172, v172, v153
    v_cvt_pk_bf16_f32 v118, v152, v153
    v_mfma_f32_16x16x32_bf16 a[8:11], a[232:235], v[132:135], a[8:11]
    v_exp_f32 v154, v90
    v_mfma_f32_16x16x32_bf16 a[12:15], a[236:239], v[132:135], a[12:15]
    ds_read_b128 a[192:195], v2 offset:24576
    v_add_f32 v172, v172, v154
    v_mfma_f32_16x16x32_bf16 a[16:19], a[240:243], v[132:135], a[16:19]
    v_exp_f32 v155, v91
    v_mfma_f32_16x16x32_bf16 a[20:23], a[244:247], v[132:135], a[20:23]
    ds_read_b128 a[196:199], v2 offset:25600
    v_add_f32 v172, v172, v155
    v_cmp_lt_f32 vcc, s37, v172
    v_mfma_f32_16x16x32_bf16 a[24:27], a[248:251], v[132:135], a[24:27]
    s_waitcnt lgkmcnt(2)
    v_exp_f32 v148, v92
    v_mfma_f32_16x16x32_bf16 a[28:31], a[252:255], v[132:135], a[28:31]
    s_cbranch_vccnz L_mega_kernel_cc_1_39_out
L_mega_kernel_cc_1_39:
    v_cvt_pk_bf16_f32 v119, v154, v155
    v_add_f32 v176, v176, v172
    v_mfma_f32_16x16x32_bf16 a[32:35], a[224:227], v[136:139], a[32:35]
    v_exp_f32 v149, v93
    v_mfma_f32_16x16x32_bf16 a[36:39], a[228:231], v[136:139], a[36:39]
    v_add_f32 v173, v148, v149
    v_cvt_pk_bf16_f32 v120, v148, v149
    v_mfma_f32_16x16x32_bf16 a[40:43], a[232:235], v[136:139], a[40:43]
    v_exp_f32 v150, v94
    v_mfma_f32_16x16x32_bf16 a[44:47], a[236:239], v[136:139], a[44:47]
    ds_read_b128 a[200:203], v2 offset:26624
    v_add_f32 v173, v173, v150
    v_mfma_f32_16x16x32_bf16 a[48:51], a[240:243], v[136:139], a[48:51]
    v_exp_f32 v151, v95
    v_mfma_f32_16x16x32_bf16 a[52:55], a[244:247], v[136:139], a[52:55]
    v_add_f32 v173, v173, v151
    v_cvt_pk_bf16_f32 v121, v150, v151
    v_mfma_f32_16x16x32_bf16 a[56:59], a[248:251], v[136:139], a[56:59]
    v_exp_f32 v152, v96
    v_mfma_f32_16x16x32_bf16 a[60:63], a[252:255], v[136:139], a[60:63]
    ds_read_b128 a[204:207], v2 offset:27648
    v_add_f32 v173, v173, v152
    v_mfma_f32_16x16x32_bf16 a[64:67], a[224:227], v[140:143], a[64:67]
    v_exp_f32 v153, v97
    v_mfma_f32_16x16x32_bf16 a[68:71], a[228:231], v[140:143], a[68:71]
    v_add_f32 v173, v173, v153
    v_cvt_pk_bf16_f32 v122, v152, v153
    v_mfma_f32_16x16x32_bf16 a[72:75], a[232:235], v[140:143], a[72:75]
    v_exp_f32 v154, v98
    v_mfma_f32_16x16x32_bf16 a[76:79], a[236:239], v[140:143], a[76:79]
    ds_read_b128 a[208:211], v2 offset:28672
    v_add_f32 v173, v173, v154
    v_mfma_f32_16x16x32_bf16 a[80:83], a[240:243], v[140:143], a[80:83]
    v_exp_f32 v155, v99
    v_mfma_f32_16x16x32_bf16 a[84:87], a[244:247], v[140:143], a[84:87]
    ds_read_b128 a[212:215], v2 offset:29696
    v_add_f32 v173, v173, v155
    v_cmp_lt_f32 vcc, s37, v173
    v_mfma_f32_16x16x32_bf16 a[88:91], a[248:251], v[140:143], a[88:91]
    v_exp_f32 v148, v100
    v_mfma_f32_16x16x32_bf16 a[92:95], a[252:255], v[140:143], a[92:95]
    s_cbranch_vccnz L_mega_kernel_cc_1_55_out
L_mega_kernel_cc_1_55:
    v_cvt_pk_bf16_f32 v123, v154, v155
    v_add_f32 v177, v177, v173
    v_mfma_f32_16x16x32_bf16 a[96:99], a[224:227], v[144:147], a[96:99]
    v_exp_f32 v149, v101
    v_mfma_f32_16x16x32_bf16 a[100:103], a[228:231], v[144:147], a[100:103]
    v_add_f32 v174, v148, v149
    v_cvt_pk_bf16_f32 v124, v148, v149
    v_mfma_f32_16x16x32_bf16 a[104:107], a[232:235], v[144:147], a[104:107]
    v_exp_f32 v150, v102
    v_mfma_f32_16x16x32_bf16 a[108:111], a[236:239], v[144:147], a[108:111]
    ds_read_b128 a[216:219], v2 offset:30720
    v_add_f32 v174, v174, v150
    v_mfma_f32_16x16x32_bf16 a[112:115], a[240:243], v[144:147], a[112:115]
    v_exp_f32 v151, v103
    v_mfma_f32_16x16x32_bf16 a[116:119], a[244:247], v[144:147], a[116:119]
    v_add_f32 v174, v174, v151
    v_cvt_pk_bf16_f32 v125, v150, v151
    v_mfma_f32_16x16x32_bf16 a[120:123], a[248:251], v[144:147], a[120:123]
    v_exp_f32 v152, v104
    v_mfma_f32_16x16x32_bf16 a[124:127], a[252:255], v[144:147], a[124:127]
    s_waitcnt lgkmcnt(0)
    ds_read_b128 a[220:223], v2 offset:31744
    v_add_f32 v174, v174, v152
    v_mfma_f32_16x16x32_bf16 v[84:87], a[192:195], v[20:23], v[156:159]
    v_exp_f32 v153, v105
    v_mfma_f32_16x16x32_bf16 v[84:87], a[196:199], v[24:27], v[84:87]
    v_add_f32 v174, v174, v153
    v_cvt_pk_bf16_f32 v126, v152, v153
    v_mfma_f32_16x16x32_bf16 v[84:87], a[200:203], v[28:31], v[84:87]
    v_exp_f32 v154, v106
    v_mfma_f32_16x16x32_bf16 v[84:87], a[204:207], v[32:35], v[84:87]
    ds_read_b128 a[224:227], v2 offset:57344
    v_add_f32 v174, v174, v154
    v_mfma_f32_16x16x32_bf16 v[88:91], a[208:211], v[20:23], v[156:159]
    v_exp_f32 v155, v107
    v_mfma_f32_16x16x32_bf16 v[88:91], a[212:215], v[24:27], v[88:91]
    ds_read_b128 a[228:231], v2 offset:58368
    v_add_f32 v174, v174, v155
    v_cmp_lt_f32 vcc, s37, v174
    v_mfma_f32_16x16x32_bf16 v[88:91], a[216:219], v[28:31], v[88:91]
    s_waitcnt lgkmcnt(2)
    v_exp_f32 v148, v108
    v_mfma_f32_16x16x32_bf16 v[88:91], a[220:223], v[32:35], v[88:91]
    s_cbranch_vccnz L_mega_kernel_cc_2_7_out
L_mega_kernel_cc_2_7:
    v_cvt_pk_bf16_f32 v127, v154, v155
    v_add_f32 v178, v178, v174
    v_mfma_f32_16x16x32_bf16 v[92:95], a[192:195], v[36:39], v[160:163]
    v_exp_f32 v149, v109
    v_mfma_f32_16x16x32_bf16 v[92:95], a[196:199], v[40:43], v[92:95]
    v_add_f32 v175, v148, v149
    v_cvt_pk_bf16_f32 v128, v148, v149
    v_mfma_f32_16x16x32_bf16 v[92:95], a[200:203], v[44:47], v[92:95]
    v_exp_f32 v150, v110
    v_mfma_f32_16x16x32_bf16 v[92:95], a[204:207], v[48:51], v[92:95]
    ds_read_b128 a[232:235], v2 offset:59392
    v_add_f32 v175, v175, v150
    v_mfma_f32_16x16x32_bf16 v[96:99], a[208:211], v[36:39], v[160:163]
    v_exp_f32 v151, v111
    v_mfma_f32_16x16x32_bf16 v[96:99], a[212:215], v[40:43], v[96:99]
    v_add_f32 v175, v175, v151
    v_cvt_pk_bf16_f32 v129, v150, v151
    v_mfma_f32_16x16x32_bf16 v[96:99], a[216:219], v[44:47], v[96:99]
    v_exp_f32 v152, v112
    v_mfma_f32_16x16x32_bf16 v[96:99], a[220:223], v[48:51], v[96:99]
    ds_read_b128 a[236:239], v2 offset:60416
    v_add_f32 v175, v175, v152
    v_mfma_f32_16x16x32_bf16 v[100:103], a[192:195], v[52:55], v[164:167]
    v_exp_f32 v153, v113
    v_mfma_f32_16x16x32_bf16 v[100:103], a[196:199], v[56:59], v[100:103]
    v_add_f32 v175, v175, v153
    v_cvt_pk_bf16_f32 v130, v152, v153
    v_mfma_f32_16x16x32_bf16 v[100:103], a[200:203], v[60:63], v[100:103]
    v_exp_f32 v154, v114
    v_mfma_f32_16x16x32_bf16 v[100:103], a[204:207], v[64:67], v[100:103]
    ds_read_b128 a[240:243], v2 offset:61440
    v_add_f32 v175, v175, v154
    v_mfma_f32_16x16x32_bf16 v[104:107], a[208:211], v[52:55], v[164:167]
    v_exp_f32 v155, v115
    v_mfma_f32_16x16x32_bf16 v[104:107], a[212:215], v[56:59], v[104:107]
    ds_read_b128 a[244:247], v2 offset:62464
    v_add_f32 v175, v175, v155
    v_cmp_lt_f32 vcc, s37, v175
    v_mfma_f32_16x16x32_bf16 v[104:107], a[216:219], v[60:63], v[104:107]
    v_exp_f32 v148, v84
    v_mfma_f32_16x16x32_bf16 v[104:107], a[220:223], v[64:67], v[104:107]
    s_cbranch_vccnz L_mega_kernel_cc_2_23_out
L_mega_kernel_cc_2_23:
    v_cvt_pk_bf16_f32 v131, v154, v155
    v_add_f32 v179, v179, v175
    v_mfma_f32_16x16x32_bf16 v[108:111], a[192:195], v[68:71], v[168:171]
    v_exp_f32 v149, v85
    v_mfma_f32_16x16x32_bf16 v[108:111], a[196:199], v[72:75], v[108:111]
    ds_read_b128 a[248:251], v2 offset:63488
    v_add_f32 v172, v148, v149
    v_cvt_pk_bf16_f32 v132, v148, v149
    v_mfma_f32_16x16x32_bf16 v[108:111], a[200:203], v[76:79], v[108:111]
    v_exp_f32 v150, v86
    v_mfma_f32_16x16x32_bf16 v[108:111], a[204:207], v[80:83], v[108:111]
    ds_read_b128 a[252:255], v2 offset:64512
    v_add_f32 v172, v172, v150
    v_mfma_f32_16x16x32_bf16 v[112:115], a[208:211], v[68:71], v[168:171]
    v_exp_f32 v151, v87
    v_mfma_f32_16x16x32_bf16 v[112:115], a[212:215], v[72:75], v[112:115]
    v_add_f32 v172, v172, v151
    v_cvt_pk_bf16_f32 v133, v150, v151
    v_mfma_f32_16x16x32_bf16 v[112:115], a[216:219], v[76:79], v[112:115]
    v_exp_f32 v152, v88
    v_mfma_f32_16x16x32_bf16 v[112:115], a[220:223], v[80:83], v[112:115]
    s_waitcnt lgkmcnt(0)
    v_add_f32 v172, v172, v152
    v_mfma_f32_16x16x32_bf16 a[0:3], a[224:227], v[116:119], a[0:3]
    v_exp_f32 v153, v89
    v_mfma_f32_16x16x32_bf16 a[4:7], a[228:231], v[116:119], a[4:7]
    s_waitcnt vmcnt(0) lgkmcnt(0)
    s_barrier
    v_add_f32 v172, v172, v153
    v_cvt_pk_bf16_f32 v134, v152, v153
    v_mfma_f32_16x16x32_bf16 a[8:11], a[232:235], v[116:119], a[8:11]
    v_exp_f32 v154, v90
    v_mfma_f32_16x16x32_bf16 a[12:15], a[236:239], v[116:119], a[12:15]
    ds_read_b128 a[192:195], v3 offset:0
    s_add_u32 m0, s36, 0
    v_add_f32 v172, v172, v154
    v_mfma_f32_16x16x32_bf16 a[16:19], a[240:243], v[116:119], a[16:19]
    buffer_load_dwordx4 v1, s[16:19], s33 offen offset:0 sc1 lds
    v_exp_f32 v155, v91
    v_mfma_f32_16x16x32_bf16 a[20:23], a[244:247], v[116:119], a[20:23]
    ds_read_b128 a[196:199], v3 offset:1024
    v_add_f32 v172, v172, v155
    v_cmp_lt_f32 vcc, s37, v172
    v_mfma_f32_16x16x32_bf16 a[24:27], a[248:251], v[116:119], a[24:27]
    v_exp_f32 v148, v92
    v_mfma_f32_16x16x32_bf16 a[28:31], a[252:255], v[116:119], a[28:31]
    s_cbranch_vccnz L_mega_kernel_cc_2_39_out
L_mega_kernel_cc_2_39:
    v_cvt_pk_bf16_f32 v135, v154, v155
    v_add_f32 v176, v176, v172
    v_mfma_f32_16x16x32_bf16 a[32:35], a[224:227], v[120:123], a[32:35]
    v_exp_f32 v149, v93
    v_mfma_f32_16x16x32_bf16 a[36:39], a[228:231], v[120:123], a[36:39]
    v_add_f32 v173, v148, v149
    v_cvt_pk_bf16_f32 v136, v148, v149
    v_mfma_f32_16x16x32_bf16 a[40:43], a[232:235], v[120:123], a[40:43]
    v_exp_f32 v150, v94
    v_mfma_f32_16x16x32_bf16 a[44:47], a[236:239], v[120:123], a[44:47]
    ds_read_b128 a[200:203], v3 offset:2048
    v_add_f32 v173, v173, v150
    v_mfma_f32_16x16x32_bf16 a[48:51], a[240:243], v[120:123], a[48:51]
    buffer_load_dwordx4 v1, s[16:19], s33 offen offset:1024 sc1 lds
    v_exp_f32 v151, v95
    v_mfma_f32_16x16x32_bf16 a[52:55], a[244:247], v[120:123], a[52:55]
    v_add_f32 v173, v173, v151
    v_cvt_pk_bf16_f32 v137, v150, v151
    v_mfma_f32_16x16x32_bf16 a[56:59], a[248:251], v[120:123], a[56:59]
    v_exp_f32 v152, v96
    v_mfma_f32_16x16x32_bf16 a[60:63], a[252:255], v[120:123], a[60:63]
    ds_read_b128 a[204:207], v3 offset:3072
    v_add_f32 v173, v173, v152
    v_mfma_f32_16x16x32_bf16 a[64:67], a[224:227], v[124:127], a[64:67]
    v_exp_f32 v153, v97
    v_mfma_f32_16x16x32_bf16 a[68:71], a[228:231], v[124:127], a[68:71]
    v_add_f32 v173, v173, v153
    v_cvt_pk_bf16_f32 v138, v152, v153
    v_mfma_f32_16x16x32_bf16 a[72:75], a[232:235], v[124:127], a[72:75]
    v_exp_f32 v154, v98
    v_mfma_f32_16x16x32_bf16 a[76:79], a[236:239], v[124:127], a[76:79]
    ds_read_b128 a[208:211], v3 offset:4096
    v_add_f32 v173, v173, v154
    v_mfma_f32_16x16x32_bf16 a[80:83], a[240:243], v[124:127], a[80:83]
    buffer_load_dwordx4 v1, s[16:19], s33 offen offset:2048 sc1 lds
    v_exp_f32 v155, v99
    v_mfma_f32_16x16x32_bf16 a[84:87], a[244:247], v[124:127], a[84:87]
    ds_read_b128 a[212:215], v3 offset:5120
    v_add_f32 v173, v173, v155
    v_cmp_lt_f32 vcc, s37, v173
    v_mfma_f32_16x16x32_bf16 a[88:91], a[248:251], v[124:127], a[88:91]
    v_exp_f32 v148, v100
    v_mfma_f32_16x16x32_bf16 a[92:95], a[252:255], v[124:127], a[92:95]
    s_cbranch_vccnz L_mega_kernel_cc_2_55_out
L_mega_kernel_cc_2_55:
    v_cvt_pk_bf16_f32 v139, v154, v155
    v_add_f32 v177, v177, v173
    v_mfma_f32_16x16x32_bf16 a[96:99], a[224:227], v[128:131], a[96:99]
    v_exp_f32 v149, v101
    v_mfma_f32_16x16x32_bf16 a[100:103], a[228:231], v[128:131], a[100:103]
    v_add_f32 v174, v148, v149
    v_cvt_pk_bf16_f32 v140, v148, v149
    v_mfma_f32_16x16x32_bf16 a[104:107], a[232:235], v[128:131], a[104:107]
    v_exp_f32 v150, v102
    v_mfma_f32_16x16x32_bf16 a[108:111], a[236:239], v[128:131], a[108:111]
    ds_read_b128 a[216:219], v3 offset:6144
    v_add_f32 v174, v174, v150
    v_mfma_f32_16x16x32_bf16 a[112:115], a[240:243], v[128:131], a[112:115]
    buffer_load_dwordx4 v1, s[16:19], s33 offen offset:3072 sc1 lds
    v_exp_f32 v151, v103
    v_mfma_f32_16x16x32_bf16 a[116:119], a[244:247], v[128:131], a[116:119]
    v_add_f32 v174, v174, v151
    v_cvt_pk_bf16_f32 v141, v150, v151
    v_mfma_f32_16x16x32_bf16 a[120:123], a[248:251], v[128:131], a[120:123]
    v_exp_f32 v152, v104
    v_mfma_f32_16x16x32_bf16 a[124:127], a[252:255], v[128:131], a[124:127]
    s_waitcnt lgkmcnt(0)
    ds_read_b128 a[220:223], v3 offset:7168
    v_add_f32 v174, v174, v152
    v_mfma_f32_16x16x32_bf16 v[84:87], a[192:195], v[20:23], v[156:159]
    v_exp_f32 v153, v105
    v_mfma_f32_16x16x32_bf16 v[84:87], a[196:199], v[24:27], v[84:87]
    v_add_f32 v174, v174, v153
    v_cvt_pk_bf16_f32 v142, v152, v153
    v_mfma_f32_16x16x32_bf16 v[84:87], a[200:203], v[28:31], v[84:87]
    v_exp_f32 v154, v106
    v_mfma_f32_16x16x32_bf16 v[84:87], a[204:207], v[32:35], v[84:87]
    ds_read_b128 a[224:227], v3 offset:32768
    v_add_f32 v174, v174, v154
    v_mfma_f32_16x16x32_bf16 v[88:91], a[208:211], v[20:23], v[156:159]
    v_exp_f32 v155, v107
    v_mfma_f32_16x16x32_bf16 v[88:91], a[212:215], v[24:27], v[88:91]
    ds_read_b128 a[228:231], v3 offset:33792
    v_add_f32 v174, v174, v155
    v_cmp_lt_f32 vcc, s37, v174
    v_mfma_f32_16x16x32_bf16 v[88:91], a[216:219], v[28:31], v[88:91]
    s_waitcnt lgkmcnt(2)
    v_exp_f32 v148, v108
    v_mfma_f32_16x16x32_bf16 v[88:91], a[220:223], v[32:35], v[88:91]
    s_cbranch_vccnz L_mega_kernel_cc_3_7_out
L_mega_kernel_cc_3_7:
    s_add_u32 m0, s36, 4096
    s_add_u32 s38, s33, 4096
    v_cvt_pk_bf16_f32 v143, v154, v155
    v_add_f32 v178, v178, v174
    v_mfma_f32_16x16x32_bf16 v[92:95], a[192:195], v[36:39], v[160:163]
    buffer_load_dwordx4 v1, s[16:19], s38 offen offset:0 sc1 lds
    v_exp_f32 v149, v109
    v_mfma_f32_16x16x32_bf16 v[92:95], a[196:199], v[40:43], v[92:95]
    v_add_f32 v175, v148, v149
    v_cvt_pk_bf16_f32 v144, v148, v149
    v_mfma_f32_16x16x32_bf16 v[92:95], a[200:203], v[44:47], v[92:95]
    v_exp_f32 v150, v110
    v_mfma_f32_16x16x32_bf16 v[92:95], a[204:207], v[48:51], v[92:95]
    ds_read_b128 a[232:235], v3 offset:34816
    v_add_f32 v175, v175, v150
    v_mfma_f32_16x16x32_bf16 v[96:99], a[208:211], v[36:39], v[160:163]
    v_exp_f32 v151, v111
    v_mfma_f32_16x16x32_bf16 v[96:99], a[212:215], v[40:43], v[96:99]
    v_add_f32 v175, v175, v151
    v_cvt_pk_bf16_f32 v145, v150, v151
    v_mfma_f32_16x16x32_bf16 v[96:99], a[216:219], v[44:47], v[96:99]
    v_exp_f32 v152, v112
    v_mfma_f32_16x16x32_bf16 v[96:99], a[220:223], v[48:51], v[96:99]
    ds_read_b128 a[236:239], v3 offset:35840
    v_add_f32 v175, v175, v152
    v_mfma_f32_16x16x32_bf16 v[100:103], a[192:195], v[52:55], v[164:167]
    v_exp_f32 v153, v113
    v_mfma_f32_16x16x32_bf16 v[100:103], a[196:199], v[56:59], v[100:103]
    v_add_f32 v175, v175, v153
    v_cvt_pk_bf16_f32 v146, v152, v153
    v_mfma_f32_16x16x32_bf16 v[100:103], a[200:203], v[60:63], v[100:103]
    v_exp_f32 v154, v114
    v_mfma_f32_16x16x32_bf16 v[100:103], a[204:207], v[64:67], v[100:103]
    ds_read_b128 a[240:243], v3 offset:36864
    v_add_f32 v175, v175, v154
    v_mfma_f32_16x16x32_bf16 v[104:107], a[208:211], v[52:55], v[164:167]
    v_exp_f32 v155, v115
    v_mfma_f32_16x16x32_bf16 v[104:107], a[212:215], v[56:59], v[104:107]
    ds_read_b128 a[244:247], v3 offset:37888
    v_add_f32 v175, v175, v155
    v_cmp_lt_f32 vcc, s37, v175
    v_mfma_f32_16x16x32_bf16 v[104:107], a[216:219], v[60:63], v[104:107]
    v_exp_f32 v148, v84
    v_mfma_f32_16x16x32_bf16 v[104:107], a[220:223], v[64:67], v[104:107]
    s_cbranch_vccnz L_mega_kernel_cc_3_23_out
L_mega_kernel_cc_3_23:
    v_cvt_pk_bf16_f32 v147, v154, v155
    v_add_f32 v179, v179, v175
    v_mfma_f32_16x16x32_bf16 v[108:111], a[192:195], v[68:71], v[168:171]
    buffer_load_dwordx4 v1, s[16:19], s38 offen offset:1024 sc1 lds
    v_exp_f32 v149, v85
    v_mfma_f32_16x16x32_bf16 v[108:111], a[196:199], v[72:75], v[108:111]
    v_add_f32 v172, v148, v149
    v_cvt_pk_bf16_f32 v116, v148, v149
    v_mfma_f32_16x16x32_bf16 v[108:111], a[200:203], v[76:79], v[108:111]
    v_exp_f32 v150, v86
    v_mfma_f32_16x16x32_bf16 v[108:111], a[204:207], v[80:83], v[108:111]
    ds_read_b128 a[248:251], v3 offset:38912
    v_add_f32 v172, v172, v150
    v_mfma_f32_16x16x32_bf16 v[112:115], a[208:211], v[68:71], v[168:171]
    v_exp_f32 v151, v87
    v_mfma_f32_16x16x32_bf16 v[112:115], a[212:215], v[72:75], v[112:115]
    v_add_f32 v172, v172, v151
    v_cvt_pk_bf16_f32 v117, v150, v151
    v_mfma_f32_16x16x32_bf16 v[112:115], a[216:219], v[76:79], v[112:115]
    v_exp_f32 v152, v88
    v_mfma_f32_16x16x32_bf16 v[112:115], a[220:223], v[80:83], v[112:115]
    s_waitcnt lgkmcnt(0)
    ds_read_b128 a[252:255], v3 offset:39936
    v_add_f32 v172, v172, v152
    v_mfma_f32_16x16x32_bf16 a[0:3], a[224:227], v[132:135], a[0:3]
    v_exp_f32 v153, v89
    v_mfma_f32_16x16x32_bf16 a[4:7], a[228:231], v[132:135], a[4:7]
    v_add_f32 v172, v172, v153
    v_cvt_pk_bf16_f32 v118, v152, v153
    v_mfma_f32_16x16x32_bf16 a[8:11], a[232:235], v[132:135], a[8:11]
    v_exp_f32 v154, v90
    v_mfma_f32_16x16x32_bf16 a[12:15], a[236:239], v[132:135], a[12:15]
    ds_read_b128 a[192:195], v3 offset:8192
    v_add_f32 v172, v172, v154
    v_mfma_f32_16x16x32_bf16 a[16:19], a[240:243], v[132:135], a[16:19]
    v_exp_f32 v155, v91
    v_mfma_f32_16x16x32_bf16 a[20:23], a[244:247], v[132:135], a[20:23]
    ds_read_b128 a[196:199], v3 offset:9216
    v_add_f32 v172, v172, v155
    v_cmp_lt_f32 vcc, s37, v172
    v_mfma_f32_16x16x32_bf16 a[24:27], a[248:251], v[132:135], a[24:27]
    s_waitcnt lgkmcnt(2)
    v_exp_f32 v148, v92
    v_mfma_f32_16x16x32_bf16 a[28:31], a[252:255], v[132:135], a[28:31]
    s_cbranch_vccnz L_mega_kernel_cc_3_39_out
L_mega_kernel_cc_3_39:
    v_cvt_pk_bf16_f32 v119, v154, v155
    v_add_f32 v176, v176, v172
    v_mfma_f32_16x16x32_bf16 a[32:35], a[224:227], v[136:139], a[32:35]
    buffer_load_dwordx4 v1, s[16:19], s38 offen offset:2048 sc1 lds
    v_exp_f32 v149, v93
    v_mfma_f32_16x16x32_bf16 a[36:39], a[228:231], v[136:139], a[36:39]
    v_add_f32 v173, v148, v149
    v_cvt_pk_bf16_f32 v120, v148, v149
    v_mfma_f32_16x16x32_bf16 a[40:43], a[232:235], v[136:139], a[40:43]
    v_exp_f32 v150, v94
    v_mfma_f32_16x16x32_bf16 a[44:47], a[236:239], v[136:139], a[44:47]
    ds_read_b128 a[200:203], v3 offset:10240
    v_add_f32 v173, v173, v150
    v_mfma_f32_16x16x32_bf16 a[48:51], a[240:243], v[136:139], a[48:51]
    v_exp_f32 v151, v95
    v_mfma_f32_16x16x32_bf16 a[52:55], a[244:247], v[136:139], a[52:55]
    v_add_f32 v173, v173, v151
    v_cvt_pk_bf16_f32 v121, v150, v151
    v_mfma_f32_16x16x32_bf16 a[56:59], a[248:251], v[136:139], a[56:59]
    v_exp_f32 v152, v96
    v_mfma_f32_16x16x32_bf16 a[60:63], a[252:255], v[136:139], a[60:63]
    ds_read_b128 a[204:207], v3 offset:11264
    v_add_f32 v173, v173, v152
    v_mfma_f32_16x16x32_bf16 a[64:67], a[224:227], v[140:143], a[64:67]
    v_exp_f32 v153, v97
    v_mfma_f32_16x16x32_bf16 a[68:71], a[228:231], v[140:143], a[68:71]
    v_add_f32 v173, v173, v153
    v_cvt_pk_bf16_f32 v122, v152, v153
    v_mfma_f32_16x16x32_bf16 a[72:75], a[232:235], v[140:143], a[72:75]
    v_exp_f32 v154, v98
    v_mfma_f32_16x16x32_bf16 a[76:79], a[236:239], v[140:143], a[76:79]
    ds_read_b128 a[208:211], v3 offset:12288
    v_add_f32 v173, v173, v154
    v_mfma_f32_16x16x32_bf16 a[80:83], a[240:243], v[140:143], a[80:83]
    v_exp_f32 v155, v99
    v_mfma_f32_16x16x32_bf16 a[84:87], a[244:247], v[140:143], a[84:87]
    ds_read_b128 a[212:215], v3 offset:13312
    v_add_f32 v173, v173, v155
    v_cmp_lt_f32 vcc, s37, v173
    v_mfma_f32_16x16x32_bf16 a[88:91], a[248:251], v[140:143], a[88:91]
    v_exp_f32 v148, v100
    v_mfma_f32_16x16x32_bf16 a[92:95], a[252:255], v[140:143], a[92:95]
    s_cbranch_vccnz L_mega_kernel_cc_3_55_out
L_mega_kernel_cc_3_55:
    v_cvt_pk_bf16_f32 v123, v154, v155
    v_add_f32 v177, v177, v173
    v_mfma_f32_16x16x32_bf16 a[96:99], a[224:227], v[144:147], a[96:99]
    buffer_load_dwordx4 v1, s[16:19], s38 offen offset:3072 sc1 lds
    v_exp_f32 v149, v101
    v_mfma_f32_16x16x32_bf16 a[100:103], a[228:231], v[144:147], a[100:103]
    s_add_u32 s33, s33, 32768
    v_add_f32 v174, v148, v149
    v_cvt_pk_bf16_f32 v124, v148, v149
    v_mfma_f32_16x16x32_bf16 a[104:107], a[232:235], v[144:147], a[104:107]
    v_exp_f32 v150, v102
    v_mfma_f32_16x16x32_bf16 a[108:111], a[236:239], v[144:147], a[108:111]
    ds_read_b128 a[216:219], v3 offset:14336
    v_add_f32 v174, v174, v150
    v_mfma_f32_16x16x32_bf16 a[112:115], a[240:243], v[144:147], a[112:115]
    v_exp_f32 v151, v103
    v_mfma_f32_16x16x32_bf16 a[116:119], a[244:247], v[144:147], a[116:119]
    v_add_f32 v174, v174, v151
    v_cvt_pk_bf16_f32 v125, v150, v151
    v_mfma_f32_16x16x32_bf16 a[120:123], a[248:251], v[144:147], a[120:123]
    v_exp_f32 v152, v104
    v_mfma_f32_16x16x32_bf16 a[124:127], a[252:255], v[144:147], a[124:127]
    s_waitcnt lgkmcnt(0)
    ds_read_b128 a[220:223], v3 offset:15360
    v_add_f32 v174, v174, v152
    v_xor_b32 v2, 0x10000, v2
    v_xor_b32 v3, 0x10000, v3
    s_xor_b32 s36, s36, 0x10000
    s_xor_b32 s35, s35, 0x10000
    s_sub_u32 s32, s32, 1
    s_cmp_lg_u32 s32, 0
    s_cbranch_scc1 L_mega_kernel_mainc
    v_mfma_f32_16x16x32_bf16 v[84:87], a[192:195], v[20:23], v[156:159]
    v_exp_f32 v153, v105
    v_mfma_f32_16x16x32_bf16 v[84:87], a[196:199], v[24:27], v[84:87]
    v_add_f32 v174, v174, v153
    v_cvt_pk_bf16_f32 v126, v152, v153
    v_mfma_f32_16x16x32_bf16 v[84:87], a[200:203], v[28:31], v[84:87]
    v_exp_f32 v154, v106
    v_mfma_f32_16x16x32_bf16 v[84:87], a[204:207], v[32:35], v[84:87]
    ds_read_b128 a[224:227], v2 offset:40960
    v_add_f32 v174, v174, v154
    v_mfma_f32_16x16x32_bf16 v[88:91], a[208:211], v[20:23], v[156:159]
    v_exp_f32 v155, v107
    v_mfma_f32_16x16x32_bf16 v[88:91], a[212:215], v[24:27], v[88:91]
    ds_read_b128 a[228:231], v2 offset:41984
    v_add_f32 v174, v174, v155
    v_cmp_lt_f32 vcc, s37, v174
    v_mfma_f32_16x16x32_bf16 v[88:91], a[216:219], v[28:31], v[88:91]
    s_waitcnt lgkmcnt(2)
    v_exp_f32 v148, v108
    v_mfma_f32_16x16x32_bf16 v[88:91], a[220:223], v[32:35], v[88:91]
    s_cbranch_vccnz L_mega_kernel_cy_0_7_out
L_mega_kernel_cy_0_7:
    s_add_u32 m0, s35, 32768
    v_cvt_pk_bf16_f32 v127, v154, v155
    v_add_f32 v178, v178, v174
    v_mfma_f32_16x16x32_bf16 v[92:95], a[192:195], v[36:39], v[160:163]
    buffer_load_dwordx4 v1, s[16:19], s34 offen offset:0 sc1 lds
    v_exp_f32 v149, v109
    v_mfma_f32_16x16x32_bf16 v[92:95], a[196:199], v[40:43], v[92:95]
    v_add_f32 v175, v148, v149
    v_cvt_pk_bf16_f32 v128, v148, v149
    v_mfma_f32_16x16x32_bf16 v[92:95], a[200:203], v[44:47], v[92:95]
    v_exp_f32 v150, v110
    v_mfma_f32_16x16x32_bf16 v[92:95], a[204:207], v[48:51], v[92:95]
    ds_read_b128 a[232:235], v2 offset:43008
    v_add_f32 v175, v175, v150
    v_mfma_f32_16x16x32_bf16 v[96:99], a[208:211], v[36:39], v[160:163]
    v_exp_f32 v151, v111
    v_mfma_f32_16x16x32_bf16 v[96:99], a[212:215], v[40:43], v[96:99]
    v_add_f32 v175, v175, v151
    v_cvt_pk_bf16_f32 v129, v150, v151
    v_mfma_f32_16x16x32_bf16 v[96:99], a[216:219], v[44:47], v[96:99]
    v_exp_f32 v152, v112
    v_mfma_f32_16x16x32_bf16 v[96:99], a[220:223], v[48:51], v[96:99]
    ds_read_b128 a[236:239], v2 offset:44032
    v_add_f32 v175, v175, v152
    v_mfma_f32_16x16x32_bf16 v[100:103], a[192:195], v[52:55], v[164:167]
    v_exp_f32 v153, v113
    v_mfma_f32_16x16x32_bf16 v[100:103], a[196:199], v[56:59], v[100:103]
    v_add_f32 v175, v175, v153
    v_cvt_pk_bf16_f32 v130, v152, v153
    v_mfma_f32_16x16x32_bf16 v[100:103], a[200:203], v[60:63], v[100:103]
    v_exp_f32 v154, v114
    v_mfma_f32_16x16x32_bf16 v[100:103], a[204:207], v[64:67], v[100:103]
    ds_read_b128 a[240:243], v2 offset:45056
    v_add_f32 v175, v175, v154
    v_mfma_f32_16x16x32_bf16 v[104:107], a[208:211], v[52:55], v[164:167]
    v_exp_f32 v155, v115
    v_mfma_f32_16x16x32_bf16 v[104:107], a[212:215], v[56:59], v[104:107]
    ds_read_b128 a[244:247], v2 offset:46080
    v_add_f32 v175, v175, v155
    v_cmp_lt_f32 vcc, s37, v175
    v_mfma_f32_16x16x32_bf16 v[104:107], a[216:219], v[60:63], v[104:107]
    v_exp_f32 v148, v84
    v_mfma_f32_16x16x32_bf16 v[104:107], a[220:223], v[64:67], v[104:107]
    s_cbranch_vccnz L_mega_kernel_cy_0_23_out
L_mega_kernel_cy_0_23:
    v_cvt_pk_bf16_f32 v131, v154, v155
    v_add_f32 v179, v179, v175
    v_mfma_f32_16x16x32_bf16 v[108:111], a[192:195], v[68:71], v[168:171]
    buffer_load_dwordx4 v1, s[16:19], s34 offen offset:1024 sc1 lds
    v_exp_f32 v149, v85
    v_mfma_f32_16x16x32_bf16 v[108:111], a[196:199], v[72:75], v[108:111]
    v_add_f32 v172, v148, v149
    v_cvt_pk_bf16_f32 v132, v148, v149
    v_mfma_f32_16x16x32_bf16 v[108:111], a[200:203], v[76:79], v[108:111]
    v_exp_f32 v150, v86
    v_mfma_f32_16x16x32_bf16 v[108:111], a[204:207], v[80:83], v[108:111]
    ds_read_b128 a[248:251], v2 offset:47104
    v_add_f32 v172, v172, v150
    v_mfma_f32_16x16x32_bf16 v[112:115], a[208:211], v[68:71], v[168:171]
    v_exp_f32 v151, v87
    v_mfma_f32_16x16x32_bf16 v[112:115], a[212:215], v[72:75], v[112:115]
    v_add_f32 v172, v172, v151
    v_cvt_pk_bf16_f32 v133, v150, v151
    v_mfma_f32_16x16x32_bf16 v[112:115], a[216:219], v[76:79], v[112:115]
    v_exp_f32 v152, v88
    v_mfma_f32_16x16x32_bf16 v[112:115], a[220:223], v[80:83], v[112:115]
    s_waitcnt lgkmcnt(0)
    ds_read_b128 a[252:255], v2 offset:48128
    v_add_f32 v172, v172, v152
    v_mfma_f32_16x16x32_bf16 a[0:3], a[224:227], v[116:119], a[0:3]
    v_exp_f32 v153, v89
    v_mfma_f32_16x16x32_bf16 a[4:7], a[228:231], v[116:119], a[4:7]
    v_add_f32 v172, v172, v153
    v_cvt_pk_bf16_f32 v134, v152, v153
    v_mfma_f32_16x16x32_bf16 a[8:11], a[232:235], v[116:119], a[8:11]
    v_exp_f32 v154, v90
    v_mfma_f32_16x16x32_bf16 a[12:15], a[236:239], v[116:119], a[12:15]
    ds_read_b128 a[192:195], v2 offset:16384
    v_add_f32 v172, v172, v154
    v_mfma_f32_16x16x32_bf16 a[16:19], a[240:243], v[116:119], a[16:19]
    v_exp_f32 v155, v91
    v_mfma_f32_16x16x32_bf16 a[20:23], a[244:247], v[116:119], a[20:23]
    ds_read_b128 a[196:199], v2 offset:17408
    v_add_f32 v172, v172, v155
    v_cmp_lt_f32 vcc, s37, v172
    v_mfma_f32_16x16x32_bf16 a[24:27], a[248:251], v[116:119], a[24:27]
    s_waitcnt lgkmcnt(2)
    v_exp_f32 v148, v92
    v_mfma_f32_16x16x32_bf16 a[28:31], a[252:255], v[116:119], a[28:31]
    s_cbranch_vccnz L_mega_kernel_cy_0_39_out
L_mega_kernel_cy_0_39:
    v_cvt_pk_bf16_f32 v135, v154, v155
    v_add_f32 v176, v176, v172
    v_mfma_f32_16x16x32_bf16 a[32:35], a[224:227], v[120:123], a[32:35]
    buffer_load_dwordx4 v1, s[16:19], s34 offen offset:2048 sc1 lds
    v_exp_f32 v149, v93
    v_mfma_f32_16x16x32_bf16 a[36:39], a[228:231], v[120:123], a[36:39]
    v_add_f32 v173, v148, v149
    v_cvt_pk_bf16_f32 v136, v148, v149
    v_mfma_f32_16x16x32_bf16 a[40:43], a[232:235], v[120:123], a[40:43]
    v_exp_f32 v150, v94
    v_mfma_f32_16x16x32_bf16 a[44:47], a[236:239], v[120:123], a[44:47]
    ds_read_b128 a[200:203], v2 offset:18432
    v_add_f32 v173, v173, v150
    v_mfma_f32_16x16x32_bf16 a[48:51], a[240:243], v[120:123], a[48:51]
    v_exp_f32 v151, v95
    v_mfma_f32_16x16x32_bf16 a[52:55], a[244:247], v[120:123], a[52:55]
    v_add_f32 v173, v173, v151
    v_cvt_pk_bf16_f32 v137, v150, v151
    v_mfma_f32_16x16x32_bf16 a[56:59], a[248:251], v[120:123], a[56:59]
    v_exp_f32 v152, v96
    v_mfma_f32_16x16x32_bf16 a[60:63], a[252:255], v[120:123], a[60:63]
    ds_read_b128 a[204:207], v2 offset:19456
    v_add_f32 v173, v173, v152
    v_mfma_f32_16x16x32_bf16 a[64:67], a[224:227], v[124:127], a[64:67]
    v_exp_f32 v153, v97
    v_mfma_f32_16x16x32_bf16 a[68:71], a[228:231], v[124:127], a[68:71]
    v_add_f32 v173, v173, v153
    v_cvt_pk_bf16_f32 v138, v152, v153
    v_mfma_f32_16x16x32_bf16 a[72:75], a[232:235], v[124:127], a[72:75]
    v_exp_f32 v154, v98
    v_mfma_f32_16x16x32_bf16 a[76:79], a[236:239], v[124:127], a[76:79]
    ds_read_b128 a[208:211], v2 offset:20480
    v_add_f32 v173, v173, v154
    v_mfma_f32_16x16x32_bf16 a[80:83], a[240:243], v[124:127], a[80:83]
    v_exp_f32 v155, v99
    v_mfma_f32_16x16x32_bf16 a[84:87], a[244:247], v[124:127], a[84:87]
    ds_read_b128 a[212:215], v2 offset:21504
    v_add_f32 v173, v173, v155
    v_cmp_lt_f32 vcc, s37, v173
    v_mfma_f32_16x16x32_bf16 a[88:91], a[248:251], v[124:127], a[88:91]
    v_exp_f32 v148, v100
    v_mfma_f32_16x16x32_bf16 a[92:95], a[252:255], v[124:127], a[92:95]
    s_cbranch_vccnz L_mega_kernel_cy_0_55_out
L_mega_kernel_cy_0_55:
    v_cvt_pk_bf16_f32 v139, v154, v155
    v_add_f32 v177, v177, v173
    v_mfma_f32_16x16x32_bf16 a[96:99], a[224:227], v[128:131], a[96:99]
    buffer_load_dwordx4 v1, s[16:19], s34 offen offset:3072 sc1 lds
    v_exp_f32 v149, v101
    v_mfma_f32_16x16x32_bf16 a[100:103], a[228:231], v[128:131], a[100:103]
    v_add_f32 v174, v148, v149
    v_cvt_pk_bf16_f32 v140, v148, v149
    v_mfma_f32_16x16x32_bf16 a[104:107], a[232:235], v[128:131], a[104:107]
    v_exp_f32 v150, v102
    v_mfma_f32_16x16x32_bf16 a[108:111], a[236:239], v[128:131], a[108:111]
    ds_read_b128 a[216:219], v2 offset:22528
    v_add_f32 v174, v174, v150
    v_mfma_f32_16x16x32_bf16 a[112:115], a[240:243], v[128:131], a[112:115]
    v_exp_f32 v151, v103
    v_mfma_f32_16x16x32_bf16 a[116:119], a[244:247], v[128:131], a[116:119]
    v_add_f32 v174, v174, v151
    v_cvt_pk_bf16_f32 v141, v150, v151
    v_mfma_f32_16x16x32_bf16 a[120:123], a[248:251], v[128:131], a[120:123]
    v_exp_f32 v152, v104
    v_mfma_f32_16x16x32_bf16 a[124:127], a[252:255], v[128:131], a[124:127]
    s_waitcnt lgkmcnt(0)
    ds_read_b128 a[220:223], v2 offset:23552
    v_add_f32 v174, v174, v152
    v_mfma_f32_16x16x32_bf16 v[84:87], a[192:195], v[20:23], v[156:159]
    v_exp_f32 v153, v105
    v_mfma_f32_16x16x32_bf16 v[84:87], a[196:199], v[24:27], v[84:87]
    v_add_f32 v174, v174, v153
    v_cvt_pk_bf16_f32 v142, v152, v153
    v_mfma_f32_16x16x32_bf16 v[84:87], a[200:203], v[28:31], v[84:87]
    v_exp_f32 v154, v106
    v_mfma_f32_16x16x32_bf16 v[84:87], a[204:207], v[32:35], v[84:87]
    ds_read_b128 a[224:227], v2 offset:49152
    v_add_f32 v174, v174, v154
    v_mfma_f32_16x16x32_bf16 v[88:91], a[208:211], v[20:23], v[156:159]
    v_exp_f32 v155, v107
    v_mfma_f32_16x16x32_bf16 v[88:91], a[212:215], v[24:27], v[88:91]
    ds_read_b128 a[228:231], v2 offset:50176
    v_add_f32 v174, v174, v155
    v_cmp_lt_f32 vcc, s37, v174
    v_mfma_f32_16x16x32_bf16 v[88:91], a[216:219], v[28:31], v[88:91]
    s_waitcnt lgkmcnt(2)
    v_exp_f32 v148, v108
    v_mfma_f32_16x16x32_bf16 v[88:91], a[220:223], v[32:35], v[88:91]
    s_cbranch_vccnz L_mega_kernel_cy_1_7_out
L_mega_kernel_cy_1_7:
    s_add_u32 m0, s35, 36864
    s_add_u32 s38, s34, 4096
    v_cvt_pk_bf16_f32 v143, v154, v155
    v_add_f32 v178, v178, v174
    v_mfma_f32_16x16x32_bf16 v[92:95], a[192:195], v[36:39], v[160:163]
    buffer_load_dwordx4 v1, s[16:19], s38 offen offset:0 sc1 lds
    v_exp_f32 v149, v109
    v_mfma_f32_16x16x32_bf16 v[92:95], a[196:199], v[40:43], v[92:95]
    v_add_f32 v175, v148, v149
    v_cvt_pk_bf16_f32 v144, v148, v149
    v_mfma_f32_16x16x32_bf16 v[92:95], a[200:203], v[44:47], v[92:95]
    v_exp_f32 v150, v110
    v_mfma_f32_16x16x32_bf16 v[92:95], a[204:207], v[48:51], v[92:95]
    ds_read_b128 a[232:235], v2 offset:51200
    v_add_f32 v175, v175, v150
    v_mfma_f32_16x16x32_bf16 v[96:99], a[208:211], v[36:39], v[160:163]
    v_exp_f32 v151, v111
    v_mfma_f32_16x16x32_bf16 v[96:99], a[212:215], v[40:43], v[96:99]
    v_add_f32 v175, v175, v151
    v_cvt_pk_bf16_f32 v145, v150, v151
    v_mfma_f32_16x16x32_bf16 v[96:99], a[216:219], v[44:47], v[96:99]
    buffer_load_dwordx4 v1, s[16:19], s38 offen offset:1024 sc1 lds
    v_exp_f32 v152, v112
    v_mfma_f32_16x16x32_bf16 v[96:99], a[220:223], v[48:51], v[96:99]
    ds_read_b128 a[236:239], v2 offset:52224
    v_add_f32 v175, v175, v152
    v_mfma_f32_16x16x32_bf16 v[100:103], a[192:195], v[52:55], v[164:167]
    v_exp_f32 v153, v113
    v_mfma_f32_16x16x32_bf16 v[100:103], a[196:199], v[56:59], v[100:103]
    v_add_f32 v175, v175, v153
    v_cvt_pk_bf16_f32 v146, v152, v153
    v_mfma_f32_16x16x32_bf16 v[100:103], a[200:203], v[60:63], v[100:103]
    v_exp_f32 v154, v114
    v_mfma_f32_16x16x32_bf16 v[100:103], a[204:207], v[64:67], v[100:103]
    ds_read_b128 a[240:243], v2 offset:53248
    v_add_f32 v175, v175, v154
    v_mfma_f32_16x16x32_bf16 v[104:107], a[208:211], v[52:55], v[164:167]
    buffer_load_dwordx4 v1, s[16:19], s38 offen offset:2048 sc1 lds
    v_exp_f32 v155, v115
    v_mfma_f32_16x16x32_bf16 v[104:107], a[212:215], v[56:59], v[104:107]
    ds_read_b128 a[244:247], v2 offset:54272
    v_add_f32 v175, v175, v155
    v_cmp_lt_f32 vcc, s37, v175
    v_mfma_f32_16x16x32_bf16 v[104:107], a[216:219], v[60:63], v[104:107]
    v_exp_f32 v148, v84
    v_mfma_f32_16x16x32_bf16 v[104:107], a[220:223], v[64:67], v[104:107]
    s_cbranch_vccnz L_mega_kernel_cy_1_23_out
L_mega_kernel_cy_1_23:
    v_cvt_pk_bf16_f32 v147, v154, v155
    v_add_f32 v179, v179, v175
    v_mfma_f32_16x16x32_bf16 v[108:111], a[192:195], v[68:71], v[168:171]
    v_exp_f32 v149, v85
    v_mfma_f32_16x16x32_bf16 v[108:111], a[196:199], v[72:75], v[108:111]
    v_add_f32 v172, v148, v149
    v_cvt_pk_bf16_f32 v116, v148, v149
    v_mfma_f32_16x16x32_bf16 v[108:111], a[200:203], v[76:79], v[108:111]
    buffer_load_dwordx4 v1, s[16:19], s38 offen offset:3072 sc1 lds
    v_exp_f32 v150, v86
    v_mfma_f32_16x16x32_bf16 v[108:111], a[204:207], v[80:83], v[108:111]
    ds_read_b128 a[248:251], v2 offset:55296
    s_add_u32 s34, s34, 32768
    v_add_f32 v172, v172, v150
    v_mfma_f32_16x16x32_bf16 v[112:115], a[208:211], v[68:71], v[168:171]
    v_exp_f32 v151, v87
    v_mfma_f32_16x16x32_bf16 v[112:115], a[212:215], v[72:75], v[112:115]
    v_add_f32 v172, v172, v151
    v_cvt_pk_bf16_f32 v117, v150, v151
    v_mfma_f32_16x16x32_bf16 v[112:115], a[216:219], v[76:79], v[112:115]
    v_exp_f32 v152, v88
    v_mfma_f32_16x16x32_bf16 v[112:115], a[220:223], v[80:83], v[112:115]
    s_waitcnt lgkmcnt(0)
    ds_read_b128 a[252:255], v2 offset:56320
    v_add_f32 v172, v172, v152
    v_mfma_f32_16x16x32_bf16 a[0:3], a[224:227], v[132:135], a[0:3]
    v_exp_f32 v153, v89
    v_mfma_f32_16x16x32_bf16 a[4:7], a[228:231], v[132:135], a[4:7]
    v_add_f32 v172, v172, v153
    v_cvt_pk_bf16_f32 v118, v152, v153
    v_mfma_f32_16x16x32_bf16 a[8:11], a[232:235], v[132:135], a[8:11]
    v_exp_f32 v154, v90
    v_mfma_f32_16x16x32_bf16 a[12:15], a[236:239], v[132:135], a[12:15]
    ds_read_b128 a[192:195], v2 offset:24576
    v_add_f32 v172, v172, v154
    v_mfma_f32_16x16x32_bf16 a[16:19], a[240:243], v[132:135], a[16:19]
    v_exp_f32 v155, v91
    v_mfma_f32_16x16x32_bf16 a[20:23], a[244:247], v[132:135], a[20:23]
    ds_read_b128 a[196:199], v2 offset:25600
    v_add_f32 v172, v172, v155
    v_cmp_lt_f32 vcc, s37, v172
    v_mfma_f32_16x16x32_bf16 a[24:27], a[248:251], v[132:135], a[24:27]
    s_waitcnt lgkmcnt(2)
    v_exp_f32 v148, v92
    v_mfma_f32_16x16x32_bf16 a[28:31], a[252:255], v[132:135], a[28:31]
    s_cbranch_vccnz L_mega_kernel_cy_1_39_out
L_mega_kernel_cy_1_39:
    v_cvt_pk_bf16_f32 v119, v154, v155
    v_add_f32 v176, v176, v172
    v_mfma_f32_16x16x32_bf16 a[32:35], a[224:227], v[136:139], a[32:35]
    v_exp_f32 v149, v93
    v_mfma_f32_16x16x32_bf16 a[36:39], a[228:231], v[136:139], a[36:39]
    v_add_f32 v173, v148, v149
    v_cvt_pk_bf16_f32 v120, v148, v149
    v_mfma_f32_16x16x32_bf16 a[40:43], a[232:235], v[136:139], a[40:43]
    v_exp_f32 v150, v94
    v_mfma_f32_16x16x32_bf16 a[44:47], a[236:239], v[136:139], a[44:47]
    ds_read_b128 a[200:203], v2 offset:26624
    v_add_f32 v173, v173, v150
    v_mfma_f32_16x16x32_bf16 a[48:51], a[240:243], v[136:139], a[48:51]
    v_exp_f32 v151, v95
    v_mfma_f32_16x16x32_bf16 a[52:55], a[244:247], v[136:139], a[52:55]
    v_add_f32 v173, v173, v151
    v_cvt_pk_bf16_f32 v121, v150, v151
    v_mfma_f32_16x16x32_bf16 a[56:59], a[248:251], v[136:139], a[56:59]
    v_exp_f32 v152, v96
    v_mfma_f32_16x16x32_bf16 a[60:63], a[252:255], v[136:139], a[60:63]
    ds_read_b128 a[204:207], v2 offset:27648
    v_add_f32 v173, v173, v152
    v_mfma_f32_16x16x32_bf16 a[64:67], a[224:227], v[140:143], a[64:67]
    v_exp_f32 v153, v97
    v_mfma_f32_16x16x32_bf16 a[68:71], a[228:231], v[140:143], a[68:71]
    v_add_f32 v173, v173, v153
    v_cvt_pk_bf16_f32 v122, v152, v153
    v_mfma_f32_16x16x32_bf16 a[72:75], a[232:235], v[140:143], a[72:75]
    v_exp_f32 v154, v98
    v_mfma_f32_16x16x32_bf16 a[76:79], a[236:239], v[140:143], a[76:79]
    ds_read_b128 a[208:211], v2 offset:28672
    v_add_f32 v173, v173, v154
    v_mfma_f32_16x16x32_bf16 a[80:83], a[240:243], v[140:143], a[80:83]
    v_exp_f32 v155, v99
    v_mfma_f32_16x16x32_bf16 a[84:87], a[244:247], v[140:143], a[84:87]
    ds_read_b128 a[212:215], v2 offset:29696
    v_add_f32 v173, v173, v155
    v_cmp_lt_f32 vcc, s37, v173
    v_mfma_f32_16x16x32_bf16 a[88:91], a[248:251], v[140:143], a[88:91]
    v_exp_f32 v148, v100
    v_mfma_f32_16x16x32_bf16 a[92:95], a[252:255], v[140:143], a[92:95]
    s_cbranch_vccnz L_mega_kernel_cy_1_55_out
L_mega_kernel_cy_1_55:
    v_cvt_pk_bf16_f32 v123, v154, v155
    v_add_f32 v177, v177, v173
    v_mfma_f32_16x16x32_bf16 a[96:99], a[224:227], v[144:147], a[96:99]
    v_exp_f32 v149, v101
    v_mfma_f32_16x16x32_bf16 a[100:103], a[228:231], v[144:147], a[100:103]
    v_add_f32 v174, v148, v149
    v_cvt_pk_bf16_f32 v124, v148, v149
    v_mfma_f32_16x16x32_bf16 a[104:107], a[232:235], v[144:147], a[104:107]
    v_exp_f32 v150, v102
    v_mfma_f32_16x16x32_bf16 a[108:111], a[236:239], v[144:147], a[108:111]
    ds_read_b128 a[216:219], v2 offset:30720
    v_add_f32 v174, v174, v150
    v_mfma_f32_16x16x32_bf16 a[112:115], a[240:243], v[144:147], a[112:115]
    v_exp_f32 v151, v103
    v_mfma_f32_16x16x32_bf16 a[116:119], a[244:247], v[144:147], a[116:119]
    v_add_f32 v174, v174, v151
    v_cvt_pk_bf16_f32 v125, v150, v151
    v_mfma_f32_16x16x32_bf16 a[120:123], a[248:251], v[144:147], a[120:123]
    v_exp_f32 v152, v104
    v_mfma_f32_16x16x32_bf16 a[124:127], a[252:255], v[144:147], a[124:127]
    s_waitcnt lgkmcnt(0)
    ds_read_b128 a[220:223], v2 offset:31744
    v_add_f32 v174, v174, v152
    v_mfma_f32_16x16x32_bf16 v[84:87], a[192:195], v[20:23], v[156:159]
    v_exp_f32 v153, v105
    v_mfma_f32_16x16x32_bf16 v[84:87], a[196:199], v[24:27], v[84:87]
    v_add_f32 v174, v174, v153
    v_cvt_pk_bf16_f32 v126, v152, v153
    v_mfma_f32_16x16x32_bf16 v[84:87], a[200:203], v[28:31], v[84:87]
    v_exp_f32 v154, v106
    v_mfma_f32_16x16x32_bf16 v[84:87], a[204:207], v[32:35], v[84:87]
    ds_read_b128 a[224:227], v2 offset:57344
    v_add_f32 v174, v174, v154
    v_mfma_f32_16x16x32_bf16 v[88:91], a[208:211], v[20:23], v[156:159]
    v_exp_f32 v155, v107
    v_mfma_f32_16x16x32_bf16 v[88:91], a[212:215], v[24:27], v[88:91]
    ds_read_b128 a[228:231], v2 offset:58368
    v_add_f32 v174, v174, v155
    v_cmp_lt_f32 vcc, s37, v174
    v_mfma_f32_16x16x32_bf16 v[88:91], a[216:219], v[28:31], v[88:91]
    s_waitcnt lgkmcnt(2)
    v_exp_f32 v148, v108
    v_mfma_f32_16x16x32_bf16 v[88:91], a[220:223], v[32:35], v[88:91]
    s_cbranch_vccnz L_mega_kernel_cy_2_7_out
L_mega_kernel_cy_2_7:
    v_cvt_pk_bf16_f32 v127, v154, v155
    v_add_f32 v178, v178, v174
    v_mfma_f32_16x16x32_bf16 v[92:95], a[192:195], v[36:39], v[160:163]
    v_exp_f32 v149, v109
    v_mfma_f32_16x16x32_bf16 v[92:95], a[196:199], v[40:43], v[92:95]
    v_add_f32 v175, v148, v149
    v_cvt_pk_bf16_f32 v128, v148, v149
    v_mfma_f32_16x16x32_bf16 v[92:95], a[200:203], v[44:47], v[92:95]
    v_exp_f32 v150, v110
    v_mfma_f32_16x16x32_bf16 v[92:95], a[204:207], v[48:51], v[92:95]
    ds_read_b128 a[232:235], v2 offset:59392
    v_add_f32 v175, v175, v150
    v_mfma_f32_16x16x32_bf16 v[96:99], a[208:211], v[36:39], v[160:163]
    v_exp_f32 v151, v111
    v_mfma_f32_16x16x32_bf16 v[96:99], a[212:215], v[40:43], v[96:99]
    v_add_f32 v175, v175, v151
    v_cvt_pk_bf16_f32 v129, v150, v151
    v_mfma_f32_16x16x32_bf16 v[96:99], a[216:219], v[44:47], v[96:99]
    v_exp_f32 v152, v112
    v_mfma_f32_16x16x32_bf16 v[96:99], a[220:223], v[48:51], v[96:99]
    ds_read_b128 a[236:239], v2 offset:60416
    v_add_f32 v175, v175, v152
    v_mfma_f32_16x16x32_bf16 v[100:103], a[192:195], v[52:55], v[164:167]
    v_exp_f32 v153, v113
    v_mfma_f32_16x16x32_bf16 v[100:103], a[196:199], v[56:59], v[100:103]
    v_add_f32 v175, v175, v153
    v_cvt_pk_bf16_f32 v130, v152, v153
    v_mfma_f32_16x16x32_bf16 v[100:103], a[200:203], v[60:63], v[100:103]
    v_exp_f32 v154, v114
    v_mfma_f32_16x16x32_bf16 v[100:103], a[204:207], v[64:67], v[100:103]
    ds_read_b128 a[240:243], v2 offset:61440
    v_add_f32 v175, v175, v154
    v_mfma_f32_16x16x32_bf16 v[104:107], a[208:211], v[52:55], v[164:167]
    v_exp_f32 v155, v115
    v_mfma_f32_16x16x32_bf16 v[104:107], a[212:215], v[56:59], v[104:107]
    ds_read_b128 a[244:247], v2 offset:62464
    v_add_f32 v175, v175, v155
    v_cmp_lt_f32 vcc, s37, v175
    v_mfma_f32_16x16x32_bf16 v[104:107], a[216:219], v[60:63], v[104:107]
    v_exp_f32 v148, v84
    v_mfma_f32_16x16x32_bf16 v[104:107], a[220:223], v[64:67], v[104:107]
    s_cbranch_vccnz L_mega_kernel_cy_2_23_out
L_mega_kernel_cy_2_23:
    v_cvt_pk_bf16_f32 v131, v154, v155
    v_add_f32 v179, v179, v175
    v_mfma_f32_16x16x32_bf16 v[108:111], a[192:195], v[68:71], v[168:171]
    v_exp_f32 v149, v85
    v_mfma_f32_16x16x32_bf16 v[108:111], a[196:199], v[72:75], v[108:111]
    ds_read_b128 a[248:251], v2 offset:63488
    v_add_f32 v172, v148, v149
    v_cvt_pk_bf16_f32 v132, v148, v149
    v_mfma_f32_16x16x32_bf16 v[108:111], a[200:203], v[76:79], v[108:111]
    v_exp_f32 v150, v86
    v_mfma_f32_16x16x32_bf16 v[108:111], a[204:207], v[80:83], v[108:111]
    ds_read_b128 a[252:255], v2 offset:64512
    v_add_f32 v172, v172, v150
    v_mfma_f32_16x16x32_bf16 v[112:115], a[208:211], v[68:71], v[168:171]
    v_exp_f32 v151, v87
    v_mfma_f32_16x16x32_bf16 v[112:115], a[212:215], v[72:75], v[112:115]
    v_add_f32 v172, v172, v151
    v_cvt_pk_bf16_f32 v133, v150, v151
    v_mfma_f32_16x16x32_bf16 v[112:115], a[216:219], v[76:79], v[112:115]
    v_exp_f32 v152, v88
    v_mfma_f32_16x16x32_bf16 v[112:115], a[220:223], v[80:83], v[112:115]
    s_waitcnt lgkmcnt(0)
    v_add_f32 v172, v172, v152
    v_mfma_f32_16x16x32_bf16 a[0:3], a[224:227], v[116:119], a[0:3]
    v_exp_f32 v153, v89
    v_mfma_f32_16x16x32_bf16 a[4:7], a[228:231], v[116:119], a[4:7]
    s_waitcnt vmcnt(0) lgkmcnt(0)
    s_barrier
    v_add_f32 v172, v172, v153
    v_cvt_pk_bf16_f32 v134, v152, v153
    v_mfma_f32_16x16x32_bf16 a[8:11], a[232:235], v[116:119], a[8:11]
    v_exp_f32 v154, v90
    v_mfma_f32_16x16x32_bf16 a[12:15], a[236:239], v[116:119], a[12:15]
    ds_read_b128 a[192:195], v3 offset:32768
    v_add_f32 v172, v172, v154
    v_mfma_f32_16x16x32_bf16 a[16:19], a[240:243], v[116:119], a[16:19]
    v_exp_f32 v155, v91
    v_mfma_f32_16x16x32_bf16 a[20:23], a[244:247], v[116:119], a[20:23]
    ds_read_b128 a[196:199], v3 offset:33792
    v_add_f32 v172, v172, v155
    v_cmp_lt_f32 vcc, s37, v172
    v_mfma_f32_16x16x32_bf16 a[24:27], a[248:251], v[116:119], a[24:27]
    v_exp_f32 v148, v92
    v_mfma_f32_16x16x32_bf16 a[28:31], a[252:255], v[116:119], a[28:31]
    s_cbranch_vccnz L_mega_kernel_cy_2_39_out
L_mega_kernel_cy_2_39:
    v_cvt_pk_bf16_f32 v135, v154, v155
    v_add_f32 v176, v176, v172
    v_mfma_f32_16x16x32_bf16 a[32:35], a[224:227], v[120:123], a[32:35]
    v_exp_f32 v149, v93
    v_mfma_f32_16x16x32_bf16 a[36:39], a[228:231], v[120:123], a[36:39]
    v_add_f32 v173, v148, v149
    v_cvt_pk_bf16_f32 v136, v148, v149
    v_mfma_f32_16x16x32_bf16 a[40:43], a[232:235], v[120:123], a[40:43]
    v_exp_f32 v150, v94
    v_mfma_f32_16x16x32_bf16 a[44:47], a[236:239], v[120:123], a[44:47]
    ds_read_b128 a[200:203], v3 offset:34816
    v_add_f32 v173, v173, v150
    v_mfma_f32_16x16x32_bf16 a[48:51], a[240:243], v[120:123], a[48:51]
    v_exp_f32 v151, v95
    v_mfma_f32_16x16x32_bf16 a[52:55], a[244:247], v[120:123], a[52:55]
    v_add_f32 v173, v173, v151
    v_cvt_pk_bf16_f32 v137, v150, v151
    v_mfma_f32_16x16x32_bf16 a[56:59], a[248:251], v[120:123], a[56:59]
    v_exp_f32 v152, v96
    v_mfma_f32_16x16x32_bf16 a[60:63], a[252:255], v[120:123], a[60:63]
    ds_read_b128 a[204:207], v3 offset:35840
    v_add_f32 v173, v173, v152
    v_mfma_f32_16x16x32_bf16 a[64:67], a[224:227], v[124:127], a[64:67]
    v_exp_f32 v153, v97
    v_mfma_f32_16x16x32_bf16 a[68:71], a[228:231], v[124:127], a[68:71]
    v_add_f32 v173, v173, v153
    v_cvt_pk_bf16_f32 v138, v152, v153
    v_mfma_f32_16x16x32_bf16 a[72:75], a[232:235], v[124:127], a[72:75]
    v_exp_f32 v154, v98
    v_mfma_f32_16x16x32_bf16 a[76:79], a[236:239], v[124:127], a[76:79]
    ds_read_b128 a[208:211], v3 offset:36864
    v_add_f32 v173, v173, v154
    v_mfma_f32_16x16x32_bf16 a[80:83], a[240:243], v[124:127], a[80:83]
    v_exp_f32 v155, v99
    v_mfma_f32_16x16x32_bf16 a[84:87], a[244:247], v[124:127], a[84:87]
    ds_read_b128 a[212:215], v3 offset:37888
    v_add_f32 v173, v173, v155
    v_cmp_lt_f32 vcc, s37, v173
    v_mfma_f32_16x16x32_bf16 a[88:91], a[248:251], v[124:127], a[88:91]
    v_exp_f32 v148, v100
    v_mfma_f32_16x16x32_bf16 a[92:95], a[252:255], v[124:127], a[92:95]
    s_cbranch_vccnz L_mega_kernel_cy_2_55_out
L_mega_kernel_cy_2_55:
    v_cvt_pk_bf16_f32 v139, v154, v155
    v_add_f32 v177, v177, v173
    v_mfma_f32_16x16x32_bf16 a[96:99], a[224:227], v[128:131], a[96:99]
    v_exp_f32 v149, v101
    v_mfma_f32_16x16x32_bf16 a[100:103], a[228:231], v[128:131], a[100:103]
    v_add_f32 v174, v148, v149
    v_cvt_pk_bf16_f32 v140, v148, v149
    v_mfma_f32_16x16x32_bf16 a[104:107], a[232:235], v[128:131], a[104:107]
    v_exp_f32 v150, v102
    v_mfma_f32_16x16x32_bf16 a[108:111], a[236:239], v[128:131], a[108:111]
    ds_read_b128 a[216:219], v3 offset:38912
    v_add_f32 v174, v174, v150
    v_mfma_f32_16x16x32_bf16 a[112:115], a[240:243], v[128:131], a[112:115]
    v_exp_f32 v151, v103
    v_mfma_f32_16x16x32_bf16 a[116:119], a[244:247], v[128:131], a[116:119]
    v_add_f32 v174, v174, v151
    v_cvt_pk_bf16_f32 v141, v150, v151
    v_mfma_f32_16x16x32_bf16 a[120:123], a[248:251], v[128:131], a[120:123]
    v_exp_f32 v152, v104
    v_mfma_f32_16x16x32_bf16 a[124:127], a[252:255], v[128:131], a[124:127]
    s_waitcnt lgkmcnt(0)
    ds_read_b128 a[220:223], v3 offset:39936
    v_add_f32 v174, v174, v152
    v_mfma_f32_16x16x32_bf16 a[0:3], a[192:195], v[132:135], a[0:3]
    v_exp_f32 v153, v105
    v_mfma_f32_16x16x32_bf16 a[4:7], a[196:199], v[132:135], a[4:7]
    v_add_f32 v174, v174, v153
    v_cvt_pk_bf16_f32 v142, v152, v153
    v_mfma_f32_16x16x32_bf16 a[8:11], a[200:203], v[132:135], a[8:11]
    v_exp_f32 v154, v106
    v_mfma_f32_16x16x32_bf16 a[12:15], a[204:207], v[132:135], a[12:15]
    v_add_f32 v174, v174, v154
    v_mfma_f32_16x16x32_bf16 a[16:19], a[208:211], v[132:135], a[16:19]
    v_exp_f32 v155, v107
    v_mfma_f32_16x16x32_bf16 a[20:23], a[212:215], v[132:135], a[20:23]
    v_add_f32 v174, v174, v155
    v_cmp_lt_f32 vcc, s37, v174
    v_mfma_f32_16x16x32_bf16 a[24:27], a[216:219], v[132:135], a[24:27]
    s_waitcnt lgkmcnt(0)
    v_exp_f32 v148, v108
    v_mfma_f32_16x16x32_bf16 a[28:31], a[220:223], v[132:135], a[28:31]
    s_cbranch_vccnz L_mega_kernel_cy_3_7_out
L_mega_kernel_cy_3_7:
    v_cvt_pk_bf16_f32 v143, v154, v155
    v_add_f32 v178, v178, v174
    v_mfma_f32_16x16x32_bf16 a[32:35], a[192:195], v[136:139], a[32:35]
    v_exp_f32 v149, v109
    v_mfma_f32_16x16x32_bf16 a[36:39], a[196:199], v[136:139], a[36:39]
    v_add_f32 v175, v148, v149
    v_cvt_pk_bf16_f32 v144, v148, v149
    v_mfma_f32_16x16x32_bf16 a[40:43], a[200:203], v[136:139], a[40:43]
    v_exp_f32 v150, v110
    v_mfma_f32_16x16x32_bf16 a[44:47], a[204:207], v[136:139], a[44:47]
    v_add_f32 v175, v175, v150
    v_mfma_f32_16x16x32_bf16 a[48:51], a[208:211], v[136:139], a[48:51]
    v_exp_f32 v151, v111
    v_mfma_f32_16x16x32_bf16 a[52:55], a[212:215], v[136:139], a[52:55]
    v_add_f32 v175, v175, v151
    v_cvt_pk_bf16_f32 v145, v150, v151
    v_mfma_f32_16x16x32_bf16 a[56:59], a[216:219], v[136:139], a[56:59]
    v_exp_f32 v152, v112
    v_mfma_f32_16x16x32_bf16 a[60:63], a[220:223], v[136:139], a[60:63]
    v_add_f32 v175, v175, v152
    v_mfma_f32_16x16x32_bf16 a[64:67], a[192:195], v[140:143], a[64:67]
    v_exp_f32 v153, v113
    v_mfma_f32_16x16x32_bf16 a[68:71], a[196:199], v[140:143], a[68:71]
    v_add_f32 v175, v175, v153
    v_cvt_pk_bf16_f32 v146, v152, v153
    v_mfma_f32_16x16x32_bf16 a[72:75], a[200:203], v[140:143], a[72:75]
    v_exp_f32 v154, v114
    v_mfma_f32_16x16x32_bf16 a[76:79], a[204:207], v[140:143], a[76:79]
    v_add_f32 v175, v175, v154
    v_mfma_f32_16x16x32_bf16 a[80:83], a[208:211], v[140:143], a[80:83]
    v_exp_f32 v155, v115
    v_mfma_f32_16x16x32_bf16 a[84:87], a[212:215], v[140:143], a[84:87]
    v_add_f32 v175, v175, v155
    v_cmp_lt_f32 vcc, s37, v175
    v_mfma_f32_16x16x32_bf16 a[88:91], a[216:219], v[140:143], a[88:91]
    v_mfma_f32_16x16x32_bf16 a[92:95], a[220:223], v[140:143], a[92:95]
    s_cbranch_vccnz L_mega_kernel_cy_3_23_out
L_mega_kernel_cy_3_23:
    v_cvt_pk_bf16_f32 v147, v154, v155
    v_add_f32 v179, v179, v175
    s_nop 0
    s_nop 0
    v_mfma_f32_16x16x32_bf16 a[96:99], a[192:195], v[144:147], a[96:99]
    v_mfma_f32_16x16x32_bf16 a[100:103], a[196:199], v[144:147], a[100:103]
    v_mfma_f32_16x16x32_bf16 a[104:107], a[200:203], v[144:147], a[104:107]
    v_mfma_f32_16x16x32_bf16 a[108:111], a[204:207], v[144:147], a[108:111]
    v_mfma_f32_16x16x32_bf16 a[112:115], a[208:211], v[144:147], a[112:115]
    v_mfma_f32_16x16x32_bf16 a[116:119], a[212:215], v[144:147], a[116:119]
    v_mfma_f32_16x16x32_bf16 a[120:123], a[216:219], v[144:147], a[120:123]
    v_mfma_f32_16x16x32_bf16 a[124:127], a[220:223], v[144:147], a[124:127]
    s_branch L_mega_kernel_post
L_mega_kernel_fallback:
    s_mov_b32 s3, 1
    s_lshl_b32 s38, s27, 19
    s_lshl_b32 s39, s24, 13
    s_add_u32 s33, s38, s39
    s_add_u32 s34, s33, 0x1fe000
    s_mov_b32 s36, s39
    s_add_u32 s35, s39, 0x10000
    v_mov_b32 v2, v1
    v_add_u32 v3, 0x10000, v1
    s_add_u32 m0, s36, 0
    s_nop 0
    buffer_load_dwordx4 v1, s[16:19], s33 offen offset:0 sc1 lds
    buffer_load_dwordx4 v1, s[16:19], s33 offen offset:1024 sc1 lds
    buffer_load_dwordx4 v1, s[16:19], s33 offen offset:2048 sc1 lds
    buffer_load_dwordx4 v1, s[16:19], s33 offen offset:3072 sc1 lds
    s_add_u32 m0, s36, 4096
    s_add_u32 s38, s33, 4096
    s_nop 0
    buffer_load_dwordx4 v1, s[16:19], s38 offen offset:0 sc1 lds
    buffer_load_dwordx4 v1, s[16:19], s38 offen offset:1024 sc1 lds
    buffer_load_dwordx4 v1, s[16:19], s38 offen offset:2048 sc1 lds
    buffer_load_dwordx4 v1, s[16:19], s38 offen offset:3072 sc1 lds
    s_add_u32 s33, s33, 32768
    s_add_u32 m0, s36, 32768
    s_nop 0
    buffer_load_dwordx4 v1, s[16:19], s34 offen offset:0 sc1 lds
    buffer_load_dwordx4 v1, s[16:19], s34 offen offset:1024 sc1 lds
    buffer_load_dwordx4 v1, s[16:19], s34 offen offset:2048 sc1 lds
    buffer_load_dwordx4 v1, s[16:19], s34 offen offset:3072 sc1 lds
    s_add_u32 m0, s36, 36864
    s_add_u32 s38, s34, 4096
    s_nop 0
    buffer_load_dwordx4 v1, s[16:19], s38 offen offset:0 sc1 lds
    buffer_load_dwordx4 v1, s[16:19], s38 offen offset:1024 sc1 lds
    buffer_load_dwordx4 v1, s[16:19], s38 offen offset:2048 sc1 lds
    buffer_load_dwordx4 v1, s[16:19], s38 offen offset:3072 sc1 lds
    s_add_u32 s34, s34, 32768
    v_accvgpr_write_b32 a0, 0
    v_accvgpr_write_b32 a1, 0
    v_accvgpr_write_b32 a2, 0
    v_accvgpr_write_b32 a3, 0
    v_accvgpr_write_b32 a4, 0
    v_accvgpr_write_b32 a5, 0
    v_accvgpr_write_b32 a6, 0
    v_accvgpr_write_b32 a7, 0
    v_accvgpr_write_b32 a8, 0
    v_accvgpr_write_b32 a9, 0
    v_accvgpr_write_b32 a10, 0
    v_accvgpr_write_b32 a11, 0
    v_accvgpr_write_b32 a12, 0
    v_accvgpr_write_b32 a13, 0
    v_accvgpr_write_b32 a14, 0
    v_accvgpr_write_b32 a15, 0
    v_accvgpr_write_b32 a16, 0
    v_accvgpr_write_b32 a17, 0
    v_accvgpr_write_b32 a18, 0
    v_accvgpr_write_b32 a19, 0
    v_accvgpr_write_b32 a20, 0
    v_accvgpr_write_b32 a21, 0
    v_accvgpr_write_b32 a22, 0
    v_accvgpr_write_b32 a23, 0
    v_accvgpr_write_b32 a24, 0
    v_accvgpr_write_b32 a25, 0
    v_accvgpr_write_b32 a26, 0
    v_accvgpr_write_b32 a27, 0
    v_accvgpr_write_b32 a28, 0
    v_accvgpr_write_b32 a29, 0
    v_accvgpr_write_b32 a30, 0
    v_accvgpr_write_b32 a31, 0
    v_accvgpr_write_b32 a32, 0
    v_accvgpr_write_b32 a33, 0
    v_accvgpr_write_b32 a34, 0
    v_accvgpr_write_b32 a35, 0
    v_accvgpr_write_b32 a36, 0
    v_accvgpr_write_b32 a37, 0
    v_accvgpr_write_b32 a38, 0
    v_accvgpr_write_b32 a39, 0
    v_accvgpr_write_b32 a40, 0
    v_accvgpr_write_b32 a41, 0
    v_accvgpr_write_b32 a42, 0
    v_accvgpr_write_b32 a43, 0
    v_accvgpr_write_b32 a44, 0
    v_accvgpr_write_b32 a45, 0
    v_accvgpr_write_b32 a46, 0
    v_accvgpr_write_b32 a47, 0
    v_accvgpr_write_b32 a48, 0
    v_accvgpr_write_b32 a49, 0
    v_accvgpr_write_b32 a50, 0
    v_accvgpr_write_b32 a51, 0
    v_accvgpr_write_b32 a52, 0
    v_accvgpr_write_b32 a53, 0
    v_accvgpr_write_b32 a54, 0
    v_accvgpr_write_b32 a55, 0
    v_accvgpr_write_b32 a56, 0
    v_accvgpr_write_b32 a57, 0
    v_accvgpr_write_b32 a58, 0
    v_accvgpr_write_b32 a59, 0
    v_accvgpr_write_b32 a60, 0
    v_accvgpr_write_b32 a61, 0
    v_accvgpr_write_b32 a62, 0
    v_accvgpr_write_b32 a63, 0
    v_accvgpr_write_b32 a64, 0
    v_accvgpr_write_b32 a65, 0
    v_accvgpr_write_b32 a66, 0
    v_accvgpr_write_b32 a67, 0
    v_accvgpr_write_b32 a68, 0
    v_accvgpr_write_b32 a69, 0
    v_accvgpr_write_b32 a70, 0
    v_accvgpr_write_b32 a71, 0
    v_accvgpr_write_b32 a72, 0
    v_accvgpr_write_b32 a73, 0
    v_accvgpr_write_b32 a74, 0
    v_accvgpr_write_b32 a75, 0
    v_accvgpr_write_b32 a76, 0
    v_accvgpr_write_b32 a77, 0
    v_accvgpr_write_b32 a78, 0
    v_accvgpr_write_b32 a79, 0
    v_accvgpr_write_b32 a80, 0
    v_accvgpr_write_b32 a81, 0
    v_accvgpr_write_b32 a82, 0
    v_accvgpr_write_b32 a83, 0
    v_accvgpr_write_b32 a84, 0
    v_accvgpr_write_b32 a85, 0
    v_accvgpr_write_b32 a86, 0
    v_accvgpr_write_b32 a87, 0
    v_accvgpr_write_b32 a88, 0
    v_accvgpr_write_b32 a89, 0
    v_accvgpr_write_b32 a90, 0
    v_accvgpr_write_b32 a91, 0
    v_accvgpr_write_b32 a92, 0
    v_accvgpr_write_b32 a93, 0
    v_accvgpr_write_b32 a94, 0
    v_accvgpr_write_b32 a95, 0
    v_accvgpr_write_b32 a96, 0
    v_accvgpr_write_b32 a97, 0
    v_accvgpr_write_b32 a98, 0
    v_accvgpr_write_b32 a99, 0
    v_accvgpr_write_b32 a100, 0
    v_accvgpr_write_b32 a101, 0
    v_accvgpr_write_b32 a102, 0
    v_accvgpr_write_b32 a103, 0
    v_accvgpr_write_b32 a104, 0
    v_accvgpr_write_b32 a105, 0
    v_accvgpr_write_b32 a106, 0
    v_accvgpr_write_b32 a107, 0
    v_accvgpr_write_b32 a108, 0
    v_accvgpr_write_b32 a109, 0
    v_accvgpr_write_b32 a110, 0
    v_accvgpr_write_b32 a111, 0
    v_accvgpr_write_b32 a112, 0
    v_accvgpr_write_b32 a113, 0
    v_accvgpr_write_b32 a114, 0
    v_accvgpr_write_b32 a115, 0
    v_accvgpr_write_b32 a116, 0
    v_accvgpr_write_b32 a117, 0
    v_accvgpr_write_b32 a118, 0
    v_accvgpr_write_b32 a119, 0
    v_accvgpr_write_b32 a120, 0
    v_accvgpr_write_b32 a121, 0
    v_accvgpr_write_b32 a122, 0
    v_accvgpr_write_b32 a123, 0
    v_accvgpr_write_b32 a124, 0
    v_accvgpr_write_b32 a125, 0
    v_accvgpr_write_b32 a126, 0
    v_accvgpr_write_b32 a127, 0
    s_branch L_mega_kernel_restart
L_mega_kernel_kvspin:
    s_mov_b64 s[88:89], exec
    s_mov_b64 exec, -1
    v_lshlrev_b32 v252, 2, v0
    v_add_u32 v252, s61, v252
    s_mov_b32 s87, 262144
L_fz_p5:
    buffer_load_dword v253, v252, s[92:95], 0 offen sc1
    s_waitcnt vmcnt(0)
    v_cmp_ne_u32 vcc, 1, v253
    s_cbranch_vccz L_fz_g5
    s_sub_u32 s87, s87, 1
    s_cmp_lg_u32 s87, 0
    s_cbranch_scc1 L_fz_p5
L_fz_g5:
    s_mov_b64 exec, s[88:89]
    s_branch L_mega_kernel_kvok
L_mega_kernel_cc_0_7_out:
    s_call_b64 s[40:41], L_mega_kernel_slow_2_0
    s_branch L_mega_kernel_cc_0_7
L_mega_kernel_cc_0_23_out:
    s_call_b64 s[40:41], L_mega_kernel_slow_3_0
    s_branch L_mega_kernel_cc_0_23
L_mega_kernel_cc_0_39_out:
    s_call_b64 s[40:41], L_mega_kernel_slow_0_1
    s_branch L_mega_kernel_cc_0_39
L_mega_kernel_cc_0_55_out:
    s_call_b64 s[40:41], L_mega_kernel_slow_1_1
    s_branch L_mega_kernel_cc_0_55
L_mega_kernel_cc_1_7_out:
    s_call_b64 s[40:41], L_mega_kernel_slow_2_1
    s_branch L_mega_kernel_cc_1_7
L_mega_kernel_cc_1_23_out:
    s_call_b64 s[40:41], L_mega_kernel_slow_3_1
    s_branch L_mega_kernel_cc_1_23
L_mega_kernel_cc_1_39_out:
    s_call_b64 s[40:41], L_mega_kernel_slow_0_0
    s_branch L_mega_kernel_cc_1_39
L_mega_kernel_cc_1_55_out:
    s_call_b64 s[40:41], L_mega_kernel_slow_1_0
    s_branch L_mega_kernel_cc_1_55
L_mega_kernel_cc_2_7_out:
    s_call_b64 s[40:41], L_mega_kernel_slow_2_0
    s_branch L_mega_kernel_cc_2_7
L_mega_kernel_cc_2_23_out:
    s_call_b64 s[40:41], L_mega_kernel_slow_3_0
    s_branch L_mega_kernel_cc_2_23
L_mega_kernel_cc_2_39_out:
    s_call_b64 s[40:41], L_mega_kernel_slow_0_1
    s_branch L_mega_kernel_cc_2_39
L_mega_kernel_cc_2_55_out:
    s_call_b64 s[40:41], L_mega_kernel_slow_1_1
    s_branch L_mega_kernel_cc_2_55
L_mega_kernel_cc_3_7_out:
    s_call_b64 s[40:41], L_mega_kernel_slow_2_1
    s_branch L_mega_kernel_cc_3_7
L_mega_kernel_cc_3_23_out:
    s_call_b64 s[40:41], L_mega_kernel_slow_3_1
    s_branch L_mega_kernel_cc_3_23
L_mega_kernel_cc_3_39_out:
    s_call_b64 s[40:41], L_mega_kernel_slow_0_0
    s_branch L_mega_kernel_cc_3_39
L_mega_kernel_cc_3_55_out:
    s_call_b64 s[40:41], L_mega_kernel_slow_1_0
    s_branch L_mega_kernel_cc_3_55
L_mega_kernel_cy_0_7_out:
    s_call_b64 s[40:41], L_mega_kernel_slow_2_0
    s_branch L_mega_kernel_cy_0_7
L_mega_kernel_cy_0_23_out:
    s_call_b64 s[40:41], L_mega_kernel_slow_3_0
    s_branch L_mega_kernel_cy_0_23
L_mega_kernel_cy_0_39_out:
    s_call_b64 s[40:41], L_mega_kernel_slow_0_1
    s_branch L_mega_kernel_cy_0_39
L_mega_kernel_cy_0_55_out:
    s_call_b64 s[40:41], L_mega_kernel_slow_1_1
    s_branch L_mega_kernel_cy_0_55
L_mega_kernel_cy_1_7_out:
    s_call_b64 s[40:41], L_mega_kernel_slow_2_1
    s_branch L_mega_kernel_cy_1_7
L_mega_kernel_cy_1_23_out:
    s_call_b64 s[40:41], L_mega_kernel_slow_3_1
    s_branch L_mega_kernel_cy_1_23
L_mega_kernel_cy_1_39_out:
    s_call_b64 s[40:41], L_mega_kernel_slow_0_0
    s_branch L_mega_kernel_cy_1_39
L_mega_kernel_cy_1_55_out:
    s_call_b64 s[40:41], L_mega_kernel_slow_1_0
    s_branch L_mega_kernel_cy_1_55
L_mega_kernel_cy_2_7_out:
    s_call_b64 s[40:41], L_mega_kernel_slow_2_0
    s_branch L_mega_kernel_cy_2_7
L_mega_kernel_cy_2_23_out:
    s_call_b64 s[40:41], L_mega_kernel_slow_3_0
    s_branch L_mega_kernel_cy_2_23
L_mega_kernel_cy_2_39_out:
    s_call_b64 s[40:41], L_mega_kernel_slow_0_1
    s_branch L_mega_kernel_cy_2_39
L_mega_kernel_cy_2_55_out:
    s_call_b64 s[40:41], L_mega_kernel_slow_1_1
    s_branch L_mega_kernel_cy_2_55
L_mega_kernel_cy_3_7_out:
    s_call_b64 s[40:41], L_mega_kernel_slow_2_1
    s_branch L_mega_kernel_cy_3_7
L_mega_kernel_cy_3_23_out:
    s_call_b64 s[40:41], L_mega_kernel_slow_3_1
    s_branch L_mega_kernel_cy_3_23
L_mega_kernel_slow_0_0:
    s_nop 7
    s_nop 3
    v_max3_f32 v180, v84, v85, v86
    v_max3_f32 v180, v180, v87, v88
    v_max3_f32 v180, v180, v89, v90
    v_max_f32 v180, v180, v91
    v_mov_b32 v181, v180
    s_nop 1
    v_permlane16_swap_b32 v180, v181
    v_max_f32 v180, v180, v181
    v_mov_b32 v181, v180
    s_nop 1
    v_permlane32_swap_b32 v180, v181
    v_max_f32 v180, v180, v181
    v_ceil_f32 v182, v180
    v_add_f32 v182, 0x41c00000, v182
    v_max_f32 v182, 0, v182
    v_cvt_i32_f32 v181, v182
    v_sub_u32 v181, 0, v181
    v_ldexp_f32 v183, 1.0, v181
    v_sub_f32 v84, v84, v182
    v_sub_f32 v85, v85, v182
    v_sub_f32 v86, v86, v182
    v_sub_f32 v87, v87, v182
    v_sub_f32 v88, v88, v182
    v_sub_f32 v89, v89, v182
    v_sub_f32 v90, v90, v182
    v_sub_f32 v91, v91, v182
    v_sub_f32 v156, v156, v182
    v_sub_f32 v157, v157, v182
    v_sub_f32 v158, v158, v182
    v_sub_f32 v159, v159, v182
    v_mul_f32 v176, v176, v183
    v_accvgpr_read_b32 v180, a0
    v_mul_f32 v180, v180, v183
    v_accvgpr_write_b32 a0, v180
    v_accvgpr_read_b32 v180, a1
    v_mul_f32 v180, v180, v183
    v_accvgpr_write_b32 a1, v180
    v_accvgpr_read_b32 v180, a2
    v_mul_f32 v180, v180, v183
    v_accvgpr_write_b32 a2, v180
    v_accvgpr_read_b32 v180, a3
    v_mul_f32 v180, v180, v183
    v_accvgpr_write_b32 a3, v180
    v_accvgpr_read_b32 v180, a4
    v_mul_f32 v180, v180, v183
    v_accvgpr_write_b32 a4, v180
    v_accvgpr_read_b32 v180, a5
    v_mul_f32 v180, v180, v183
    v_accvgpr_write_b32 a5, v180
    v_accvgpr_read_b32 v180, a6
    v_mul_f32 v180, v180, v183
    v_accvgpr_write_b32 a6, v180
    v_accvgpr_read_b32 v180, a7
    v_mul_f32 v180, v180, v183
    v_accvgpr_write_b32 a7, v180
    v_accvgpr_read_b32 v180, a8
    v_mul_f32 v180, v180, v183
    v_accvgpr_write_b32 a8, v180
    v_accvgpr_read_b32 v180, a9
    v_mul_f32 v180, v180, v183
    v_accvgpr_write_b32 a9, v180
    v_accvgpr_read_b32 v180, a10
    v_mul_f32 v180, v180, v183
    v_accvgpr_write_b32 a10, v180
    v_accvgpr_read_b32 v180, a11
    v_mul_f32 v180, v180, v183
    v_accvgpr_write_b32 a11, v180
    v_accvgpr_read_b32 v180, a12
    v_mul_f32 v180, v180, v183
    v_accvgpr_write_b32 a12, v180
    v_accvgpr_read_b32 v180, a13
    v_mul_f32 v180, v180, v183
    v_accvgpr_write_b32 a13, v180
    v_accvgpr_read_b32 v180, a14
    v_mul_f32 v180, v180, v183
    v_accvgpr_write_b32 a14, v180
    v_accvgpr_read_b32 v180, a15
    v_mul_f32 v180, v180, v183
    v_accvgpr_write_b32 a15, v180
    v_accvgpr_read_b32 v180, a16
    v_mul_f32 v180, v180, v183
    v_accvgpr_write_b32 a16, v180
    v_accvgpr_read_b32 v180, a17
    v_mul_f32 v180, v180, v183
    v_accvgpr_write_b32 a17, v180
    v_accvgpr_read_b32 v180, a18
    v_mul_f32 v180, v180, v183
    v_accvgpr_write_b32 a18, v180
    v_accvgpr_read_b32 v180, a19
    v_mul_f32 v180, v180, v183
    v_accvgpr_write_b32 a19, v180
    v_accvgpr_read_b32 v180, a20
    v_mul_f32 v180, v180, v183
    v_accvgpr_write_b32 a20, v180
    v_accvgpr_read_b32 v180, a21
    v_mul_f32 v180, v180, v183
    v_accvgpr_write_b32 a21, v180
    v_accvgpr_read_b32 v180, a22
    v_mul_f32 v180, v180, v183
    v_accvgpr_write_b32 a22, v180
    v_accvgpr_read_b32 v180, a23
    v_mul_f32 v180, v180, v183
    v_accvgpr_write_b32 a23, v180
    v_accvgpr_read_b32 v180, a24
    v_mul_f32 v180, v180, v183
    v_accvgpr_write_b32 a24, v180
    v_accvgpr_read_b32 v180, a25
    v_mul_f32 v180, v180, v183
    v_accvgpr_write_b32 a25, v180
    v_accvgpr_read_b32 v180, a26
    v_mul_f32 v180, v180, v183
    v_accvgpr_write_b32 a26, v180
    v_accvgpr_read_b32 v180, a27
    v_mul_f32 v180, v180, v183
    v_accvgpr_write_b32 a27, v180
    v_accvgpr_read_b32 v180, a28
    v_mul_f32 v180, v180, v183
    v_accvgpr_write_b32 a28, v180
    v_accvgpr_read_b32 v180, a29
    v_mul_f32 v180, v180, v183
    v_accvgpr_write_b32 a29, v180
    v_accvgpr_read_b32 v180, a30
    v_mul_f32 v180, v180, v183
    v_accvgpr_write_b32 a30, v180
    v_accvgpr_read_b32 v180, a31
    v_mul_f32 v180, v180, v183
    v_accvgpr_write_b32 a31, v180
    v_exp_f32 v184, v84
    v_exp_f32 v185, v85
    v_exp_f32 v186, v86
    v_exp_f32 v187, v87
    v_exp_f32 v188, v88
    v_exp_f32 v189, v89
    v_exp_f32 v154, v90
    v_exp_f32 v155, v91
    v_add_f32 v172, v184, v185
    v_add_f32 v172, v172, v186
    v_add_f32 v172, v172, v187
    v_add_f32 v172, v172, v188
    v_add_f32 v172, v172, v189
    v_add_f32 v172, v172, v154
    v_add_f32 v172, v172, v155
    v_cvt_pk_bf16_f32 v116, v184, v185
    v_cvt_pk_bf16_f32 v117, v186, v187
    v_cvt_pk_bf16_f32 v118, v188, v189
    s_nop 1
    s_setpc_b64 s[40:41]
L_mega_kernel_slow_0_1:
    s_nop 7
    s_nop 3
    v_max3_f32 v180, v84, v85, v86
    v_max3_f32 v180, v180, v87, v88
    v_max3_f32 v180, v180, v89, v90
    v_max_f32 v180, v180, v91
    v_mov_b32 v181, v180
    s_nop 1
    v_permlane16_swap_b32 v180, v181
    v_max_f32 v180, v180, v181
    v_mov_b32 v181, v180
    s_nop 1
    v_permlane32_swap_b32 v180, v181
    v_max_f32 v180, v180, v181
    v_ceil_f32 v182, v180
    v_add_f32 v182, 0x41c00000, v182
    v_max_f32 v182, 0, v182
    v_cvt_i32_f32 v181, v182
    v_sub_u32 v181, 0, v181
    v_ldexp_f32 v183, 1.0, v181
    v_sub_f32 v84, v84, v182
    v_sub_f32 v85, v85, v182
    v_sub_f32 v86, v86, v182
    v_sub_f32 v87, v87, v182
    v_sub_f32 v88, v88, v182
    v_sub_f32 v89, v89, v182
    v_sub_f32 v90, v90, v182
    v_sub_f32 v91, v91, v182
    v_sub_f32 v156, v156, v182
    v_sub_f32 v157, v157, v182
    v_sub_f32 v158, v158, v182
    v_sub_f32 v159, v159, v182
    v_mul_f32 v176, v176, v183
    v_accvgpr_read_b32 v180, a0
    v_mul_f32 v180, v180, v183
    v_accvgpr_write_b32 a0, v180
    v_accvgpr_read_b32 v180, a1
    v_mul_f32 v180, v180, v183
    v_accvgpr_write_b32 a1, v180
    v_accvgpr_read_b32 v180, a2
    v_mul_f32 v180, v180, v183
    v_accvgpr_write_b32 a2, v180
    v_accvgpr_read_b32 v180, a3
    v_mul_f32 v180, v180, v183
    v_accvgpr_write_b32 a3, v180
    v_accvgpr_read_b32 v180, a4
    v_mul_f32 v180, v180, v183
    v_accvgpr_write_b32 a4, v180
    v_accvgpr_read_b32 v180, a5
    v_mul_f32 v180, v180, v183
    v_accvgpr_write_b32 a5, v180
    v_accvgpr_read_b32 v180, a6
    v_mul_f32 v180, v180, v183
    v_accvgpr_write_b32 a6, v180
    v_accvgpr_read_b32 v180, a7
    v_mul_f32 v180, v180, v183
    v_accvgpr_write_b32 a7, v180
    v_accvgpr_read_b32 v180, a8
    v_mul_f32 v180, v180, v183
    v_accvgpr_write_b32 a8, v180
    v_accvgpr_read_b32 v180, a9
    v_mul_f32 v180, v180, v183
    v_accvgpr_write_b32 a9, v180
    v_accvgpr_read_b32 v180, a10
    v_mul_f32 v180, v180, v183
    v_accvgpr_write_b32 a10, v180
    v_accvgpr_read_b32 v180, a11
    v_mul_f32 v180, v180, v183
    v_accvgpr_write_b32 a11, v180
    v_accvgpr_read_b32 v180, a12
    v_mul_f32 v180, v180, v183
    v_accvgpr_write_b32 a12, v180
    v_accvgpr_read_b32 v180, a13
    v_mul_f32 v180, v180, v183
    v_accvgpr_write_b32 a13, v180
    v_accvgpr_read_b32 v180, a14
    v_mul_f32 v180, v180, v183
    v_accvgpr_write_b32 a14, v180
    v_accvgpr_read_b32 v180, a15
    v_mul_f32 v180, v180, v183
    v_accvgpr_write_b32 a15, v180
    v_accvgpr_read_b32 v180, a16
    v_mul_f32 v180, v180, v183
    v_accvgpr_write_b32 a16, v180
    v_accvgpr_read_b32 v180, a17
    v_mul_f32 v180, v180, v183
    v_accvgpr_write_b32 a17, v180
    v_accvgpr_read_b32 v180, a18
    v_mul_f32 v180, v180, v183
    v_accvgpr_write_b32 a18, v180
    v_accvgpr_read_b32 v180, a19
    v_mul_f32 v180, v180, v183
    v_accvgpr_write_b32 a19, v180
    v_accvgpr_read_b32 v180, a20
    v_mul_f32 v180, v180, v183
    v_accvgpr_write_b32 a20, v180
    v_accvgpr_read_b32 v180, a21
    v_mul_f32 v180, v180, v183
    v_accvgpr_write_b32 a21, v180
    v_accvgpr_read_b32 v180, a22
    v_mul_f32 v180, v180, v183
    v_accvgpr_write_b32 a22, v180
    v_accvgpr_read_b32 v180, a23
    v_mul_f32 v180, v180, v183
    v_accvgpr_write_b32 a23, v180
    v_accvgpr_read_b32 v180, a24
    v_mul_f32 v180, v180, v183
    v_accvgpr_write_b32 a24, v180
    v_accvgpr_read_b32 v180, a25
    v_mul_f32 v180, v180, v183
    v_accvgpr_write_b32 a25, v180
    v_accvgpr_read_b32 v180, a26
    v_mul_f32 v180, v180, v183
    v_accvgpr_write_b32 a26, v180
    v_accvgpr_read_b32 v180, a27
    v_mul_f32 v180, v180, v183
    v_accvgpr_write_b32 a27, v180
    v_accvgpr_read_b32 v180, a28
    v_mul_f32 v180, v180, v183
    v_accvgpr_write_b32 a28, v180
    v_accvgpr_read_b32 v180, a29
    v_mul_f32 v180, v180, v183
    v_accvgpr_write_b32 a29, v180
    v_accvgpr_read_b32 v180, a30
    v_mul_f32 v180, v180, v183
    v_accvgpr_write_b32 a30, v180
    v_accvgpr_read_b32 v180, a31
    v_mul_f32 v180, v180, v183
    v_accvgpr_write_b32 a31, v180
    v_exp_f32 v184, v84
    v_exp_f32 v185, v85
    v_exp_f32 v186, v86
    v_exp_f32 v187, v87
    v_exp_f32 v188, v88
    v_exp_f32 v189, v89
    v_exp_f32 v154, v90
    v_exp_f32 v155, v91
    v_add_f32 v172, v184, v185
    v_add_f32 v172, v172, v186
    v_add_f32 v172, v172, v187
    v_add_f32 v172, v172, v188
    v_add_f32 v172, v172, v189
    v_add_f32 v172, v172, v154
    v_add_f32 v172, v172, v155
    v_cvt_pk_bf16_f32 v132, v184, v185
    v_cvt_pk_bf16_f32 v133, v186, v187
    v_cvt_pk_bf16_f32 v134, v188, v189
    s_nop 1
    s_setpc_b64 s[40:41]
L_mega_kernel_slow_1_0:
    s_nop 7
    s_nop 3
    v_max3_f32 v180, v92, v93, v94
    v_max3_f32 v180, v180, v95, v96
    v_max3_f32 v180, v180, v97, v98
    v_max_f32 v180, v180, v99
    v_mov_b32 v181, v180
    s_nop 1
    v_permlane16_swap_b32 v180, v181
    v_max_f32 v180, v180, v181
    v_mov_b32 v181, v180
    s_nop 1
    v_permlane32_swap_b32 v180, v181
    v_max_f32 v180, v180, v181
    v_ceil_f32 v182, v180
    v_add_f32 v182, 0x41c00000, v182
    v_max_f32 v182, 0, v182
    v_cvt_i32_f32 v181, v182
    v_sub_u32 v181, 0, v181
    v_ldexp_f32 v183, 1.0, v181
    v_sub_f32 v92, v92, v182
    v_sub_f32 v93, v93, v182
    v_sub_f32 v94, v94, v182
    v_sub_f32 v95, v95, v182
    v_sub_f32 v96, v96, v182
    v_sub_f32 v97, v97, v182
    v_sub_f32 v98, v98, v182
    v_sub_f32 v99, v99, v182
    v_sub_f32 v160, v160, v182
    v_sub_f32 v161, v161, v182
    v_sub_f32 v162, v162, v182
    v_sub_f32 v163, v163, v182
    v_mul_f32 v177, v177, v183
    v_accvgpr_read_b32 v180, a32
    v_mul_f32 v180, v180, v183
    v_accvgpr_write_b32 a32, v180
    v_accvgpr_read_b32 v180, a33
    v_mul_f32 v180, v180, v183
    v_accvgpr_write_b32 a33, v180
    v_accvgpr_read_b32 v180, a34
    v_mul_f32 v180, v180, v183
    v_accvgpr_write_b32 a34, v180
    v_accvgpr_read_b32 v180, a35
    v_mul_f32 v180, v180, v183
    v_accvgpr_write_b32 a35, v180
    v_accvgpr_read_b32 v180, a36
    v_mul_f32 v180, v180, v183
    v_accvgpr_write_b32 a36, v180
    v_accvgpr_read_b32 v180, a37
    v_mul_f32 v180, v180, v183
    v_accvgpr_write_b32 a37, v180
    v_accvgpr_read_b32 v180, a38
    v_mul_f32 v180, v180, v183
    v_accvgpr_write_b32 a38, v180
    v_accvgpr_read_b32 v180, a39
    v_mul_f32 v180, v180, v183
    v_accvgpr_write_b32 a39, v180
    v_accvgpr_read_b32 v180, a40
    v_mul_f32 v180, v180, v183
    v_accvgpr_write_b32 a40, v180
    v_accvgpr_read_b32 v180, a41
    v_mul_f32 v180, v180, v183
    v_accvgpr_write_b32 a41, v180
    v_accvgpr_read_b32 v180, a42
    v_mul_f32 v180, v180, v183
    v_accvgpr_write_b32 a42, v180
    v_accvgpr_read_b32 v180, a43
    v_mul_f32 v180, v180, v183
    v_accvgpr_write_b32 a43, v180
    v_accvgpr_read_b32 v180, a44
    v_mul_f32 v180, v180, v183
    v_accvgpr_write_b32 a44, v180
    v_accvgpr_read_b32 v180, a45
    v_mul_f32 v180, v180, v183
    v_accvgpr_write_b32 a45, v180
    v_accvgpr_read_b32 v180, a46
    v_mul_f32 v180, v180, v183
    v_accvgpr_write_b32 a46, v180
    v_accvgpr_read_b32 v180, a47
    v_mul_f32 v180, v180, v183
    v_accvgpr_write_b32 a47, v180
    v_accvgpr_read_b32 v180, a48
    v_mul_f32 v180, v180, v183
    v_accvgpr_write_b32 a48, v180
    v_accvgpr_read_b32 v180, a49
    v_mul_f32 v180, v180, v183
    v_accvgpr_write_b32 a49, v180
    v_accvgpr_read_b32 v180, a50
    v_mul_f32 v180, v180, v183
    v_accvgpr_write_b32 a50, v180
    v_accvgpr_read_b32 v180, a51
    v_mul_f32 v180, v180, v183
    v_accvgpr_write_b32 a51, v180
    v_accvgpr_read_b32 v180, a52
    v_mul_f32 v180, v180, v183
    v_accvgpr_write_b32 a52, v180
    v_accvgpr_read_b32 v180, a53
    v_mul_f32 v180, v180, v183
    v_accvgpr_write_b32 a53, v180
    v_accvgpr_read_b32 v180, a54
    v_mul_f32 v180, v180, v183
    v_accvgpr_write_b32 a54, v180
    v_accvgpr_read_b32 v180, a55
    v_mul_f32 v180, v180, v183
    v_accvgpr_write_b32 a55, v180
    v_accvgpr_read_b32 v180, a56
    v_mul_f32 v180, v180, v183
    v_accvgpr_write_b32 a56, v180
    v_accvgpr_read_b32 v180, a57
    v_mul_f32 v180, v180, v183
    v_accvgpr_write_b32 a57, v180
    v_accvgpr_read_b32 v180, a58
    v_mul_f32 v180, v180, v183
    v_accvgpr_write_b32 a58, v180
    v_accvgpr_read_b32 v180, a59
    v_mul_f32 v180, v180, v183
    v_accvgpr_write_b32 a59, v180
    v_accvgpr_read_b32 v180, a60
    v_mul_f32 v180, v180, v183
    v_accvgpr_write_b32 a60, v180
    v_accvgpr_read_b32 v180, a61
    v_mul_f32 v180, v180, v183
    v_accvgpr_write_b32 a61, v180
    v_accvgpr_read_b32 v180, a62
    v_mul_f32 v180, v180, v183
    v_accvgpr_write_b32 a62, v180
    v_accvgpr_read_b32 v180, a63
    v_mul_f32 v180, v180, v183
    v_accvgpr_write_b32 a63, v180
    v_exp_f32 v184, v92
    v_exp_f32 v185, v93
    v_exp_f32 v186, v94
    v_exp_f32 v187, v95
    v_exp_f32 v188, v96
    v_exp_f32 v189, v97
    v_exp_f32 v154, v98
    v_exp_f32 v155, v99
    v_add_f32 v173, v184, v185
    v_add_f32 v173, v173, v186
    v_add_f32 v173, v173, v187
    v_add_f32 v173, v173, v188
    v_add_f32 v173, v173, v189
    v_add_f32 v173, v173, v154
    v_add_f32 v173, v173, v155
    v_cvt_pk_bf16_f32 v120, v184, v185
    v_cvt_pk_bf16_f32 v121, v186, v187
    v_cvt_pk_bf16_f32 v122, v188, v189
    s_nop 1
    s_setpc_b64 s[40:41]
L_mega_kernel_slow_1_1:
    s_nop 7
    s_nop 3
    v_max3_f32 v180, v92, v93, v94
    v_max3_f32 v180, v180, v95, v96
    v_max3_f32 v180, v180, v97, v98
    v_max_f32 v180, v180, v99
    v_mov_b32 v181, v180
    s_nop 1
    v_permlane16_swap_b32 v180, v181
    v_max_f32 v180, v180, v181
    v_mov_b32 v181, v180
    s_nop 1
    v_permlane32_swap_b32 v180, v181
    v_max_f32 v180, v180, v181
    v_ceil_f32 v182, v180
    v_add_f32 v182, 0x41c00000, v182
    v_max_f32 v182, 0, v182
    v_cvt_i32_f32 v181, v182
    v_sub_u32 v181, 0, v181
    v_ldexp_f32 v183, 1.0, v181
    v_sub_f32 v92, v92, v182
    v_sub_f32 v93, v93, v182
    v_sub_f32 v94, v94, v182
    v_sub_f32 v95, v95, v182
    v_sub_f32 v96, v96, v182
    v_sub_f32 v97, v97, v182
    v_sub_f32 v98, v98, v182
    v_sub_f32 v99, v99, v182
    v_sub_f32 v160, v160, v182
    v_sub_f32 v161, v161, v182
    v_sub_f32 v162, v162, v182
    v_sub_f32 v163, v163, v182
    v_mul_f32 v177, v177, v183
    v_accvgpr_read_b32 v180, a32
    v_mul_f32 v180, v180, v183
    v_accvgpr_write_b32 a32, v180
    v_accvgpr_read_b32 v180, a33
    v_mul_f32 v180, v180, v183
    v_accvgpr_write_b32 a33, v180
    v_accvgpr_read_b32 v180, a34
    v_mul_f32 v180, v180, v183
    v_accvgpr_write_b32 a34, v180
    v_accvgpr_read_b32 v180, a35
    v_mul_f32 v180, v180, v183
    v_accvgpr_write_b32 a35, v180
    v_accvgpr_read_b32 v180, a36
    v_mul_f32 v180, v180, v183
    v_accvgpr_write_b32 a36, v180
    v_accvgpr_read_b32 v180, a37
    v_mul_f32 v180, v180, v183
    v_accvgpr_write_b32 a37, v180
    v_accvgpr_read_b32 v180, a38
    v_mul_f32 v180, v180, v183
    v_accvgpr_write_b32 a38, v180
    v_accvgpr_read_b32 v180, a39
    v_mul_f32 v180, v180, v183
    v_accvgpr_write_b32 a39, v180
    v_accvgpr_read_b32 v180, a40
    v_mul_f32 v180, v180, v183
    v_accvgpr_write_b32 a40, v180
    v_accvgpr_read_b32 v180, a41
    v_mul_f32 v180, v180, v183
    v_accvgpr_write_b32 a41, v180
    v_accvgpr_read_b32 v180, a42
    v_mul_f32 v180, v180, v183
    v_accvgpr_write_b32 a42, v180
    v_accvgpr_read_b32 v180, a43
    v_mul_f32 v180, v180, v183
    v_accvgpr_write_b32 a43, v180
    v_accvgpr_read_b32 v180, a44
    v_mul_f32 v180, v180, v183
    v_accvgpr_write_b32 a44, v180
    v_accvgpr_read_b32 v180, a45
    v_mul_f32 v180, v180, v183
    v_accvgpr_write_b32 a45, v180
    v_accvgpr_read_b32 v180, a46
    v_mul_f32 v180, v180, v183
    v_accvgpr_write_b32 a46, v180
    v_accvgpr_read_b32 v180, a47
    v_mul_f32 v180, v180, v183
    v_accvgpr_write_b32 a47, v180
    v_accvgpr_read_b32 v180, a48
    v_mul_f32 v180, v180, v183
    v_accvgpr_write_b32 a48, v180
    v_accvgpr_read_b32 v180, a49
    v_mul_f32 v180, v180, v183
    v_accvgpr_write_b32 a49, v180
    v_accvgpr_read_b32 v180, a50
    v_mul_f32 v180, v180, v183
    v_accvgpr_write_b32 a50, v180
    v_accvgpr_read_b32 v180, a51
    v_mul_f32 v180, v180, v183
    v_accvgpr_write_b32 a51, v180
    v_accvgpr_read_b32 v180, a52
    v_mul_f32 v180, v180, v183
    v_accvgpr_write_b32 a52, v180
    v_accvgpr_read_b32 v180, a53
    v_mul_f32 v180, v180, v183
    v_accvgpr_write_b32 a53, v180
    v_accvgpr_read_b32 v180, a54
    v_mul_f32 v180, v180, v183
    v_accvgpr_write_b32 a54, v180
    v_accvgpr_read_b32 v180, a55
    v_mul_f32 v180, v180, v183
    v_accvgpr_write_b32 a55, v180
    v_accvgpr_read_b32 v180, a56
    v_mul_f32 v180, v180, v183
    v_accvgpr_write_b32 a56, v180
    v_accvgpr_read_b32 v180, a57
    v_mul_f32 v180, v180, v183
    v_accvgpr_write_b32 a57, v180
    v_accvgpr_read_b32 v180, a58
    v_mul_f32 v180, v180, v183
    v_accvgpr_write_b32 a58, v180
    v_accvgpr_read_b32 v180, a59
    v_mul_f32 v180, v180, v183
    v_accvgpr_write_b32 a59, v180
    v_accvgpr_read_b32 v180, a60
    v_mul_f32 v180, v180, v183
    v_accvgpr_write_b32 a60, v180
    v_accvgpr_read_b32 v180, a61
    v_mul_f32 v180, v180, v183
    v_accvgpr_write_b32 a61, v180
    v_accvgpr_read_b32 v180, a62
    v_mul_f32 v180, v180, v183
    v_accvgpr_write_b32 a62, v180
    v_accvgpr_read_b32 v180, a63
    v_mul_f32 v180, v180, v183
    v_accvgpr_write_b32 a63, v180
    v_exp_f32 v184, v92
    v_exp_f32 v185, v93
    v_exp_f32 v186, v94
    v_exp_f32 v187, v95
    v_exp_f32 v188, v96
    v_exp_f32 v189, v97
    v_exp_f32 v154, v98
    v_exp_f32 v155, v99
    v_add_f32 v173, v184, v185
    v_add_f32 v173, v173, v186
    v_add_f32 v173, v173, v187
    v_add_f32 v173, v173, v188
    v_add_f32 v173, v173, v189
    v_add_f32 v173, v173, v154
    v_add_f32 v173, v173, v155
    v_cvt_pk_bf16_f32 v136, v184, v185
    v_cvt_pk_bf16_f32 v137, v186, v187
    v_cvt_pk_bf16_f32 v138, v188, v189
    s_nop 1
    s_setpc_b64 s[40:41]
L_mega_kernel_slow_2_0:
    s_nop 7
    s_nop 3
    v_max3_f32 v180, v100, v101, v102
    v_max3_f32 v180, v180, v103, v104
    v_max3_f32 v180, v180, v105, v106
    v_max_f32 v180, v180, v107
    v_mov_b32 v181, v180
    s_nop 1
    v_permlane16_swap_b32 v180, v181
    v_max_f32 v180, v180, v181
    v_mov_b32 v181, v180
    s_nop 1
    v_permlane32_swap_b32 v180, v181
    v_max_f32 v180, v180, v181
    v_ceil_f32 v182, v180
    v_add_f32 v182, 0x41c00000, v182
    v_max_f32 v182, 0, v182
    v_cvt_i32_f32 v181, v182
    v_sub_u32 v181, 0, v181
    v_ldexp_f32 v183, 1.0, v181
    v_sub_f32 v100, v100, v182
    v_sub_f32 v101, v101, v182
    v_sub_f32 v102, v102, v182
    v_sub_f32 v103, v103, v182
    v_sub_f32 v104, v104, v182
    v_sub_f32 v105, v105, v182
    v_sub_f32 v106, v106, v182
    v_sub_f32 v107, v107, v182
    v_sub_f32 v164, v164, v182
    v_sub_f32 v165, v165, v182
    v_sub_f32 v166, v166, v182
    v_sub_f32 v167, v167, v182
    v_mul_f32 v178, v178, v183
    v_accvgpr_read_b32 v180, a64
    v_mul_f32 v180, v180, v183
    v_accvgpr_write_b32 a64, v180
    v_accvgpr_read_b32 v180, a65
    v_mul_f32 v180, v180, v183
    v_accvgpr_write_b32 a65, v180
    v_accvgpr_read_b32 v180, a66
    v_mul_f32 v180, v180, v183
    v_accvgpr_write_b32 a66, v180
    v_accvgpr_read_b32 v180, a67
    v_mul_f32 v180, v180, v183
    v_accvgpr_write_b32 a67, v180
    v_accvgpr_read_b32 v180, a68
    v_mul_f32 v180, v180, v183
    v_accvgpr_write_b32 a68, v180
    v_accvgpr_read_b32 v180, a69
    v_mul_f32 v180, v180, v183
    v_accvgpr_write_b32 a69, v180
    v_accvgpr_read_b32 v180, a70
    v_mul_f32 v180, v180, v183
    v_accvgpr_write_b32 a70, v180
    v_accvgpr_read_b32 v180, a71
    v_mul_f32 v180, v180, v183
    v_accvgpr_write_b32 a71, v180
    v_accvgpr_read_b32 v180, a72
    v_mul_f32 v180, v180, v183
    v_accvgpr_write_b32 a72, v180
    v_accvgpr_read_b32 v180, a73
    v_mul_f32 v180, v180, v183
    v_accvgpr_write_b32 a73, v180
    v_accvgpr_read_b32 v180, a74
    v_mul_f32 v180, v180, v183
    v_accvgpr_write_b32 a74, v180
    v_accvgpr_read_b32 v180, a75
    v_mul_f32 v180, v180, v183
    v_accvgpr_write_b32 a75, v180
    v_accvgpr_read_b32 v180, a76
    v_mul_f32 v180, v180, v183
    v_accvgpr_write_b32 a76, v180
    v_accvgpr_read_b32 v180, a77
    v_mul_f32 v180, v180, v183
    v_accvgpr_write_b32 a77, v180
    v_accvgpr_read_b32 v180, a78
    v_mul_f32 v180, v180, v183
    v_accvgpr_write_b32 a78, v180
    v_accvgpr_read_b32 v180, a79
    v_mul_f32 v180, v180, v183
    v_accvgpr_write_b32 a79, v180
    v_accvgpr_read_b32 v180, a80
    v_mul_f32 v180, v180, v183
    v_accvgpr_write_b32 a80, v180
    v_accvgpr_read_b32 v180, a81
    v_mul_f32 v180, v180, v183
    v_accvgpr_write_b32 a81, v180
    v_accvgpr_read_b32 v180, a82
    v_mul_f32 v180, v180, v183
    v_accvgpr_write_b32 a82, v180
    v_accvgpr_read_b32 v180, a83
    v_mul_f32 v180, v180, v183
    v_accvgpr_write_b32 a83, v180
    v_accvgpr_read_b32 v180, a84
    v_mul_f32 v180, v180, v183
    v_accvgpr_write_b32 a84, v180
    v_accvgpr_read_b32 v180, a85
    v_mul_f32 v180, v180, v183
    v_accvgpr_write_b32 a85, v180
    v_accvgpr_read_b32 v180, a86
    v_mul_f32 v180, v180, v183
    v_accvgpr_write_b32 a86, v180
    v_accvgpr_read_b32 v180, a87
    v_mul_f32 v180, v180, v183
    v_accvgpr_write_b32 a87, v180
    v_accvgpr_read_b32 v180, a88
    v_mul_f32 v180, v180, v183
    v_accvgpr_write_b32 a88, v180
    v_accvgpr_read_b32 v180, a89
    v_mul_f32 v180, v180, v183
    v_accvgpr_write_b32 a89, v180
    v_accvgpr_read_b32 v180, a90
    v_mul_f32 v180, v180, v183
    v_accvgpr_write_b32 a90, v180
    v_accvgpr_read_b32 v180, a91
    v_mul_f32 v180, v180, v183
    v_accvgpr_write_b32 a91, v180
    v_accvgpr_read_b32 v180, a92
    v_mul_f32 v180, v180, v183
    v_accvgpr_write_b32 a92, v180
    v_accvgpr_read_b32 v180, a93
    v_mul_f32 v180, v180, v183
    v_accvgpr_write_b32 a93, v180
    v_accvgpr_read_b32 v180, a94
    v_mul_f32 v180, v180, v183
    v_accvgpr_write_b32 a94, v180
    v_accvgpr_read_b32 v180, a95
    v_mul_f32 v180, v180, v183
    v_accvgpr_write_b32 a95, v180
    v_exp_f32 v184, v100
    v_exp_f32 v185, v101
    v_exp_f32 v186, v102
    v_exp_f32 v187, v103
    v_exp_f32 v188, v104
    v_exp_f32 v189, v105
    v_exp_f32 v154, v106
    v_exp_f32 v155, v107
    v_add_f32 v174, v184, v185
    v_add_f32 v174, v174, v186
    v_add_f32 v174, v174, v187
    v_add_f32 v174, v174, v188
    v_add_f32 v174, v174, v189
    v_add_f32 v174, v174, v154
    v_add_f32 v174, v174, v155
    v_cvt_pk_bf16_f32 v124, v184, v185
    v_cvt_pk_bf16_f32 v125, v186, v187
    v_cvt_pk_bf16_f32 v126, v188, v189
    s_nop 1
    s_setpc_b64 s[40:41]
L_mega_kernel_slow_2_1:
    s_nop 7
    s_nop 3
    v_max3_f32 v180, v100, v101, v102
    v_max3_f32 v180, v180, v103, v104
    v_max3_f32 v180, v180, v105, v106
    v_max_f32 v180, v180, v107
    v_mov_b32 v181, v180
    s_nop 1
    v_permlane16_swap_b32 v180, v181
    v_max_f32 v180, v180, v181
    v_mov_b32 v181, v180
    s_nop 1
    v_permlane32_swap_b32 v180, v181
    v_max_f32 v180, v180, v181
    v_ceil_f32 v182, v180
    v_add_f32 v182, 0x41c00000, v182
    v_max_f32 v182, 0, v182
    v_cvt_i32_f32 v181, v182
    v_sub_u32 v181, 0, v181
    v_ldexp_f32 v183, 1.0, v181
    v_sub_f32 v100, v100, v182
    v_sub_f32 v101, v101, v182
    v_sub_f32 v102, v102, v182
    v_sub_f32 v103, v103, v182
    v_sub_f32 v104, v104, v182
    v_sub_f32 v105, v105, v182
    v_sub_f32 v106, v106, v182
    v_sub_f32 v107, v107, v182
    v_sub_f32 v164, v164, v182
    v_sub_f32 v165, v165, v182
    v_sub_f32 v166, v166, v182
    v_sub_f32 v167, v167, v182
    v_mul_f32 v178, v178, v183
    v_accvgpr_read_b32 v180, a64
    v_mul_f32 v180, v180, v183
    v_accvgpr_write_b32 a64, v180
    v_accvgpr_read_b32 v180, a65
    v_mul_f32 v180, v180, v183
    v_accvgpr_write_b32 a65, v180
    v_accvgpr_read_b32 v180, a66
    v_mul_f32 v180, v180, v183
    v_accvgpr_write_b32 a66, v180
    v_accvgpr_read_b32 v180, a67
    v_mul_f32 v180, v180, v183
    v_accvgpr_write_b32 a67, v180
    v_accvgpr_read_b32 v180, a68
    v_mul_f32 v180, v180, v183
    v_accvgpr_write_b32 a68, v180
    v_accvgpr_read_b32 v180, a69
    v_mul_f32 v180, v180, v183
    v_accvgpr_write_b32 a69, v180
    v_accvgpr_read_b32 v180, a70
    v_mul_f32 v180, v180, v183
    v_accvgpr_write_b32 a70, v180
    v_accvgpr_read_b32 v180, a71
    v_mul_f32 v180, v180, v183
    v_accvgpr_write_b32 a71, v180
    v_accvgpr_read_b32 v180, a72
    v_mul_f32 v180, v180, v183
    v_accvgpr_write_b32 a72, v180
    v_accvgpr_read_b32 v180, a73
    v_mul_f32 v180, v180, v183
    v_accvgpr_write_b32 a73, v180
    v_accvgpr_read_b32 v180, a74
    v_mul_f32 v180, v180, v183
    v_accvgpr_write_b32 a74, v180
    v_accvgpr_read_b32 v180, a75
    v_mul_f32 v180, v180, v183
    v_accvgpr_write_b32 a75, v180
    v_accvgpr_read_b32 v180, a76
    v_mul_f32 v180, v180, v183
    v_accvgpr_write_b32 a76, v180
    v_accvgpr_read_b32 v180, a77
    v_mul_f32 v180, v180, v183
    v_accvgpr_write_b32 a77, v180
    v_accvgpr_read_b32 v180, a78
    v_mul_f32 v180, v180, v183
    v_accvgpr_write_b32 a78, v180
    v_accvgpr_read_b32 v180, a79
    v_mul_f32 v180, v180, v183
    v_accvgpr_write_b32 a79, v180
    v_accvgpr_read_b32 v180, a80
    v_mul_f32 v180, v180, v183
    v_accvgpr_write_b32 a80, v180
    v_accvgpr_read_b32 v180, a81
    v_mul_f32 v180, v180, v183
    v_accvgpr_write_b32 a81, v180
    v_accvgpr_read_b32 v180, a82
    v_mul_f32 v180, v180, v183
    v_accvgpr_write_b32 a82, v180
    v_accvgpr_read_b32 v180, a83
    v_mul_f32 v180, v180, v183
    v_accvgpr_write_b32 a83, v180
    v_accvgpr_read_b32 v180, a84
    v_mul_f32 v180, v180, v183
    v_accvgpr_write_b32 a84, v180
    v_accvgpr_read_b32 v180, a85
    v_mul_f32 v180, v180, v183
    v_accvgpr_write_b32 a85, v180
    v_accvgpr_read_b32 v180, a86
    v_mul_f32 v180, v180, v183
    v_accvgpr_write_b32 a86, v180
    v_accvgpr_read_b32 v180, a87
    v_mul_f32 v180, v180, v183
    v_accvgpr_write_b32 a87, v180
    v_accvgpr_read_b32 v180, a88
    v_mul_f32 v180, v180, v183
    v_accvgpr_write_b32 a88, v180
    v_accvgpr_read_b32 v180, a89
    v_mul_f32 v180, v180, v183
    v_accvgpr_write_b32 a89, v180
    v_accvgpr_read_b32 v180, a90
    v_mul_f32 v180, v180, v183
    v_accvgpr_write_b32 a90, v180
    v_accvgpr_read_b32 v180, a91
    v_mul_f32 v180, v180, v183
    v_accvgpr_write_b32 a91, v180
    v_accvgpr_read_b32 v180, a92
    v_mul_f32 v180, v180, v183
    v_accvgpr_write_b32 a92, v180
    v_accvgpr_read_b32 v180, a93
    v_mul_f32 v180, v180, v183
    v_accvgpr_write_b32 a93, v180
    v_accvgpr_read_b32 v180, a94
    v_mul_f32 v180, v180, v183
    v_accvgpr_write_b32 a94, v180
    v_accvgpr_read_b32 v180, a95
    v_mul_f32 v180, v180, v183
    v_accvgpr_write_b32 a95, v180
    v_exp_f32 v184, v100
    v_exp_f32 v185, v101
    v_exp_f32 v186, v102
    v_exp_f32 v187, v103
    v_exp_f32 v188, v104
    v_exp_f32 v189, v105
    v_exp_f32 v154, v106
    v_exp_f32 v155, v107
    v_add_f32 v174, v184, v185
    v_add_f32 v174, v174, v186
    v_add_f32 v174, v174, v187
    v_add_f32 v174, v174, v188
    v_add_f32 v174, v174, v189
    v_add_f32 v174, v174, v154
    v_add_f32 v174, v174, v155
    v_cvt_pk_bf16_f32 v140, v184, v185
    v_cvt_pk_bf16_f32 v141, v186, v187
    v_cvt_pk_bf16_f32 v142, v188, v189
    s_nop 1
    s_setpc_b64 s[40:41]
L_mega_kernel_slow_3_0:
    s_nop 7
    s_nop 3
    v_max3_f32 v180, v108, v109, v110
    v_max3_f32 v180, v180, v111, v112
    v_max3_f32 v180, v180, v113, v114
    v_max_f32 v180, v180, v115
    v_mov_b32 v181, v180
    s_nop 1
    v_permlane16_swap_b32 v180, v181
    v_max_f32 v180, v180, v181
    v_mov_b32 v181, v180
    s_nop 1
    v_permlane32_swap_b32 v180, v181
    v_max_f32 v180, v180, v181
    v_ceil_f32 v182, v180
    v_add_f32 v182, 0x41c00000, v182
    v_max_f32 v182, 0, v182
    v_cvt_i32_f32 v181, v182
    v_sub_u32 v181, 0, v181
    v_ldexp_f32 v183, 1.0, v181
    v_sub_f32 v108, v108, v182
    v_sub_f32 v109, v109, v182
    v_sub_f32 v110, v110, v182
    v_sub_f32 v111, v111, v182
    v_sub_f32 v112, v112, v182
    v_sub_f32 v113, v113, v182
    v_sub_f32 v114, v114, v182
    v_sub_f32 v115, v115, v182
    v_sub_f32 v168, v168, v182
    v_sub_f32 v169, v169, v182
    v_sub_f32 v170, v170, v182
    v_sub_f32 v171, v171, v182
    v_mul_f32 v179, v179, v183
    v_accvgpr_read_b32 v180, a96
    v_mul_f32 v180, v180, v183
    v_accvgpr_write_b32 a96, v180
    v_accvgpr_read_b32 v180, a97
    v_mul_f32 v180, v180, v183
    v_accvgpr_write_b32 a97, v180
    v_accvgpr_read_b32 v180, a98
    v_mul_f32 v180, v180, v183
    v_accvgpr_write_b32 a98, v180
    v_accvgpr_read_b32 v180, a99
    v_mul_f32 v180, v180, v183
    v_accvgpr_write_b32 a99, v180
    v_accvgpr_read_b32 v180, a100
    v_mul_f32 v180, v180, v183
    v_accvgpr_write_b32 a100, v180
    v_accvgpr_read_b32 v180, a101
    v_mul_f32 v180, v180, v183
    v_accvgpr_write_b32 a101, v180
    v_accvgpr_read_b32 v180, a102
    v_mul_f32 v180, v180, v183
    v_accvgpr_write_b32 a102, v180
    v_accvgpr_read_b32 v180, a103
    v_mul_f32 v180, v180, v183
    v_accvgpr_write_b32 a103, v180
    v_accvgpr_read_b32 v180, a104
    v_mul_f32 v180, v180, v183
    v_accvgpr_write_b32 a104, v180
    v_accvgpr_read_b32 v180, a105
    v_mul_f32 v180, v180, v183
    v_accvgpr_write_b32 a105, v180
    v_accvgpr_read_b32 v180, a106
    v_mul_f32 v180, v180, v183
    v_accvgpr_write_b32 a106, v180
    v_accvgpr_read_b32 v180, a107
    v_mul_f32 v180, v180, v183
    v_accvgpr_write_b32 a107, v180
    v_accvgpr_read_b32 v180, a108
    v_mul_f32 v180, v180, v183
    v_accvgpr_write_b32 a108, v180
    v_accvgpr_read_b32 v180, a109
    v_mul_f32 v180, v180, v183
    v_accvgpr_write_b32 a109, v180
    v_accvgpr_read_b32 v180, a110
    v_mul_f32 v180, v180, v183
    v_accvgpr_write_b32 a110, v180
    v_accvgpr_read_b32 v180, a111
    v_mul_f32 v180, v180, v183
    v_accvgpr_write_b32 a111, v180
    v_accvgpr_read_b32 v180, a112
    v_mul_f32 v180, v180, v183
    v_accvgpr_write_b32 a112, v180
    v_accvgpr_read_b32 v180, a113
    v_mul_f32 v180, v180, v183
    v_accvgpr_write_b32 a113, v180
    v_accvgpr_read_b32 v180, a114
    v_mul_f32 v180, v180, v183
    v_accvgpr_write_b32 a114, v180
    v_accvgpr_read_b32 v180, a115
    v_mul_f32 v180, v180, v183
    v_accvgpr_write_b32 a115, v180
    v_accvgpr_read_b32 v180, a116
    v_mul_f32 v180, v180, v183
    v_accvgpr_write_b32 a116, v180
    v_accvgpr_read_b32 v180, a117
    v_mul_f32 v180, v180, v183
    v_accvgpr_write_b32 a117, v180
    v_accvgpr_read_b32 v180, a118
    v_mul_f32 v180, v180, v183
    v_accvgpr_write_b32 a118, v180
    v_accvgpr_read_b32 v180, a119
    v_mul_f32 v180, v180, v183
    v_accvgpr_write_b32 a119, v180
    v_accvgpr_read_b32 v180, a120
    v_mul_f32 v180, v180, v183
    v_accvgpr_write_b32 a120, v180
    v_accvgpr_read_b32 v180, a121
    v_mul_f32 v180, v180, v183
    v_accvgpr_write_b32 a121, v180
    v_accvgpr_read_b32 v180, a122
    v_mul_f32 v180, v180, v183
    v_accvgpr_write_b32 a122, v180
    v_accvgpr_read_b32 v180, a123
    v_mul_f32 v180, v180, v183
    v_accvgpr_write_b32 a123, v180
    v_accvgpr_read_b32 v180, a124
    v_mul_f32 v180, v180, v183
    v_accvgpr_write_b32 a124, v180
    v_accvgpr_read_b32 v180, a125
    v_mul_f32 v180, v180, v183
    v_accvgpr_write_b32 a125, v180
    v_accvgpr_read_b32 v180, a126
    v_mul_f32 v180, v180, v183
    v_accvgpr_write_b32 a126, v180
    v_accvgpr_read_b32 v180, a127
    v_mul_f32 v180, v180, v183
    v_accvgpr_write_b32 a127, v180
    v_exp_f32 v184, v108
    v_exp_f32 v185, v109
    v_exp_f32 v186, v110
    v_exp_f32 v187, v111
    v_exp_f32 v188, v112
    v_exp_f32 v189, v113
    v_exp_f32 v154, v114
    v_exp_f32 v155, v115
    v_add_f32 v175, v184, v185
    v_add_f32 v175, v175, v186
    v_add_f32 v175, v175, v187
    v_add_f32 v175, v175, v188
    v_add_f32 v175, v175, v189
    v_add_f32 v175, v175, v154
    v_add_f32 v175, v175, v155
    v_cvt_pk_bf16_f32 v128, v184, v185
    v_cvt_pk_bf16_f32 v129, v186, v187
    v_cvt_pk_bf16_f32 v130, v188, v189
    s_nop 1
    s_setpc_b64 s[40:41]
L_mega_kernel_slow_3_1:
    s_nop 7
    s_nop 3
    v_max3_f32 v180, v108, v109, v110
    v_max3_f32 v180, v180, v111, v112
    v_max3_f32 v180, v180, v113, v114
    v_max_f32 v180, v180, v115
    v_mov_b32 v181, v180
    s_nop 1
    v_permlane16_swap_b32 v180, v181
    v_max_f32 v180, v180, v181
    v_mov_b32 v181, v180
    s_nop 1
    v_permlane32_swap_b32 v180, v181
    v_max_f32 v180, v180, v181
    v_ceil_f32 v182, v180
    v_add_f32 v182, 0x41c00000, v182
    v_max_f32 v182, 0, v182
    v_cvt_i32_f32 v181, v182
    v_sub_u32 v181, 0, v181
    v_ldexp_f32 v183, 1.0, v181
    v_sub_f32 v108, v108, v182
    v_sub_f32 v109, v109, v182
    v_sub_f32 v110, v110, v182
    v_sub_f32 v111, v111, v182
    v_sub_f32 v112, v112, v182
    v_sub_f32 v113, v113, v182
    v_sub_f32 v114, v114, v182
    v_sub_f32 v115, v115, v182
    v_sub_f32 v168, v168, v182
    v_sub_f32 v169, v169, v182
    v_sub_f32 v170, v170, v182
    v_sub_f32 v171, v171, v182
    v_mul_f32 v179, v179, v183
    v_accvgpr_read_b32 v180, a96
    v_mul_f32 v180, v180, v183
    v_accvgpr_write_b32 a96, v180
    v_accvgpr_read_b32 v180, a97
    v_mul_f32 v180, v180, v183
    v_accvgpr_write_b32 a97, v180
    v_accvgpr_read_b32 v180, a98
    v_mul_f32 v180, v180, v183
    v_accvgpr_write_b32 a98, v180
    v_accvgpr_read_b32 v180, a99
    v_mul_f32 v180, v180, v183
    v_accvgpr_write_b32 a99, v180
    v_accvgpr_read_b32 v180, a100
    v_mul_f32 v180, v180, v183
    v_accvgpr_write_b32 a100, v180
    v_accvgpr_read_b32 v180, a101
    v_mul_f32 v180, v180, v183
    v_accvgpr_write_b32 a101, v180
    v_accvgpr_read_b32 v180, a102
    v_mul_f32 v180, v180, v183
    v_accvgpr_write_b32 a102, v180
    v_accvgpr_read_b32 v180, a103
    v_mul_f32 v180, v180, v183
    v_accvgpr_write_b32 a103, v180
    v_accvgpr_read_b32 v180, a104
    v_mul_f32 v180, v180, v183
    v_accvgpr_write_b32 a104, v180
    v_accvgpr_read_b32 v180, a105
    v_mul_f32 v180, v180, v183
    v_accvgpr_write_b32 a105, v180
    v_accvgpr_read_b32 v180, a106
    v_mul_f32 v180, v180, v183
    v_accvgpr_write_b32 a106, v180
    v_accvgpr_read_b32 v180, a107
    v_mul_f32 v180, v180, v183
    v_accvgpr_write_b32 a107, v180
    v_accvgpr_read_b32 v180, a108
    v_mul_f32 v180, v180, v183
    v_accvgpr_write_b32 a108, v180
    v_accvgpr_read_b32 v180, a109
    v_mul_f32 v180, v180, v183
    v_accvgpr_write_b32 a109, v180
    v_accvgpr_read_b32 v180, a110
    v_mul_f32 v180, v180, v183
    v_accvgpr_write_b32 a110, v180
    v_accvgpr_read_b32 v180, a111
    v_mul_f32 v180, v180, v183
    v_accvgpr_write_b32 a111, v180
    v_accvgpr_read_b32 v180, a112
    v_mul_f32 v180, v180, v183
    v_accvgpr_write_b32 a112, v180
    v_accvgpr_read_b32 v180, a113
    v_mul_f32 v180, v180, v183
    v_accvgpr_write_b32 a113, v180
    v_accvgpr_read_b32 v180, a114
    v_mul_f32 v180, v180, v183
    v_accvgpr_write_b32 a114, v180
    v_accvgpr_read_b32 v180, a115
    v_mul_f32 v180, v180, v183
    v_accvgpr_write_b32 a115, v180
    v_accvgpr_read_b32 v180, a116
    v_mul_f32 v180, v180, v183
    v_accvgpr_write_b32 a116, v180
    v_accvgpr_read_b32 v180, a117
    v_mul_f32 v180, v180, v183
    v_accvgpr_write_b32 a117, v180
    v_accvgpr_read_b32 v180, a118
    v_mul_f32 v180, v180, v183
    v_accvgpr_write_b32 a118, v180
    v_accvgpr_read_b32 v180, a119
    v_mul_f32 v180, v180, v183
    v_accvgpr_write_b32 a119, v180
    v_accvgpr_read_b32 v180, a120
    v_mul_f32 v180, v180, v183
    v_accvgpr_write_b32 a120, v180
    v_accvgpr_read_b32 v180, a121
    v_mul_f32 v180, v180, v183
    v_accvgpr_write_b32 a121, v180
    v_accvgpr_read_b32 v180, a122
    v_mul_f32 v180, v180, v183
    v_accvgpr_write_b32 a122, v180
    v_accvgpr_read_b32 v180, a123
    v_mul_f32 v180, v180, v183
    v_accvgpr_write_b32 a123, v180
    v_accvgpr_read_b32 v180, a124
    v_mul_f32 v180, v180, v183
    v_accvgpr_write_b32 a124, v180
    v_accvgpr_read_b32 v180, a125
    v_mul_f32 v180, v180, v183
    v_accvgpr_write_b32 a125, v180
    v_accvgpr_read_b32 v180, a126
    v_mul_f32 v180, v180, v183
    v_accvgpr_write_b32 a126, v180
    v_accvgpr_read_b32 v180, a127
    v_mul_f32 v180, v180, v183
    v_accvgpr_write_b32 a127, v180
    v_exp_f32 v184, v108
    v_exp_f32 v185, v109
    v_exp_f32 v186, v110
    v_exp_f32 v187, v111
    v_exp_f32 v188, v112
    v_exp_f32 v189, v113
    v_exp_f32 v154, v114
    v_exp_f32 v155, v115
    v_add_f32 v175, v184, v185
    v_add_f32 v175, v175, v186
    v_add_f32 v175, v175, v187
    v_add_f32 v175, v175, v188
    v_add_f32 v175, v175, v189
    v_add_f32 v175, v175, v154
    v_add_f32 v175, v175, v155
    v_cvt_pk_bf16_f32 v144, v184, v185
    v_cvt_pk_bf16_f32 v145, v186, v187
    v_cvt_pk_bf16_f32 v146, v188, v189
    s_nop 1
    s_setpc_b64 s[40:41]
L_mega_kernel_next:
    s_mov_b64 s[6:7], s[74:75]
    s_mov_b64 s[8:9], s[82:83]
    s_mov_b32 s40, s100
    s_and_b32 s52, s2, 7
    s_lshr_b32 s53, s2, 3
    s_and_b32 s43, s52, 1
    s_lshr_b32 s52, s52, 1
    s_lshl_b32 s52, s52, 2
    s_lshr_b32 s41, s53, 3
    s_add_u32 s41, s41, s52
    s_and_b32 s42, s53, 7
    s_mov_b32 s12, s6
    s_mov_b32 s13, s7
    s_mov_b32 s14, 0x800000
    s_mov_b32 s15, 0x20000
    s_add_u32 s16, s4, 0x1000000
    s_addc_u32 s17, s5, 0
    s_mov_b32 s18, 0x1000000
    s_mov_b32 s19, 0x20000
    s_mov_b32 s20, s8
    s_mov_b32 s21, s9
    s_mov_b32 s22, 0x400000
    s_mov_b32 s23, 0x20000
    s_add_u32 s24, s4, 0x5000000
    s_addc_u32 s25, s5, 0
    s_mov_b32 s26, 0x800000
    s_mov_b32 s27, 0x20000
    s_add_u32 s28, s4, 0x2000
    s_addc_u32 s29, s5, 0
    s_mov_b32 s30, 0x13000
    s_mov_b32 s31, 0x20000
    s_add_u32 s32, s4, 0x4000000
    s_addc_u32 s33, s5, 0
    s_mov_b32 s34, 0x800000
    s_mov_b32 s35, 0x20000
    s_add_u32 s36, s4, 0x5800000
    s_addc_u32 s37, s5, 0
    s_mov_b32 s38, 0xa800
    s_mov_b32 s39, 0x20000
    v_lshlrev_b32 v1, 4, v0
    v_lshrrev_b32 v19, 4, v0
    s_and_b32 s52, s40, 1
    s_lshl_b32 s52, s52, 2
    v_or_b32 v17, s52, v19
    v_bfe_u32 v18, v0, 1, 3
    v_xor_b32 v17, v17, v18
    v_lshlrev_b32 v17, 5, v17
    v_and_b32 v18, 1, v0
    v_lshl_add_u32 v17, v18, 4, v17
    v_lshl_add_u32 v17, v19, 11, v17
    s_lshl_b32 s52, s42, 8
    v_add_u32 v2, s52, v17
    v_add_u32 v16, 32768, v2
    s_mul_i32 s44, s43, 4194304
    s_lshl_b32 s52, s40, 13
    s_add_u32 s44, s44, s52
    s_lshl_b32 s46, s40, 10
    s_add_u32 s47, s46, 0x10000
    s_mov_b32 s51, s46
    s_lshl_b32 s52, s41, 3
    s_lshl_b32 s53, s40, 1
    s_add_u32 s52, s52, s53
    s_mul_i32 s52, s52, 131072
    v_add_u32 v3, s52, v1
    v_add_u32 v4, 131072, v3
    s_mul_i32 s48, s43, 65536
    v_lshrrev_b32 v19, 4, v0
    v_bfe_u32 v17, v0, 2, 2
    v_lshl_add_u32 v19, v19, 2, v17
    v_and_b32 v17, 7, v19
    v_lshlrev_b32 v19, 8, v19
    v_and_b32 v18, 3, v0
    v_lshl_add_u32 v19, v18, 3, v19
    v_xor_b32 v18, 0, v17
    v_lshl_add_u32 v8, v18, 5, v19
    v_xor_b32 v18, 1, v17
    v_lshl_add_u32 v9, v18, 5, v19
    v_xor_b32 v18, 2, v17
    v_lshl_add_u32 v10, v18, 5, v19
    v_xor_b32 v18, 3, v17
    v_lshl_add_u32 v11, v18, 5, v19
    v_xor_b32 v18, 4, v17
    v_lshl_add_u32 v12, v18, 5, v19
    v_xor_b32 v18, 5, v17
    v_lshl_add_u32 v13, v18, 5, v19
    v_xor_b32 v18, 6, v17
    v_lshl_add_u32 v14, v18, 5, v19
    v_xor_b32 v18, 7, v17
    v_lshl_add_u32 v15, v18, 5, v19
    s_lshr_b32 s52, s41, 1
    s_add_u32 s52, s52, 256
    s_lshl_b32 s91, s52, 7
    s_lshl_b32 s52, s43, 6
    s_add_u32 s91, s91, s52
    s_waitcnt vmcnt(0)
    s_barrier
    s_cmp_lg_u32 s100, 0
    s_cbranch_scc1 L_fz_s6
    s_mov_b64 s[88:89], exec
    s_mov_b64 exec, 1
    v_mov_b32 v250, 1
    v_mov_b32 v251, s90
    buffer_store_dword v250, v251, s[92:95], 0 offen sc1
    s_mov_b64 exec, s[88:89]
L_fz_s6:
    s_cmp_lg_u32 s100, 0
    s_cbranch_scc1 L_fz_w7
    s_mov_b64 s[88:89], exec
    s_mov_b64 exec, 0xffff
    v_lshlrev_b32 v252, 2, v0
    v_add_u32 v252, s91, v252
    s_mov_b32 s87, 262144
L_fz_p7:
    buffer_load_dword v253, v252, s[92:95], 0 offen sc1
    s_waitcnt vmcnt(0)
    v_cmp_ne_u32 vcc, 1, v253
    s_cbranch_vccz L_fz_g7
    s_sub_u32 s87, s87, 1
    s_cmp_lg_u32 s87, 0
    s_cbranch_scc1 L_fz_p7
L_fz_g7:
    s_mov_b64 exec, s[88:89]
L_fz_w7:
    s_add_u32 m0, s46, 0
    s_nop 0
    buffer_load_dwordx4 v2, s[12:15], s44 offen lds
    s_add_u32 m0, s46, 4096
    s_nop 0
    buffer_load_dwordx4 v16, s[12:15], s44 offen lds
    s_add_u32 s44, s44, 65536
    s_add_u32 m0, s46, 8192
    s_nop 0
    buffer_load_dwordx4 v2, s[12:15], s44 offen lds
    s_add_u32 m0, s46, 12288
    s_nop 0
    buffer_load_dwordx4 v16, s[12:15], s44 offen lds
    s_add_u32 s44, s44, 65536
    s_add_u32 m0, s46, 16384
    s_nop 0
    buffer_load_dwordx4 v2, s[12:15], s44 offen lds
    s_add_u32 m0, s46, 20480
    s_nop 0
    buffer_load_dwordx4 v16, s[12:15], s44 offen lds
    s_add_u32 s44, s44, 65536
    s_add_u32 m0, s46, 24576
    s_nop 0
    buffer_load_dwordx4 v2, s[12:15], s44 offen lds
    s_add_u32 m0, s46, 28672
    s_nop 0
    buffer_load_dwordx4 v16, s[12:15], s44 offen lds
    s_add_u32 s44, s44, 65536
    s_add_u32 m0, s46, 32768
    s_nop 0
    buffer_load_dwordx4 v2, s[12:15], s44 offen lds
    s_add_u32 m0, s46, 36864
    s_nop 0
    buffer_load_dwordx4 v16, s[12:15], s44 offen lds
    s_add_u32 s44, s44, 65536
    s_add_u32 m0, s46, 40960
    s_nop 0
    buffer_load_dwordx4 v2, s[12:15], s44 offen lds
    s_add_u32 m0, s46, 45056
    s_nop 0
    buffer_load_dwordx4 v16, s[12:15], s44 offen lds
    s_add_u32 s44, s44, 65536
    s_add_u32 m0, s46, 49152
    s_nop 0
    buffer_load_dwordx4 v2, s[12:15], s44 offen lds
    s_add_u32 m0, s46, 53248
    s_nop 0
    buffer_load_dwordx4 v16, s[12:15], s44 offen lds
    s_add_u32 s44, s44, 65536
    s_add_u32 m0, s46, 57344
    s_nop 0
    buffer_load_dwordx4 v2, s[12:15], s44 offen lds
    s_add_u32 m0, s46, 61440
    s_nop 0
    buffer_load_dwordx4 v16, s[12:15], s44 offen lds
    s_add_u32 s44, s44, 65536
    s_add_u32 m0, s46, 65536
    s_nop 0
    buffer_load_dwordx4 v2, s[12:15], s44 offen lds
    s_add_u32 m0, s46, 69632
    s_nop 0
    buffer_load_dwordx4 v16, s[12:15], s44 offen lds
    s_add_u32 s44, s44, 65536
    s_add_u32 m0, s46, 73728
    s_nop 0
    buffer_load_dwordx4 v2, s[12:15], s44 offen lds
    s_add_u32 m0, s46, 77824
    s_nop 0
    buffer_load_dwordx4 v16, s[12:15], s44 offen lds
    s_add_u32 s44, s44, 65536
    s_add_u32 m0, s46, 81920
    s_nop 0
    buffer_load_dwordx4 v2, s[12:15], s44 offen lds
    s_add_u32 m0, s46, 86016
    s_nop 0
    buffer_load_dwordx4 v16, s[12:15], s44 offen lds
    s_add_u32 s44, s44, 65536
    s_add_u32 m0, s46, 90112
    s_nop 0
    buffer_load_dwordx4 v2, s[12:15], s44 offen lds
    s_add_u32 m0, s46, 94208
    s_nop 0
    buffer_load_dwordx4 v16, s[12:15], s44 offen lds
    s_add_u32 s44, s44, 65536
    s_barrier
    buffer_load_dwordx4 a[64:67], v3, s[16:19], s48 offen sc1
    buffer_load_dwordx4 a[68:71], v4, s[16:19], s48 offen sc1
    s_add_u32 s48, s48, 1024
    buffer_load_dwordx4 a[72:75], v3, s[16:19], s48 offen sc1
    buffer_load_dwordx4 a[76:79], v4, s[16:19], s48 offen sc1
    s_add_u32 s48, s48, 1024
    buffer_load_dwordx4 a[80:83], v3, s[16:19], s48 offen sc1
    buffer_load_dwordx4 a[84:87], v4, s[16:19], s48 offen sc1
    s_add_u32 s48, s48, 1024
    buffer_load_dwordx4 a[88:91], v3, s[16:19], s48 offen sc1
    buffer_load_dwordx4 a[92:95], v4, s[16:19], s48 offen sc1
    s_add_u32 s48, s48, 1024
    buffer_load_dwordx4 a[96:99], v3, s[16:19], s48 offen sc1
    buffer_load_dwordx4 a[100:103], v4, s[16:19], s48 offen sc1
    s_add_u32 s48, s48, 1024
    buffer_load_dwordx4 a[104:107], v3, s[16:19], s48 offen sc1
    buffer_load_dwordx4 a[108:111], v4, s[16:19], s48 offen sc1
    s_add_u32 s48, s48, 1024
    v_and_b32 v19, 15, v0
    s_lshl_b32 s52, s41, 7
    s_lshl_b32 s53, s40, 5
    s_add_u32 s52, s52, s53
    v_add_u32 v19, s52, v19
    v_lshlrev_b32 v19, 11, v19
    v_bfe_u32 v17, v0, 4, 1
    v_lshlrev_b32 v17, 4, v17
    v_bfe_u32 v18, v0, 5, 1
    v_lshl_or_b32 v17, v18, 3, v17
    s_lshl_b32 s52, s42, 7
    v_add_u32 v17, s52, v17
    v_lshl_add_u32 v5, v17, 1, v19
    v_lshlrev_b32 v6, 2, v17
    s_waitcnt vmcnt(12)
    s_barrier
    ds_read_b64_tr_b16 a[0:1], v8 offset:0
    ds_read_b64_tr_b16 a[2:3], v8 offset:4096
    ds_read_b64_tr_b16 a[128:129], v8 offset:8192
    ds_read_b64_tr_b16 a[130:131], v8 offset:12288
    ds_read_b64_tr_b16 a[4:5], v9 offset:0
    ds_read_b64_tr_b16 a[6:7], v9 offset:4096
    ds_read_b64_tr_b16 a[132:133], v9 offset:8192
    ds_read_b64_tr_b16 a[134:135], v9 offset:12288
    ds_read_b64_tr_b16 a[8:9], v10 offset:0
    ds_read_b64_tr_b16 a[10:11], v10 offset:4096
    ds_read_b64_tr_b16 a[136:137], v10 offset:8192
    ds_read_b64_tr_b16 a[138:139], v10 offset:12288
    s_waitcnt lgkmcnt(4)
    ds_read_b64_tr_b16 a[12:13], v11 offset:0
    ds_read_b64_tr_b16 a[14:15], v11 offset:4096
    ds_read_b64_tr_b16 a[140:141], v11 offset:8192
    ds_read_b64_tr_b16 a[142:143], v11 offset:12288
    ds_read_b64_tr_b16 a[16:17], v12 offset:0
    ds_read_b64_tr_b16 a[18:19], v12 offset:4096
    ds_read_b64_tr_b16 a[144:145], v12 offset:8192
    ds_read_b64_tr_b16 a[146:147], v12 offset:12288
    s_waitcnt lgkmcnt(4)
    ds_read_b64_tr_b16 a[20:21], v13 offset:0
    ds_read_b64_tr_b16 a[22:23], v13 offset:4096
    ds_read_b64_tr_b16 a[148:149], v13 offset:8192
    ds_read_b64_tr_b16 a[150:151], v13 offset:12288
    ds_read_b64_tr_b16 a[24:25], v14 offset:0
    ds_read_b64_tr_b16 a[26:27], v14 offset:4096
    ds_read_b64_tr_b16 a[152:153], v14 offset:8192
    ds_read_b64_tr_b16 a[154:155], v14 offset:12288
    s_waitcnt vmcnt(8)
    s_waitcnt lgkmcnt(12)
    v_mfma_f32_16x16x32_bf16 v[64:67], a[0:3], a[64:67], 0
    ds_read_b64_tr_b16 a[28:29], v15 offset:0
    s_add_u32 m0, s47, 32768
    v_mfma_f32_16x16x32_bf16 v[64:67], a[128:131], a[72:75], v[64:67]
    ds_read_b64_tr_b16 a[30:31], v15 offset:4096
    buffer_load_dwordx4 v2, s[12:15], s44 offen lds
    v_mfma_f32_16x16x32_bf16 v[68:71], a[0:3], a[68:71], 0
    ds_read_b64_tr_b16 a[156:157], v15 offset:8192
    v_mfma_f32_16x16x32_bf16 v[68:71], a[128:131], a[76:79], v[68:71]
    ds_read_b64_tr_b16 a[158:159], v15 offset:12288
    s_waitcnt lgkmcnt(12)
    v_mfma_f32_16x16x32_bf16 v[72:75], a[4:7], a[64:67], 0
    ds_read_b64_tr_b16 a[0:1], v8 offset:16384
    s_add_u32 m0, s47, 36864
    v_mfma_f32_16x16x32_bf16 v[72:75], a[132:135], a[72:75], v[72:75]
    ds_read_b64_tr_b16 a[2:3], v8 offset:20480
    buffer_load_dwordx4 v16, s[12:15], s44 offen lds
    v_mfma_f32_16x16x32_bf16 v[76:79], a[4:7], a[68:71], 0
    ds_read_b64_tr_b16 a[128:129], v8 offset:24576
    s_add_u32 s44, s44, 65536
    v_mfma_f32_16x16x32_bf16 v[76:79], a[132:135], a[76:79], v[76:79]
    ds_read_b64_tr_b16 a[130:131], v8 offset:28672
    s_waitcnt lgkmcnt(12)
    v_mfma_f32_16x16x32_bf16 v[80:83], a[8:11], a[64:67], 0
    ds_read_b64_tr_b16 a[4:5], v9 offset:16384
    v_mfma_f32_16x16x32_bf16 v[80:83], a[136:139], a[72:75], v[80:83]
    ds_read_b64_tr_b16 a[6:7], v9 offset:20480
    buffer_load_dwordx4 a[112:115], v3, s[16:19], s48 offen sc1
    v_mfma_f32_16x16x32_bf16 v[84:87], a[8:11], a[68:71], 0
    ds_read_b64_tr_b16 a[132:133], v9 offset:24576
    v_mfma_f32_16x16x32_bf16 v[84:87], a[136:139], a[76:79], v[84:87]
    ds_read_b64_tr_b16 a[134:135], v9 offset:28672
    s_waitcnt lgkmcnt(12)
    v_mfma_f32_16x16x32_bf16 v[88:91], a[12:15], a[64:67], 0
    ds_read_b64_tr_b16 a[8:9], v10 offset:16384
    v_mfma_f32_16x16x32_bf16 v[88:91], a[140:143], a[72:75], v[88:91]
    ds_read_b64_tr_b16 a[10:11], v10 offset:20480
    buffer_load_dwordx4 a[116:119], v4, s[16:19], s48 offen sc1
    v_mfma_f32_16x16x32_bf16 v[92:95], a[12:15], a[68:71], 0
    ds_read_b64_tr_b16 a[136:137], v10 offset:24576
    s_add_u32 s48, s48, 1024
    v_mfma_f32_16x16x32_bf16 v[92:95], a[140:143], a[76:79], v[92:95]
    ds_read_b64_tr_b16 a[138:139], v10 offset:28672
    s_waitcnt lgkmcnt(12)
    v_mfma_f32_16x16x32_bf16 v[96:99], a[16:19], a[64:67], 0
    ds_read_b64_tr_b16 a[12:13], v11 offset:16384
    s_add_u32 m0, s47, 40960
    v_mfma_f32_16x16x32_bf16 v[96:99], a[144:147], a[72:75], v[96:99]
    ds_read_b64_tr_b16 a[14:15], v11 offset:20480
    buffer_load_dwordx4 v2, s[12:15], s44 offen lds
    v_mfma_f32_16x16x32_bf16 v[100:103], a[16:19], a[68:71], 0
    ds_read_b64_tr_b16 a[140:141], v11 offset:24576
    v_mfma_f32_16x16x32_bf16 v[100:103], a[144:147], a[76:79], v[100:103]
    ds_read_b64_tr_b16 a[142:143], v11 offset:28672
    s_waitcnt lgkmcnt(12)
    v_mfma_f32_16x16x32_bf16 v[104:107], a[20:23], a[64:67], 0
    ds_read_b64_tr_b16 a[16:17], v12 offset:16384
    s_add_u32 m0, s47, 45056
    v_mfma_f32_16x16x32_bf16 v[104:107], a[148:151], a[72:75], v[104:107]
    ds_read_b64_tr_b16 a[18:19], v12 offset:20480
    buffer_load_dwordx4 v16, s[12:15], s44 offen lds
    v_mfma_f32_16x16x32_bf16 v[108:111], a[20:23], a[68:71], 0
    ds_read_b64_tr_b16 a[144:145], v12 offset:24576
    s_add_u32 s44, s44, 65536
    v_mfma_f32_16x16x32_bf16 v[108:111], a[148:151], a[76:79], v[108:111]
    ds_read_b64_tr_b16 a[146:147], v12 offset:28672
    s_waitcnt lgkmcnt(12)
    v_mfma_f32_16x16x32_bf16 v[112:115], a[24:27], a[64:67], 0
    ds_read_b64_tr_b16 a[20:21], v13 offset:16384
    v_mfma_f32_16x16x32_bf16 v[112:115], a[152:155], a[72:75], v[112:115]
    ds_read_b64_tr_b16 a[22:23], v13 offset:20480
    buffer_load_dwordx4 a[120:123], v3, s[16:19], s48 offen sc1
    v_mfma_f32_16x16x32_bf16 v[116:119], a[24:27], a[68:71], 0
    ds_read_b64_tr_b16 a[148:149], v13 offset:24576
    v_mfma_f32_16x16x32_bf16 v[116:119], a[152:155], a[76:79], v[116:119]
    ds_read_b64_tr_b16 a[150:151], v13 offset:28672
    s_waitcnt lgkmcnt(12)
    v_mfma_f32_16x16x32_bf16 v[120:123], a[28:31], a[64:67], 0
    ds_read_b64_tr_b16 a[24:25], v14 offset:16384
    v_mfma_f32_16x16x32_bf16 v[120:123], a[156:159], a[72:75], v[120:123]
    ds_read_b64_tr_b16 a[26:27], v14 offset:20480
    buffer_load_dwordx4 a[124:127], v4, s[16:19], s48 offen sc1
    v_mfma_f32_16x16x32_bf16 v[124:127], a[28:31], a[68:71], 0
    ds_read_b64_tr_b16 a[152:153], v14 offset:24576
    s_add_u32 s48, s48, 1024
    v_mfma_f32_16x16x32_bf16 v[124:127], a[156:159], a[76:79], v[124:127]
    ds_read_b64_tr_b16 a[154:155], v14 offset:28672
    s_waitcnt vmcnt(12)
    s_barrier
    s_waitcnt lgkmcnt(12)
    v_mfma_f32_16x16x32_bf16 v[64:67], a[0:3], a[80:83], v[64:67]
    ds_read_b64_tr_b16 a[28:29], v15 offset:16384
    s_add_u32 m0, s47, 49152
    v_mfma_f32_16x16x32_bf16 v[64:67], a[128:131], a[88:91], v[64:67]
    ds_read_b64_tr_b16 a[30:31], v15 offset:20480
    buffer_load_dwordx4 v2, s[12:15], s44 offen lds
    v_mfma_f32_16x16x32_bf16 v[68:71], a[0:3], a[84:87], v[68:71]
    ds_read_b64_tr_b16 a[156:157], v15 offset:24576
    v_mfma_f32_16x16x32_bf16 v[68:71], a[128:131], a[92:95], v[68:71]
    ds_read_b64_tr_b16 a[158:159], v15 offset:28672
    s_waitcnt lgkmcnt(12)
    v_mfma_f32_16x16x32_bf16 v[72:75], a[4:7], a[80:83], v[72:75]
    ds_read_b64_tr_b16 a[0:1], v8 offset:32768
    s_add_u32 m0, s47, 53248
    v_mfma_f32_16x16x32_bf16 v[72:75], a[132:135], a[88:91], v[72:75]
    ds_read_b64_tr_b16 a[2:3], v8 offset:36864
    buffer_load_dwordx4 v16, s[12:15], s44 offen lds
    v_mfma_f32_16x16x32_bf16 v[76:79], a[4:7], a[84:87], v[76:79]
    ds_read_b64_tr_b16 a[128:129], v8 offset:40960
    s_add_u32 s44, s44, 65536
    v_mfma_f32_16x16x32_bf16 v[76:79], a[132:135], a[92:95], v[76:79]
    ds_read_b64_tr_b16 a[130:131], v8 offset:45056
    s_waitcnt lgkmcnt(12)
    v_mfma_f32_16x16x32_bf16 v[80:83], a[8:11], a[80:83], v[80:83]
    ds_read_b64_tr_b16 a[4:5], v9 offset:32768
    v_mfma_f32_16x16x32_bf16 v[80:83], a[136:139], a[88:91], v[80:83]
    ds_read_b64_tr_b16 a[6:7], v9 offset:36864
    buffer_load_dwordx4 a[64:67], v3, s[16:19], s48 offen sc1
    v_mfma_f32_16x16x32_bf16 v[84:87], a[8:11], a[84:87], v[84:87]
    ds_read_b64_tr_b16 a[132:133], v9 offset:40960
    v_mfma_f32_16x16x32_bf16 v[84:87], a[136:139], a[92:95], v[84:87]
    ds_read_b64_tr_b16 a[134:135], v9 offset:45056
    s_waitcnt lgkmcnt(12)
    v_mfma_f32_16x16x32_bf16 v[88:91], a[12:15], a[80:83], v[88:91]
    ds_read_b64_tr_b16 a[8:9], v10 offset:32768
    v_mfma_f32_16x16x32_bf16 v[88:91], a[140:143], a[88:91], v[88:91]
    ds_read_b64_tr_b16 a[10:11], v10 offset:36864
    buffer_load_dwordx4 a[68:71], v4, s[16:19], s48 offen sc1
    v_mfma_f32_16x16x32_bf16 v[92:95], a[12:15], a[84:87], v[92:95]
    ds_read_b64_tr_b16 a[136:137], v10 offset:40960
    s_add_u32 s48, s48, 1024
    v_mfma_f32_16x16x32_bf16 v[92:95], a[140:143], a[92:95], v[92:95]
    ds_read_b64_tr_b16 a[138:139], v10 offset:45056
    s_waitcnt lgkmcnt(12)
    v_mfma_f32_16x16x32_bf16 v[96:99], a[16:19], a[80:83], v[96:99]
    ds_read_b64_tr_b16 a[12:13], v11 offset:32768
    s_add_u32 m0, s47, 57344
    v_mfma_f32_16x16x32_bf16 v[96:99], a[144:147], a[88:91], v[96:99]
    ds_read_b64_tr_b16 a[14:15], v11 offset:36864
    buffer_load_dwordx4 v2, s[12:15], s44 offen lds
    v_mfma_f32_16x16x32_bf16 v[100:103], a[16:19], a[84:87], v[100:103]
    ds_read_b64_tr_b16 a[140:141], v11 offset:40960
    v_mfma_f32_16x16x32_bf16 v[100:103], a[144:147], a[92:95], v[100:103]
    ds_read_b64_tr_b16 a[142:143], v11 offset:45056
    s_waitcnt lgkmcnt(12)
    v_mfma_f32_16x16x32_bf16 v[104:107], a[20:23], a[80:83], v[104:107]
    ds_read_b64_tr_b16 a[16:17], v12 offset:32768
    s_add_u32 m0, s47, 61440
    v_mfma_f32_16x16x32_bf16 v[104:107], a[148:151], a[88:91], v[104:107]
    ds_read_b64_tr_b16 a[18:19], v12 offset:36864
    buffer_load_dwordx4 v16, s[12:15], s44 offen lds
    v_mfma_f32_16x16x32_bf16 v[108:111], a[20:23], a[84:87], v[108:111]
    ds_read_b64_tr_b16 a[144:145], v12 offset:40960
    s_add_u32 s44, s44, 65536
    v_mfma_f32_16x16x32_bf16 v[108:111], a[148:151], a[92:95], v[108:111]
    ds_read_b64_tr_b16 a[146:147], v12 offset:45056
    s_waitcnt lgkmcnt(12)
    v_mfma_f32_16x16x32_bf16 v[112:115], a[24:27], a[80:83], v[112:115]
    ds_read_b64_tr_b16 a[20:21], v13 offset:32768
    v_mfma_f32_16x16x32_bf16 v[112:115], a[152:155], a[88:91], v[112:115]
    ds_read_b64_tr_b16 a[22:23], v13 offset:36864
    buffer_load_dwordx4 a[72:75], v3, s[16:19], s48 offen sc1
    v_mfma_f32_16x16x32_bf16 v[116:119], a[24:27], a[84:87], v[116:119]
    ds_read_b64_tr_b16 a[148:149], v13 offset:40960
    v_mfma_f32_16x16x32_bf16 v[116:119], a[152:155], a[92:95], v[116:119]
    ds_read_b64_tr_b16 a[150:151], v13 offset:45056
    s_waitcnt lgkmcnt(12)
    v_mfma_f32_16x16x32_bf16 v[120:123], a[28:31], a[80:83], v[120:123]
    ds_read_b64_tr_b16 a[24:25], v14 offset:32768
    v_mfma_f32_16x16x32_bf16 v[120:123], a[156:159], a[88:91], v[120:123]
    ds_read_b64_tr_b16 a[26:27], v14 offset:36864
    buffer_load_dwordx4 a[76:79], v4, s[16:19], s48 offen sc1
    v_mfma_f32_16x16x32_bf16 v[124:127], a[28:31], a[84:87], v[124:127]
    ds_read_b64_tr_b16 a[152:153], v14 offset:40960
    s_add_u32 s48, s48, 1024
    v_mfma_f32_16x16x32_bf16 v[124:127], a[156:159], a[92:95], v[124:127]
    ds_read_b64_tr_b16 a[154:155], v14 offset:45056
    s_waitcnt vmcnt(16)
    s_waitcnt lgkmcnt(12)
    v_mfma_f32_16x16x32_bf16 v[64:67], a[0:3], a[96:99], v[64:67]
    ds_read_b64_tr_b16 a[28:29], v15 offset:32768
    s_add_u32 m0, s51, 0
    v_mfma_f32_16x16x32_bf16 v[64:67], a[128:131], a[104:107], v[64:67]
    ds_read_b64_tr_b16 a[30:31], v15 offset:36864
    buffer_load_dwordx4 v2, s[12:15], s44 offen lds
    v_mfma_f32_16x16x32_bf16 v[68:71], a[0:3], a[100:103], v[68:71]
    ds_read_b64_tr_b16 a[156:157], v15 offset:40960
    v_mfma_f32_16x16x32_bf16 v[68:71], a[128:131], a[108:111], v[68:71]
    ds_read_b64_tr_b16 a[158:159], v15 offset:45056
    s_waitcnt lgkmcnt(12)
    v_mfma_f32_16x16x32_bf16 v[72:75], a[4:7], a[96:99], v[72:75]
    ds_read_b64_tr_b16 a[0:1], v8 offset:49152
    s_add_u32 m0, s51, 4096
    v_mfma_f32_16x16x32_bf16 v[72:75], a[132:135], a[104:107], v[72:75]
    ds_read_b64_tr_b16 a[2:3], v8 offset:53248
    buffer_load_dwordx4 v16, s[12:15], s44 offen lds
    v_mfma_f32_16x16x32_bf16 v[76:79], a[4:7], a[100:103], v[76:79]
    ds_read_b64_tr_b16 a[128:129], v8 offset:57344
    s_add_u32 s44, s44, 65536
    v_mfma_f32_16x16x32_bf16 v[76:79], a[132:135], a[108:111], v[76:79]
    ds_read_b64_tr_b16 a[130:131], v8 offset:61440
    s_waitcnt lgkmcnt(12)
    v_mfma_f32_16x16x32_bf16 v[80:83], a[8:11], a[96:99], v[80:83]
    ds_read_b64_tr_b16 a[4:5], v9 offset:49152
    v_mfma_f32_16x16x32_bf16 v[80:83], a[136:139], a[104:107], v[80:83]
    ds_read_b64_tr_b16 a[6:7], v9 offset:53248
    buffer_load_dwordx4 a[80:83], v3, s[16:19], s48 offen sc1
    v_mfma_f32_16x16x32_bf16 v[84:87], a[8:11], a[100:103], v[84:87]
    ds_read_b64_tr_b16 a[132:133], v9 offset:57344
    v_mfma_f32_16x16x32_bf16 v[84:87], a[136:139], a[108:111], v[84:87]
    ds_read_b64_tr_b16 a[134:135], v9 offset:61440
    s_waitcnt lgkmcnt(12)
    v_mfma_f32_16x16x32_bf16 v[88:91], a[12:15], a[96:99], v[88:91]
    ds_read_b64_tr_b16 a[8:9], v10 offset:49152
    v_mfma_f32_16x16x32_bf16 v[88:91], a[140:143], a[104:107], v[88:91]
    ds_read_b64_tr_b16 a[10:11], v10 offset:53248
    buffer_load_dwordx4 a[84:87], v4, s[16:19], s48 offen sc1
    v_mfma_f32_16x16x32_bf16 v[92:95], a[12:15], a[100:103], v[92:95]
    ds_read_b64_tr_b16 a[136:137], v10 offset:57344
    s_add_u32 s48, s48, 1024
    v_mfma_f32_16x16x32_bf16 v[92:95], a[140:143], a[108:111], v[92:95]
    ds_read_b64_tr_b16 a[138:139], v10 offset:61440
    s_waitcnt lgkmcnt(12)
    v_mfma_f32_16x16x32_bf16 v[96:99], a[16:19], a[96:99], v[96:99]
    ds_read_b64_tr_b16 a[12:13], v11 offset:49152
    s_add_u32 m0, s51, 8192
    v_mfma_f32_16x16x32_bf16 v[96:99], a[144:147], a[104:107], v[96:99]
    ds_read_b64_tr_b16 a[14:15], v11 offset:53248
    buffer_load_dwordx4 v2, s[12:15], s44 offen lds
    v_mfma_f32_16x16x32_bf16 v[100:103], a[16:19], a[100:103], v[100:103]
    ds_read_b64_tr_b16 a[140:141], v11 offset:57344
    v_mfma_f32_16x16x32_bf16 v[100:103], a[144:147], a[108:111], v[100:103]
    ds_read_b64_tr_b16 a[142:143], v11 offset:61440
    s_waitcnt lgkmcnt(12)
    v_mfma_f32_16x16x32_bf16 v[104:107], a[20:23], a[96:99], v[104:107]
    ds_read_b64_tr_b16 a[16:17], v12 offset:49152
    s_add_u32 m0, s51, 12288
    v_mfma_f32_16x16x32_bf16 v[104:107], a[148:151], a[104:107], v[104:107]
    ds_read_b64_tr_b16 a[18:19], v12 offset:53248
    buffer_load_dwordx4 v16, s[12:15], s44 offen lds
    v_mfma_f32_16x16x32_bf16 v[108:111], a[20:23], a[100:103], v[108:111]
    ds_read_b64_tr_b16 a[144:145], v12 offset:57344
    s_add_u32 s44, s44, 65536
    v_mfma_f32_16x16x32_bf16 v[108:111], a[148:151], a[108:111], v[108:111]
    ds_read_b64_tr_b16 a[146:147], v12 offset:61440
    s_waitcnt lgkmcnt(12)
    v_mfma_f32_16x16x32_bf16 v[112:115], a[24:27], a[96:99], v[112:115]
    ds_read_b64_tr_b16 a[20:21], v13 offset:49152
    v_mfma_f32_16x16x32_bf16 v[112:115], a[152:155], a[104:107], v[112:115]
    ds_read_b64_tr_b16 a[22:23], v13 offset:53248
    buffer_load_dwordx4 a[88:91], v3, s[16:19], s48 offen sc1
    v_mfma_f32_16x16x32_bf16 v[116:119], a[24:27], a[100:103], v[116:119]
    ds_read_b64_tr_b16 a[148:149], v13 offset:57344
    v_mfma_f32_16x16x32_bf16 v[116:119], a[152:155], a[108:111], v[116:119]
    ds_read_b64_tr_b16 a[150:151], v13 offset:61440
    s_waitcnt lgkmcnt(12)
    v_mfma_f32_16x16x32_bf16 v[120:123], a[28:31], a[96:99], v[120:123]
    ds_read_b64_tr_b16 a[24:25], v14 offset:49152
    v_mfma_f32_16x16x32_bf16 v[120:123], a[156:159], a[104:107], v[120:123]
    ds_read_b64_tr_b16 a[26:27], v14 offset:53248
    buffer_load_dwordx4 a[92:95], v4, s[16:19], s48 offen sc1
    v_mfma_f32_16x16x32_bf16 v[124:127], a[28:31], a[100:103], v[124:127]
    ds_read_b64_tr_b16 a[152:153], v14 offset:57344
    s_add_u32 s48, s48, 1024
    v_mfma_f32_16x16x32_bf16 v[124:127], a[156:159], a[108:111], v[124:127]
    ds_read_b64_tr_b16 a[154:155], v14 offset:61440
    s_waitcnt vmcnt(16)
    s_barrier
    s_waitcnt lgkmcnt(12)
    v_mfma_f32_16x16x32_bf16 v[64:67], a[0:3], a[112:115], v[64:67]
    ds_read_b64_tr_b16 a[28:29], v15 offset:49152
    s_add_u32 m0, s51, 16384
    v_mfma_f32_16x16x32_bf16 v[64:67], a[128:131], a[120:123], v[64:67]
    ds_read_b64_tr_b16 a[30:31], v15 offset:53248
    buffer_load_dwordx4 v2, s[12:15], s44 offen lds
    v_mfma_f32_16x16x32_bf16 v[68:71], a[0:3], a[116:119], v[68:71]
    ds_read_b64_tr_b16 a[156:157], v15 offset:57344
    v_mfma_f32_16x16x32_bf16 v[68:71], a[128:131], a[124:127], v[68:71]
    ds_read_b64_tr_b16 a[158:159], v15 offset:61440
    v_xor_b32 v8, 0x10000, v8
    s_waitcnt lgkmcnt(12)
    v_mfma_f32_16x16x32_bf16 v[72:75], a[4:7], a[112:115], v[72:75]
    ds_read_b64_tr_b16 a[0:1], v8 offset:0
    s_add_u32 m0, s51, 20480
    v_mfma_f32_16x16x32_bf16 v[72:75], a[132:135], a[120:123], v[72:75]
    ds_read_b64_tr_b16 a[2:3], v8 offset:4096
    buffer_load_dwordx4 v16, s[12:15], s44 offen lds
    v_mfma_f32_16x16x32_bf16 v[76:79], a[4:7], a[116:119], v[76:79]
    ds_read_b64_tr_b16 a[128:129], v8 offset:8192
    s_add_u32 s44, s44, 65536
    v_mfma_f32_16x16x32_bf16 v[76:79], a[132:135], a[124:127], v[76:79]
    ds_read_b64_tr_b16 a[130:131], v8 offset:12288
    v_xor_b32 v9, 0x10000, v9
    s_waitcnt lgkmcnt(12)
    v_mfma_f32_16x16x32_bf16 v[80:83], a[8:11], a[112:115], v[80:83]
    ds_read_b64_tr_b16 a[4:5], v9 offset:0
    v_mfma_f32_16x16x32_bf16 v[80:83], a[136:139], a[120:123], v[80:83]
    ds_read_b64_tr_b16 a[6:7], v9 offset:4096
    buffer_load_dwordx4 a[96:99], v3, s[16:19], s48 offen sc1
    v_mfma_f32_16x16x32_bf16 v[84:87], a[8:11], a[116:119], v[84:87]
    ds_read_b64_tr_b16 a[132:133], v9 offset:8192
    v_mfma_f32_16x16x32_bf16 v[84:87], a[136:139], a[124:127], v[84:87]
    ds_read_b64_tr_b16 a[134:135], v9 offset:12288
    v_xor_b32 v10, 0x10000, v10
    s_waitcnt lgkmcnt(12)
    v_mfma_f32_16x16x32_bf16 v[88:91], a[12:15], a[112:115], v[88:91]
    ds_read_b64_tr_b16 a[8:9], v10 offset:0
    v_mfma_f32_16x16x32_bf16 v[88:91], a[140:143], a[120:123], v[88:91]
    ds_read_b64_tr_b16 a[10:11], v10 offset:4096
    buffer_load_dwordx4 a[100:103], v4, s[16:19], s48 offen sc1
    v_mfma_f32_16x16x32_bf16 v[92:95], a[12:15], a[116:119], v[92:95]
    ds_read_b64_tr_b16 a[136:137], v10 offset:8192
    s_add_u32 s48, s48, 1024
    v_mfma_f32_16x16x32_bf16 v[92:95], a[140:143], a[124:127], v[92:95]
    ds_read_b64_tr_b16 a[138:139], v10 offset:12288
    v_xor_b32 v11, 0x10000, v11
    s_waitcnt lgkmcnt(12)
    v_mfma_f32_16x16x32_bf16 v[96:99], a[16:19], a[112:115], v[96:99]
    ds_read_b64_tr_b16 a[12:13], v11 offset:0
    s_add_u32 m0, s51, 24576
    v_mfma_f32_16x16x32_bf16 v[96:99], a[144:147], a[120:123], v[96:99]
    ds_read_b64_tr_b16 a[14:15], v11 offset:4096
    buffer_load_dwordx4 v2, s[12:15], s44 offen lds
    v_mfma_f32_16x16x32_bf16 v[100:103], a[16:19], a[116:119], v[100:103]
    ds_read_b64_tr_b16 a[140:141], v11 offset:8192
    v_mfma_f32_16x16x32_bf16 v[100:103], a[144:147], a[124:127], v[100:103]
    ds_read_b64_tr_b16 a[142:143], v11 offset:12288
    v_xor_b32 v12, 0x10000, v12
    s_waitcnt lgkmcnt(12)
    v_mfma_f32_16x16x32_bf16 v[104:107], a[20:23], a[112:115], v[104:107]
    ds_read_b64_tr_b16 a[16:17], v12 offset:0
    s_add_u32 m0, s51, 28672
    v_mfma_f32_16x16x32_bf16 v[104:107], a[148:151], a[120:123], v[104:107]
    ds_read_b64_tr_b16 a[18:19], v12 offset:4096
    buffer_load_dwordx4 v16, s[12:15], s44 offen lds
    v_mfma_f32_16x16x32_bf16 v[108:111], a[20:23], a[116:119], v[108:111]
    ds_read_b64_tr_b16 a[144:145], v12 offset:8192
    s_add_u32 s44, s44, 65536
    v_mfma_f32_16x16x32_bf16 v[108:111], a[148:151], a[124:127], v[108:111]
    ds_read_b64_tr_b16 a[146:147], v12 offset:12288
    v_xor_b32 v13, 0x10000, v13
    s_waitcnt lgkmcnt(12)
    v_mfma_f32_16x16x32_bf16 v[112:115], a[24:27], a[112:115], v[112:115]
    ds_read_b64_tr_b16 a[20:21], v13 offset:0
    v_mfma_f32_16x16x32_bf16 v[112:115], a[152:155], a[120:123], v[112:115]
    ds_read_b64_tr_b16 a[22:23], v13 offset:4096
    buffer_load_dwordx4 a[104:107], v3, s[16:19], s48 offen sc1
    v_mfma_f32_16x16x32_bf16 v[116:119], a[24:27], a[116:119], v[116:119]
    ds_read_b64_tr_b16 a[148:149], v13 offset:8192
    v_mfma_f32_16x16x32_bf16 v[116:119], a[152:155], a[124:127], v[116:119]
    ds_read_b64_tr_b16 a[150:151], v13 offset:12288
    v_xor_b32 v14, 0x10000, v14
    s_xor_b32 s47, s47, 0x10000
    s_waitcnt lgkmcnt(12)
    v_mfma_f32_16x16x32_bf16 v[120:123], a[28:31], a[112:115], v[120:123]
    ds_read_b64_tr_b16 a[24:25], v14 offset:0
    s_xor_b32 s51, s51, 0x10000
    v_mfma_f32_16x16x32_bf16 v[120:123], a[156:159], a[120:123], v[120:123]
    ds_read_b64_tr_b16 a[26:27], v14 offset:4096
    buffer_load_dwordx4 a[108:111], v4, s[16:19], s48 offen sc1
    v_mfma_f32_16x16x32_bf16 v[124:127], a[28:31], a[116:119], v[124:127]
    ds_read_b64_tr_b16 a[152:153], v14 offset:8192
    s_add_u32 s48, s48, 1024
    v_mfma_f32_16x16x32_bf16 v[124:127], a[156:159], a[124:127], v[124:127]
    ds_read_b64_tr_b16 a[154:155], v14 offset:12288
    v_xor_b32 v15, 0x10000, v15
    s_mov_b32 s49, 5
.p2align 6
L_oproj_kernel_k:
    s_waitcnt vmcnt(16)
    s_waitcnt lgkmcnt(12)
    v_mfma_f32_16x16x32_bf16 v[64:67], a[0:3], a[64:67], v[64:67]
    ds_read_b64_tr_b16 a[28:29], v15 offset:0
    s_add_u32 m0, s47, 32768
    v_mfma_f32_16x16x32_bf16 v[64:67], a[128:131], a[72:75], v[64:67]
    ds_read_b64_tr_b16 a[30:31], v15 offset:4096
    buffer_load_dwordx4 v2, s[12:15], s44 offen lds
    v_mfma_f32_16x16x32_bf16 v[68:71], a[0:3], a[68:71], v[68:71]
    ds_read_b64_tr_b16 a[156:157], v15 offset:8192
    v_mfma_f32_16x16x32_bf16 v[68:71], a[128:131], a[76:79], v[68:71]
    ds_read_b64_tr_b16 a[158:159], v15 offset:12288
    s_waitcnt lgkmcnt(12)
    v_mfma_f32_16x16x32_bf16 v[72:75], a[4:7], a[64:67], v[72:75]
    ds_read_b64_tr_b16 a[0:1], v8 offset:16384
    s_add_u32 m0, s47, 36864
    v_mfma_f32_16x16x32_bf16 v[72:75], a[132:135], a[72:75], v[72:75]
    ds_read_b64_tr_b16 a[2:3], v8 offset:20480
    buffer_load_dwordx4 v16, s[12:15], s44 offen lds
    v_mfma_f32_16x16x32_bf16 v[76:79], a[4:7], a[68:71], v[76:79]
    ds_read_b64_tr_b16 a[128:129], v8 offset:24576
    s_add_u32 s44, s44, 65536
    v_mfma_f32_16x16x32_bf16 v[76:79], a[132:135], a[76:79], v[76:79]
    ds_read_b64_tr_b16 a[130:131], v8 offset:28672
    s_waitcnt lgkmcnt(12)
    v_mfma_f32_16x16x32_bf16 v[80:83], a[8:11], a[64:67], v[80:83]
    ds_read_b64_tr_b16 a[4:5], v9 offset:16384
    v_mfma_f32_16x16x32_bf16 v[80:83], a[136:139], a[72:75], v[80:83]
    ds_read_b64_tr_b16 a[6:7], v9 offset:20480
    buffer_load_dwordx4 a[112:115], v3, s[16:19], s48 offen sc1
    v_mfma_f32_16x16x32_bf16 v[84:87], a[8:11], a[68:71], v[84:87]
    ds_read_b64_tr_b16 a[132:133], v9 offset:24576
    v_mfma_f32_16x16x32_bf16 v[84:87], a[136:139], a[76:79], v[84:87]
    ds_read_b64_tr_b16 a[134:135], v9 offset:28672
    s_waitcnt lgkmcnt(12)
    v_mfma_f32_16x16x32_bf16 v[88:91], a[12:15], a[64:67], v[88:91]
    ds_read_b64_tr_b16 a[8:9], v10 offset:16384
    v_mfma_f32_16x16x32_bf16 v[88:91], a[140:143], a[72:75], v[88:91]
    ds_read_b64_tr_b16 a[10:11], v10 offset:20480
    buffer_load_dwordx4 a[116:119], v4, s[16:19], s48 offen sc1
    v_mfma_f32_16x16x32_bf16 v[92:95], a[12:15], a[68:71], v[92:95]
    ds_read_b64_tr_b16 a[136:137], v10 offset:24576
    s_add_u32 s48, s48, 1024
    v_mfma_f32_16x16x32_bf16 v[92:95], a[140:143], a[76:79], v[92:95]
    ds_read_b64_tr_b16 a[138:139], v10 offset:28672
    s_waitcnt lgkmcnt(12)
    v_mfma_f32_16x16x32_bf16 v[96:99], a[16:19], a[64:67], v[96:99]
    ds_read_b64_tr_b16 a[12:13], v11 offset:16384
    s_add_u32 m0, s47, 40960
    v_mfma_f32_16x16x32_bf16 v[96:99], a[144:147], a[72:75], v[96:99]
    ds_read_b64_tr_b16 a[14:15], v11 offset:20480
    buffer_load_dwordx4 v2, s[12:15], s44 offen lds
    v_mfma_f32_16x16x32_bf16 v[100:103], a[16:19], a[68:71], v[100:103]
    ds_read_b64_tr_b16 a[140:141], v11 offset:24576
    v_mfma_f32_16x16x32_bf16 v[100:103], a[144:147], a[76:79], v[100:103]
    ds_read_b64_tr_b16 a[142:143], v11 offset:28672
    s_waitcnt lgkmcnt(12)
    v_mfma_f32_16x16x32_bf16 v[104:107], a[20:23], a[64:67], v[104:107]
    ds_read_b64_tr_b16 a[16:17], v12 offset:16384
    s_add_u32 m0, s47, 45056
    v_mfma_f32_16x16x32_bf16 v[104:107], a[148:151], a[72:75], v[104:107]
    ds_read_b64_tr_b16 a[18:19], v12 offset:20480
    buffer_load_dwordx4 v16, s[12:15], s44 offen lds
    v_mfma_f32_16x16x32_bf16 v[108:111], a[20:23], a[68:71], v[108:111]
    ds_read_b64_tr_b16 a[144:145], v12 offset:24576
    s_add_u32 s44, s44, 65536
    v_mfma_f32_16x16x32_bf16 v[108:111], a[148:151], a[76:79], v[108:111]
    ds_read_b64_tr_b16 a[146:147], v12 offset:28672
    s_waitcnt lgkmcnt(12)
    v_mfma_f32_16x16x32_bf16 v[112:115], a[24:27], a[64:67], v[112:115]
    ds_read_b64_tr_b16 a[20:21], v13 offset:16384
    v_mfma_f32_16x16x32_bf16 v[112:115], a[152:155], a[72:75], v[112:115]
    ds_read_b64_tr_b16 a[22:23], v13 offset:20480
    buffer_load_dwordx4 a[120:123], v3, s[16:19], s48 offen sc1
    v_mfma_f32_16x16x32_bf16 v[116:119], a[24:27], a[68:71], v[116:119]
    ds_read_b64_tr_b16 a[148:149], v13 offset:24576
    v_mfma_f32_16x16x32_bf16 v[116:119], a[152:155], a[76:79], v[116:119]
    ds_read_b64_tr_b16 a[150:151], v13 offset:28672
    s_waitcnt lgkmcnt(12)
    v_mfma_f32_16x16x32_bf16 v[120:123], a[28:31], a[64:67], v[120:123]
    ds_read_b64_tr_b16 a[24:25], v14 offset:16384
    v_mfma_f32_16x16x32_bf16 v[120:123], a[156:159], a[72:75], v[120:123]
    ds_read_b64_tr_b16 a[26:27], v14 offset:20480
    buffer_load_dwordx4 a[124:127], v4, s[16:19], s48 offen sc1
    v_mfma_f32_16x16x32_bf16 v[124:127], a[28:31], a[68:71], v[124:127]
    ds_read_b64_tr_b16 a[152:153], v14 offset:24576
    s_add_u32 s48, s48, 1024
    v_mfma_f32_16x16x32_bf16 v[124:127], a[156:159], a[76:79], v[124:127]
    ds_read_b64_tr_b16 a[154:155], v14 offset:28672
    s_waitcnt vmcnt(16)
    s_barrier
    s_waitcnt lgkmcnt(12)
    v_mfma_f32_16x16x32_bf16 v[64:67], a[0:3], a[80:83], v[64:67]
    ds_read_b64_tr_b16 a[28:29], v15 offset:16384
    s_add_u32 m0, s47, 49152
    v_mfma_f32_16x16x32_bf16 v[64:67], a[128:131], a[88:91], v[64:67]
    ds_read_b64_tr_b16 a[30:31], v15 offset:20480
    buffer_load_dwordx4 v2, s[12:15], s44 offen lds
    v_mfma_f32_16x16x32_bf16 v[68:71], a[0:3], a[84:87], v[68:71]
    ds_read_b64_tr_b16 a[156:157], v15 offset:24576
    v_mfma_f32_16x16x32_bf16 v[68:71], a[128:131], a[92:95], v[68:71]
    ds_read_b64_tr_b16 a[158:159], v15 offset:28672
    s_waitcnt lgkmcnt(12)
    v_mfma_f32_16x16x32_bf16 v[72:75], a[4:7], a[80:83], v[72:75]
    ds_read_b64_tr_b16 a[0:1], v8 offset:32768
    s_add_u32 m0, s47, 53248
    v_mfma_f32_16x16x32_bf16 v[72:75], a[132:135], a[88:91], v[72:75]
    ds_read_b64_tr_b16 a[2:3], v8 offset:36864
    buffer_load_dwordx4 v16, s[12:15], s44 offen lds
    v_mfma_f32_16x16x32_bf16 v[76:79], a[4:7], a[84:87], v[76:79]
    ds_read_b64_tr_b16 a[128:129], v8 offset:40960
    s_add_u32 s44, s44, 65536
    v_mfma_f32_16x16x32_bf16 v[76:79], a[132:135], a[92:95], v[76:79]
    ds_read_b64_tr_b16 a[130:131], v8 offset:45056
    s_waitcnt lgkmcnt(12)
    v_mfma_f32_16x16x32_bf16 v[80:83], a[8:11], a[80:83], v[80:83]
    ds_read_b64_tr_b16 a[4:5], v9 offset:32768
    v_mfma_f32_16x16x32_bf16 v[80:83], a[136:139], a[88:91], v[80:83]
    ds_read_b64_tr_b16 a[6:7], v9 offset:36864
    buffer_load_dwordx4 a[64:67], v3, s[16:19], s48 offen sc1
    v_mfma_f32_16x16x32_bf16 v[84:87], a[8:11], a[84:87], v[84:87]
    ds_read_b64_tr_b16 a[132:133], v9 offset:40960
    v_mfma_f32_16x16x32_bf16 v[84:87], a[136:139], a[92:95], v[84:87]
    ds_read_b64_tr_b16 a[134:135], v9 offset:45056
    s_waitcnt lgkmcnt(12)
    v_mfma_f32_16x16x32_bf16 v[88:91], a[12:15], a[80:83], v[88:91]
    ds_read_b64_tr_b16 a[8:9], v10 offset:32768
    v_mfma_f32_16x16x32_bf16 v[88:91], a[140:143], a[88:91], v[88:91]
    ds_read_b64_tr_b16 a[10:11], v10 offset:36864
    buffer_load_dwordx4 a[68:71], v4, s[16:19], s48 offen sc1
    v_mfma_f32_16x16x32_bf16 v[92:95], a[12:15], a[84:87], v[92:95]
    ds_read_b64_tr_b16 a[136:137], v10 offset:40960
    s_add_u32 s48, s48, 1024
    v_mfma_f32_16x16x32_bf16 v[92:95], a[140:143], a[92:95], v[92:95]
    ds_read_b64_tr_b16 a[138:139], v10 offset:45056
    s_waitcnt lgkmcnt(12)
    v_mfma_f32_16x16x32_bf16 v[96:99], a[16:19], a[80:83], v[96:99]
    ds_read_b64_tr_b16 a[12:13], v11 offset:32768
    s_add_u32 m0, s47, 57344
    v_mfma_f32_16x16x32_bf16 v[96:99], a[144:147], a[88:91], v[96:99]
    ds_read_b64_tr_b16 a[14:15], v11 offset:36864
    buffer_load_dwordx4 v2, s[12:15], s44 offen lds
    v_mfma_f32_16x16x32_bf16 v[100:103], a[16:19], a[84:87], v[100:103]
    ds_read_b64_tr_b16 a[140:141], v11 offset:40960
    v_mfma_f32_16x16x32_bf16 v[100:103], a[144:147], a[92:95], v[100:103]
    ds_read_b64_tr_b16 a[142:143], v11 offset:45056
    s_waitcnt lgkmcnt(12)
    v_mfma_f32_16x16x32_bf16 v[104:107], a[20:23], a[80:83], v[104:107]
    ds_read_b64_tr_b16 a[16:17], v12 offset:32768
    s_add_u32 m0, s47, 61440
    v_mfma_f32_16x16x32_bf16 v[104:107], a[148:151], a[88:91], v[104:107]
    ds_read_b64_tr_b16 a[18:19], v12 offset:36864
    buffer_load_dwordx4 v16, s[12:15], s44 offen lds
    v_mfma_f32_16x16x32_bf16 v[108:111], a[20:23], a[84:87], v[108:111]
    ds_read_b64_tr_b16 a[144:145], v12 offset:40960
    s_add_u32 s44, s44, 65536
    v_mfma_f32_16x16x32_bf16 v[108:111], a[148:151], a[92:95], v[108:111]
    ds_read_b64_tr_b16 a[146:147], v12 offset:45056
    s_waitcnt lgkmcnt(12)
    v_mfma_f32_16x16x32_bf16 v[112:115], a[24:27], a[80:83], v[112:115]
    ds_read_b64_tr_b16 a[20:21], v13 offset:32768
    v_mfma_f32_16x16x32_bf16 v[112:115], a[152:155], a[88:91], v[112:115]
    ds_read_b64_tr_b16 a[22:23], v13 offset:36864
    buffer_load_dwordx4 a[72:75], v3, s[16:19], s48 offen sc1
    v_mfma_f32_16x16x32_bf16 v[116:119], a[24:27], a[84:87], v[116:119]
    ds_read_b64_tr_b16 a[148:149], v13 offset:40960
    v_mfma_f32_16x16x32_bf16 v[116:119], a[152:155], a[92:95], v[116:119]
    ds_read_b64_tr_b16 a[150:151], v13 offset:45056
    s_waitcnt lgkmcnt(12)
    v_mfma_f32_16x16x32_bf16 v[120:123], a[28:31], a[80:83], v[120:123]
    ds_read_b64_tr_b16 a[24:25], v14 offset:32768
    v_mfma_f32_16x16x32_bf16 v[120:123], a[156:159], a[88:91], v[120:123]
    ds_read_b64_tr_b16 a[26:27], v14 offset:36864
    buffer_load_dwordx4 a[76:79], v4, s[16:19], s48 offen sc1
    v_mfma_f32_16x16x32_bf16 v[124:127], a[28:31], a[84:87], v[124:127]
    ds_read_b64_tr_b16 a[152:153], v14 offset:40960
    s_add_u32 s48, s48, 1024
    v_mfma_f32_16x16x32_bf16 v[124:127], a[156:159], a[92:95], v[124:127]
    ds_read_b64_tr_b16 a[154:155], v14 offset:45056
    s_waitcnt vmcnt(16)
    s_waitcnt lgkmcnt(12)
    v_mfma_f32_16x16x32_bf16 v[64:67], a[0:3], a[96:99], v[64:67]
    ds_read_b64_tr_b16 a[28:29], v15 offset:32768
    s_add_u32 m0, s51, 0
    v_mfma_f32_16x16x32_bf16 v[64:67], a[128:131], a[104:107], v[64:67]
    ds_read_b64_tr_b16 a[30:31], v15 offset:36864
    buffer_load_dwordx4 v2, s[12:15], s44 offen lds
    v_mfma_f32_16x16x32_bf16 v[68:71], a[0:3], a[100:103], v[68:71]
    ds_read_b64_tr_b16 a[156:157], v15 offset:40960
    v_mfma_f32_16x16x32_bf16 v[68:71], a[128:131], a[108:111], v[68:71]
    ds_read_b64_tr_b16 a[158:159], v15 offset:45056
    s_waitcnt lgkmcnt(12)
    v_mfma_f32_16x16x32_bf16 v[72:75], a[4:7], a[96:99], v[72:75]
    ds_read_b64_tr_b16 a[0:1], v8 offset:49152
    s_add_u32 m0, s51, 4096
    v_mfma_f32_16x16x32_bf16 v[72:75], a[132:135], a[104:107], v[72:75]
    ds_read_b64_tr_b16 a[2:3], v8 offset:53248
    buffer_load_dwordx4 v16, s[12:15], s44 offen lds
    v_mfma_f32_16x16x32_bf16 v[76:79], a[4:7], a[100:103], v[76:79]
    ds_read_b64_tr_b16 a[128:129], v8 offset:57344
    s_add_u32 s44, s44, 65536
    v_mfma_f32_16x16x32_bf16 v[76:79], a[132:135], a[108:111], v[76:79]
    ds_read_b64_tr_b16 a[130:131], v8 offset:61440
    s_waitcnt lgkmcnt(12)
    v_mfma_f32_16x16x32_bf16 v[80:83], a[8:11], a[96:99], v[80:83]
    ds_read_b64_tr_b16 a[4:5], v9 offset:49152
    v_mfma_f32_16x16x32_bf16 v[80:83], a[136:139], a[104:107], v[80:83]
    ds_read_b64_tr_b16 a[6:7], v9 offset:53248
    buffer_load_dwordx4 a[80:83], v3, s[16:19], s48 offen sc1
    v_mfma_f32_16x16x32_bf16 v[84:87], a[8:11], a[100:103], v[84:87]
    ds_read_b64_tr_b16 a[132:133], v9 offset:57344
    v_mfma_f32_16x16x32_bf16 v[84:87], a[136:139], a[108:111], v[84:87]
    ds_read_b64_tr_b16 a[134:135], v9 offset:61440
    s_waitcnt lgkmcnt(12)
    v_mfma_f32_16x16x32_bf16 v[88:91], a[12:15], a[96:99], v[88:91]
    ds_read_b64_tr_b16 a[8:9], v10 offset:49152
    v_mfma_f32_16x16x32_bf16 v[88:91], a[140:143], a[104:107], v[88:91]
    ds_read_b64_tr_b16 a[10:11], v10 offset:53248
    buffer_load_dwordx4 a[84:87], v4, s[16:19], s48 offen sc1
    v_mfma_f32_16x16x32_bf16 v[92:95], a[12:15], a[100:103], v[92:95]
    ds_read_b64_tr_b16 a[136:137], v10 offset:57344
    s_add_u32 s48, s48, 1024
    v_mfma_f32_16x16x32_bf16 v[92:95], a[140:143], a[108:111], v[92:95]
    ds_read_b64_tr_b16 a[138:139], v10 offset:61440
    s_waitcnt lgkmcnt(12)
    v_mfma_f32_16x16x32_bf16 v[96:99], a[16:19], a[96:99], v[96:99]
    ds_read_b64_tr_b16 a[12:13], v11 offset:49152
    s_add_u32 m0, s51, 8192
    v_mfma_f32_16x16x32_bf16 v[96:99], a[144:147], a[104:107], v[96:99]
    ds_read_b64_tr_b16 a[14:15], v11 offset:53248
    buffer_load_dwordx4 v2, s[12:15], s44 offen lds
    v_mfma_f32_16x16x32_bf16 v[100:103], a[16:19], a[100:103], v[100:103]
    ds_read_b64_tr_b16 a[140:141], v11 offset:57344
    v_mfma_f32_16x16x32_bf16 v[100:103], a[144:147], a[108:111], v[100:103]
    ds_read_b64_tr_b16 a[142:143], v11 offset:61440
    s_waitcnt lgkmcnt(12)
    v_mfma_f32_16x16x32_bf16 v[104:107], a[20:23], a[96:99], v[104:107]
    ds_read_b64_tr_b16 a[16:17], v12 offset:49152
    s_add_u32 m0, s51, 12288
    v_mfma_f32_16x16x32_bf16 v[104:107], a[148:151], a[104:107], v[104:107]
    ds_read_b64_tr_b16 a[18:19], v12 offset:53248
    buffer_load_dwordx4 v16, s[12:15], s44 offen lds
    v_mfma_f32_16x16x32_bf16 v[108:111], a[20:23], a[100:103], v[108:111]
    ds_read_b64_tr_b16 a[144:145], v12 offset:57344
    s_add_u32 s44, s44, 65536
    v_mfma_f32_16x16x32_bf16 v[108:111], a[148:151], a[108:111], v[108:111]
    ds_read_b64_tr_b16 a[146:147], v12 offset:61440
    s_waitcnt lgkmcnt(12)
    v_mfma_f32_16x16x32_bf16 v[112:115], a[24:27], a[96:99], v[112:115]
    ds_read_b64_tr_b16 a[20:21], v13 offset:49152
    v_mfma_f32_16x16x32_bf16 v[112:115], a[152:155], a[104:107], v[112:115]
    ds_read_b64_tr_b16 a[22:23], v13 offset:53248
    buffer_load_dwordx4 a[88:91], v3, s[16:19], s48 offen sc1
    v_mfma_f32_16x16x32_bf16 v[116:119], a[24:27], a[100:103], v[116:119]
    ds_read_b64_tr_b16 a[148:149], v13 offset:57344
    v_mfma_f32_16x16x32_bf16 v[116:119], a[152:155], a[108:111], v[116:119]
    ds_read_b64_tr_b16 a[150:151], v13 offset:61440
    s_waitcnt lgkmcnt(12)
    v_mfma_f32_16x16x32_bf16 v[120:123], a[28:31], a[96:99], v[120:123]
    ds_read_b64_tr_b16 a[24:25], v14 offset:49152
    v_mfma_f32_16x16x32_bf16 v[120:123], a[156:159], a[104:107], v[120:123]
    ds_read_b64_tr_b16 a[26:27], v14 offset:53248
    buffer_load_dwordx4 a[92:95], v4, s[16:19], s48 offen sc1
    v_mfma_f32_16x16x32_bf16 v[124:127], a[28:31], a[100:103], v[124:127]
    ds_read_b64_tr_b16 a[152:153], v14 offset:57344
    s_add_u32 s48, s48, 1024
    v_mfma_f32_16x16x32_bf16 v[124:127], a[156:159], a[108:111], v[124:127]
    ds_read_b64_tr_b16 a[154:155], v14 offset:61440
    s_waitcnt vmcnt(16)
    s_barrier
    s_waitcnt lgkmcnt(12)
    v_mfma_f32_16x16x32_bf16 v[64:67], a[0:3], a[112:115], v[64:67]
    ds_read_b64_tr_b16 a[28:29], v15 offset:49152
    s_add_u32 m0, s51, 16384
    v_mfma_f32_16x16x32_bf16 v[64:67], a[128:131], a[120:123], v[64:67]
    ds_read_b64_tr_b16 a[30:31], v15 offset:53248
    buffer_load_dwordx4 v2, s[12:15], s44 offen lds
    v_mfma_f32_16x16x32_bf16 v[68:71], a[0:3], a[116:119], v[68:71]
    ds_read_b64_tr_b16 a[156:157], v15 offset:57344
    v_mfma_f32_16x16x32_bf16 v[68:71], a[128:131], a[124:127], v[68:71]
    ds_read_b64_tr_b16 a[158:159], v15 offset:61440
    v_xor_b32 v8, 0x10000, v8
    s_waitcnt lgkmcnt(12)
    v_mfma_f32_16x16x32_bf16 v[72:75], a[4:7], a[112:115], v[72:75]
    ds_read_b64_tr_b16 a[0:1], v8 offset:0
    s_add_u32 m0, s51, 20480
    v_mfma_f32_16x16x32_bf16 v[72:75], a[132:135], a[120:123], v[72:75]
    ds_read_b64_tr_b16 a[2:3], v8 offset:4096
    buffer_load_dwordx4 v16, s[12:15], s44 offen lds
    v_mfma_f32_16x16x32_bf16 v[76:79], a[4:7], a[116:119], v[76:79]
    ds_read_b64_tr_b16 a[128:129], v8 offset:8192
    s_add_u32 s44, s44, 65536
    v_mfma_f32_16x16x32_bf16 v[76:79], a[132:135], a[124:127], v[76:79]
    ds_read_b64_tr_b16 a[130:131], v8 offset:12288
    v_xor_b32 v9, 0x10000, v9
    s_waitcnt lgkmcnt(12)
    v_mfma_f32_16x16x32_bf16 v[80:83], a[8:11], a[112:115], v[80:83]
    ds_read_b64_tr_b16 a[4:5], v9 offset:0
    v_mfma_f32_16x16x32_bf16 v[80:83], a[136:139], a[120:123], v[80:83]
    ds_read_b64_tr_b16 a[6:7], v9 offset:4096
    buffer_load_dwordx4 a[96:99], v3, s[16:19], s48 offen sc1
    v_mfma_f32_16x16x32_bf16 v[84:87], a[8:11], a[116:119], v[84:87]
    ds_read_b64_tr_b16 a[132:133], v9 offset:8192
    v_mfma_f32_16x16x32_bf16 v[84:87], a[136:139], a[124:127], v[84:87]
    ds_read_b64_tr_b16 a[134:135], v9 offset:12288
    v_xor_b32 v10, 0x10000, v10
    s_waitcnt lgkmcnt(12)
    v_mfma_f32_16x16x32_bf16 v[88:91], a[12:15], a[112:115], v[88:91]
    ds_read_b64_tr_b16 a[8:9], v10 offset:0
    v_mfma_f32_16x16x32_bf16 v[88:91], a[140:143], a[120:123], v[88:91]
    ds_read_b64_tr_b16 a[10:11], v10 offset:4096
    buffer_load_dwordx4 a[100:103], v4, s[16:19], s48 offen sc1
    v_mfma_f32_16x16x32_bf16 v[92:95], a[12:15], a[116:119], v[92:95]
    ds_read_b64_tr_b16 a[136:137], v10 offset:8192
    s_add_u32 s48, s48, 1024
    v_mfma_f32_16x16x32_bf16 v[92:95], a[140:143], a[124:127], v[92:95]
    ds_read_b64_tr_b16 a[138:139], v10 offset:12288
    v_xor_b32 v11, 0x10000, v11
    s_waitcnt lgkmcnt(12)
    v_mfma_f32_16x16x32_bf16 v[96:99], a[16:19], a[112:115], v[96:99]
    ds_read_b64_tr_b16 a[12:13], v11 offset:0
    s_add_u32 m0, s51, 24576
    v_mfma_f32_16x16x32_bf16 v[96:99], a[144:147], a[120:123], v[96:99]
    ds_read_b64_tr_b16 a[14:15], v11 offset:4096
    buffer_load_dwordx4 v2, s[12:15], s44 offen lds
    v_mfma_f32_16x16x32_bf16 v[100:103], a[16:19], a[116:119], v[100:103]
    ds_read_b64_tr_b16 a[140:141], v11 offset:8192
    v_mfma_f32_16x16x32_bf16 v[100:103], a[144:147], a[124:127], v[100:103]
    ds_read_b64_tr_b16 a[142:143], v11 offset:12288
    v_xor_b32 v12, 0x10000, v12
    s_waitcnt lgkmcnt(12)
    v_mfma_f32_16x16x32_bf16 v[104:107], a[20:23], a[112:115], v[104:107]
    ds_read_b64_tr_b16 a[16:17], v12 offset:0
    s_add_u32 m0, s51, 28672
    v_mfma_f32_16x16x32_bf16 v[104:107], a[148:151], a[120:123], v[104:107]
    ds_read_b64_tr_b16 a[18:19], v12 offset:4096
    buffer_load_dwordx4 v16, s[12:15], s44 offen lds
    v_mfma_f32_16x16x32_bf16 v[108:111], a[20:23], a[116:119], v[108:111]
    ds_read_b64_tr_b16 a[144:145], v12 offset:8192
    s_add_u32 s44, s44, 65536
    v_mfma_f32_16x16x32_bf16 v[108:111], a[148:151], a[124:127], v[108:111]
    ds_read_b64_tr_b16 a[146:147], v12 offset:12288
    v_xor_b32 v13, 0x10000, v13
    s_waitcnt lgkmcnt(12)
    v_mfma_f32_16x16x32_bf16 v[112:115], a[24:27], a[112:115], v[112:115]
    ds_read_b64_tr_b16 a[20:21], v13 offset:0
    v_mfma_f32_16x16x32_bf16 v[112:115], a[152:155], a[120:123], v[112:115]
    ds_read_b64_tr_b16 a[22:23], v13 offset:4096
    buffer_load_dwordx4 a[104:107], v3, s[16:19], s48 offen sc1
    v_mfma_f32_16x16x32_bf16 v[116:119], a[24:27], a[116:119], v[116:119]
    ds_read_b64_tr_b16 a[148:149], v13 offset:8192
    v_mfma_f32_16x16x32_bf16 v[116:119], a[152:155], a[124:127], v[116:119]
    ds_read_b64_tr_b16 a[150:151], v13 offset:12288
    v_xor_b32 v14, 0x10000, v14
    s_xor_b32 s47, s47, 0x10000
    s_waitcnt lgkmcnt(12)
    v_mfma_f32_16x16x32_bf16 v[120:123], a[28:31], a[112:115], v[120:123]
    ds_read_b64_tr_b16 a[24:25], v14 offset:0
    s_xor_b32 s51, s51, 0x10000
    v_mfma_f32_16x16x32_bf16 v[120:123], a[156:159], a[120:123], v[120:123]
    ds_read_b64_tr_b16 a[26:27], v14 offset:4096
    buffer_load_dwordx4 a[108:111], v4, s[16:19], s48 offen sc1
    v_mfma_f32_16x16x32_bf16 v[124:127], a[28:31], a[116:119], v[124:127]
    ds_read_b64_tr_b16 a[152:153], v14 offset:8192
    s_add_u32 s48, s48, 1024
    v_mfma_f32_16x16x32_bf16 v[124:127], a[156:159], a[124:127], v[124:127]
    ds_read_b64_tr_b16 a[154:155], v14 offset:12288
    v_xor_b32 v15, 0x10000, v15
    s_sub_u32 s49, s49, 1
    s_cmp_lg_u32 s49, 0
    s_cbranch_scc1 L_oproj_kernel_k
    s_waitcnt vmcnt(16)
    s_waitcnt lgkmcnt(12)
    v_mfma_f32_16x16x32_bf16 v[64:67], a[0:3], a[64:67], v[64:67]
    ds_read_b64_tr_b16 a[28:29], v15 offset:0
    s_add_u32 m0, s47, 32768
    v_mfma_f32_16x16x32_bf16 v[64:67], a[128:131], a[72:75], v[64:67]
    ds_read_b64_tr_b16 a[30:31], v15 offset:4096
    buffer_load_dwordx4 v2, s[12:15], s44 offen lds
    v_mfma_f32_16x16x32_bf16 v[68:71], a[0:3], a[68:71], v[68:71]
    ds_read_b64_tr_b16 a[156:157], v15 offset:8192
    v_mfma_f32_16x16x32_bf16 v[68:71], a[128:131], a[76:79], v[68:71]
    ds_read_b64_tr_b16 a[158:159], v15 offset:12288
    s_waitcnt lgkmcnt(12)
    v_mfma_f32_16x16x32_bf16 v[72:75], a[4:7], a[64:67], v[72:75]
    ds_read_b64_tr_b16 a[0:1], v8 offset:16384
    s_add_u32 m0, s47, 36864
    v_mfma_f32_16x16x32_bf16 v[72:75], a[132:135], a[72:75], v[72:75]
    ds_read_b64_tr_b16 a[2:3], v8 offset:20480
    buffer_load_dwordx4 v16, s[12:15], s44 offen lds
    v_mfma_f32_16x16x32_bf16 v[76:79], a[4:7], a[68:71], v[76:79]
    ds_read_b64_tr_b16 a[128:129], v8 offset:24576
    s_add_u32 s44, s44, 65536
    v_mfma_f32_16x16x32_bf16 v[76:79], a[132:135], a[76:79], v[76:79]
    ds_read_b64_tr_b16 a[130:131], v8 offset:28672
    s_waitcnt lgkmcnt(12)
    v_mfma_f32_16x16x32_bf16 v[80:83], a[8:11], a[64:67], v[80:83]
    ds_read_b64_tr_b16 a[4:5], v9 offset:16384
    v_mfma_f32_16x16x32_bf16 v[80:83], a[136:139], a[72:75], v[80:83]
    ds_read_b64_tr_b16 a[6:7], v9 offset:20480
    buffer_load_dwordx4 a[112:115], v3, s[16:19], s48 offen sc1
    v_mfma_f32_16x16x32_bf16 v[84:87], a[8:11], a[68:71], v[84:87]
    ds_read_b64_tr_b16 a[132:133], v9 offset:24576
    v_mfma_f32_16x16x32_bf16 v[84:87], a[136:139], a[76:79], v[84:87]
    ds_read_b64_tr_b16 a[134:135], v9 offset:28672
    s_waitcnt lgkmcnt(12)
    v_mfma_f32_16x16x32_bf16 v[88:91], a[12:15], a[64:67], v[88:91]
    ds_read_b64_tr_b16 a[8:9], v10 offset:16384
    v_mfma_f32_16x16x32_bf16 v[88:91], a[140:143], a[72:75], v[88:91]
    ds_read_b64_tr_b16 a[10:11], v10 offset:20480
    buffer_load_dwordx4 a[116:119], v4, s[16:19], s48 offen sc1
    v_mfma_f32_16x16x32_bf16 v[92:95], a[12:15], a[68:71], v[92:95]
    ds_read_b64_tr_b16 a[136:137], v10 offset:24576
    s_add_u32 s48, s48, 1024
    v_mfma_f32_16x16x32_bf16 v[92:95], a[140:143], a[76:79], v[92:95]
    ds_read_b64_tr_b16 a[138:139], v10 offset:28672
    s_waitcnt lgkmcnt(12)
    v_mfma_f32_16x16x32_bf16 v[96:99], a[16:19], a[64:67], v[96:99]
    ds_read_b64_tr_b16 a[12:13], v11 offset:16384
    s_add_u32 m0, s47, 40960
    v_mfma_f32_16x16x32_bf16 v[96:99], a[144:147], a[72:75], v[96:99]
    ds_read_b64_tr_b16 a[14:15], v11 offset:20480
    buffer_load_dwordx4 v2, s[12:15], s44 offen lds
    v_mfma_f32_16x16x32_bf16 v[100:103], a[16:19], a[68:71], v[100:103]
    ds_read_b64_tr_b16 a[140:141], v11 offset:24576
    v_mfma_f32_16x16x32_bf16 v[100:103], a[144:147], a[76:79], v[100:103]
    ds_read_b64_tr_b16 a[142:143], v11 offset:28672
    s_waitcnt lgkmcnt(12)
    v_mfma_f32_16x16x32_bf16 v[104:107], a[20:23], a[64:67], v[104:107]
    ds_read_b64_tr_b16 a[16:17], v12 offset:16384
    s_add_u32 m0, s47, 45056
    v_mfma_f32_16x16x32_bf16 v[104:107], a[148:151], a[72:75], v[104:107]
    ds_read_b64_tr_b16 a[18:19], v12 offset:20480
    buffer_load_dwordx4 v16, s[12:15], s44 offen lds
    v_mfma_f32_16x16x32_bf16 v[108:111], a[20:23], a[68:71], v[108:111]
    ds_read_b64_tr_b16 a[144:145], v12 offset:24576
    s_add_u32 s44, s44, 65536
    v_mfma_f32_16x16x32_bf16 v[108:111], a[148:151], a[76:79], v[108:111]
    ds_read_b64_tr_b16 a[146:147], v12 offset:28672
    s_waitcnt lgkmcnt(12)
    v_mfma_f32_16x16x32_bf16 v[112:115], a[24:27], a[64:67], v[112:115]
    ds_read_b64_tr_b16 a[20:21], v13 offset:16384
    v_mfma_f32_16x16x32_bf16 v[112:115], a[152:155], a[72:75], v[112:115]
    ds_read_b64_tr_b16 a[22:23], v13 offset:20480
    buffer_load_dwordx4 a[120:123], v3, s[16:19], s48 offen sc1
    v_mfma_f32_16x16x32_bf16 v[116:119], a[24:27], a[68:71], v[116:119]
    ds_read_b64_tr_b16 a[148:149], v13 offset:24576
    v_mfma_f32_16x16x32_bf16 v[116:119], a[152:155], a[76:79], v[116:119]
    ds_read_b64_tr_b16 a[150:151], v13 offset:28672
    s_waitcnt lgkmcnt(12)
    v_mfma_f32_16x16x32_bf16 v[120:123], a[28:31], a[64:67], v[120:123]
    ds_read_b64_tr_b16 a[24:25], v14 offset:16384
    v_mfma_f32_16x16x32_bf16 v[120:123], a[156:159], a[72:75], v[120:123]
    ds_read_b64_tr_b16 a[26:27], v14 offset:20480
    buffer_load_dwordx4 a[124:127], v4, s[16:19], s48 offen sc1
    v_mfma_f32_16x16x32_bf16 v[124:127], a[28:31], a[68:71], v[124:127]
    ds_read_b64_tr_b16 a[152:153], v14 offset:24576
    s_add_u32 s48, s48, 1024
    v_mfma_f32_16x16x32_bf16 v[124:127], a[156:159], a[76:79], v[124:127]
    ds_read_b64_tr_b16 a[154:155], v14 offset:28672
    s_waitcnt vmcnt(16)
    s_barrier
    s_waitcnt lgkmcnt(12)
    v_mfma_f32_16x16x32_bf16 v[64:67], a[0:3], a[80:83], v[64:67]
    ds_read_b64_tr_b16 a[28:29], v15 offset:16384
    s_add_u32 m0, s47, 49152
    v_mfma_f32_16x16x32_bf16 v[64:67], a[128:131], a[88:91], v[64:67]
    ds_read_b64_tr_b16 a[30:31], v15 offset:20480
    buffer_load_dwordx4 v2, s[12:15], s44 offen lds
    v_mfma_f32_16x16x32_bf16 v[68:71], a[0:3], a[84:87], v[68:71]
    ds_read_b64_tr_b16 a[156:157], v15 offset:24576
    v_mfma_f32_16x16x32_bf16 v[68:71], a[128:131], a[92:95], v[68:71]
    ds_read_b64_tr_b16 a[158:159], v15 offset:28672
    s_waitcnt lgkmcnt(12)
    v_mfma_f32_16x16x32_bf16 v[72:75], a[4:7], a[80:83], v[72:75]
    ds_read_b64_tr_b16 a[0:1], v8 offset:32768
    s_add_u32 m0, s47, 53248
    v_mfma_f32_16x16x32_bf16 v[72:75], a[132:135], a[88:91], v[72:75]
    ds_read_b64_tr_b16 a[2:3], v8 offset:36864
    buffer_load_dwordx4 v16, s[12:15], s44 offen lds
    v_mfma_f32_16x16x32_bf16 v[76:79], a[4:7], a[84:87], v[76:79]
    ds_read_b64_tr_b16 a[128:129], v8 offset:40960
    s_add_u32 s44, s44, 65536
    v_mfma_f32_16x16x32_bf16 v[76:79], a[132:135], a[92:95], v[76:79]
    ds_read_b64_tr_b16 a[130:131], v8 offset:45056
    s_waitcnt lgkmcnt(12)
    v_mfma_f32_16x16x32_bf16 v[80:83], a[8:11], a[80:83], v[80:83]
    ds_read_b64_tr_b16 a[4:5], v9 offset:32768
    v_mfma_f32_16x16x32_bf16 v[80:83], a[136:139], a[88:91], v[80:83]
    ds_read_b64_tr_b16 a[6:7], v9 offset:36864
    buffer_load_dwordx4 a[64:67], v3, s[16:19], s48 offen sc1
    v_mfma_f32_16x16x32_bf16 v[84:87], a[8:11], a[84:87], v[84:87]
    ds_read_b64_tr_b16 a[132:133], v9 offset:40960
    v_mfma_f32_16x16x32_bf16 v[84:87], a[136:139], a[92:95], v[84:87]
    ds_read_b64_tr_b16 a[134:135], v9 offset:45056
    s_waitcnt lgkmcnt(12)
    v_mfma_f32_16x16x32_bf16 v[88:91], a[12:15], a[80:83], v[88:91]
    ds_read_b64_tr_b16 a[8:9], v10 offset:32768
    v_mfma_f32_16x16x32_bf16 v[88:91], a[140:143], a[88:91], v[88:91]
    ds_read_b64_tr_b16 a[10:11], v10 offset:36864
    buffer_load_dwordx4 a[68:71], v4, s[16:19], s48 offen sc1
    v_mfma_f32_16x16x32_bf16 v[92:95], a[12:15], a[84:87], v[92:95]
    ds_read_b64_tr_b16 a[136:137], v10 offset:40960
    s_add_u32 s48, s48, 1024
    v_mfma_f32_16x16x32_bf16 v[92:95], a[140:143], a[92:95], v[92:95]
    ds_read_b64_tr_b16 a[138:139], v10 offset:45056
    s_waitcnt lgkmcnt(12)
    v_mfma_f32_16x16x32_bf16 v[96:99], a[16:19], a[80:83], v[96:99]
    ds_read_b64_tr_b16 a[12:13], v11 offset:32768
    s_add_u32 m0, s47, 57344
    v_mfma_f32_16x16x32_bf16 v[96:99], a[144:147], a[88:91], v[96:99]
    ds_read_b64_tr_b16 a[14:15], v11 offset:36864
    buffer_load_dwordx4 v2, s[12:15], s44 offen lds
    v_mfma_f32_16x16x32_bf16 v[100:103], a[16:19], a[84:87], v[100:103]
    ds_read_b64_tr_b16 a[140:141], v11 offset:40960
    v_mfma_f32_16x16x32_bf16 v[100:103], a[144:147], a[92:95], v[100:103]
    ds_read_b64_tr_b16 a[142:143], v11 offset:45056
    s_waitcnt lgkmcnt(12)
    v_mfma_f32_16x16x32_bf16 v[104:107], a[20:23], a[80:83], v[104:107]
    ds_read_b64_tr_b16 a[16:17], v12 offset:32768
    s_add_u32 m0, s47, 61440
    v_mfma_f32_16x16x32_bf16 v[104:107], a[148:151], a[88:91], v[104:107]
    ds_read_b64_tr_b16 a[18:19], v12 offset:36864
    buffer_load_dwordx4 v16, s[12:15], s44 offen lds
    v_mfma_f32_16x16x32_bf16 v[108:111], a[20:23], a[84:87], v[108:111]
    ds_read_b64_tr_b16 a[144:145], v12 offset:40960
    s_add_u32 s44, s44, 65536
    v_mfma_f32_16x16x32_bf16 v[108:111], a[148:151], a[92:95], v[108:111]
    ds_read_b64_tr_b16 a[146:147], v12 offset:45056
    s_waitcnt lgkmcnt(12)
    v_mfma_f32_16x16x32_bf16 v[112:115], a[24:27], a[80:83], v[112:115]
    ds_read_b64_tr_b16 a[20:21], v13 offset:32768
    v_mfma_f32_16x16x32_bf16 v[112:115], a[152:155], a[88:91], v[112:115]
    ds_read_b64_tr_b16 a[22:23], v13 offset:36864
    buffer_load_dwordx4 a[72:75], v3, s[16:19], s48 offen sc1
    v_mfma_f32_16x16x32_bf16 v[116:119], a[24:27], a[84:87], v[116:119]
    ds_read_b64_tr_b16 a[148:149], v13 offset:40960
    v_mfma_f32_16x16x32_bf16 v[116:119], a[152:155], a[92:95], v[116:119]
    ds_read_b64_tr_b16 a[150:151], v13 offset:45056
    s_waitcnt lgkmcnt(12)
    v_mfma_f32_16x16x32_bf16 v[120:123], a[28:31], a[80:83], v[120:123]
    ds_read_b64_tr_b16 a[24:25], v14 offset:32768
    v_mfma_f32_16x16x32_bf16 v[120:123], a[156:159], a[88:91], v[120:123]
    ds_read_b64_tr_b16 a[26:27], v14 offset:36864
    buffer_load_dwordx4 a[76:79], v4, s[16:19], s48 offen sc1
    v_mfma_f32_16x16x32_bf16 v[124:127], a[28:31], a[84:87], v[124:127]
    ds_read_b64_tr_b16 a[152:153], v14 offset:40960
    s_add_u32 s48, s48, 1024
    v_mfma_f32_16x16x32_bf16 v[124:127], a[156:159], a[92:95], v[124:127]
    ds_read_b64_tr_b16 a[154:155], v14 offset:45056
    s_waitcnt vmcnt(16)
    s_waitcnt lgkmcnt(12)
    v_mfma_f32_16x16x32_bf16 v[64:67], a[0:3], a[96:99], v[64:67]
    ds_read_b64_tr_b16 a[28:29], v15 offset:32768
    v_mfma_f32_16x16x32_bf16 v[64:67], a[128:131], a[104:107], v[64:67]
    ds_read_b64_tr_b16 a[30:31], v15 offset:36864
    v_mfma_f32_16x16x32_bf16 v[68:71], a[0:3], a[100:103], v[68:71]
    ds_read_b64_tr_b16 a[156:157], v15 offset:40960
    v_mfma_f32_16x16x32_bf16 v[68:71], a[128:131], a[108:111], v[68:71]
    ds_read_b64_tr_b16 a[158:159], v15 offset:45056
    s_waitcnt lgkmcnt(12)
    v_mfma_f32_16x16x32_bf16 v[72:75], a[4:7], a[96:99], v[72:75]
    ds_read_b64_tr_b16 a[0:1], v8 offset:49152
    v_mfma_f32_16x16x32_bf16 v[72:75], a[132:135], a[104:107], v[72:75]
    ds_read_b64_tr_b16 a[2:3], v8 offset:53248
    v_mfma_f32_16x16x32_bf16 v[76:79], a[4:7], a[100:103], v[76:79]
    ds_read_b64_tr_b16 a[128:129], v8 offset:57344
    v_mfma_f32_16x16x32_bf16 v[76:79], a[132:135], a[108:111], v[76:79]
    ds_read_b64_tr_b16 a[130:131], v8 offset:61440
    s_waitcnt lgkmcnt(12)
    v_mfma_f32_16x16x32_bf16 v[80:83], a[8:11], a[96:99], v[80:83]
    ds_read_b64_tr_b16 a[4:5], v9 offset:49152
    v_mfma_f32_16x16x32_bf16 v[80:83], a[136:139], a[104:107], v[80:83]
    ds_read_b64_tr_b16 a[6:7], v9 offset:53248
    buffer_load_dwordx4 a[80:83], v3, s[16:19], s48 offen sc1
    v_mfma_f32_16x16x32_bf16 v[84:87], a[8:11], a[100:103], v[84:87]
    ds_read_b64_tr_b16 a[132:133], v9 offset:57344
    v_mfma_f32_16x16x32_bf16 v[84:87], a[136:139], a[108:111], v[84:87]
    ds_read_b64_tr_b16 a[134:135], v9 offset:61440
    s_waitcnt lgkmcnt(12)
    v_mfma_f32_16x16x32_bf16 v[88:91], a[12:15], a[96:99], v[88:91]
    ds_read_b64_tr_b16 a[8:9], v10 offset:49152
    v_mfma_f32_16x16x32_bf16 v[88:91], a[140:143], a[104:107], v[88:91]
    ds_read_b64_tr_b16 a[10:11], v10 offset:53248
    buffer_load_dwordx4 a[84:87], v4, s[16:19], s48 offen sc1
    v_mfma_f32_16x16x32_bf16 v[92:95], a[12:15], a[100:103], v[92:95]
    ds_read_b64_tr_b16 a[136:137], v10 offset:57344
    s_add_u32 s48, s48, 1024
    v_mfma_f32_16x16x32_bf16 v[92:95], a[140:143], a[108:111], v[92:95]
    ds_read_b64_tr_b16 a[138:139], v10 offset:61440
    s_waitcnt lgkmcnt(12)
    v_mfma_f32_16x16x32_bf16 v[96:99], a[16:19], a[96:99], v[96:99]
    ds_read_b64_tr_b16 a[12:13], v11 offset:49152
    v_mfma_f32_16x16x32_bf16 v[96:99], a[144:147], a[104:107], v[96:99]
    ds_read_b64_tr_b16 a[14:15], v11 offset:53248
    v_mfma_f32_16x16x32_bf16 v[100:103], a[16:19], a[100:103], v[100:103]
    ds_read_b64_tr_b16 a[140:141], v11 offset:57344
    v_mfma_f32_16x16x32_bf16 v[100:103], a[144:147], a[108:111], v[100:103]
    ds_read_b64_tr_b16 a[142:143], v11 offset:61440
    s_waitcnt lgkmcnt(12)
    v_mfma_f32_16x16x32_bf16 v[104:107], a[20:23], a[96:99], v[104:107]
    ds_read_b64_tr_b16 a[16:17], v12 offset:49152
    v_mfma_f32_16x16x32_bf16 v[104:107], a[148:151], a[104:107], v[104:107]
    ds_read_b64_tr_b16 a[18:19], v12 offset:53248
    v_mfma_f32_16x16x32_bf16 v[108:111], a[20:23], a[100:103], v[108:111]
    ds_read_b64_tr_b16 a[144:145], v12 offset:57344
    v_mfma_f32_16x16x32_bf16 v[108:111], a[148:151], a[108:111], v[108:111]
    ds_read_b64_tr_b16 a[146:147], v12 offset:61440
    s_waitcnt lgkmcnt(12)
    v_mfma_f32_16x16x32_bf16 v[112:115], a[24:27], a[96:99], v[112:115]
    ds_read_b64_tr_b16 a[20:21], v13 offset:49152
    v_mfma_f32_16x16x32_bf16 v[112:115], a[152:155], a[104:107], v[112:115]
    ds_read_b64_tr_b16 a[22:23], v13 offset:53248
    buffer_load_dwordx4 a[88:91], v3, s[16:19], s48 offen sc1
    v_mfma_f32_16x16x32_bf16 v[116:119], a[24:27], a[100:103], v[116:119]
    ds_read_b64_tr_b16 a[148:149], v13 offset:57344
    v_mfma_f32_16x16x32_bf16 v[116:119], a[152:155], a[108:111], v[116:119]
    ds_read_b64_tr_b16 a[150:151], v13 offset:61440
    s_waitcnt lgkmcnt(12)
    v_mfma_f32_16x16x32_bf16 v[120:123], a[28:31], a[96:99], v[120:123]
    ds_read_b64_tr_b16 a[24:25], v14 offset:49152
    v_mfma_f32_16x16x32_bf16 v[120:123], a[156:159], a[104:107], v[120:123]
    ds_read_b64_tr_b16 a[26:27], v14 offset:53248
    buffer_load_dwordx4 a[92:95], v4, s[16:19], s48 offen sc1
    v_mfma_f32_16x16x32_bf16 v[124:127], a[28:31], a[100:103], v[124:127]
    ds_read_b64_tr_b16 a[152:153], v14 offset:57344
    s_add_u32 s48, s48, 1024
    v_mfma_f32_16x16x32_bf16 v[124:127], a[156:159], a[108:111], v[124:127]
    ds_read_b64_tr_b16 a[154:155], v14 offset:61440
    s_waitcnt vmcnt(12)
    s_barrier
    s_waitcnt lgkmcnt(12)
    v_mfma_f32_16x16x32_bf16 v[64:67], a[0:3], a[112:115], v[64:67]
    ds_read_b64_tr_b16 a[28:29], v15 offset:49152
    v_mfma_f32_16x16x32_bf16 v[64:67], a[128:131], a[120:123], v[64:67]
    ds_read_b64_tr_b16 a[30:31], v15 offset:53248
    v_mfma_f32_16x16x32_bf16 v[68:71], a[0:3], a[116:119], v[68:71]
    ds_read_b64_tr_b16 a[156:157], v15 offset:57344
    v_mfma_f32_16x16x32_bf16 v[68:71], a[128:131], a[124:127], v[68:71]
    ds_read_b64_tr_b16 a[158:159], v15 offset:61440
    v_xor_b32 v8, 0x10000, v8
    s_waitcnt lgkmcnt(12)
    v_mfma_f32_16x16x32_bf16 v[72:75], a[4:7], a[112:115], v[72:75]
    ds_read_b64_tr_b16 a[0:1], v8 offset:0
    v_mfma_f32_16x16x32_bf16 v[72:75], a[132:135], a[120:123], v[72:75]
    ds_read_b64_tr_b16 a[2:3], v8 offset:4096
    v_mfma_f32_16x16x32_bf16 v[76:79], a[4:7], a[116:119], v[76:79]
    v_mfma_f32_16x16x32_bf16 v[76:79], a[132:135], a[124:127], v[76:79]
    v_xor_b32 v9, 0x10000, v9
    s_waitcnt lgkmcnt(12)
    v_mfma_f32_16x16x32_bf16 v[80:83], a[8:11], a[112:115], v[80:83]
    ds_read_b64_tr_b16 a[4:5], v9 offset:0
    v_mfma_f32_16x16x32_bf16 v[80:83], a[136:139], a[120:123], v[80:83]
    ds_read_b64_tr_b16 a[6:7], v9 offset:4096
    buffer_load_dwordx4 a[96:99], v3, s[16:19], s48 offen sc1
    v_mfma_f32_16x16x32_bf16 v[84:87], a[8:11], a[116:119], v[84:87]
    v_mfma_f32_16x16x32_bf16 v[84:87], a[136:139], a[124:127], v[84:87]
    v_xor_b32 v10, 0x10000, v10
    s_waitcnt lgkmcnt(12)
    v_mfma_f32_16x16x32_bf16 v[88:91], a[12:15], a[112:115], v[88:91]
    ds_read_b64_tr_b16 a[8:9], v10 offset:0
    v_mfma_f32_16x16x32_bf16 v[88:91], a[140:143], a[120:123], v[88:91]
    ds_read_b64_tr_b16 a[10:11], v10 offset:4096
    buffer_load_dwordx4 a[100:103], v4, s[16:19], s48 offen sc1
    v_mfma_f32_16x16x32_bf16 v[92:95], a[12:15], a[116:119], v[92:95]
    s_add_u32 s48, s48, 1024
    v_mfma_f32_16x16x32_bf16 v[92:95], a[140:143], a[124:127], v[92:95]
    v_xor_b32 v11, 0x10000, v11
    s_waitcnt lgkmcnt(6)
    v_mfma_f32_16x16x32_bf16 v[96:99], a[16:19], a[112:115], v[96:99]
    ds_read_b64_tr_b16 a[12:13], v11 offset:0
    v_mfma_f32_16x16x32_bf16 v[96:99], a[144:147], a[120:123], v[96:99]
    ds_read_b64_tr_b16 a[14:15], v11 offset:4096
    v_mfma_f32_16x16x32_bf16 v[100:103], a[16:19], a[116:119], v[100:103]
    v_mfma_f32_16x16x32_bf16 v[100:103], a[144:147], a[124:127], v[100:103]
    v_xor_b32 v12, 0x10000, v12
    s_waitcnt lgkmcnt(6)
    v_mfma_f32_16x16x32_bf16 v[104:107], a[20:23], a[112:115], v[104:107]
    ds_read_b64_tr_b16 a[16:17], v12 offset:0
    v_mfma_f32_16x16x32_bf16 v[104:107], a[148:151], a[120:123], v[104:107]
    ds_read_b64_tr_b16 a[18:19], v12 offset:4096
    v_mfma_f32_16x16x32_bf16 v[108:111], a[20:23], a[116:119], v[108:111]
    v_mfma_f32_16x16x32_bf16 v[108:111], a[148:151], a[124:127], v[108:111]
    v_xor_b32 v13, 0x10000, v13
    s_waitcnt lgkmcnt(6)
    v_mfma_f32_16x16x32_bf16 v[112:115], a[24:27], a[112:115], v[112:115]
    ds_read_b64_tr_b16 a[20:21], v13 offset:0
    v_mfma_f32_16x16x32_bf16 v[112:115], a[152:155], a[120:123], v[112:115]
    ds_read_b64_tr_b16 a[22:23], v13 offset:4096
    buffer_load_dwordx4 a[104:107], v3, s[16:19], s48 offen sc1
    v_mfma_f32_16x16x32_bf16 v[116:119], a[24:27], a[116:119], v[116:119]
    v_mfma_f32_16x16x32_bf16 v[116:119], a[152:155], a[124:127], v[116:119]
    v_xor_b32 v14, 0x10000, v14
    s_xor_b32 s47, s47, 0x10000
    s_waitcnt lgkmcnt(6)
    v_mfma_f32_16x16x32_bf16 v[120:123], a[28:31], a[112:115], v[120:123]
    ds_read_b64_tr_b16 a[24:25], v14 offset:0
    s_xor_b32 s51, s51, 0x10000
    v_mfma_f32_16x16x32_bf16 v[120:123], a[156:159], a[120:123], v[120:123]
    ds_read_b64_tr_b16 a[26:27], v14 offset:4096
    buffer_load_dwordx4 a[108:111], v4, s[16:19], s48 offen sc1
    v_mfma_f32_16x16x32_bf16 v[124:127], a[28:31], a[116:119], v[124:127]
    s_add_u32 s48, s48, 1024
    v_mfma_f32_16x16x32_bf16 v[124:127], a[156:159], a[124:127], v[124:127]
    v_xor_b32 v15, 0x10000, v15
    s_lshl_b32 s52, s43, 22
    s_waitcnt vmcnt(12)
    ds_read_b64_tr_b16 a[28:29], v15 offset:0
    ds_read_b64_tr_b16 a[30:31], v15 offset:4096
    s_waitcnt lgkmcnt(6)
    v_mfma_f32_16x16x32_bf16 v[96:99], a[16:19], a[64:67], v[96:99]
    ds_read_b64_tr_b16 a[144:145], v12 offset:8192
    v_mfma_f32_16x16x32_bf16 v[100:103], a[16:19], a[68:71], v[100:103]
    ds_read_b64_tr_b16 a[146:147], v12 offset:12288
    buffer_load_dwordx4 a[112:115], v3, s[16:19], s48 offen sc1
    s_waitcnt lgkmcnt(6)
    v_mfma_f32_16x16x32_bf16 v[104:107], a[20:23], a[64:67], v[104:107]
    ds_read_b64_tr_b16 a[148:149], v13 offset:8192
    v_mfma_f32_16x16x32_bf16 v[108:111], a[20:23], a[68:71], v[108:111]
    ds_read_b64_tr_b16 a[150:151], v13 offset:12288
    s_waitcnt lgkmcnt(6)
    v_mfma_f32_16x16x32_bf16 v[112:115], a[24:27], a[64:67], v[112:115]
    ds_read_b64_tr_b16 a[152:153], v14 offset:8192
    v_mfma_f32_16x16x32_bf16 v[116:119], a[24:27], a[68:71], v[116:119]
    ds_read_b64_tr_b16 a[154:155], v14 offset:12288
    buffer_load_dwordx4 a[116:119], v4, s[16:19], s48 offen sc1
    s_waitcnt lgkmcnt(6)
    v_mfma_f32_16x16x32_bf16 v[120:123], a[28:31], a[64:67], v[120:123]
    ds_read_b64_tr_b16 a[156:157], v15 offset:8192
    s_add_u32 s48, s48, 1024
    v_mfma_f32_16x16x32_bf16 v[124:127], a[28:31], a[68:71], v[124:127]
    ds_read_b64_tr_b16 a[158:159], v15 offset:12288
    s_waitcnt vmcnt(10)
    s_waitcnt lgkmcnt(6)
    v_mfma_f32_16x16x32_bf16 v[96:99], a[144:147], a[72:75], v[96:99]
    ds_read_b64_tr_b16 a[16:17], v12 offset:16384
    v_mfma_f32_16x16x32_bf16 v[100:103], a[144:147], a[76:79], v[100:103]
    ds_read_b64_tr_b16 a[18:19], v12 offset:20480
    buffer_load_dwordx4 a[120:123], v3, s[16:19], s48 offen sc1
    s_waitcnt lgkmcnt(6)
    v_mfma_f32_16x16x32_bf16 v[104:107], a[148:151], a[72:75], v[104:107]
    ds_read_b64_tr_b16 a[20:21], v13 offset:16384
    v_mfma_f32_16x16x32_bf16 v[108:111], a[148:151], a[76:79], v[108:111]
    ds_read_b64_tr_b16 a[22:23], v13 offset:20480
    s_waitcnt lgkmcnt(6)
    v_mfma_f32_16x16x32_bf16 v[112:115], a[152:155], a[72:75], v[112:115]
    ds_read_b64_tr_b16 a[24:25], v14 offset:16384
    v_mfma_f32_16x16x32_bf16 v[116:119], a[152:155], a[76:79], v[116:119]
    ds_read_b64_tr_b16 a[26:27], v14 offset:20480
    buffer_load_dwordx4 a[124:127], v4, s[16:19], s48 offen sc1
    s_waitcnt lgkmcnt(6)
    v_mfma_f32_16x16x32_bf16 v[120:123], a[156:159], a[72:75], v[120:123]
    ds_read_b64_tr_b16 a[28:29], v15 offset:16384
    s_add_u32 s48, s48, 1024
    v_mfma_f32_16x16x32_bf16 v[124:127], a[156:159], a[76:79], v[124:127]
    ds_read_b64_tr_b16 a[30:31], v15 offset:20480
    s_waitcnt vmcnt(10)
    s_waitcnt lgkmcnt(6)
    v_mfma_f32_16x16x32_bf16 v[96:99], a[16:19], a[80:83], v[96:99]
    ds_read_b64_tr_b16 a[144:145], v12 offset:24576
    v_mfma_f32_16x16x32_bf16 v[100:103], a[16:19], a[84:87], v[100:103]
    ds_read_b64_tr_b16 a[146:147], v12 offset:28672
    s_waitcnt lgkmcnt(6)
    v_mfma_f32_16x16x32_bf16 v[104:107], a[20:23], a[80:83], v[104:107]
    ds_read_b64_tr_b16 a[148:149], v13 offset:24576
    v_mfma_f32_16x16x32_bf16 v[108:111], a[20:23], a[84:87], v[108:111]
    ds_read_b64_tr_b16 a[150:151], v13 offset:28672
    s_waitcnt lgkmcnt(6)
    v_mfma_f32_16x16x32_bf16 v[112:115], a[24:27], a[80:83], v[112:115]
    ds_read_b64_tr_b16 a[152:153], v14 offset:24576
    v_mfma_f32_16x16x32_bf16 v[116:119], a[24:27], a[84:87], v[116:119]
    ds_read_b64_tr_b16 a[154:155], v14 offset:28672
    s_waitcnt lgkmcnt(6)
    v_mfma_f32_16x16x32_bf16 v[120:123], a[28:31], a[80:83], v[120:123]
    ds_read_b64_tr_b16 a[156:157], v15 offset:24576
    v_mfma_f32_16x16x32_bf16 v[124:127], a[28:31], a[84:87], v[124:127]
    ds_read_b64_tr_b16 a[158:159], v15 offset:28672
    s_waitcnt vmcnt(8)
    s_barrier
    s_waitcnt lgkmcnt(6)
    v_mfma_f32_16x16x32_bf16 v[96:99], a[144:147], a[88:91], v[96:99]
    ds_read_b64_tr_b16 a[16:17], v12 offset:32768
    v_mfma_f32_16x16x32_bf16 v[100:103], a[144:147], a[92:95], v[100:103]
    ds_read_b64_tr_b16 a[18:19], v12 offset:36864
    s_waitcnt lgkmcnt(6)
    v_mfma_f32_16x16x32_bf16 v[104:107], a[148:151], a[88:91], v[104:107]
    ds_read_b64_tr_b16 a[20:21], v13 offset:32768
    v_mfma_f32_16x16x32_bf16 v[108:111], a[148:151], a[92:95], v[108:111]
    ds_read_b64_tr_b16 a[22:23], v13 offset:36864
    s_waitcnt lgkmcnt(6)
    v_mfma_f32_16x16x32_bf16 v[112:115], a[152:155], a[88:91], v[112:115]
    ds_read_b64_tr_b16 a[24:25], v14 offset:32768
    v_mfma_f32_16x16x32_bf16 v[116:119], a[152:155], a[92:95], v[116:119]
    ds_read_b64_tr_b16 a[26:27], v14 offset:36864
    s_waitcnt lgkmcnt(6)
    v_mfma_f32_16x16x32_bf16 v[120:123], a[156:159], a[88:91], v[120:123]
    ds_read_b64_tr_b16 a[28:29], v15 offset:32768
    v_mfma_f32_16x16x32_bf16 v[124:127], a[156:159], a[92:95], v[124:127]
    ds_read_b64_tr_b16 a[30:31], v15 offset:36864
    s_waitcnt vmcnt(6)
    s_waitcnt lgkmcnt(6)
    v_mfma_f32_16x16x32_bf16 v[96:99], a[16:19], a[96:99], v[96:99]
    ds_read_b64_tr_b16 a[144:145], v12 offset:40960
    v_mfma_f32_16x16x32_bf16 v[100:103], a[16:19], a[100:103], v[100:103]
    ds_read_b64_tr_b16 a[146:147], v12 offset:45056
    s_waitcnt lgkmcnt(6)
    v_mfma_f32_16x16x32_bf16 v[104:107], a[20:23], a[96:99], v[104:107]
    ds_read_b64_tr_b16 a[148:149], v13 offset:40960
    v_mfma_f32_16x16x32_bf16 v[108:111], a[20:23], a[100:103], v[108:111]
    ds_read_b64_tr_b16 a[150:151], v13 offset:45056
    s_waitcnt lgkmcnt(6)
    v_mfma_f32_16x16x32_bf16 v[112:115], a[24:27], a[96:99], v[112:115]
    ds_read_b64_tr_b16 a[152:153], v14 offset:40960
    v_mfma_f32_16x16x32_bf16 v[116:119], a[24:27], a[100:103], v[116:119]
    ds_read_b64_tr_b16 a[154:155], v14 offset:45056
    s_waitcnt lgkmcnt(6)
    v_mfma_f32_16x16x32_bf16 v[120:123], a[28:31], a[96:99], v[120:123]
    ds_read_b64_tr_b16 a[156:157], v15 offset:40960
    v_mfma_f32_16x16x32_bf16 v[124:127], a[28:31], a[100:103], v[124:127]
    ds_read_b64_tr_b16 a[158:159], v15 offset:45056
    s_waitcnt vmcnt(4)
    s_waitcnt lgkmcnt(6)
    v_mfma_f32_16x16x32_bf16 v[96:99], a[144:147], a[104:107], v[96:99]
    ds_read_b64_tr_b16 a[16:17], v12 offset:49152
    v_mfma_f32_16x16x32_bf16 v[100:103], a[144:147], a[108:111], v[100:103]
    ds_read_b64_tr_b16 a[18:19], v12 offset:53248
    s_waitcnt lgkmcnt(6)
    v_mfma_f32_16x16x32_bf16 v[104:107], a[148:151], a[104:107], v[104:107]
    ds_read_b64_tr_b16 a[20:21], v13 offset:49152
    v_mfma_f32_16x16x32_bf16 v[108:111], a[148:151], a[108:111], v[108:111]
    ds_read_b64_tr_b16 a[22:23], v13 offset:53248
    s_waitcnt lgkmcnt(6)
    v_mfma_f32_16x16x32_bf16 v[112:115], a[152:155], a[104:107], v[112:115]
    ds_read_b64_tr_b16 a[24:25], v14 offset:49152
    v_mfma_f32_16x16x32_bf16 v[116:119], a[152:155], a[108:111], v[116:119]
    ds_read_b64_tr_b16 a[26:27], v14 offset:53248
    s_waitcnt lgkmcnt(6)
    v_mfma_f32_16x16x32_bf16 v[120:123], a[156:159], a[104:107], v[120:123]
    ds_read_b64_tr_b16 a[28:29], v15 offset:49152
    v_mfma_f32_16x16x32_bf16 v[124:127], a[156:159], a[108:111], v[124:127]
    ds_read_b64_tr_b16 a[30:31], v15 offset:53248
    s_waitcnt vmcnt(2)
    s_waitcnt lgkmcnt(6)
    v_mfma_f32_16x16x32_bf16 v[96:99], a[16:19], a[112:115], v[96:99]
    ds_read_b64_tr_b16 a[144:145], v12 offset:57344
    v_mfma_f32_16x16x32_bf16 v[100:103], a[16:19], a[116:119], v[100:103]
    ds_read_b64_tr_b16 a[146:147], v12 offset:61440
    s_waitcnt lgkmcnt(6)
    v_mfma_f32_16x16x32_bf16 v[104:107], a[20:23], a[112:115], v[104:107]
    ds_read_b64_tr_b16 a[148:149], v13 offset:57344
    v_mfma_f32_16x16x32_bf16 v[108:111], a[20:23], a[116:119], v[108:111]
    ds_read_b64_tr_b16 a[150:151], v13 offset:61440
    s_waitcnt lgkmcnt(6)
    v_mfma_f32_16x16x32_bf16 v[112:115], a[24:27], a[112:115], v[112:115]
    ds_read_b64_tr_b16 a[152:153], v14 offset:57344
    v_mfma_f32_16x16x32_bf16 v[116:119], a[24:27], a[116:119], v[116:119]
    ds_read_b64_tr_b16 a[154:155], v14 offset:61440
    s_waitcnt lgkmcnt(6)
    v_mfma_f32_16x16x32_bf16 v[120:123], a[28:31], a[112:115], v[120:123]
    ds_read_b64_tr_b16 a[156:157], v15 offset:57344
    v_mfma_f32_16x16x32_bf16 v[124:127], a[28:31], a[116:119], v[124:127]
    ds_read_b64_tr_b16 a[158:159], v15 offset:61440
    s_waitcnt vmcnt(0)
    s_waitcnt lgkmcnt(6)
    v_mfma_f32_16x16x32_bf16 v[96:99], a[144:147], a[120:123], v[96:99]
    v_mfma_f32_16x16x32_bf16 v[100:103], a[144:147], a[124:127], v[100:103]
    s_waitcnt lgkmcnt(4)
    v_mfma_f32_16x16x32_bf16 v[104:107], a[148:151], a[120:123], v[104:107]
    v_mfma_f32_16x16x32_bf16 v[108:111], a[148:151], a[124:127], v[108:111]
    s_waitcnt lgkmcnt(2)
    v_mfma_f32_16x16x32_bf16 v[112:115], a[152:155], a[120:123], v[112:115]
    v_mfma_f32_16x16x32_bf16 v[116:119], a[152:155], a[124:127], v[116:119]
    s_waitcnt lgkmcnt(0)
    v_mfma_f32_16x16x32_bf16 v[120:123], a[156:159], a[120:123], v[120:123]
    v_mfma_f32_16x16x32_bf16 v[124:127], a[156:159], a[124:127], v[124:127]
    v_mfma_f32_16x16x32_bf16 v[64:67], a[0:3], a[64:67], v[64:67]
    ds_read_b64_tr_b16 a[128:129], v8 offset:8192
    v_mfma_f32_16x16x32_bf16 v[68:71], a[0:3], a[68:71], v[68:71]
    ds_read_b64_tr_b16 a[130:131], v8 offset:12288
    v_mfma_f32_16x16x32_bf16 v[72:75], a[4:7], a[64:67], v[72:75]
    ds_read_b64_tr_b16 a[132:133], v9 offset:8192
    v_mfma_f32_16x16x32_bf16 v[76:79], a[4:7], a[68:71], v[76:79]
    ds_read_b64_tr_b16 a[134:135], v9 offset:12288
    v_mfma_f32_16x16x32_bf16 v[80:83], a[8:11], a[64:67], v[80:83]
    ds_read_b64_tr_b16 a[136:137], v10 offset:8192
    v_mfma_f32_16x16x32_bf16 v[84:87], a[8:11], a[68:71], v[84:87]
    ds_read_b64_tr_b16 a[138:139], v10 offset:12288
    v_mfma_f32_16x16x32_bf16 v[88:91], a[12:15], a[64:67], v[88:91]
    ds_read_b64_tr_b16 a[140:141], v11 offset:8192
    v_mfma_f32_16x16x32_bf16 v[92:95], a[12:15], a[68:71], v[92:95]
    ds_read_b64_tr_b16 a[142:143], v11 offset:12288
    s_waitcnt lgkmcnt(6)
    v_mfma_f32_16x16x32_bf16 v[64:67], a[128:131], a[72:75], v[64:67]
    ds_read_b64_tr_b16 a[0:1], v8 offset:16384
    v_permlane16_swap_b32 v96, v104
    v_mfma_f32_16x16x32_bf16 v[68:71], a[128:131], a[76:79], v[68:71]
    ds_read_b64_tr_b16 a[2:3], v8 offset:20480
    v_permlane16_swap_b32 v97, v105
    s_waitcnt lgkmcnt(6)
    v_mfma_f32_16x16x32_bf16 v[72:75], a[132:135], a[72:75], v[72:75]
    ds_read_b64_tr_b16 a[4:5], v9 offset:16384
    v_permlane16_swap_b32 v98, v106
    v_mfma_f32_16x16x32_bf16 v[76:79], a[132:135], a[76:79], v[76:79]
    ds_read_b64_tr_b16 a[6:7], v9 offset:20480
    v_permlane16_swap_b32 v99, v107
    s_waitcnt lgkmcnt(6)
    v_mfma_f32_16x16x32_bf16 v[80:83], a[136:139], a[72:75], v[80:83]
    ds_read_b64_tr_b16 a[8:9], v10 offset:16384
    v_cvt_pk_bf16_f32 v20, v96, v97
    v_mfma_f32_16x16x32_bf16 v[84:87], a[136:139], a[76:79], v[84:87]
    ds_read_b64_tr_b16 a[10:11], v10 offset:20480
    v_cvt_pk_bf16_f32 v21, v98, v99
    s_waitcnt lgkmcnt(6)
    v_mfma_f32_16x16x32_bf16 v[88:91], a[140:143], a[72:75], v[88:91]
    ds_read_b64_tr_b16 a[12:13], v11 offset:16384
    v_cvt_pk_bf16_f32 v22, v104, v105
    v_mfma_f32_16x16x32_bf16 v[92:95], a[140:143], a[76:79], v[92:95]
    ds_read_b64_tr_b16 a[14:15], v11 offset:20480
    v_cvt_pk_bf16_f32 v23, v106, v107
    s_add_u32 s53, s52, 128
    buffer_store_dwordx4 v[20:23], v5, s[24:27], s53 offen sc1
    s_waitcnt lgkmcnt(6)
    v_mfma_f32_16x16x32_bf16 v[64:67], a[0:3], a[80:83], v[64:67]
    ds_read_b64_tr_b16 a[128:129], v8 offset:24576
    v_permlane16_swap_b32 v100, v108
    v_mfma_f32_16x16x32_bf16 v[68:71], a[0:3], a[84:87], v[68:71]
    ds_read_b64_tr_b16 a[130:131], v8 offset:28672
    v_permlane16_swap_b32 v101, v109
    s_waitcnt lgkmcnt(6)
    v_mfma_f32_16x16x32_bf16 v[72:75], a[4:7], a[80:83], v[72:75]
    ds_read_b64_tr_b16 a[132:133], v9 offset:24576
    v_permlane16_swap_b32 v102, v110
    v_mfma_f32_16x16x32_bf16 v[76:79], a[4:7], a[84:87], v[76:79]
    ds_read_b64_tr_b16 a[134:135], v9 offset:28672
    v_permlane16_swap_b32 v103, v111
    s_waitcnt lgkmcnt(6)
    v_mfma_f32_16x16x32_bf16 v[80:83], a[8:11], a[80:83], v[80:83]
    ds_read_b64_tr_b16 a[136:137], v10 offset:24576
    v_cvt_pk_bf16_f32 v24, v100, v101
    v_mfma_f32_16x16x32_bf16 v[84:87], a[8:11], a[84:87], v[84:87]
    ds_read_b64_tr_b16 a[138:139], v10 offset:28672
    v_cvt_pk_bf16_f32 v25, v102, v103
    s_waitcnt lgkmcnt(6)
    v_mfma_f32_16x16x32_bf16 v[88:91], a[12:15], a[80:83], v[88:91]
    ds_read_b64_tr_b16 a[140:141], v11 offset:24576
    v_cvt_pk_bf16_f32 v26, v108, v109
    v_mfma_f32_16x16x32_bf16 v[92:95], a[12:15], a[84:87], v[92:95]
    ds_read_b64_tr_b16 a[142:143], v11 offset:28672
    v_cvt_pk_bf16_f32 v27, v110, v111
    s_add_u32 s53, s52, 32896
    buffer_store_dwordx4 v[24:27], v5, s[24:27], s53 offen sc1
    s_waitcnt lgkmcnt(6)
    v_mfma_f32_16x16x32_bf16 v[64:67], a[128:131], a[88:91], v[64:67]
    ds_read_b64_tr_b16 a[0:1], v8 offset:32768
    v_permlane16_swap_b32 v112, v120
    v_mfma_f32_16x16x32_bf16 v[68:71], a[128:131], a[92:95], v[68:71]
    ds_read_b64_tr_b16 a[2:3], v8 offset:36864
    v_permlane16_swap_b32 v113, v121
    s_waitcnt lgkmcnt(6)
    v_mfma_f32_16x16x32_bf16 v[72:75], a[132:135], a[88:91], v[72:75]
    ds_read_b64_tr_b16 a[4:5], v9 offset:32768
    v_permlane16_swap_b32 v114, v122
    v_mfma_f32_16x16x32_bf16 v[76:79], a[132:135], a[92:95], v[76:79]
    ds_read_b64_tr_b16 a[6:7], v9 offset:36864
    v_permlane16_swap_b32 v115, v123
    s_waitcnt lgkmcnt(6)
    v_mfma_f32_16x16x32_bf16 v[80:83], a[136:139], a[88:91], v[80:83]
    ds_read_b64_tr_b16 a[8:9], v10 offset:32768
    v_cvt_pk_bf16_f32 v28, v112, v113
    v_mfma_f32_16x16x32_bf16 v[84:87], a[136:139], a[92:95], v[84:87]
    ds_read_b64_tr_b16 a[10:11], v10 offset:36864
    v_cvt_pk_bf16_f32 v29, v114, v115
    s_waitcnt lgkmcnt(6)
    v_mfma_f32_16x16x32_bf16 v[88:91], a[140:143], a[88:91], v[88:91]
    ds_read_b64_tr_b16 a[12:13], v11 offset:32768
    v_cvt_pk_bf16_f32 v30, v120, v121
    v_mfma_f32_16x16x32_bf16 v[92:95], a[140:143], a[92:95], v[92:95]
    ds_read_b64_tr_b16 a[14:15], v11 offset:36864
    v_cvt_pk_bf16_f32 v31, v122, v123
    s_add_u32 s53, s52, 192
    buffer_store_dwordx4 v[28:31], v5, s[24:27], s53 offen sc1
    s_waitcnt lgkmcnt(6)
    v_mfma_f32_16x16x32_bf16 v[64:67], a[0:3], a[96:99], v[64:67]
    ds_read_b64_tr_b16 a[128:129], v8 offset:40960
    v_permlane16_swap_b32 v116, v124
    v_mfma_f32_16x16x32_bf16 v[68:71], a[0:3], a[100:103], v[68:71]
    ds_read_b64_tr_b16 a[130:131], v8 offset:45056
    v_permlane16_swap_b32 v117, v125
    s_waitcnt lgkmcnt(6)
    v_mfma_f32_16x16x32_bf16 v[72:75], a[4:7], a[96:99], v[72:75]
    ds_read_b64_tr_b16 a[132:133], v9 offset:40960
    v_permlane16_swap_b32 v118, v126
    v_mfma_f32_16x16x32_bf16 v[76:79], a[4:7], a[100:103], v[76:79]
    ds_read_b64_tr_b16 a[134:135], v9 offset:45056
    v_permlane16_swap_b32 v119, v127
    s_waitcnt lgkmcnt(6)
    v_mfma_f32_16x16x32_bf16 v[80:83], a[8:11], a[96:99], v[80:83]
    ds_read_b64_tr_b16 a[136:137], v10 offset:40960
    v_cvt_pk_bf16_f32 v32, v116, v117
    v_mfma_f32_16x16x32_bf16 v[84:87], a[8:11], a[100:103], v[84:87]
    ds_read_b64_tr_b16 a[138:139], v10 offset:45056
    v_cvt_pk_bf16_f32 v33, v118, v119
    s_waitcnt lgkmcnt(6)
    v_mfma_f32_16x16x32_bf16 v[88:91], a[12:15], a[96:99], v[88:91]
    ds_read_b64_tr_b16 a[140:141], v11 offset:40960
    v_cvt_pk_bf16_f32 v34, v124, v125
    v_mfma_f32_16x16x32_bf16 v[92:95], a[12:15], a[100:103], v[92:95]
    ds_read_b64_tr_b16 a[142:143], v11 offset:45056
    v_cvt_pk_bf16_f32 v35, v126, v127
    s_add_u32 s53, s52, 32960
    buffer_store_dwordx4 v[32:35], v5, s[24:27], s53 offen sc1
    s_waitcnt lgkmcnt(6)
    v_mfma_f32_16x16x32_bf16 v[64:67], a[128:131], a[104:107], v[64:67]
    ds_read_b64_tr_b16 a[0:1], v8 offset:49152
    v_mfma_f32_16x16x32_bf16 v[68:71], a[128:131], a[108:111], v[68:71]
    ds_read_b64_tr_b16 a[2:3], v8 offset:53248
    s_waitcnt lgkmcnt(6)
    v_mfma_f32_16x16x32_bf16 v[72:75], a[132:135], a[104:107], v[72:75]
    ds_read_b64_tr_b16 a[4:5], v9 offset:49152
    v_mfma_f32_16x16x32_bf16 v[76:79], a[132:135], a[108:111], v[76:79]
    ds_read_b64_tr_b16 a[6:7], v9 offset:53248
    s_waitcnt lgkmcnt(6)
    v_mfma_f32_16x16x32_bf16 v[80:83], a[136:139], a[104:107], v[80:83]
    ds_read_b64_tr_b16 a[8:9], v10 offset:49152
    v_mfma_f32_16x16x32_bf16 v[84:87], a[136:139], a[108:111], v[84:87]
    ds_read_b64_tr_b16 a[10:11], v10 offset:53248
    s_waitcnt lgkmcnt(6)
    v_mfma_f32_16x16x32_bf16 v[88:91], a[140:143], a[104:107], v[88:91]
    ds_read_b64_tr_b16 a[12:13], v11 offset:49152
    v_mfma_f32_16x16x32_bf16 v[92:95], a[140:143], a[108:111], v[92:95]
    ds_read_b64_tr_b16 a[14:15], v11 offset:53248
    s_waitcnt lgkmcnt(6)
    v_mfma_f32_16x16x32_bf16 v[64:67], a[0:3], a[112:115], v[64:67]
    ds_read_b64_tr_b16 a[128:129], v8 offset:57344
    v_mfma_f32_16x16x32_bf16 v[68:71], a[0:3], a[116:119], v[68:71]
    ds_read_b64_tr_b16 a[130:131], v8 offset:61440
    s_waitcnt lgkmcnt(6)
    v_mfma_f32_16x16x32_bf16 v[72:75], a[4:7], a[112:115], v[72:75]
    ds_read_b64_tr_b16 a[132:133], v9 offset:57344
    v_mfma_f32_16x16x32_bf16 v[76:79], a[4:7], a[116:119], v[76:79]
    ds_read_b64_tr_b16 a[134:135], v9 offset:61440
    s_waitcnt lgkmcnt(6)
    v_mfma_f32_16x16x32_bf16 v[80:83], a[8:11], a[112:115], v[80:83]
    ds_read_b64_tr_b16 a[136:137], v10 offset:57344
    v_mfma_f32_16x16x32_bf16 v[84:87], a[8:11], a[116:119], v[84:87]
    ds_read_b64_tr_b16 a[138:139], v10 offset:61440
    s_waitcnt lgkmcnt(6)
    v_mfma_f32_16x16x32_bf16 v[88:91], a[12:15], a[112:115], v[88:91]
    ds_read_b64_tr_b16 a[140:141], v11 offset:57344
    v_mfma_f32_16x16x32_bf16 v[92:95], a[12:15], a[116:119], v[92:95]
    ds_read_b64_tr_b16 a[142:143], v11 offset:61440
    s_waitcnt lgkmcnt(6)
    v_mfma_f32_16x16x32_bf16 v[64:67], a[128:131], a[120:123], v[64:67]
    v_mfma_f32_16x16x32_bf16 v[68:71], a[128:131], a[124:127], v[68:71]
    s_waitcnt lgkmcnt(4)
    v_mfma_f32_16x16x32_bf16 v[72:75], a[132:135], a[120:123], v[72:75]
    v_mfma_f32_16x16x32_bf16 v[76:79], a[132:135], a[124:127], v[76:79]
    s_waitcnt lgkmcnt(2)
    v_mfma_f32_16x16x32_bf16 v[80:83], a[136:139], a[120:123], v[80:83]
    v_mfma_f32_16x16x32_bf16 v[84:87], a[136:139], a[124:127], v[84:87]
    s_waitcnt lgkmcnt(0)
    v_mfma_f32_16x16x32_bf16 v[88:91], a[140:143], a[120:123], v[88:91]
    v_mfma_f32_16x16x32_bf16 v[92:95], a[140:143], a[124:127], v[92:95]
    s_barrier
    s_nop 4
    s_lshl_b32 s52, s43, 22
    v_permlane16_swap_b32 v64, v72
    v_permlane16_swap_b32 v65, v73
    v_permlane16_swap_b32 v66, v74
    v_permlane16_swap_b32 v67, v75
    v_cvt_pk_bf16_f32 v20, v64, v65
    v_cvt_pk_bf16_f32 v21, v66, v67
    v_cvt_pk_bf16_f32 v22, v72, v73
    v_cvt_pk_bf16_f32 v23, v74, v75
    s_add_u32 s53, s52, 0
    buffer_store_dwordx4 v[20:23], v5, s[24:27], s53 offen sc1
    v_permlane16_swap_b32 v68, v76
    v_permlane16_swap_b32 v69, v77
    v_permlane16_swap_b32 v70, v78
    v_permlane16_swap_b32 v71, v79
    v_cvt_pk_bf16_f32 v24, v68, v69
    v_cvt_pk_bf16_f32 v25, v70, v71
    v_cvt_pk_bf16_f32 v26, v76, v77
    v_cvt_pk_bf16_f32 v27, v78, v79
    s_add_u32 s53, s52, 32768
    buffer_store_dwordx4 v[24:27], v5, s[24:27], s53 offen sc1
    v_permlane16_swap_b32 v80, v88
    v_permlane16_swap_b32 v81, v89
    v_permlane16_swap_b32 v82, v90
    v_permlane16_swap_b32 v83, v91
    v_cvt_pk_bf16_f32 v28, v80, v81
    v_cvt_pk_bf16_f32 v29, v82, v83
    v_cvt_pk_bf16_f32 v30, v88, v89
    v_cvt_pk_bf16_f32 v31, v90, v91
    s_add_u32 s53, s52, 64
    buffer_store_dwordx4 v[28:31], v5, s[24:27], s53 offen sc1
    v_permlane16_swap_b32 v84, v92
    v_permlane16_swap_b32 v85, v93
    v_permlane16_swap_b32 v86, v94
    v_permlane16_swap_b32 v87, v95
    v_cvt_pk_bf16_f32 v32, v84, v85
    v_cvt_pk_bf16_f32 v33, v86, v87
    v_cvt_pk_bf16_f32 v34, v92, v93
    v_cvt_pk_bf16_f32 v35, v94, v95
    s_add_u32 s53, s52, 32832
    buffer_store_dwordx4 v[32:35], v5, s[24:27], s53 offen sc1
    s_add_u32 s52, s41, 272
    s_lshl_b32 s90, s52, 7
    s_lshl_b32 s52, s42, 1
    s_add_u32 s52, s52, s43
    s_lshl_b32 s52, s52, 2
    s_add_u32 s90, s90, s52
    s_mov_b64 s[6:7], s[82:83]
    s_mov_b32 s24, s100
    v_mov_b32 v1, v0
    s_mov_b32 s8, s6
    s_mov_b32 s9, s7
    s_mov_b32 s10, 0x400000
    s_mov_b32 s11, 0x20000
    s_add_u32 s28, s4, 0x5000000
    s_addc_u32 s29, s5, 0
    s_mov_b32 s30, 0x800000
    s_mov_b32 s31, 0x20000
    s_add_u32 s32, s4, 0x2000000
    s_addc_u32 s33, s5, 0
    s_mov_b32 s34, 0x400000
    s_mov_b32 s35, 0x20000
    s_add_u32 s12, s4, 0x2400000
    s_addc_u32 s13, s5, 0
    s_mov_b32 s14, 0x400000
    s_mov_b32 s15, 0x20000
    s_mov_b32 s16, s4
    s_mov_b32 s17, s5
    s_mov_b32 s18, 0x18000
    s_mov_b32 s19, 0x20000
    s_add_u32 s20, s4, 0x20000
    s_addc_u32 s21, s5, 0
    s_mov_b32 s22, 0x6000
    s_mov_b32 s23, 0x20000
    s_and_b32 s40, s2, 7
    s_lshr_b32 s41, s2, 3
    s_lshr_b32 s42, s40, 1
    s_lshl_b32 s42, s42, 2
    s_lshr_b32 s43, s41, 3
    s_add_u32 s42, s42, s43
    s_and_b32 s41, s41, 7
    s_lshl_b32 s41, s41, 1
    s_and_b32 s40, s40, 1
    s_add_u32 s41, s41, s40
    s_lshl_b32 s25, s42, 7
    s_lshl_b32 s41, s41, 3
    s_add_u32 s25, s25, s41
    s_add_u32 s43, s42, 272
    s_lshl_b32 s91, s43, 7
    v_and_b32 v2, 7, v1
    v_add_u32 v2, s25, v2
    v_lshrrev_b32 v3, 3, v1
    v_lshlrev_b32 v5, 11, v2
    v_lshl_add_u32 v5, v3, 4, v5
    s_lshl_b32 s26, s24, 9
    v_add_u32 v5, s26, v5
    buffer_load_dwordx4 v[32:35], v5, s[8:11], 0 offen offset:0
    buffer_load_dwordx4 v[36:39], v5, s[8:11], 0 offen offset:128
    buffer_load_dwordx4 v[40:43], v5, s[8:11], 0 offen offset:256
    buffer_load_dwordx4 v[44:47], v5, s[8:11], 0 offen offset:384
    s_lshl_b32 s26, s24, 10
    v_lshlrev_b32 v6, 4, v0
    v_add_u32 v6, s26, v6
    s_mov_b32 s26, 12288
    s_mov_b32 s27, 16384
    buffer_load_dwordx4 v[64:67], v6, s[16:19], s26 offen
    buffer_load_dwordx4 v[68:71], v6, s[16:19], s27 offen
    s_mov_b32 s26, 36864
    s_mov_b32 s27, 40960
    buffer_load_dwordx4 v[72:75], v6, s[16:19], s26 offen
    buffer_load_dwordx4 v[76:79], v6, s[16:19], s27 offen
    s_mov_b32 s26, 61440
    s_mov_b32 s27, 65536
    buffer_load_dwordx4 v[80:83], v6, s[16:19], s26 offen
    buffer_load_dwordx4 v[84:87], v6, s[16:19], s27 offen
    s_mov_b32 s26, 86016
    s_mov_b32 s27, 90112
    buffer_load_dwordx4 v[88:91], v6, s[16:19], s26 offen
    buffer_load_dwordx4 v[92:95], v6, s[16:19], s27 offen
    s_mov_b32 s26, 8192
    buffer_load_dwordx4 v[164:167], v6, s[16:19], s26 offen
    s_mov_b32 s26, 32768
    buffer_load_dwordx4 v[168:171], v6, s[16:19], s26 offen
    s_mov_b32 s26, 57344
    buffer_load_dwordx4 v[172:175], v6, s[16:19], s26 offen
    s_mov_b32 s26, 81920
    buffer_load_dwordx4 v[176:179], v6, s[16:19], s26 offen
    s_waitcnt vmcnt(16)
    s_barrier
    s_cmp_lg_u32 s100, 0
    s_cbranch_scc1 L_fz_s8
    s_mov_b64 s[88:89], exec
    s_mov_b64 exec, 1
    v_mov_b32 v250, 1
    v_mov_b32 v251, s90
    buffer_store_dword v250, v251, s[92:95], 0 offen sc1
    s_mov_b64 exec, s[88:89]
L_fz_s8:
    v_lshlrev_b32 v13, 5, v3
    s_lshl_b32 s26, s24, 10
    v_add_u32 v13, s26, v13
    v_add_u32 v13, 131072, v13
    v_and_b32 v14, 7, v1
    v_lshlrev_b32 v14, 2, v14
    v_add_u32 v14, 143360, v14
    s_lshl_b32 s26, s24, 5
    v_add_u32 v20, s26, v14
    v_lshrrev_b32 v12, 4, v2
    v_lshlrev_b32 v12, 15, v12
    s_lshl_b32 s26, s24, 13
    v_add_u32 v12, s26, v12
    v_lshrrev_b32 v16, 2, v3
    v_lshl_add_u32 v12, v16, 10, v12
    v_and_b32 v16, 3, v3
    v_lshl_add_u32 v12, v16, 8, v12
    v_and_b32 v16, 15, v2
    v_lshl_add_u32 v12, v16, 4, v12
    s_waitcnt vmcnt(0)
    v_add_f32 v164, v164, v168
    v_add_f32 v172, v172, v176
    v_add_f32 v164, v164, v172
    v_add_f32 v165, v165, v169
    v_add_f32 v173, v173, v177
    v_add_f32 v165, v165, v173
    v_add_f32 v166, v166, v170
    v_add_f32 v174, v174, v178
    v_add_f32 v166, v166, v174
    v_add_f32 v167, v167, v171
    v_add_f32 v175, v175, v179
    v_add_f32 v167, v167, v175
    v_cvt_pk_bf16_f32 v168, v164, v165
    v_cvt_pk_bf16_f32 v169, v166, v167
    v_lshlrev_b32 v164, 16, v168
    v_and_b32 v165, 0xffff0000, v168
    v_lshlrev_b32 v166, 16, v169
    v_and_b32 v167, 0xffff0000, v169
    v_add_f32 v64, v64, v72
    v_add_f32 v80, v80, v88
    v_add_f32 v64, v64, v80
    v_add_f32 v65, v65, v73
    v_add_f32 v81, v81, v89
    v_add_f32 v65, v65, v81
    v_add_f32 v66, v66, v74
    v_add_f32 v82, v82, v90
    v_add_f32 v66, v66, v82
    v_add_f32 v67, v67, v75
    v_add_f32 v83, v83, v91
    v_add_f32 v67, v67, v83
    v_add_f32 v68, v68, v76
    v_add_f32 v84, v84, v92
    v_add_f32 v68, v68, v84
    v_add_f32 v69, v69, v77
    v_add_f32 v85, v85, v93
    v_add_f32 v69, v69, v85
    v_add_f32 v70, v70, v78
    v_add_f32 v86, v86, v94
    v_add_f32 v70, v70, v86
    v_add_f32 v71, v71, v79
    v_add_f32 v87, v87, v95
    v_add_f32 v71, v71, v87
    v_cvt_pk_bf16_f32 v72, v64, v65
    v_cvt_pk_bf16_f32 v73, v66, v67
    v_cvt_pk_bf16_f32 v74, v68, v69
    v_cvt_pk_bf16_f32 v75, v70, v71
    v_lshlrev_b32 v64, 16, v72
    v_and_b32 v65, 0xffff0000, v72
    v_lshlrev_b32 v66, 16, v73
    v_and_b32 v67, 0xffff0000, v73
    v_lshlrev_b32 v68, 16, v74
    v_and_b32 v69, 0xffff0000, v74
    v_lshlrev_b32 v70, 16, v75
    v_and_b32 v71, 0xffff0000, v75
    v_add_f32 v68, 1.0, v68
    v_add_f32 v69, 1.0, v69
    v_add_f32 v70, 1.0, v70
    v_add_f32 v71, 1.0, v71
    v_cvt_pk_bf16_f32 v72, v68, v69
    v_cvt_pk_bf16_f32 v73, v70, v71
    v_lshlrev_b32 v68, 16, v72
    v_and_b32 v69, 0xffff0000, v72
    v_lshlrev_b32 v70, 16, v73
    v_and_b32 v71, 0xffff0000, v73
    s_mov_b32 s26, 0x3fb8aa3b
    v_mul_f32 v64, s26, v64
    v_mul_f32 v65, s26, v65
    v_mul_f32 v66, s26, v66
    v_mul_f32 v67, s26, v67
    v_mul_f32 v68, s26, v68
    v_mul_f32 v69, s26, v69
    v_mul_f32 v70, s26, v70
    v_mul_f32 v71, s26, v71
    v_add_u32 v6, 131072, v6
    ds_write_b128 v6, v[164:167] offset:8192
    ds_write_b128 v6, v[64:67]
    ds_write_b128 v6, v[68:71] offset:4096
    v_lshlrev_b32 v100, 16, v32
    v_and_b32 v101, 0xffff0000, v32
    v_lshlrev_b32 v102, 16, v33
    v_and_b32 v103, 0xffff0000, v33
    v_lshlrev_b32 v104, 16, v34
    v_and_b32 v105, 0xffff0000, v34
    v_lshlrev_b32 v106, 16, v35
    v_and_b32 v107, 0xffff0000, v35
    v_lshlrev_b32 v108, 16, v36
    v_and_b32 v109, 0xffff0000, v36
    v_lshlrev_b32 v110, 16, v37
    v_and_b32 v111, 0xffff0000, v37
    v_lshlrev_b32 v112, 16, v38
    v_and_b32 v113, 0xffff0000, v38
    v_lshlrev_b32 v114, 16, v39
    v_and_b32 v115, 0xffff0000, v39
    v_lshlrev_b32 v116, 16, v40
    v_and_b32 v117, 0xffff0000, v40
    v_lshlrev_b32 v118, 16, v41
    v_and_b32 v119, 0xffff0000, v41
    v_lshlrev_b32 v120, 16, v42
    v_and_b32 v121, 0xffff0000, v42
    v_lshlrev_b32 v122, 16, v43
    v_and_b32 v123, 0xffff0000, v43
    v_lshlrev_b32 v124, 16, v44
    v_and_b32 v125, 0xffff0000, v44
    v_lshlrev_b32 v126, 16, v45
    v_and_b32 v127, 0xffff0000, v45
    v_lshlrev_b32 v128, 16, v46
    v_and_b32 v129, 0xffff0000, v46
    v_lshlrev_b32 v130, 16, v47
    v_and_b32 v131, 0xffff0000, v47
    s_waitcnt lgkmcnt(0)
    s_barrier
    ds_read_b128 v[196:199], v13 offset:8192
    ds_read_b128 v[200:203], v13 offset:8208
    ds_read_b128 v[204:207], v13 offset:8448
    ds_read_b128 v[208:211], v13 offset:8464
    ds_read_b128 v[212:215], v13 offset:8704
    ds_read_b128 v[216:219], v13 offset:8720
    ds_read_b128 v[220:223], v13 offset:8960
    ds_read_b128 v[224:227], v13 offset:8976
    s_cmp_lg_u32 s100, 0
    s_cbranch_scc1 L_fz_w9
    s_mov_b64 s[88:89], exec
    s_mov_b64 exec, 0xffff
    v_lshlrev_b32 v252, 2, v0
    v_add_u32 v252, s91, v252
    s_mov_b32 s87, 262144
L_fz_p9:
    buffer_load_dword v253, v252, s[92:95], 0 offen sc1
    s_waitcnt vmcnt(0)
    v_cmp_ne_u32 vcc, 1, v253
    s_cbranch_vccz L_fz_g9
    s_sub_u32 s87, s87, 1
    s_cmp_lg_u32 s87, 0
    s_cbranch_scc1 L_fz_p9
L_fz_g9:
    s_mov_b64 exec, s[88:89]
L_fz_w9:
    s_barrier
    s_mov_b32 s26, 4194304
    buffer_load_dwordx4 v[132:135], v5, s[28:31], 0 offen offset:0 sc1
    buffer_load_dwordx4 v[136:139], v5, s[28:31], 0 offen offset:128 sc1
    buffer_load_dwordx4 v[140:143], v5, s[28:31], 0 offen offset:256 sc1
    buffer_load_dwordx4 v[144:147], v5, s[28:31], 0 offen offset:384 sc1
    buffer_load_dwordx4 v[148:151], v5, s[28:31], s26 offen offset:0 sc1
    buffer_load_dwordx4 v[152:155], v5, s[28:31], s26 offen offset:128 sc1
    buffer_load_dwordx4 v[156:159], v5, s[28:31], s26 offen offset:256 sc1
    buffer_load_dwordx4 v[160:163], v5, s[28:31], s26 offen offset:384 sc1
    s_waitcnt vmcnt(3) lgkmcnt(0)
    v_lshlrev_b32 v16, 16, v132
    v_and_b32 v17, 0xffff0000, v132
    v_lshlrev_b32 v18, 16, v148
    v_and_b32 v19, 0xffff0000, v148
    v_pk_add_f32 v[16:17], v[16:17], v[18:19]
    v_pk_fma_f32 v[100:101], v[16:17], v[196:197], v[100:101]
    v_cvt_pk_bf16_f32 v32, v100, v101
    v_lshlrev_b32 v100, 16, v32
    v_and_b32 v101, 0xffff0000, v32
    v_lshlrev_b32 v16, 16, v133
    v_and_b32 v17, 0xffff0000, v133
    v_lshlrev_b32 v18, 16, v149
    v_and_b32 v19, 0xffff0000, v149
    v_pk_add_f32 v[16:17], v[16:17], v[18:19]
    v_pk_fma_f32 v[102:103], v[16:17], v[198:199], v[102:103]
    v_cvt_pk_bf16_f32 v33, v102, v103
    v_lshlrev_b32 v102, 16, v33
    v_and_b32 v103, 0xffff0000, v33
    v_lshlrev_b32 v16, 16, v134
    v_and_b32 v17, 0xffff0000, v134
    v_lshlrev_b32 v18, 16, v150
    v_and_b32 v19, 0xffff0000, v150
    v_pk_add_f32 v[16:17], v[16:17], v[18:19]
    v_pk_fma_f32 v[104:105], v[16:17], v[200:201], v[104:105]
    v_cvt_pk_bf16_f32 v34, v104, v105
    v_lshlrev_b32 v104, 16, v34
    v_and_b32 v105, 0xffff0000, v34
    v_lshlrev_b32 v16, 16, v135
    v_and_b32 v17, 0xffff0000, v135
    v_lshlrev_b32 v18, 16, v151
    v_and_b32 v19, 0xffff0000, v151
    v_pk_add_f32 v[16:17], v[16:17], v[18:19]
    v_pk_fma_f32 v[106:107], v[16:17], v[202:203], v[106:107]
    v_cvt_pk_bf16_f32 v35, v106, v107
    v_lshlrev_b32 v106, 16, v35
    v_and_b32 v107, 0xffff0000, v35
    buffer_store_dwordx4 v[32:35], v5, s[32:35], 0 offen offset:0 sc1
    s_waitcnt vmcnt(3)
    v_lshlrev_b32 v16, 16, v136
    v_and_b32 v17, 0xffff0000, v136
    v_lshlrev_b32 v18, 16, v152
    v_and_b32 v19, 0xffff0000, v152
    v_pk_add_f32 v[16:17], v[16:17], v[18:19]
    v_pk_fma_f32 v[108:109], v[16:17], v[204:205], v[108:109]
    v_cvt_pk_bf16_f32 v36, v108, v109
    v_lshlrev_b32 v108, 16, v36
    v_and_b32 v109, 0xffff0000, v36
    v_lshlrev_b32 v16, 16, v137
    v_and_b32 v17, 0xffff0000, v137
    v_lshlrev_b32 v18, 16, v153
    v_and_b32 v19, 0xffff0000, v153
    v_pk_add_f32 v[16:17], v[16:17], v[18:19]
    v_pk_fma_f32 v[110:111], v[16:17], v[206:207], v[110:111]
    v_cvt_pk_bf16_f32 v37, v110, v111
    v_lshlrev_b32 v110, 16, v37
    v_and_b32 v111, 0xffff0000, v37
    v_lshlrev_b32 v16, 16, v138
    v_and_b32 v17, 0xffff0000, v138
    v_lshlrev_b32 v18, 16, v154
    v_and_b32 v19, 0xffff0000, v154
    v_pk_add_f32 v[16:17], v[16:17], v[18:19]
    v_pk_fma_f32 v[112:113], v[16:17], v[208:209], v[112:113]
    v_cvt_pk_bf16_f32 v38, v112, v113
    v_lshlrev_b32 v112, 16, v38
    v_and_b32 v113, 0xffff0000, v38
    v_lshlrev_b32 v16, 16, v139
    v_and_b32 v17, 0xffff0000, v139
    v_lshlrev_b32 v18, 16, v155
    v_and_b32 v19, 0xffff0000, v155
    v_pk_add_f32 v[16:17], v[16:17], v[18:19]
    v_pk_fma_f32 v[114:115], v[16:17], v[210:211], v[114:115]
    v_cvt_pk_bf16_f32 v39, v114, v115
    v_lshlrev_b32 v114, 16, v39
    v_and_b32 v115, 0xffff0000, v39
    buffer_store_dwordx4 v[36:39], v5, s[32:35], 0 offen offset:128 sc1
    s_waitcnt vmcnt(3)
    v_lshlrev_b32 v16, 16, v140
    v_and_b32 v17, 0xffff0000, v140
    v_lshlrev_b32 v18, 16, v156
    v_and_b32 v19, 0xffff0000, v156
    v_pk_add_f32 v[16:17], v[16:17], v[18:19]
    v_pk_fma_f32 v[116:117], v[16:17], v[212:213], v[116:117]
    v_cvt_pk_bf16_f32 v40, v116, v117
    v_lshlrev_b32 v116, 16, v40
    v_and_b32 v117, 0xffff0000, v40
    v_lshlrev_b32 v16, 16, v141
    v_and_b32 v17, 0xffff0000, v141
    v_lshlrev_b32 v18, 16, v157
    v_and_b32 v19, 0xffff0000, v157
    v_pk_add_f32 v[16:17], v[16:17], v[18:19]
    v_pk_fma_f32 v[118:119], v[16:17], v[214:215], v[118:119]
    v_cvt_pk_bf16_f32 v41, v118, v119
    v_lshlrev_b32 v118, 16, v41
    v_and_b32 v119, 0xffff0000, v41
    v_lshlrev_b32 v16, 16, v142
    v_and_b32 v17, 0xffff0000, v142
    v_lshlrev_b32 v18, 16, v158
    v_and_b32 v19, 0xffff0000, v158
    v_pk_add_f32 v[16:17], v[16:17], v[18:19]
    v_pk_fma_f32 v[120:121], v[16:17], v[216:217], v[120:121]
    v_cvt_pk_bf16_f32 v42, v120, v121
    v_lshlrev_b32 v120, 16, v42
    v_and_b32 v121, 0xffff0000, v42
    v_lshlrev_b32 v16, 16, v143
    v_and_b32 v17, 0xffff0000, v143
    v_lshlrev_b32 v18, 16, v159
    v_and_b32 v19, 0xffff0000, v159
    v_pk_add_f32 v[16:17], v[16:17], v[18:19]
    v_pk_fma_f32 v[122:123], v[16:17], v[218:219], v[122:123]
    v_cvt_pk_bf16_f32 v43, v122, v123
    v_lshlrev_b32 v122, 16, v43
    v_and_b32 v123, 0xffff0000, v43
    buffer_store_dwordx4 v[40:43], v5, s[32:35], 0 offen offset:256 sc1
    s_waitcnt vmcnt(3)
    v_lshlrev_b32 v16, 16, v144
    v_and_b32 v17, 0xffff0000, v144
    v_lshlrev_b32 v18, 16, v160
    v_and_b32 v19, 0xffff0000, v160
    v_pk_add_f32 v[16:17], v[16:17], v[18:19]
    v_pk_fma_f32 v[124:125], v[16:17], v[220:221], v[124:125]
    v_cvt_pk_bf16_f32 v44, v124, v125
    v_lshlrev_b32 v124, 16, v44
    v_and_b32 v125, 0xffff0000, v44
    v_lshlrev_b32 v16, 16, v145
    v_and_b32 v17, 0xffff0000, v145
    v_lshlrev_b32 v18, 16, v161
    v_and_b32 v19, 0xffff0000, v161
    v_pk_add_f32 v[16:17], v[16:17], v[18:19]
    v_pk_fma_f32 v[126:127], v[16:17], v[222:223], v[126:127]
    v_cvt_pk_bf16_f32 v45, v126, v127
    v_lshlrev_b32 v126, 16, v45
    v_and_b32 v127, 0xffff0000, v45
    v_lshlrev_b32 v16, 16, v146
    v_and_b32 v17, 0xffff0000, v146
    v_lshlrev_b32 v18, 16, v162
    v_and_b32 v19, 0xffff0000, v162
    v_pk_add_f32 v[16:17], v[16:17], v[18:19]
    v_pk_fma_f32 v[128:129], v[16:17], v[224:225], v[128:129]
    v_cvt_pk_bf16_f32 v46, v128, v129
    v_lshlrev_b32 v128, 16, v46
    v_and_b32 v129, 0xffff0000, v46
    v_lshlrev_b32 v16, 16, v147
    v_and_b32 v17, 0xffff0000, v147
    v_lshlrev_b32 v18, 16, v163
    v_and_b32 v19, 0xffff0000, v163
    v_pk_add_f32 v[16:17], v[16:17], v[18:19]
    v_pk_fma_f32 v[130:131], v[16:17], v[226:227], v[130:131]
    v_cvt_pk_bf16_f32 v47, v130, v131
    v_lshlrev_b32 v130, 16, v47
    v_and_b32 v131, 0xffff0000, v47
    buffer_store_dwordx4 v[44:47], v5, s[32:35], 0 offen offset:384 sc1
    v_pk_add_f32 v[8:9], v[100:101], v[102:103]
    v_pk_add_f32 v[10:11], v[104:105], v[106:107]
    v_pk_add_f32 v[8:9], v[8:9], v[108:109]
    v_pk_add_f32 v[10:11], v[10:11], v[110:111]
    v_pk_add_f32 v[8:9], v[8:9], v[112:113]
    v_pk_add_f32 v[10:11], v[10:11], v[114:115]
    v_pk_add_f32 v[8:9], v[8:9], v[116:117]
    v_pk_add_f32 v[10:11], v[10:11], v[118:119]
    v_pk_add_f32 v[8:9], v[8:9], v[120:121]
    v_pk_add_f32 v[10:11], v[10:11], v[122:123]
    v_pk_add_f32 v[8:9], v[8:9], v[124:125]
    v_pk_add_f32 v[10:11], v[10:11], v[126:127]
    v_pk_add_f32 v[8:9], v[8:9], v[128:129]
    v_pk_add_f32 v[10:11], v[10:11], v[130:131]
    v_pk_add_f32 v[8:9], v[8:9], v[10:11]
    v_add_f32 v8, v8, v9
    s_nop 1
    v_add_f32_dpp v8, v8, v8 row_ror:8 row_mask:0xf bank_mask:0xf
    v_mov_b32 v9, v8
    s_nop 1
    v_permlane16_swap_b32 v8, v9
    v_add_f32 v8, v8, v9
    v_mov_b32 v9, v8
    s_nop 1
    v_permlane32_swap_b32 v8, v9
    v_add_f32 v8, v8, v9
    ds_write_b32 v20, v8 offset:0
    s_waitcnt lgkmcnt(0)
    s_barrier
    ds_read_b32 v22, v14 offset:0
    ds_read_b32 v23, v14 offset:32
    ds_read_b32 v24, v14 offset:64
    ds_read_b32 v25, v14 offset:96
    s_waitcnt lgkmcnt(0)
    v_add_f32 v22, v22, v23
    v_add_f32 v24, v24, v25
    v_add_f32 v8, v22, v24
    v_mul_f32 v8, 0xba800000, v8
    v_mov_b32 v9, v8
    v_pk_add_f32 v[100:101], v[100:101], v[8:9]
    v_pk_add_f32 v[102:103], v[102:103], v[8:9]
    v_pk_add_f32 v[104:105], v[104:105], v[8:9]
    v_pk_add_f32 v[106:107], v[106:107], v[8:9]
    v_pk_add_f32 v[108:109], v[108:109], v[8:9]
    v_pk_add_f32 v[110:111], v[110:111], v[8:9]
    v_pk_add_f32 v[112:113], v[112:113], v[8:9]
    v_pk_add_f32 v[114:115], v[114:115], v[8:9]
    v_pk_add_f32 v[116:117], v[116:117], v[8:9]
    v_pk_add_f32 v[118:119], v[118:119], v[8:9]
    v_pk_add_f32 v[120:121], v[120:121], v[8:9]
    v_pk_add_f32 v[122:123], v[122:123], v[8:9]
    v_pk_add_f32 v[124:125], v[124:125], v[8:9]
    v_pk_add_f32 v[126:127], v[126:127], v[8:9]
    v_pk_add_f32 v[128:129], v[128:129], v[8:9]
    v_pk_add_f32 v[130:131], v[130:131], v[8:9]
    v_pk_mul_f32 v[26:27], v[100:101], v[100:101]
    v_pk_mul_f32 v[28:29], v[102:103], v[102:103]
    v_pk_fma_f32 v[26:27], v[104:105], v[104:105], v[26:27]
    v_pk_fma_f32 v[28:29], v[106:107], v[106:107], v[28:29]
    v_pk_fma_f32 v[26:27], v[108:109], v[108:109], v[26:27]
    v_pk_fma_f32 v[28:29], v[110:111], v[110:111], v[28:29]
    v_pk_fma_f32 v[26:27], v[112:113], v[112:113], v[26:27]
    v_pk_fma_f32 v[28:29], v[114:115], v[114:115], v[28:29]
    v_pk_fma_f32 v[26:27], v[116:117], v[116:117], v[26:27]
    v_pk_fma_f32 v[28:29], v[118:119], v[118:119], v[28:29]
    v_pk_fma_f32 v[26:27], v[120:121], v[120:121], v[26:27]
    v_pk_fma_f32 v[28:29], v[122:123], v[122:123], v[28:29]
    v_pk_fma_f32 v[26:27], v[124:125], v[124:125], v[26:27]
    v_pk_fma_f32 v[28:29], v[126:127], v[126:127], v[28:29]
    v_pk_fma_f32 v[26:27], v[128:129], v[128:129], v[26:27]
    v_pk_fma_f32 v[28:29], v[130:131], v[130:131], v[28:29]
    v_pk_add_f32 v[26:27], v[26:27], v[28:29]
    v_add_f32 v10, v26, v27
    ds_read_b128 v[164:167], v13 offset:0
    ds_read_b128 v[168:171], v13 offset:16
    ds_read_b128 v[172:175], v13 offset:4096
    ds_read_b128 v[176:179], v13 offset:4112
    ds_read_b128 v[180:183], v13 offset:256
    ds_read_b128 v[184:187], v13 offset:272
    ds_read_b128 v[188:191], v13 offset:4352
    ds_read_b128 v[192:195], v13 offset:4368
    s_waitcnt lgkmcnt(0)
    ds_read_b128 v[196:199], v13 offset:512
    ds_read_b128 v[200:203], v13 offset:528
    ds_read_b128 v[204:207], v13 offset:4608
    ds_read_b128 v[208:211], v13 offset:4624
    ds_read_b128 v[212:215], v13 offset:768
    ds_read_b128 v[216:219], v13 offset:784
    ds_read_b128 v[220:223], v13 offset:4864
    ds_read_b128 v[224:227], v13 offset:4880
    s_waitcnt lgkmcnt(0)
    s_nop 1
    v_add_f32_dpp v10, v10, v10 row_ror:8 row_mask:0xf bank_mask:0xf
    v_mov_b32 v9, v10
    s_nop 1
    v_permlane16_swap_b32 v10, v9
    v_add_f32 v10, v10, v9
    v_mov_b32 v9, v10
    s_nop 1
    v_permlane32_swap_b32 v10, v9
    v_add_f32 v10, v10, v9
    ds_write_b32 v20, v10 offset:128
    s_waitcnt lgkmcnt(0)
    s_barrier
    ds_read_b32 v22, v14 offset:128
    ds_read_b32 v23, v14 offset:160
    ds_read_b32 v24, v14 offset:192
    ds_read_b32 v25, v14 offset:224
    s_waitcnt lgkmcnt(0)
    v_add_f32 v22, v22, v23
    v_add_f32 v24, v24, v25
    v_add_f32 v10, v22, v24
    v_mov_b32 v16, 0x3727c5ac
    v_fmac_f32 v16, 0x3a800000, v10
    v_rsq_f32 v16, v16
    s_nop 0
    v_mov_b32 v17, v16
    v_pk_mul_f32 v[100:101], v[100:101], v[16:17]
    v_pk_mul_f32 v[102:103], v[102:103], v[16:17]
    v_pk_mul_f32 v[104:105], v[104:105], v[16:17]
    v_pk_mul_f32 v[106:107], v[106:107], v[16:17]
    v_pk_fma_f32 v[100:101], v[100:101], v[172:173], v[164:165]
    v_pk_fma_f32 v[102:103], v[102:103], v[174:175], v[166:167]
    v_pk_fma_f32 v[104:105], v[104:105], v[176:177], v[168:169]
    v_pk_fma_f32 v[106:107], v[106:107], v[178:179], v[170:171]
    v_cvt_pk_bf16_f32 v80, v100, v101
    v_cvt_pk_bf16_f32 v81, v102, v103
    v_cvt_pk_bf16_f32 v82, v104, v105
    v_cvt_pk_bf16_f32 v83, v106, v107
    s_mov_b32 s26, 0
    buffer_store_dwordx4 v[80:83], v12, s[12:15], s26 offen sc1
    v_pk_mul_f32 v[108:109], v[108:109], v[16:17]
    v_pk_mul_f32 v[110:111], v[110:111], v[16:17]
    v_pk_mul_f32 v[112:113], v[112:113], v[16:17]
    v_pk_mul_f32 v[114:115], v[114:115], v[16:17]
    v_pk_fma_f32 v[108:109], v[108:109], v[188:189], v[180:181]
    v_pk_fma_f32 v[110:111], v[110:111], v[190:191], v[182:183]
    v_pk_fma_f32 v[112:113], v[112:113], v[192:193], v[184:185]
    v_pk_fma_f32 v[114:115], v[114:115], v[194:195], v[186:187]
    v_cvt_pk_bf16_f32 v84, v108, v109
    v_cvt_pk_bf16_f32 v85, v110, v111
    v_cvt_pk_bf16_f32 v86, v112, v113
    v_cvt_pk_bf16_f32 v87, v114, v115
    s_mov_b32 s26, 2048
    buffer_store_dwordx4 v[84:87], v12, s[12:15], s26 offen sc1
    v_pk_mul_f32 v[116:117], v[116:117], v[16:17]
    v_pk_mul_f32 v[118:119], v[118:119], v[16:17]
    v_pk_mul_f32 v[120:121], v[120:121], v[16:17]
    v_pk_mul_f32 v[122:123], v[122:123], v[16:17]
    v_pk_fma_f32 v[116:117], v[116:117], v[204:205], v[196:197]
    v_pk_fma_f32 v[118:119], v[118:119], v[206:207], v[198:199]
    v_pk_fma_f32 v[120:121], v[120:121], v[208:209], v[200:201]
    v_pk_fma_f32 v[122:123], v[122:123], v[210:211], v[202:203]
    v_cvt_pk_bf16_f32 v88, v116, v117
    v_cvt_pk_bf16_f32 v89, v118, v119
    v_cvt_pk_bf16_f32 v90, v120, v121
    v_cvt_pk_bf16_f32 v91, v122, v123
    s_mov_b32 s26, 4096
    buffer_store_dwordx4 v[88:91], v12, s[12:15], s26 offen sc1
    v_pk_mul_f32 v[124:125], v[124:125], v[16:17]
    v_pk_mul_f32 v[126:127], v[126:127], v[16:17]
    v_pk_mul_f32 v[128:129], v[128:129], v[16:17]
    v_pk_mul_f32 v[130:131], v[130:131], v[16:17]
    v_pk_fma_f32 v[124:125], v[124:125], v[220:221], v[212:213]
    v_pk_fma_f32 v[126:127], v[126:127], v[222:223], v[214:215]
    v_pk_fma_f32 v[128:129], v[128:129], v[224:225], v[216:217]
    v_pk_fma_f32 v[130:131], v[130:131], v[226:227], v[218:219]
    v_cvt_pk_bf16_f32 v92, v124, v125
    v_cvt_pk_bf16_f32 v93, v126, v127
    v_cvt_pk_bf16_f32 v94, v128, v129
    v_cvt_pk_bf16_f32 v95, v130, v131
    s_mov_b32 s26, 6144
    buffer_store_dwordx4 v[92:95], v12, s[12:15], s26 offen sc1
    s_lshr_b32 s43, s42, 1
    s_add_u32 s43, s43, 288
    s_lshl_b32 s90, s43, 7
    s_and_b32 s43, s42, 1
    s_lshl_b32 s43, s43, 6
    s_lshr_b32 s41, s41, 1
    s_add_u32 s43, s43, s41
    s_add_u32 s90, s90, s43
    s_mov_b64 s[6:7], s[76:77]
    s_mov_b64 s[8:9], s[78:79]
    s_mov_b32 s28, s100
    s_and_b32 s38, s2, 7
    s_lshr_b32 s39, s2, 3
    s_and_b32 s40, s38, 1
    s_lshl_b32 s40, s40, 2
    s_lshr_b32 s29, s39, 3
    s_add_u32 s29, s29, s40
    s_lshr_b32 s40, s38, 1
    s_lshl_b32 s40, s40, 3
    s_and_b32 s39, s39, 7
    s_add_u32 s30, s40, s39
    s_mov_b32 s12, s6
    s_mov_b32 s13, s7
    s_mov_b32 s14, 0x700000
    s_mov_b32 s15, 0x20000
    s_mov_b32 s16, s8
    s_mov_b32 s17, s9
    s_mov_b32 s18, 0x700000
    s_mov_b32 s19, 0x20000
    s_add_u32 s20, s4, 0x2400000
    s_addc_u32 s21, s5, 0
    s_mov_b32 s22, 0x400000
    s_mov_b32 s23, 0x20000
    s_add_u32 s24, s4, 0x2800000
    s_addc_u32 s25, s5, 0
    s_mov_b32 s26, 0xe00000
    s_mov_b32 s27, 0x20000
    v_lshlrev_b32 v1, 4, v0
    v_lshrrev_b32 v9, 4, v0
    s_and_b32 s38, s28, 1
    s_lshl_b32 s38, s38, 2
    v_or_b32 v10, s38, v9
    v_bfe_u32 v11, v0, 1, 3
    v_xor_b32 v10, v10, v11
    v_cmp_eq_u32 vcc, 7, v10
    v_lshlrev_b32 v10, 5, v10
    v_and_b32 v11, 1, v0
    v_lshlrev_b32 v11, 4, v11
    v_mul_u32_u24 v12, 7168, v9
    v_add3_u32 v10, v10, v11, v12
    s_mul_i32 s38, s30, 224
    v_add_u32 v10, s38, v10
    v_mov_b32 v11, 0x40000000
    v_cndmask_b32 v2, v10, v11, vcc
    s_lshl_b32 s38, s29, 4
    s_lshl_b32 s39, s28, 2
    s_add_u32 s38, s38, s39
    s_lshl_b32 s38, s38, 15
    v_add_u32 v3, s38, v1
    v_add_u32 v4, 0x8000, v3
    v_add_u32 v5, 0x8000, v4
    v_add_u32 v6, 0x8000, v5
    v_lshrrev_b32 v17, 4, v0
    v_bfe_u32 v18, v0, 2, 2
    v_lshl_add_u32 v19, v17, 3, v18
    v_lshlrev_b32 v19, 8, v19
    v_and_b32 v20, 3, v0
    v_lshl_add_u32 v19, v20, 3, v19
    v_and_b32 v17, 1, v17
    v_lshl_or_b32 v18, v17, 2, v18
    v_xor_b32 v20, 0, v18
    v_lshl_add_u32 v8, v20, 5, v19
    v_xor_b32 v20, 1, v18
    v_lshl_add_u32 v9, v20, 5, v19
    v_xor_b32 v20, 2, v18
    v_lshl_add_u32 v10, v20, 5, v19
    v_xor_b32 v20, 3, v18
    v_lshl_add_u32 v11, v20, 5, v19
    v_xor_b32 v20, 4, v18
    v_lshl_add_u32 v12, v20, 5, v19
    v_xor_b32 v20, 5, v18
    v_lshl_add_u32 v13, v20, 5, v19
    v_xor_b32 v20, 6, v18
    v_lshl_add_u32 v14, v20, 5, v19
    s_mul_i32 s31, s28, 57344
    s_lshl_b32 s33, s28, 11
    s_mov_b32 s34, 0
    s_mov_b32 s35, 0
    s_add_u32 s38, s29, 288
    s_lshl_b32 s91, s38, 7
    s_waitcnt vmcnt(0)
    s_barrier
    s_cmp_lg_u32 s100, 0
    s_cbranch_scc1 L_fz_s10
    s_mov_b64 s[88:89], exec
    s_mov_b64 exec, 1
    v_mov_b32 v250, 1
    v_mov_b32 v251, s90
    buffer_store_dword v250, v251, s[92:95], 0 offen sc1
    s_mov_b64 exec, s[88:89]
L_fz_s10:
    s_cmp_lg_u32 s100, 0
    s_cbranch_scc1 L_fz_w11
    s_mov_b64 s[88:89], exec
    s_mov_b64 exec, 0xffffffff
    v_lshlrev_b32 v252, 2, v0
    v_add_u32 v252, s91, v252
    s_mov_b32 s87, 262144
L_fz_p11:
    buffer_load_dword v253, v252, s[92:95], 0 offen sc1
    s_waitcnt vmcnt(0)
    v_cmp_ne_u32 vcc, 1, v253
    s_cbranch_vccz L_fz_g11
    s_sub_u32 s87, s87, 1
    s_cmp_lg_u32 s87, 0
    s_cbranch_scc1 L_fz_p11
L_fz_g11:
    s_mov_b64 exec, s[88:89]
L_fz_w11:
    s_add_u32 m0, s33, 0
    s_add_u32 s32, s31, 28672
    s_nop 0
    buffer_load_dwordx4 v2, s[12:15], s31 offen lds
    s_add_u32 m0, s33, 1024
    s_nop 0
    buffer_load_dwordx4 v2, s[12:15], s32 offen lds
    s_add_u32 m0, s33, 8192
    s_nop 0
    buffer_load_dwordx4 v2, s[16:19], s31 offen lds
    s_add_u32 m0, s33, 9216
    s_nop 0
    buffer_load_dwordx4 v2, s[16:19], s32 offen lds
    s_add_u32 s31, s31, 229376
    s_add_u32 m0, s33, 16384
    s_add_u32 s32, s31, 28672
    s_nop 0
    buffer_load_dwordx4 v2, s[12:15], s31 offen lds
    s_add_u32 m0, s33, 17408
    s_nop 0
    buffer_load_dwordx4 v2, s[12:15], s32 offen lds
    s_add_u32 m0, s33, 24576
    s_nop 0
    buffer_load_dwordx4 v2, s[16:19], s31 offen lds
    s_add_u32 m0, s33, 25600
    s_nop 0
    buffer_load_dwordx4 v2, s[16:19], s32 offen lds
    s_add_u32 s31, s31, 229376
    s_add_u32 m0, s33, 32768
    s_add_u32 s32, s31, 28672
    s_nop 0
    buffer_load_dwordx4 v2, s[12:15], s31 offen lds
    s_add_u32 m0, s33, 33792
    s_nop 0
    buffer_load_dwordx4 v2, s[12:15], s32 offen lds
    s_add_u32 m0, s33, 40960
    s_nop 0
    buffer_load_dwordx4 v2, s[16:19], s31 offen lds
    s_add_u32 m0, s33, 41984
    s_nop 0
    buffer_load_dwordx4 v2, s[16:19], s32 offen lds
    s_add_u32 s31, s31, 229376
    s_add_u32 m0, s33, 49152
    s_add_u32 s32, s31, 28672
    s_nop 0
    buffer_load_dwordx4 v2, s[12:15], s31 offen lds
    s_add_u32 m0, s33, 50176
    s_nop 0
    buffer_load_dwordx4 v2, s[12:15], s32 offen lds
    s_add_u32 m0, s33, 57344
    s_nop 0
    buffer_load_dwordx4 v2, s[16:19], s31 offen lds
    s_add_u32 m0, s33, 58368
    s_nop 0
    buffer_load_dwordx4 v2, s[16:19], s32 offen lds
    s_add_u32 s31, s31, 229376
    s_barrier
    buffer_load_dwordx4 a[64:67], v3, s[20:23], s35 offen sc1
    buffer_load_dwordx4 a[68:71], v4, s[20:23], s35 offen sc1
    buffer_load_dwordx4 a[72:75], v5, s[20:23], s35 offen sc1
    buffer_load_dwordx4 a[76:79], v6, s[20:23], s35 offen sc1
    s_add_u32 s35, s35, 1024
    buffer_load_dwordx4 a[80:83], v3, s[20:23], s35 offen sc1
    buffer_load_dwordx4 a[84:87], v4, s[20:23], s35 offen sc1
    buffer_load_dwordx4 a[88:91], v5, s[20:23], s35 offen sc1
    buffer_load_dwordx4 a[92:95], v6, s[20:23], s35 offen sc1
    s_add_u32 s35, s35, 1024
    buffer_load_dwordx4 a[96:99], v3, s[20:23], s35 offen sc1
    buffer_load_dwordx4 a[100:103], v4, s[20:23], s35 offen sc1
    buffer_load_dwordx4 a[104:107], v5, s[20:23], s35 offen sc1
    buffer_load_dwordx4 a[108:111], v6, s[20:23], s35 offen sc1
    s_add_u32 s35, s35, 1024
    buffer_load_dwordx4 a[112:115], v3, s[20:23], s35 offen sc1
    buffer_load_dwordx4 a[116:119], v4, s[20:23], s35 offen sc1
    buffer_load_dwordx4 a[120:123], v5, s[20:23], s35 offen sc1
    buffer_load_dwordx4 a[124:127], v6, s[20:23], s35 offen sc1
    s_add_u32 s35, s35, 1024
    s_waitcnt vmcnt(16)
    s_barrier
    ds_read_b64_tr_b16 a[0:1], v8 offset:0
    ds_read_b64_tr_b16 a[2:3], v8 offset:1024
    ds_read_b64_tr_b16 a[4:5], v8 offset:16384
    ds_read_b64_tr_b16 a[6:7], v8 offset:17408
    ds_read_b64_tr_b16 a[8:9], v8 offset:32768
    ds_read_b64_tr_b16 a[10:11], v8 offset:33792
    ds_read_b64_tr_b16 a[12:13], v8 offset:49152
    ds_read_b64_tr_b16 a[14:15], v8 offset:50176
    s_waitcnt lgkmcnt(4)
    ds_read_b64_tr_b16 a[16:17], v8 offset:8192
    ds_read_b64_tr_b16 a[18:19], v8 offset:9216
    ds_read_b64_tr_b16 a[20:21], v8 offset:24576
    ds_read_b64_tr_b16 a[22:23], v8 offset:25600
    ds_read_b64_tr_b16 a[24:25], v8 offset:40960
    ds_read_b64_tr_b16 a[26:27], v8 offset:41984
    ds_read_b64_tr_b16 a[28:29], v8 offset:57344
    ds_read_b64_tr_b16 a[30:31], v8 offset:58368
    s_waitcnt vmcnt(0)
    s_waitcnt lgkmcnt(8)
    v_mfma_f32_16x16x32_bf16 v[32:35], a[0:3], a[64:67], 0
    ds_read_b64_tr_b16 a[32:33], v9 offset:0
    s_add_u32 m0, s33, 65536
    s_add_u32 s32, s31, 28672
    v_mfma_f32_16x16x32_bf16 v[32:35], a[4:7], a[80:83], v[32:35]
    ds_read_b64_tr_b16 a[34:35], v9 offset:1024
    buffer_load_dwordx4 v2, s[12:15], s31 offen lds
    v_mfma_f32_16x16x32_bf16 v[32:35], a[8:11], a[96:99], v[32:35]
    ds_read_b64_tr_b16 a[36:37], v9 offset:16384
    v_mfma_f32_16x16x32_bf16 v[32:35], a[12:15], a[112:115], v[32:35]
    ds_read_b64_tr_b16 a[38:39], v9 offset:17408
    v_mfma_f32_16x16x32_bf16 v[36:39], a[0:3], a[68:71], 0
    ds_read_b64_tr_b16 a[40:41], v9 offset:32768
    v_mfma_f32_16x16x32_bf16 v[36:39], a[4:7], a[84:87], v[36:39]
    ds_read_b64_tr_b16 a[42:43], v9 offset:33792
    v_mfma_f32_16x16x32_bf16 v[36:39], a[8:11], a[100:103], v[36:39]
    ds_read_b64_tr_b16 a[44:45], v9 offset:49152
    s_add_u32 m0, s33, 66560
    v_mfma_f32_16x16x32_bf16 v[36:39], a[12:15], a[116:119], v[36:39]
    ds_read_b64_tr_b16 a[46:47], v9 offset:50176
    buffer_load_dwordx4 v2, s[12:15], s32 offen lds
    v_mfma_f32_16x16x32_bf16 v[40:43], a[0:3], a[72:75], 0
    v_xor_b32 v8, 0x10000, v8
    v_mfma_f32_16x16x32_bf16 v[40:43], a[4:7], a[88:91], v[40:43]
    v_mfma_f32_16x16x32_bf16 v[40:43], a[8:11], a[104:107], v[40:43]
    v_mfma_f32_16x16x32_bf16 v[40:43], a[12:15], a[120:123], v[40:43]
    v_mfma_f32_16x16x32_bf16 v[44:47], a[0:3], a[76:79], 0
    s_add_u32 m0, s33, 73728
    v_mfma_f32_16x16x32_bf16 v[44:47], a[4:7], a[92:95], v[44:47]
    buffer_load_dwordx4 v2, s[16:19], s31 offen lds
    v_mfma_f32_16x16x32_bf16 v[44:47], a[8:11], a[108:111], v[44:47]
    v_mfma_f32_16x16x32_bf16 v[44:47], a[12:15], a[124:127], v[44:47]
    s_waitcnt lgkmcnt(8)
    v_mfma_f32_16x16x32_bf16 v[48:51], a[16:19], a[64:67], 0
    ds_read_b64_tr_b16 a[48:49], v9 offset:8192
    v_mfma_f32_16x16x32_bf16 v[48:51], a[20:23], a[80:83], v[48:51]
    ds_read_b64_tr_b16 a[50:51], v9 offset:9216
    v_mfma_f32_16x16x32_bf16 v[48:51], a[24:27], a[96:99], v[48:51]
    ds_read_b64_tr_b16 a[52:53], v9 offset:24576
    s_add_u32 m0, s33, 74752
    v_mfma_f32_16x16x32_bf16 v[48:51], a[28:31], a[112:115], v[48:51]
    ds_read_b64_tr_b16 a[54:55], v9 offset:25600
    buffer_load_dwordx4 v2, s[16:19], s32 offen lds
    v_mfma_f32_16x16x32_bf16 v[52:55], a[16:19], a[68:71], 0
    ds_read_b64_tr_b16 a[56:57], v9 offset:40960
    s_add_u32 s31, s31, 229376
    v_mfma_f32_16x16x32_bf16 v[52:55], a[20:23], a[84:87], v[52:55]
    ds_read_b64_tr_b16 a[58:59], v9 offset:41984
    v_mfma_f32_16x16x32_bf16 v[52:55], a[24:27], a[100:103], v[52:55]
    ds_read_b64_tr_b16 a[60:61], v9 offset:57344
    v_mfma_f32_16x16x32_bf16 v[52:55], a[28:31], a[116:119], v[52:55]
    ds_read_b64_tr_b16 a[62:63], v9 offset:58368
    v_mfma_f32_16x16x32_bf16 v[56:59], a[16:19], a[72:75], 0
    s_add_u32 m0, s33, 81920
    s_add_u32 s32, s31, 28672
    v_mfma_f32_16x16x32_bf16 v[56:59], a[20:23], a[88:91], v[56:59]
    buffer_load_dwordx4 v2, s[12:15], s31 offen lds
    v_mfma_f32_16x16x32_bf16 v[56:59], a[24:27], a[104:107], v[56:59]
    v_mfma_f32_16x16x32_bf16 v[56:59], a[28:31], a[120:123], v[56:59]
    v_mfma_f32_16x16x32_bf16 v[60:63], a[16:19], a[76:79], 0
    v_mfma_f32_16x16x32_bf16 v[60:63], a[20:23], a[92:95], v[60:63]
    v_mfma_f32_16x16x32_bf16 v[60:63], a[24:27], a[108:111], v[60:63]
    s_add_u32 m0, s33, 82944
    v_mfma_f32_16x16x32_bf16 v[60:63], a[28:31], a[124:127], v[60:63]
    buffer_load_dwordx4 v2, s[12:15], s32 offen lds
    s_waitcnt lgkmcnt(8)
    v_mfma_f32_16x16x32_bf16 v[64:67], a[32:35], a[64:67], 0
    ds_read_b64_tr_b16 a[0:1], v10 offset:0
    v_mfma_f32_16x16x32_bf16 v[64:67], a[36:39], a[80:83], v[64:67]
    ds_read_b64_tr_b16 a[2:3], v10 offset:1024
    v_mfma_f32_16x16x32_bf16 v[64:67], a[40:43], a[96:99], v[64:67]
    ds_read_b64_tr_b16 a[4:5], v10 offset:16384
    v_mfma_f32_16x16x32_bf16 v[64:67], a[44:47], a[112:115], v[64:67]
    ds_read_b64_tr_b16 a[6:7], v10 offset:17408
    v_mfma_f32_16x16x32_bf16 v[68:71], a[32:35], a[68:71], 0
    ds_read_b64_tr_b16 a[8:9], v10 offset:32768
    s_add_u32 m0, s33, 90112
    v_mfma_f32_16x16x32_bf16 v[68:71], a[36:39], a[84:87], v[68:71]
    ds_read_b64_tr_b16 a[10:11], v10 offset:33792
    buffer_load_dwordx4 v2, s[16:19], s31 offen lds
    v_mfma_f32_16x16x32_bf16 v[68:71], a[40:43], a[100:103], v[68:71]
    ds_read_b64_tr_b16 a[12:13], v10 offset:49152
    v_mfma_f32_16x16x32_bf16 v[68:71], a[44:47], a[116:119], v[68:71]
    ds_read_b64_tr_b16 a[14:15], v10 offset:50176
    v_mfma_f32_16x16x32_bf16 v[72:75], a[32:35], a[72:75], 0
    v_xor_b32 v9, 0x10000, v9
    v_mfma_f32_16x16x32_bf16 v[72:75], a[36:39], a[88:91], v[72:75]
    v_mfma_f32_16x16x32_bf16 v[72:75], a[40:43], a[104:107], v[72:75]
    s_add_u32 m0, s33, 91136
    v_mfma_f32_16x16x32_bf16 v[72:75], a[44:47], a[120:123], v[72:75]
    buffer_load_dwordx4 v2, s[16:19], s32 offen lds
    v_mfma_f32_16x16x32_bf16 v[76:79], a[32:35], a[76:79], 0
    s_add_u32 s31, s31, 229376
    v_mfma_f32_16x16x32_bf16 v[76:79], a[36:39], a[92:95], v[76:79]
    v_mfma_f32_16x16x32_bf16 v[76:79], a[40:43], a[108:111], v[76:79]
    v_mfma_f32_16x16x32_bf16 v[76:79], a[44:47], a[124:127], v[76:79]
    s_waitcnt lgkmcnt(8)
    v_mfma_f32_16x16x32_bf16 v[80:83], a[48:51], a[64:67], 0
    ds_read_b64_tr_b16 a[16:17], v10 offset:8192
    s_add_u32 m0, s33, 98304
    s_add_u32 s32, s31, 28672
    v_mfma_f32_16x16x32_bf16 v[80:83], a[52:55], a[80:83], v[80:83]
    ds_read_b64_tr_b16 a[18:19], v10 offset:9216
    buffer_load_dwordx4 v2, s[12:15], s31 offen lds
    v_mfma_f32_16x16x32_bf16 v[80:83], a[56:59], a[96:99], v[80:83]
    ds_read_b64_tr_b16 a[20:21], v10 offset:24576
    v_mfma_f32_16x16x32_bf16 v[80:83], a[60:63], a[112:115], v[80:83]
    ds_read_b64_tr_b16 a[22:23], v10 offset:25600
    v_mfma_f32_16x16x32_bf16 v[84:87], a[48:51], a[68:71], 0
    ds_read_b64_tr_b16 a[24:25], v10 offset:40960
    v_mfma_f32_16x16x32_bf16 v[84:87], a[52:55], a[84:87], v[84:87]
    ds_read_b64_tr_b16 a[26:27], v10 offset:41984
    v_mfma_f32_16x16x32_bf16 v[84:87], a[56:59], a[100:103], v[84:87]
    ds_read_b64_tr_b16 a[28:29], v10 offset:57344
    s_add_u32 m0, s33, 99328
    v_mfma_f32_16x16x32_bf16 v[84:87], a[60:63], a[116:119], v[84:87]
    ds_read_b64_tr_b16 a[30:31], v10 offset:58368
    buffer_load_dwordx4 v2, s[12:15], s32 offen lds
    v_mfma_f32_16x16x32_bf16 v[88:91], a[48:51], a[72:75], 0
    v_mfma_f32_16x16x32_bf16 v[88:91], a[52:55], a[88:91], v[88:91]
    v_mfma_f32_16x16x32_bf16 v[88:91], a[56:59], a[104:107], v[88:91]
    v_mfma_f32_16x16x32_bf16 v[88:91], a[60:63], a[120:123], v[88:91]
    v_mfma_f32_16x16x32_bf16 v[92:95], a[48:51], a[76:79], 0
    s_add_u32 m0, s33, 106496
    v_mfma_f32_16x16x32_bf16 v[92:95], a[52:55], a[92:95], v[92:95]
    buffer_load_dwordx4 v2, s[16:19], s31 offen lds
    v_mfma_f32_16x16x32_bf16 v[92:95], a[56:59], a[108:111], v[92:95]
    v_mfma_f32_16x16x32_bf16 v[92:95], a[60:63], a[124:127], v[92:95]
    s_waitcnt lgkmcnt(8)
    v_mfma_f32_16x16x32_bf16 v[96:99], a[0:3], a[64:67], 0
    ds_read_b64_tr_b16 a[32:33], v11 offset:0
    v_mfma_f32_16x16x32_bf16 v[96:99], a[4:7], a[80:83], v[96:99]
    ds_read_b64_tr_b16 a[34:35], v11 offset:1024
    v_mfma_f32_16x16x32_bf16 v[96:99], a[8:11], a[96:99], v[96:99]
    ds_read_b64_tr_b16 a[36:37], v11 offset:16384
    s_add_u32 m0, s33, 107520
    v_mfma_f32_16x16x32_bf16 v[96:99], a[12:15], a[112:115], v[96:99]
    ds_read_b64_tr_b16 a[38:39], v11 offset:17408
    buffer_load_dwordx4 v2, s[16:19], s32 offen lds
    v_mfma_f32_16x16x32_bf16 v[100:103], a[0:3], a[68:71], 0
    ds_read_b64_tr_b16 a[40:41], v11 offset:32768
    s_add_u32 s31, s31, 229376
    v_mfma_f32_16x16x32_bf16 v[100:103], a[4:7], a[84:87], v[100:103]
    ds_read_b64_tr_b16 a[42:43], v11 offset:33792
    v_mfma_f32_16x16x32_bf16 v[100:103], a[8:11], a[100:103], v[100:103]
    ds_read_b64_tr_b16 a[44:45], v11 offset:49152
    v_mfma_f32_16x16x32_bf16 v[100:103], a[12:15], a[116:119], v[100:103]
    ds_read_b64_tr_b16 a[46:47], v11 offset:50176
    v_mfma_f32_16x16x32_bf16 v[104:107], a[0:3], a[72:75], 0
    v_xor_b32 v10, 0x10000, v10
    s_add_u32 m0, s33, 114688
    s_add_u32 s32, s31, 28672
    v_mfma_f32_16x16x32_bf16 v[104:107], a[4:7], a[88:91], v[104:107]
    buffer_load_dwordx4 v2, s[12:15], s31 offen lds
    v_mfma_f32_16x16x32_bf16 v[104:107], a[8:11], a[104:107], v[104:107]
    v_mfma_f32_16x16x32_bf16 v[104:107], a[12:15], a[120:123], v[104:107]
    v_mfma_f32_16x16x32_bf16 v[108:111], a[0:3], a[76:79], 0
    v_mfma_f32_16x16x32_bf16 v[108:111], a[4:7], a[92:95], v[108:111]
    v_mfma_f32_16x16x32_bf16 v[108:111], a[8:11], a[108:111], v[108:111]
    s_add_u32 m0, s33, 115712
    v_mfma_f32_16x16x32_bf16 v[108:111], a[12:15], a[124:127], v[108:111]
    buffer_load_dwordx4 v2, s[12:15], s32 offen lds
    s_waitcnt lgkmcnt(8)
    v_mfma_f32_16x16x32_bf16 v[112:115], a[16:19], a[64:67], 0
    ds_read_b64_tr_b16 a[48:49], v11 offset:8192
    v_mfma_f32_16x16x32_bf16 v[112:115], a[20:23], a[80:83], v[112:115]
    ds_read_b64_tr_b16 a[50:51], v11 offset:9216
    v_mfma_f32_16x16x32_bf16 v[112:115], a[24:27], a[96:99], v[112:115]
    ds_read_b64_tr_b16 a[52:53], v11 offset:24576
    v_mfma_f32_16x16x32_bf16 v[112:115], a[28:31], a[112:115], v[112:115]
    ds_read_b64_tr_b16 a[54:55], v11 offset:25600
    v_mfma_f32_16x16x32_bf16 v[116:119], a[16:19], a[68:71], 0
    ds_read_b64_tr_b16 a[56:57], v11 offset:40960
    s_add_u32 m0, s33, 122880
    v_mfma_f32_16x16x32_bf16 v[116:119], a[20:23], a[84:87], v[116:119]
    ds_read_b64_tr_b16 a[58:59], v11 offset:41984
    buffer_load_dwordx4 v2, s[16:19], s31 offen lds
    v_mfma_f32_16x16x32_bf16 v[116:119], a[24:27], a[100:103], v[116:119]
    ds_read_b64_tr_b16 a[60:61], v11 offset:57344
    v_mfma_f32_16x16x32_bf16 v[116:119], a[28:31], a[116:119], v[116:119]
    ds_read_b64_tr_b16 a[62:63], v11 offset:58368
    v_mfma_f32_16x16x32_bf16 v[120:123], a[16:19], a[72:75], 0
    v_mfma_f32_16x16x32_bf16 v[120:123], a[20:23], a[88:91], v[120:123]
    v_mfma_f32_16x16x32_bf16 v[120:123], a[24:27], a[104:107], v[120:123]
    s_add_u32 m0, s33, 123904
    v_mfma_f32_16x16x32_bf16 v[120:123], a[28:31], a[120:123], v[120:123]
    buffer_load_dwordx4 v2, s[16:19], s32 offen lds
    v_mfma_f32_16x16x32_bf16 v[124:127], a[16:19], a[76:79], 0
    s_add_u32 s31, s31, 229376
    v_mfma_f32_16x16x32_bf16 v[124:127], a[20:23], a[92:95], v[124:127]
    v_mfma_f32_16x16x32_bf16 v[124:127], a[24:27], a[108:111], v[124:127]
    v_mfma_f32_16x16x32_bf16 v[124:127], a[28:31], a[124:127], v[124:127]
    s_waitcnt lgkmcnt(8)
    v_mfma_f32_16x16x32_bf16 v[128:131], a[32:35], a[64:67], 0
    ds_read_b64_tr_b16 a[0:1], v12 offset:0
    v_mfma_f32_16x16x32_bf16 v[128:131], a[36:39], a[80:83], v[128:131]
    ds_read_b64_tr_b16 a[2:3], v12 offset:1024
    buffer_load_dwordx4 a[128:131], v3, s[20:23], s35 offen sc1
    v_mfma_f32_16x16x32_bf16 v[128:131], a[40:43], a[96:99], v[128:131]
    ds_read_b64_tr_b16 a[4:5], v12 offset:16384
    v_mfma_f32_16x16x32_bf16 v[128:131], a[44:47], a[112:115], v[128:131]
    ds_read_b64_tr_b16 a[6:7], v12 offset:17408
    v_mfma_f32_16x16x32_bf16 v[132:135], a[32:35], a[68:71], 0
    ds_read_b64_tr_b16 a[8:9], v12 offset:32768
    v_mfma_f32_16x16x32_bf16 v[132:135], a[36:39], a[84:87], v[132:135]
    ds_read_b64_tr_b16 a[10:11], v12 offset:33792
    v_mfma_f32_16x16x32_bf16 v[132:135], a[40:43], a[100:103], v[132:135]
    ds_read_b64_tr_b16 a[12:13], v12 offset:49152
    v_mfma_f32_16x16x32_bf16 v[132:135], a[44:47], a[116:119], v[132:135]
    ds_read_b64_tr_b16 a[14:15], v12 offset:50176
    buffer_load_dwordx4 a[132:135], v4, s[20:23], s35 offen sc1
    v_mfma_f32_16x16x32_bf16 v[136:139], a[32:35], a[72:75], 0
    v_xor_b32 v11, 0x10000, v11
    v_mfma_f32_16x16x32_bf16 v[136:139], a[36:39], a[88:91], v[136:139]
    v_mfma_f32_16x16x32_bf16 v[136:139], a[40:43], a[104:107], v[136:139]
    v_mfma_f32_16x16x32_bf16 v[136:139], a[44:47], a[120:123], v[136:139]
    v_mfma_f32_16x16x32_bf16 v[140:143], a[32:35], a[76:79], 0
    v_mfma_f32_16x16x32_bf16 v[140:143], a[36:39], a[92:95], v[140:143]
    buffer_load_dwordx4 a[136:139], v5, s[20:23], s35 offen sc1
    v_mfma_f32_16x16x32_bf16 v[140:143], a[40:43], a[108:111], v[140:143]
    v_mfma_f32_16x16x32_bf16 v[140:143], a[44:47], a[124:127], v[140:143]
    s_waitcnt lgkmcnt(8)
    v_mfma_f32_16x16x32_bf16 v[144:147], a[48:51], a[64:67], 0
    ds_read_b64_tr_b16 a[16:17], v12 offset:8192
    v_mfma_f32_16x16x32_bf16 v[144:147], a[52:55], a[80:83], v[144:147]
    ds_read_b64_tr_b16 a[18:19], v12 offset:9216
    v_mfma_f32_16x16x32_bf16 v[144:147], a[56:59], a[96:99], v[144:147]
    ds_read_b64_tr_b16 a[20:21], v12 offset:24576
    v_mfma_f32_16x16x32_bf16 v[144:147], a[60:63], a[112:115], v[144:147]
    ds_read_b64_tr_b16 a[22:23], v12 offset:25600
    buffer_load_dwordx4 a[140:143], v6, s[20:23], s35 offen sc1
    v_mfma_f32_16x16x32_bf16 v[148:151], a[48:51], a[68:71], 0
    ds_read_b64_tr_b16 a[24:25], v12 offset:40960
    s_add_u32 s35, s35, 1024
    v_mfma_f32_16x16x32_bf16 v[148:151], a[52:55], a[84:87], v[148:151]
    ds_read_b64_tr_b16 a[26:27], v12 offset:41984
    v_mfma_f32_16x16x32_bf16 v[148:151], a[56:59], a[100:103], v[148:151]
    ds_read_b64_tr_b16 a[28:29], v12 offset:57344
    v_mfma_f32_16x16x32_bf16 v[148:151], a[60:63], a[116:119], v[148:151]
    ds_read_b64_tr_b16 a[30:31], v12 offset:58368
    v_mfma_f32_16x16x32_bf16 v[152:155], a[48:51], a[72:75], 0
    v_mfma_f32_16x16x32_bf16 v[152:155], a[52:55], a[88:91], v[152:155]
    buffer_load_dwordx4 a[144:147], v3, s[20:23], s35 offen sc1
    v_mfma_f32_16x16x32_bf16 v[152:155], a[56:59], a[104:107], v[152:155]
    v_mfma_f32_16x16x32_bf16 v[152:155], a[60:63], a[120:123], v[152:155]
    v_mfma_f32_16x16x32_bf16 v[156:159], a[48:51], a[76:79], 0
    v_mfma_f32_16x16x32_bf16 v[156:159], a[52:55], a[92:95], v[156:159]
    v_mfma_f32_16x16x32_bf16 v[156:159], a[56:59], a[108:111], v[156:159]
    v_mfma_f32_16x16x32_bf16 v[156:159], a[60:63], a[124:127], v[156:159]
    buffer_load_dwordx4 a[148:151], v4, s[20:23], s35 offen sc1
    s_waitcnt lgkmcnt(8)
    v_mfma_f32_16x16x32_bf16 v[160:163], a[0:3], a[64:67], 0
    ds_read_b64_tr_b16 a[32:33], v13 offset:0
    v_mfma_f32_16x16x32_bf16 v[160:163], a[4:7], a[80:83], v[160:163]
    ds_read_b64_tr_b16 a[34:35], v13 offset:1024
    v_mfma_f32_16x16x32_bf16 v[160:163], a[8:11], a[96:99], v[160:163]
    ds_read_b64_tr_b16 a[36:37], v13 offset:16384
    v_mfma_f32_16x16x32_bf16 v[160:163], a[12:15], a[112:115], v[160:163]
    ds_read_b64_tr_b16 a[38:39], v13 offset:17408
    v_mfma_f32_16x16x32_bf16 v[164:167], a[0:3], a[68:71], 0
    ds_read_b64_tr_b16 a[40:41], v13 offset:32768
    v_mfma_f32_16x16x32_bf16 v[164:167], a[4:7], a[84:87], v[164:167]
    ds_read_b64_tr_b16 a[42:43], v13 offset:33792
    buffer_load_dwordx4 a[152:155], v5, s[20:23], s35 offen sc1
    v_mfma_f32_16x16x32_bf16 v[164:167], a[8:11], a[100:103], v[164:167]
    ds_read_b64_tr_b16 a[44:45], v13 offset:49152
    v_mfma_f32_16x16x32_bf16 v[164:167], a[12:15], a[116:119], v[164:167]
    ds_read_b64_tr_b16 a[46:47], v13 offset:50176
    v_mfma_f32_16x16x32_bf16 v[168:171], a[0:3], a[72:75], 0
    v_xor_b32 v12, 0x10000, v12
    v_mfma_f32_16x16x32_bf16 v[168:171], a[4:7], a[88:91], v[168:171]
    v_mfma_f32_16x16x32_bf16 v[168:171], a[8:11], a[104:107], v[168:171]
    v_mfma_f32_16x16x32_bf16 v[168:171], a[12:15], a[120:123], v[168:171]
    buffer_load_dwordx4 a[156:159], v6, s[20:23], s35 offen sc1
    v_mfma_f32_16x16x32_bf16 v[172:175], a[0:3], a[76:79], 0
    s_add_u32 s35, s35, 1024
    v_mfma_f32_16x16x32_bf16 v[172:175], a[4:7], a[92:95], v[172:175]
    v_mfma_f32_16x16x32_bf16 v[172:175], a[8:11], a[108:111], v[172:175]
    v_mfma_f32_16x16x32_bf16 v[172:175], a[12:15], a[124:127], v[172:175]
    s_waitcnt lgkmcnt(8)
    v_mfma_f32_16x16x32_bf16 v[176:179], a[16:19], a[64:67], 0
    ds_read_b64_tr_b16 a[48:49], v13 offset:8192
    v_mfma_f32_16x16x32_bf16 v[176:179], a[20:23], a[80:83], v[176:179]
    ds_read_b64_tr_b16 a[50:51], v13 offset:9216
    buffer_load_dwordx4 a[160:163], v3, s[20:23], s35 offen sc1
    v_mfma_f32_16x16x32_bf16 v[176:179], a[24:27], a[96:99], v[176:179]
    ds_read_b64_tr_b16 a[52:53], v13 offset:24576
    v_mfma_f32_16x16x32_bf16 v[176:179], a[28:31], a[112:115], v[176:179]
    ds_read_b64_tr_b16 a[54:55], v13 offset:25600
    v_mfma_f32_16x16x32_bf16 v[180:183], a[16:19], a[68:71], 0
    ds_read_b64_tr_b16 a[56:57], v13 offset:40960
    v_mfma_f32_16x16x32_bf16 v[180:183], a[20:23], a[84:87], v[180:183]
    ds_read_b64_tr_b16 a[58:59], v13 offset:41984
    v_mfma_f32_16x16x32_bf16 v[180:183], a[24:27], a[100:103], v[180:183]
    ds_read_b64_tr_b16 a[60:61], v13 offset:57344
    v_mfma_f32_16x16x32_bf16 v[180:183], a[28:31], a[116:119], v[180:183]
    ds_read_b64_tr_b16 a[62:63], v13 offset:58368
    buffer_load_dwordx4 a[164:167], v4, s[20:23], s35 offen sc1
    v_mfma_f32_16x16x32_bf16 v[184:187], a[16:19], a[72:75], 0
    v_mfma_f32_16x16x32_bf16 v[184:187], a[20:23], a[88:91], v[184:187]
    v_mfma_f32_16x16x32_bf16 v[184:187], a[24:27], a[104:107], v[184:187]
    v_mfma_f32_16x16x32_bf16 v[184:187], a[28:31], a[120:123], v[184:187]
    v_mfma_f32_16x16x32_bf16 v[188:191], a[16:19], a[76:79], 0
    v_mfma_f32_16x16x32_bf16 v[188:191], a[20:23], a[92:95], v[188:191]
    buffer_load_dwordx4 a[168:171], v5, s[20:23], s35 offen sc1
    v_mfma_f32_16x16x32_bf16 v[188:191], a[24:27], a[108:111], v[188:191]
    v_mfma_f32_16x16x32_bf16 v[188:191], a[28:31], a[124:127], v[188:191]
    s_waitcnt lgkmcnt(8)
    v_mfma_f32_16x16x32_bf16 v[192:195], a[32:35], a[64:67], 0
    ds_read_b64_tr_b16 a[0:1], v14 offset:0
    v_mfma_f32_16x16x32_bf16 v[192:195], a[36:39], a[80:83], v[192:195]
    ds_read_b64_tr_b16 a[2:3], v14 offset:1024
    v_mfma_f32_16x16x32_bf16 v[192:195], a[40:43], a[96:99], v[192:195]
    ds_read_b64_tr_b16 a[4:5], v14 offset:16384
    v_mfma_f32_16x16x32_bf16 v[192:195], a[44:47], a[112:115], v[192:195]
    ds_read_b64_tr_b16 a[6:7], v14 offset:17408
    buffer_load_dwordx4 a[172:175], v6, s[20:23], s35 offen sc1
    v_mfma_f32_16x16x32_bf16 v[196:199], a[32:35], a[68:71], 0
    ds_read_b64_tr_b16 a[8:9], v14 offset:32768
    s_add_u32 s35, s35, 1024
    v_mfma_f32_16x16x32_bf16 v[196:199], a[36:39], a[84:87], v[196:199]
    ds_read_b64_tr_b16 a[10:11], v14 offset:33792
    v_mfma_f32_16x16x32_bf16 v[196:199], a[40:43], a[100:103], v[196:199]
    ds_read_b64_tr_b16 a[12:13], v14 offset:49152
    v_mfma_f32_16x16x32_bf16 v[196:199], a[44:47], a[116:119], v[196:199]
    ds_read_b64_tr_b16 a[14:15], v14 offset:50176
    v_mfma_f32_16x16x32_bf16 v[200:203], a[32:35], a[72:75], 0
    v_xor_b32 v13, 0x10000, v13
    v_mfma_f32_16x16x32_bf16 v[200:203], a[36:39], a[88:91], v[200:203]
    buffer_load_dwordx4 a[176:179], v3, s[20:23], s35 offen sc1
    v_mfma_f32_16x16x32_bf16 v[200:203], a[40:43], a[104:107], v[200:203]
    v_mfma_f32_16x16x32_bf16 v[200:203], a[44:47], a[120:123], v[200:203]
    v_mfma_f32_16x16x32_bf16 v[204:207], a[32:35], a[76:79], 0
    v_mfma_f32_16x16x32_bf16 v[204:207], a[36:39], a[92:95], v[204:207]
    v_mfma_f32_16x16x32_bf16 v[204:207], a[40:43], a[108:111], v[204:207]
    v_mfma_f32_16x16x32_bf16 v[204:207], a[44:47], a[124:127], v[204:207]
    buffer_load_dwordx4 a[180:183], v4, s[20:23], s35 offen sc1
    s_waitcnt lgkmcnt(8)
    v_mfma_f32_16x16x32_bf16 v[208:211], a[48:51], a[64:67], 0
    ds_read_b64_tr_b16 a[16:17], v14 offset:8192
    v_mfma_f32_16x16x32_bf16 v[208:211], a[52:55], a[80:83], v[208:211]
    ds_read_b64_tr_b16 a[18:19], v14 offset:9216
    v_mfma_f32_16x16x32_bf16 v[208:211], a[56:59], a[96:99], v[208:211]
    ds_read_b64_tr_b16 a[20:21], v14 offset:24576
    v_mfma_f32_16x16x32_bf16 v[208:211], a[60:63], a[112:115], v[208:211]
    ds_read_b64_tr_b16 a[22:23], v14 offset:25600
    v_mfma_f32_16x16x32_bf16 v[212:215], a[48:51], a[68:71], 0
    ds_read_b64_tr_b16 a[24:25], v14 offset:40960
    v_mfma_f32_16x16x32_bf16 v[212:215], a[52:55], a[84:87], v[212:215]
    ds_read_b64_tr_b16 a[26:27], v14 offset:41984
    buffer_load_dwordx4 a[184:187], v5, s[20:23], s35 offen sc1
    v_mfma_f32_16x16x32_bf16 v[212:215], a[56:59], a[100:103], v[212:215]
    ds_read_b64_tr_b16 a[28:29], v14 offset:57344
    v_mfma_f32_16x16x32_bf16 v[212:215], a[60:63], a[116:119], v[212:215]
    ds_read_b64_tr_b16 a[30:31], v14 offset:58368
    v_mfma_f32_16x16x32_bf16 v[216:219], a[48:51], a[72:75], 0
    v_mfma_f32_16x16x32_bf16 v[216:219], a[52:55], a[88:91], v[216:219]
    v_mfma_f32_16x16x32_bf16 v[216:219], a[56:59], a[104:107], v[216:219]
    v_mfma_f32_16x16x32_bf16 v[216:219], a[60:63], a[120:123], v[216:219]
    buffer_load_dwordx4 a[188:191], v6, s[20:23], s35 offen sc1
    v_mfma_f32_16x16x32_bf16 v[220:223], a[48:51], a[76:79], 0
    s_add_u32 s35, s35, 1024
    v_mfma_f32_16x16x32_bf16 v[220:223], a[52:55], a[92:95], v[220:223]
    v_mfma_f32_16x16x32_bf16 v[220:223], a[56:59], a[108:111], v[220:223]
    v_mfma_f32_16x16x32_bf16 v[220:223], a[60:63], a[124:127], v[220:223]
    s_waitcnt vmcnt(16) lgkmcnt(0)
    s_barrier
    v_mfma_f32_16x16x32_bf16 v[224:227], a[0:3], a[64:67], 0
    ds_read_b64_tr_b16 a[32:33], v8 offset:0
    v_mfma_f32_16x16x32_bf16 v[224:227], a[4:7], a[80:83], v[224:227]
    ds_read_b64_tr_b16 a[34:35], v8 offset:1024
    v_mfma_f32_16x16x32_bf16 v[224:227], a[8:11], a[96:99], v[224:227]
    ds_read_b64_tr_b16 a[36:37], v8 offset:16384
    v_mfma_f32_16x16x32_bf16 v[224:227], a[12:15], a[112:115], v[224:227]
    ds_read_b64_tr_b16 a[38:39], v8 offset:17408
    v_mfma_f32_16x16x32_bf16 v[228:231], a[0:3], a[68:71], 0
    ds_read_b64_tr_b16 a[40:41], v8 offset:32768
    v_mfma_f32_16x16x32_bf16 v[228:231], a[4:7], a[84:87], v[228:231]
    ds_read_b64_tr_b16 a[42:43], v8 offset:33792
    v_mfma_f32_16x16x32_bf16 v[228:231], a[8:11], a[100:103], v[228:231]
    ds_read_b64_tr_b16 a[44:45], v8 offset:49152
    v_mfma_f32_16x16x32_bf16 v[228:231], a[12:15], a[116:119], v[228:231]
    ds_read_b64_tr_b16 a[46:47], v8 offset:50176
    v_mfma_f32_16x16x32_bf16 v[232:235], a[0:3], a[72:75], 0
    v_xor_b32 v14, 0x10000, v14
    v_mfma_f32_16x16x32_bf16 v[232:235], a[4:7], a[88:91], v[232:235]
    v_mfma_f32_16x16x32_bf16 v[232:235], a[8:11], a[104:107], v[232:235]
    v_mfma_f32_16x16x32_bf16 v[232:235], a[12:15], a[120:123], v[232:235]
    v_mfma_f32_16x16x32_bf16 v[236:239], a[0:3], a[76:79], 0
    v_mfma_f32_16x16x32_bf16 v[236:239], a[4:7], a[92:95], v[236:239]
    v_mfma_f32_16x16x32_bf16 v[236:239], a[8:11], a[108:111], v[236:239]
    v_mfma_f32_16x16x32_bf16 v[236:239], a[12:15], a[124:127], v[236:239]
    s_waitcnt lgkmcnt(8)
    v_mfma_f32_16x16x32_bf16 v[240:243], a[16:19], a[64:67], 0
    ds_read_b64_tr_b16 a[48:49], v8 offset:8192
    v_mfma_f32_16x16x32_bf16 v[240:243], a[20:23], a[80:83], v[240:243]
    ds_read_b64_tr_b16 a[50:51], v8 offset:9216
    v_mfma_f32_16x16x32_bf16 v[240:243], a[24:27], a[96:99], v[240:243]
    ds_read_b64_tr_b16 a[52:53], v8 offset:24576
    v_mfma_f32_16x16x32_bf16 v[240:243], a[28:31], a[112:115], v[240:243]
    ds_read_b64_tr_b16 a[54:55], v8 offset:25600
    v_mfma_f32_16x16x32_bf16 v[244:247], a[16:19], a[68:71], 0
    ds_read_b64_tr_b16 a[56:57], v8 offset:40960
    v_mfma_f32_16x16x32_bf16 v[244:247], a[20:23], a[84:87], v[244:247]
    ds_read_b64_tr_b16 a[58:59], v8 offset:41984
    v_mfma_f32_16x16x32_bf16 v[244:247], a[24:27], a[100:103], v[244:247]
    ds_read_b64_tr_b16 a[60:61], v8 offset:57344
    v_mfma_f32_16x16x32_bf16 v[244:247], a[28:31], a[116:119], v[244:247]
    ds_read_b64_tr_b16 a[62:63], v8 offset:58368
    v_mfma_f32_16x16x32_bf16 v[248:251], a[16:19], a[72:75], 0
    v_mfma_f32_16x16x32_bf16 v[248:251], a[20:23], a[88:91], v[248:251]
    v_mfma_f32_16x16x32_bf16 v[248:251], a[24:27], a[104:107], v[248:251]
    v_mfma_f32_16x16x32_bf16 v[248:251], a[28:31], a[120:123], v[248:251]
    v_mfma_f32_16x16x32_bf16 v[252:255], a[16:19], a[76:79], 0
    v_mfma_f32_16x16x32_bf16 v[252:255], a[20:23], a[92:95], v[252:255]
    v_mfma_f32_16x16x32_bf16 v[252:255], a[24:27], a[108:111], v[252:255]
    v_mfma_f32_16x16x32_bf16 v[252:255], a[28:31], a[124:127], v[252:255]
    s_mov_b32 s36, 3
.p2align 6
L_gup_k:
    s_waitcnt vmcnt(0)
    s_waitcnt lgkmcnt(8)
    v_mfma_f32_16x16x32_bf16 v[32:35], a[32:35], a[128:131], v[32:35]
    ds_read_b64_tr_b16 a[0:1], v9 offset:0
    s_add_u32 m0, s33, 0
    s_add_u32 s32, s31, 28672
    v_mfma_f32_16x16x32_bf16 v[32:35], a[36:39], a[144:147], v[32:35]
    ds_read_b64_tr_b16 a[2:3], v9 offset:1024
    buffer_load_dwordx4 v2, s[12:15], s31 offen lds
    v_mfma_f32_16x16x32_bf16 v[32:35], a[40:43], a[160:163], v[32:35]
    ds_read_b64_tr_b16 a[4:5], v9 offset:16384
    v_mfma_f32_16x16x32_bf16 v[32:35], a[44:47], a[176:179], v[32:35]
    ds_read_b64_tr_b16 a[6:7], v9 offset:17408
    v_mfma_f32_16x16x32_bf16 v[36:39], a[32:35], a[132:135], v[36:39]
    ds_read_b64_tr_b16 a[8:9], v9 offset:32768
    v_mfma_f32_16x16x32_bf16 v[36:39], a[36:39], a[148:151], v[36:39]
    ds_read_b64_tr_b16 a[10:11], v9 offset:33792
    v_mfma_f32_16x16x32_bf16 v[36:39], a[40:43], a[164:167], v[36:39]
    ds_read_b64_tr_b16 a[12:13], v9 offset:49152
    s_add_u32 m0, s33, 1024
    v_mfma_f32_16x16x32_bf16 v[36:39], a[44:47], a[180:183], v[36:39]
    ds_read_b64_tr_b16 a[14:15], v9 offset:50176
    buffer_load_dwordx4 v2, s[12:15], s32 offen lds
    v_mfma_f32_16x16x32_bf16 v[40:43], a[32:35], a[136:139], v[40:43]
    v_xor_b32 v8, 0x10000, v8
    v_mfma_f32_16x16x32_bf16 v[40:43], a[36:39], a[152:155], v[40:43]
    v_mfma_f32_16x16x32_bf16 v[40:43], a[40:43], a[168:171], v[40:43]
    v_mfma_f32_16x16x32_bf16 v[40:43], a[44:47], a[184:187], v[40:43]
    v_mfma_f32_16x16x32_bf16 v[44:47], a[32:35], a[140:143], v[44:47]
    s_add_u32 m0, s33, 8192
    v_mfma_f32_16x16x32_bf16 v[44:47], a[36:39], a[156:159], v[44:47]
    buffer_load_dwordx4 v2, s[16:19], s31 offen lds
    v_mfma_f32_16x16x32_bf16 v[44:47], a[40:43], a[172:175], v[44:47]
    v_mfma_f32_16x16x32_bf16 v[44:47], a[44:47], a[188:191], v[44:47]
    s_waitcnt lgkmcnt(8)
    v_mfma_f32_16x16x32_bf16 v[48:51], a[48:51], a[128:131], v[48:51]
    ds_read_b64_tr_b16 a[16:17], v9 offset:8192
    v_mfma_f32_16x16x32_bf16 v[48:51], a[52:55], a[144:147], v[48:51]
    ds_read_b64_tr_b16 a[18:19], v9 offset:9216
    v_mfma_f32_16x16x32_bf16 v[48:51], a[56:59], a[160:163], v[48:51]
    ds_read_b64_tr_b16 a[20:21], v9 offset:24576
    s_add_u32 m0, s33, 9216
    v_mfma_f32_16x16x32_bf16 v[48:51], a[60:63], a[176:179], v[48:51]
    ds_read_b64_tr_b16 a[22:23], v9 offset:25600
    buffer_load_dwordx4 v2, s[16:19], s32 offen lds
    v_mfma_f32_16x16x32_bf16 v[52:55], a[48:51], a[132:135], v[52:55]
    ds_read_b64_tr_b16 a[24:25], v9 offset:40960
    s_add_u32 s31, s31, 229376
    v_mfma_f32_16x16x32_bf16 v[52:55], a[52:55], a[148:151], v[52:55]
    ds_read_b64_tr_b16 a[26:27], v9 offset:41984
    v_mfma_f32_16x16x32_bf16 v[52:55], a[56:59], a[164:167], v[52:55]
    ds_read_b64_tr_b16 a[28:29], v9 offset:57344
    v_mfma_f32_16x16x32_bf16 v[52:55], a[60:63], a[180:183], v[52:55]
    ds_read_b64_tr_b16 a[30:31], v9 offset:58368
    v_mfma_f32_16x16x32_bf16 v[56:59], a[48:51], a[136:139], v[56:59]
    s_add_u32 m0, s33, 16384
    s_add_u32 s32, s31, 28672
    v_mfma_f32_16x16x32_bf16 v[56:59], a[52:55], a[152:155], v[56:59]
    buffer_load_dwordx4 v2, s[12:15], s31 offen lds
    v_mfma_f32_16x16x32_bf16 v[56:59], a[56:59], a[168:171], v[56:59]
    v_mfma_f32_16x16x32_bf16 v[56:59], a[60:63], a[184:187], v[56:59]
    v_mfma_f32_16x16x32_bf16 v[60:63], a[48:51], a[140:143], v[60:63]
    v_mfma_f32_16x16x32_bf16 v[60:63], a[52:55], a[156:159], v[60:63]
    v_mfma_f32_16x16x32_bf16 v[60:63], a[56:59], a[172:175], v[60:63]
    s_add_u32 m0, s33, 17408
    v_mfma_f32_16x16x32_bf16 v[60:63], a[60:63], a[188:191], v[60:63]
    buffer_load_dwordx4 v2, s[12:15], s32 offen lds
    s_waitcnt lgkmcnt(8)
    v_mfma_f32_16x16x32_bf16 v[64:67], a[0:3], a[128:131], v[64:67]
    ds_read_b64_tr_b16 a[32:33], v10 offset:0
    v_mfma_f32_16x16x32_bf16 v[64:67], a[4:7], a[144:147], v[64:67]
    ds_read_b64_tr_b16 a[34:35], v10 offset:1024
    v_mfma_f32_16x16x32_bf16 v[64:67], a[8:11], a[160:163], v[64:67]
    ds_read_b64_tr_b16 a[36:37], v10 offset:16384
    v_mfma_f32_16x16x32_bf16 v[64:67], a[12:15], a[176:179], v[64:67]
    ds_read_b64_tr_b16 a[38:39], v10 offset:17408
    v_mfma_f32_16x16x32_bf16 v[68:71], a[0:3], a[132:135], v[68:71]
    ds_read_b64_tr_b16 a[40:41], v10 offset:32768
    s_add_u32 m0, s33, 24576
    v_mfma_f32_16x16x32_bf16 v[68:71], a[4:7], a[148:151], v[68:71]
    ds_read_b64_tr_b16 a[42:43], v10 offset:33792
    buffer_load_dwordx4 v2, s[16:19], s31 offen lds
    v_mfma_f32_16x16x32_bf16 v[68:71], a[8:11], a[164:167], v[68:71]
    ds_read_b64_tr_b16 a[44:45], v10 offset:49152
    v_mfma_f32_16x16x32_bf16 v[68:71], a[12:15], a[180:183], v[68:71]
    ds_read_b64_tr_b16 a[46:47], v10 offset:50176
    v_mfma_f32_16x16x32_bf16 v[72:75], a[0:3], a[136:139], v[72:75]
    v_xor_b32 v9, 0x10000, v9
    v_mfma_f32_16x16x32_bf16 v[72:75], a[4:7], a[152:155], v[72:75]
    v_mfma_f32_16x16x32_bf16 v[72:75], a[8:11], a[168:171], v[72:75]
    s_add_u32 m0, s33, 25600
    v_mfma_f32_16x16x32_bf16 v[72:75], a[12:15], a[184:187], v[72:75]
    buffer_load_dwordx4 v2, s[16:19], s32 offen lds
    v_mfma_f32_16x16x32_bf16 v[76:79], a[0:3], a[140:143], v[76:79]
    s_add_u32 s31, s31, 229376
    v_mfma_f32_16x16x32_bf16 v[76:79], a[4:7], a[156:159], v[76:79]
    v_mfma_f32_16x16x32_bf16 v[76:79], a[8:11], a[172:175], v[76:79]
    v_mfma_f32_16x16x32_bf16 v[76:79], a[12:15], a[188:191], v[76:79]
    s_waitcnt lgkmcnt(8)
    v_mfma_f32_16x16x32_bf16 v[80:83], a[16:19], a[128:131], v[80:83]
    ds_read_b64_tr_b16 a[48:49], v10 offset:8192
    s_add_u32 m0, s33, 32768
    s_add_u32 s32, s31, 28672
    v_mfma_f32_16x16x32_bf16 v[80:83], a[20:23], a[144:147], v[80:83]
    ds_read_b64_tr_b16 a[50:51], v10 offset:9216
    buffer_load_dwordx4 v2, s[12:15], s31 offen lds
    v_mfma_f32_16x16x32_bf16 v[80:83], a[24:27], a[160:163], v[80:83]
    ds_read_b64_tr_b16 a[52:53], v10 offset:24576
    v_mfma_f32_16x16x32_bf16 v[80:83], a[28:31], a[176:179], v[80:83]
    ds_read_b64_tr_b16 a[54:55], v10 offset:25600
    v_mfma_f32_16x16x32_bf16 v[84:87], a[16:19], a[132:135], v[84:87]
    ds_read_b64_tr_b16 a[56:57], v10 offset:40960
    v_mfma_f32_16x16x32_bf16 v[84:87], a[20:23], a[148:151], v[84:87]
    ds_read_b64_tr_b16 a[58:59], v10 offset:41984
    v_mfma_f32_16x16x32_bf16 v[84:87], a[24:27], a[164:167], v[84:87]
    ds_read_b64_tr_b16 a[60:61], v10 offset:57344
    s_add_u32 m0, s33, 33792
    v_mfma_f32_16x16x32_bf16 v[84:87], a[28:31], a[180:183], v[84:87]
    ds_read_b64_tr_b16 a[62:63], v10 offset:58368
    buffer_load_dwordx4 v2, s[12:15], s32 offen lds
    v_mfma_f32_16x16x32_bf16 v[88:91], a[16:19], a[136:139], v[88:91]
    v_mfma_f32_16x16x32_bf16 v[88:91], a[20:23], a[152:155], v[88:91]
    v_mfma_f32_16x16x32_bf16 v[88:91], a[24:27], a[168:171], v[88:91]
    v_mfma_f32_16x16x32_bf16 v[88:91], a[28:31], a[184:187], v[88:91]
    v_mfma_f32_16x16x32_bf16 v[92:95], a[16:19], a[140:143], v[92:95]
    s_add_u32 m0, s33, 40960
    v_mfma_f32_16x16x32_bf16 v[92:95], a[20:23], a[156:159], v[92:95]
    buffer_load_dwordx4 v2, s[16:19], s31 offen lds
    v_mfma_f32_16x16x32_bf16 v[92:95], a[24:27], a[172:175], v[92:95]
    v_mfma_f32_16x16x32_bf16 v[92:95], a[28:31], a[188:191], v[92:95]
    s_waitcnt lgkmcnt(8)
    v_mfma_f32_16x16x32_bf16 v[96:99], a[32:35], a[128:131], v[96:99]
    ds_read_b64_tr_b16 a[0:1], v11 offset:0
    v_mfma_f32_16x16x32_bf16 v[96:99], a[36:39], a[144:147], v[96:99]
    ds_read_b64_tr_b16 a[2:3], v11 offset:1024
    v_mfma_f32_16x16x32_bf16 v[96:99], a[40:43], a[160:163], v[96:99]
    ds_read_b64_tr_b16 a[4:5], v11 offset:16384
    s_add_u32 m0, s33, 41984
    v_mfma_f32_16x16x32_bf16 v[96:99], a[44:47], a[176:179], v[96:99]
    ds_read_b64_tr_b16 a[6:7], v11 offset:17408
    buffer_load_dwordx4 v2, s[16:19], s32 offen lds
    v_mfma_f32_16x16x32_bf16 v[100:103], a[32:35], a[132:135], v[100:103]
    ds_read_b64_tr_b16 a[8:9], v11 offset:32768
    s_add_u32 s31, s31, 229376
    v_mfma_f32_16x16x32_bf16 v[100:103], a[36:39], a[148:151], v[100:103]
    ds_read_b64_tr_b16 a[10:11], v11 offset:33792
    v_mfma_f32_16x16x32_bf16 v[100:103], a[40:43], a[164:167], v[100:103]
    ds_read_b64_tr_b16 a[12:13], v11 offset:49152
    v_mfma_f32_16x16x32_bf16 v[100:103], a[44:47], a[180:183], v[100:103]
    ds_read_b64_tr_b16 a[14:15], v11 offset:50176
    v_mfma_f32_16x16x32_bf16 v[104:107], a[32:35], a[136:139], v[104:107]
    v_xor_b32 v10, 0x10000, v10
    s_add_u32 m0, s33, 49152
    s_add_u32 s32, s31, 28672
    v_mfma_f32_16x16x32_bf16 v[104:107], a[36:39], a[152:155], v[104:107]
    buffer_load_dwordx4 v2, s[12:15], s31 offen lds
    v_mfma_f32_16x16x32_bf16 v[104:107], a[40:43], a[168:171], v[104:107]
    v_mfma_f32_16x16x32_bf16 v[104:107], a[44:47], a[184:187], v[104:107]
    v_mfma_f32_16x16x32_bf16 v[108:111], a[32:35], a[140:143], v[108:111]
    v_mfma_f32_16x16x32_bf16 v[108:111], a[36:39], a[156:159], v[108:111]
    v_mfma_f32_16x16x32_bf16 v[108:111], a[40:43], a[172:175], v[108:111]
    s_add_u32 m0, s33, 50176
    v_mfma_f32_16x16x32_bf16 v[108:111], a[44:47], a[188:191], v[108:111]
    buffer_load_dwordx4 v2, s[12:15], s32 offen lds
    s_waitcnt lgkmcnt(8)
    v_mfma_f32_16x16x32_bf16 v[112:115], a[48:51], a[128:131], v[112:115]
    ds_read_b64_tr_b16 a[16:17], v11 offset:8192
    v_mfma_f32_16x16x32_bf16 v[112:115], a[52:55], a[144:147], v[112:115]
    ds_read_b64_tr_b16 a[18:19], v11 offset:9216
    v_mfma_f32_16x16x32_bf16 v[112:115], a[56:59], a[160:163], v[112:115]
    ds_read_b64_tr_b16 a[20:21], v11 offset:24576
    v_mfma_f32_16x16x32_bf16 v[112:115], a[60:63], a[176:179], v[112:115]
    ds_read_b64_tr_b16 a[22:23], v11 offset:25600
    v_mfma_f32_16x16x32_bf16 v[116:119], a[48:51], a[132:135], v[116:119]
    ds_read_b64_tr_b16 a[24:25], v11 offset:40960
    s_add_u32 m0, s33, 57344
    v_mfma_f32_16x16x32_bf16 v[116:119], a[52:55], a[148:151], v[116:119]
    ds_read_b64_tr_b16 a[26:27], v11 offset:41984
    buffer_load_dwordx4 v2, s[16:19], s31 offen lds
    v_mfma_f32_16x16x32_bf16 v[116:119], a[56:59], a[164:167], v[116:119]
    ds_read_b64_tr_b16 a[28:29], v11 offset:57344
    v_mfma_f32_16x16x32_bf16 v[116:119], a[60:63], a[180:183], v[116:119]
    ds_read_b64_tr_b16 a[30:31], v11 offset:58368
    v_mfma_f32_16x16x32_bf16 v[120:123], a[48:51], a[136:139], v[120:123]
    v_mfma_f32_16x16x32_bf16 v[120:123], a[52:55], a[152:155], v[120:123]
    v_mfma_f32_16x16x32_bf16 v[120:123], a[56:59], a[168:171], v[120:123]
    s_add_u32 m0, s33, 58368
    v_mfma_f32_16x16x32_bf16 v[120:123], a[60:63], a[184:187], v[120:123]
    buffer_load_dwordx4 v2, s[16:19], s32 offen lds
    v_mfma_f32_16x16x32_bf16 v[124:127], a[48:51], a[140:143], v[124:127]
    s_add_u32 s31, s31, 229376
    v_mfma_f32_16x16x32_bf16 v[124:127], a[52:55], a[156:159], v[124:127]
    v_mfma_f32_16x16x32_bf16 v[124:127], a[56:59], a[172:175], v[124:127]
    v_mfma_f32_16x16x32_bf16 v[124:127], a[60:63], a[188:191], v[124:127]
    s_waitcnt lgkmcnt(8)
    v_mfma_f32_16x16x32_bf16 v[128:131], a[0:3], a[128:131], v[128:131]
    ds_read_b64_tr_b16 a[32:33], v12 offset:0
    v_mfma_f32_16x16x32_bf16 v[128:131], a[4:7], a[144:147], v[128:131]
    ds_read_b64_tr_b16 a[34:35], v12 offset:1024
    buffer_load_dwordx4 a[64:67], v3, s[20:23], s35 offen sc1
    v_mfma_f32_16x16x32_bf16 v[128:131], a[8:11], a[160:163], v[128:131]
    ds_read_b64_tr_b16 a[36:37], v12 offset:16384
    v_mfma_f32_16x16x32_bf16 v[128:131], a[12:15], a[176:179], v[128:131]
    ds_read_b64_tr_b16 a[38:39], v12 offset:17408
    v_mfma_f32_16x16x32_bf16 v[132:135], a[0:3], a[132:135], v[132:135]
    ds_read_b64_tr_b16 a[40:41], v12 offset:32768
    v_mfma_f32_16x16x32_bf16 v[132:135], a[4:7], a[148:151], v[132:135]
    ds_read_b64_tr_b16 a[42:43], v12 offset:33792
    v_mfma_f32_16x16x32_bf16 v[132:135], a[8:11], a[164:167], v[132:135]
    ds_read_b64_tr_b16 a[44:45], v12 offset:49152
    v_mfma_f32_16x16x32_bf16 v[132:135], a[12:15], a[180:183], v[132:135]
    ds_read_b64_tr_b16 a[46:47], v12 offset:50176
    buffer_load_dwordx4 a[68:71], v4, s[20:23], s35 offen sc1
    v_mfma_f32_16x16x32_bf16 v[136:139], a[0:3], a[136:139], v[136:139]
    v_xor_b32 v11, 0x10000, v11
    v_mfma_f32_16x16x32_bf16 v[136:139], a[4:7], a[152:155], v[136:139]
    v_mfma_f32_16x16x32_bf16 v[136:139], a[8:11], a[168:171], v[136:139]
    v_mfma_f32_16x16x32_bf16 v[136:139], a[12:15], a[184:187], v[136:139]
    v_mfma_f32_16x16x32_bf16 v[140:143], a[0:3], a[140:143], v[140:143]
    v_mfma_f32_16x16x32_bf16 v[140:143], a[4:7], a[156:159], v[140:143]
    buffer_load_dwordx4 a[72:75], v5, s[20:23], s35 offen sc1
    v_mfma_f32_16x16x32_bf16 v[140:143], a[8:11], a[172:175], v[140:143]
    v_mfma_f32_16x16x32_bf16 v[140:143], a[12:15], a[188:191], v[140:143]
    s_waitcnt lgkmcnt(8)
    v_mfma_f32_16x16x32_bf16 v[144:147], a[16:19], a[128:131], v[144:147]
    ds_read_b64_tr_b16 a[48:49], v12 offset:8192
    v_mfma_f32_16x16x32_bf16 v[144:147], a[20:23], a[144:147], v[144:147]
    ds_read_b64_tr_b16 a[50:51], v12 offset:9216
    v_mfma_f32_16x16x32_bf16 v[144:147], a[24:27], a[160:163], v[144:147]
    ds_read_b64_tr_b16 a[52:53], v12 offset:24576
    v_mfma_f32_16x16x32_bf16 v[144:147], a[28:31], a[176:179], v[144:147]
    ds_read_b64_tr_b16 a[54:55], v12 offset:25600
    buffer_load_dwordx4 a[76:79], v6, s[20:23], s35 offen sc1
    v_mfma_f32_16x16x32_bf16 v[148:151], a[16:19], a[132:135], v[148:151]
    ds_read_b64_tr_b16 a[56:57], v12 offset:40960
    s_add_u32 s35, s35, 1024
    v_mfma_f32_16x16x32_bf16 v[148:151], a[20:23], a[148:151], v[148:151]
    ds_read_b64_tr_b16 a[58:59], v12 offset:41984
    v_mfma_f32_16x16x32_bf16 v[148:151], a[24:27], a[164:167], v[148:151]
    ds_read_b64_tr_b16 a[60:61], v12 offset:57344
    v_mfma_f32_16x16x32_bf16 v[148:151], a[28:31], a[180:183], v[148:151]
    ds_read_b64_tr_b16 a[62:63], v12 offset:58368
    v_mfma_f32_16x16x32_bf16 v[152:155], a[16:19], a[136:139], v[152:155]
    v_mfma_f32_16x16x32_bf16 v[152:155], a[20:23], a[152:155], v[152:155]
    buffer_load_dwordx4 a[80:83], v3, s[20:23], s35 offen sc1
    v_mfma_f32_16x16x32_bf16 v[152:155], a[24:27], a[168:171], v[152:155]
    v_mfma_f32_16x16x32_bf16 v[152:155], a[28:31], a[184:187], v[152:155]
    v_mfma_f32_16x16x32_bf16 v[156:159], a[16:19], a[140:143], v[156:159]
    v_mfma_f32_16x16x32_bf16 v[156:159], a[20:23], a[156:159], v[156:159]
    v_mfma_f32_16x16x32_bf16 v[156:159], a[24:27], a[172:175], v[156:159]
    v_mfma_f32_16x16x32_bf16 v[156:159], a[28:31], a[188:191], v[156:159]
    buffer_load_dwordx4 a[84:87], v4, s[20:23], s35 offen sc1
    s_waitcnt lgkmcnt(8)
    v_mfma_f32_16x16x32_bf16 v[160:163], a[32:35], a[128:131], v[160:163]
    ds_read_b64_tr_b16 a[0:1], v13 offset:0
    v_mfma_f32_16x16x32_bf16 v[160:163], a[36:39], a[144:147], v[160:163]
    ds_read_b64_tr_b16 a[2:3], v13 offset:1024
    v_mfma_f32_16x16x32_bf16 v[160:163], a[40:43], a[160:163], v[160:163]
    ds_read_b64_tr_b16 a[4:5], v13 offset:16384
    v_mfma_f32_16x16x32_bf16 v[160:163], a[44:47], a[176:179], v[160:163]
    ds_read_b64_tr_b16 a[6:7], v13 offset:17408
    v_mfma_f32_16x16x32_bf16 v[164:167], a[32:35], a[132:135], v[164:167]
    ds_read_b64_tr_b16 a[8:9], v13 offset:32768
    v_mfma_f32_16x16x32_bf16 v[164:167], a[36:39], a[148:151], v[164:167]
    ds_read_b64_tr_b16 a[10:11], v13 offset:33792
    buffer_load_dwordx4 a[88:91], v5, s[20:23], s35 offen sc1
    v_mfma_f32_16x16x32_bf16 v[164:167], a[40:43], a[164:167], v[164:167]
    ds_read_b64_tr_b16 a[12:13], v13 offset:49152
    v_mfma_f32_16x16x32_bf16 v[164:167], a[44:47], a[180:183], v[164:167]
    ds_read_b64_tr_b16 a[14:15], v13 offset:50176
    v_mfma_f32_16x16x32_bf16 v[168:171], a[32:35], a[136:139], v[168:171]
    v_xor_b32 v12, 0x10000, v12
    v_mfma_f32_16x16x32_bf16 v[168:171], a[36:39], a[152:155], v[168:171]
    v_mfma_f32_16x16x32_bf16 v[168:171], a[40:43], a[168:171], v[168:171]
    v_mfma_f32_16x16x32_bf16 v[168:171], a[44:47], a[184:187], v[168:171]
    buffer_load_dwordx4 a[92:95], v6, s[20:23], s35 offen sc1
    v_mfma_f32_16x16x32_bf16 v[172:175], a[32:35], a[140:143], v[172:175]
    s_add_u32 s35, s35, 1024
    v_mfma_f32_16x16x32_bf16 v[172:175], a[36:39], a[156:159], v[172:175]
    v_mfma_f32_16x16x32_bf16 v[172:175], a[40:43], a[172:175], v[172:175]
    v_mfma_f32_16x16x32_bf16 v[172:175], a[44:47], a[188:191], v[172:175]
    s_waitcnt lgkmcnt(8)
    v_mfma_f32_16x16x32_bf16 v[176:179], a[48:51], a[128:131], v[176:179]
    ds_read_b64_tr_b16 a[16:17], v13 offset:8192
    v_mfma_f32_16x16x32_bf16 v[176:179], a[52:55], a[144:147], v[176:179]
    ds_read_b64_tr_b16 a[18:19], v13 offset:9216
    buffer_load_dwordx4 a[96:99], v3, s[20:23], s35 offen sc1
    v_mfma_f32_16x16x32_bf16 v[176:179], a[56:59], a[160:163], v[176:179]
    ds_read_b64_tr_b16 a[20:21], v13 offset:24576
    v_mfma_f32_16x16x32_bf16 v[176:179], a[60:63], a[176:179], v[176:179]
    ds_read_b64_tr_b16 a[22:23], v13 offset:25600
    v_mfma_f32_16x16x32_bf16 v[180:183], a[48:51], a[132:135], v[180:183]
    ds_read_b64_tr_b16 a[24:25], v13 offset:40960
    v_mfma_f32_16x16x32_bf16 v[180:183], a[52:55], a[148:151], v[180:183]
    ds_read_b64_tr_b16 a[26:27], v13 offset:41984
    v_mfma_f32_16x16x32_bf16 v[180:183], a[56:59], a[164:167], v[180:183]
    ds_read_b64_tr_b16 a[28:29], v13 offset:57344
    v_mfma_f32_16x16x32_bf16 v[180:183], a[60:63], a[180:183], v[180:183]
    ds_read_b64_tr_b16 a[30:31], v13 offset:58368
    buffer_load_dwordx4 a[100:103], v4, s[20:23], s35 offen sc1
    v_mfma_f32_16x16x32_bf16 v[184:187], a[48:51], a[136:139], v[184:187]
    v_mfma_f32_16x16x32_bf16 v[184:187], a[52:55], a[152:155], v[184:187]
    v_mfma_f32_16x16x32_bf16 v[184:187], a[56:59], a[168:171], v[184:187]
    v_mfma_f32_16x16x32_bf16 v[184:187], a[60:63], a[184:187], v[184:187]
    v_mfma_f32_16x16x32_bf16 v[188:191], a[48:51], a[140:143], v[188:191]
    v_mfma_f32_16x16x32_bf16 v[188:191], a[52:55], a[156:159], v[188:191]
    buffer_load_dwordx4 a[104:107], v5, s[20:23], s35 offen sc1
    v_mfma_f32_16x16x32_bf16 v[188:191], a[56:59], a[172:175], v[188:191]
    v_mfma_f32_16x16x32_bf16 v[188:191], a[60:63], a[188:191], v[188:191]
    s_waitcnt lgkmcnt(8)
    v_mfma_f32_16x16x32_bf16 v[192:195], a[0:3], a[128:131], v[192:195]
    ds_read_b64_tr_b16 a[32:33], v14 offset:0
    v_mfma_f32_16x16x32_bf16 v[192:195], a[4:7], a[144:147], v[192:195]
    ds_read_b64_tr_b16 a[34:35], v14 offset:1024
    v_mfma_f32_16x16x32_bf16 v[192:195], a[8:11], a[160:163], v[192:195]
    ds_read_b64_tr_b16 a[36:37], v14 offset:16384
    v_mfma_f32_16x16x32_bf16 v[192:195], a[12:15], a[176:179], v[192:195]
    ds_read_b64_tr_b16 a[38:39], v14 offset:17408
    buffer_load_dwordx4 a[108:111], v6, s[20:23], s35 offen sc1
    v_mfma_f32_16x16x32_bf16 v[196:199], a[0:3], a[132:135], v[196:199]
    ds_read_b64_tr_b16 a[40:41], v14 offset:32768
    s_add_u32 s35, s35, 1024
    v_mfma_f32_16x16x32_bf16 v[196:199], a[4:7], a[148:151], v[196:199]
    ds_read_b64_tr_b16 a[42:43], v14 offset:33792
    v_mfma_f32_16x16x32_bf16 v[196:199], a[8:11], a[164:167], v[196:199]
    ds_read_b64_tr_b16 a[44:45], v14 offset:49152
    v_mfma_f32_16x16x32_bf16 v[196:199], a[12:15], a[180:183], v[196:199]
    ds_read_b64_tr_b16 a[46:47], v14 offset:50176
    v_mfma_f32_16x16x32_bf16 v[200:203], a[0:3], a[136:139], v[200:203]
    v_xor_b32 v13, 0x10000, v13
    v_mfma_f32_16x16x32_bf16 v[200:203], a[4:7], a[152:155], v[200:203]
    buffer_load_dwordx4 a[112:115], v3, s[20:23], s35 offen sc1
    v_mfma_f32_16x16x32_bf16 v[200:203], a[8:11], a[168:171], v[200:203]
    v_mfma_f32_16x16x32_bf16 v[200:203], a[12:15], a[184:187], v[200:203]
    v_mfma_f32_16x16x32_bf16 v[204:207], a[0:3], a[140:143], v[204:207]
    v_mfma_f32_16x16x32_bf16 v[204:207], a[4:7], a[156:159], v[204:207]
    v_mfma_f32_16x16x32_bf16 v[204:207], a[8:11], a[172:175], v[204:207]
    v_mfma_f32_16x16x32_bf16 v[204:207], a[12:15], a[188:191], v[204:207]
    buffer_load_dwordx4 a[116:119], v4, s[20:23], s35 offen sc1
    s_waitcnt lgkmcnt(8)
    v_mfma_f32_16x16x32_bf16 v[208:211], a[16:19], a[128:131], v[208:211]
    ds_read_b64_tr_b16 a[48:49], v14 offset:8192
    v_mfma_f32_16x16x32_bf16 v[208:211], a[20:23], a[144:147], v[208:211]
    ds_read_b64_tr_b16 a[50:51], v14 offset:9216
    v_mfma_f32_16x16x32_bf16 v[208:211], a[24:27], a[160:163], v[208:211]
    ds_read_b64_tr_b16 a[52:53], v14 offset:24576
    v_mfma_f32_16x16x32_bf16 v[208:211], a[28:31], a[176:179], v[208:211]
    ds_read_b64_tr_b16 a[54:55], v14 offset:25600
    v_mfma_f32_16x16x32_bf16 v[212:215], a[16:19], a[132:135], v[212:215]
    ds_read_b64_tr_b16 a[56:57], v14 offset:40960
    v_mfma_f32_16x16x32_bf16 v[212:215], a[20:23], a[148:151], v[212:215]
    ds_read_b64_tr_b16 a[58:59], v14 offset:41984
    buffer_load_dwordx4 a[120:123], v5, s[20:23], s35 offen sc1
    v_mfma_f32_16x16x32_bf16 v[212:215], a[24:27], a[164:167], v[212:215]
    ds_read_b64_tr_b16 a[60:61], v14 offset:57344
    v_mfma_f32_16x16x32_bf16 v[212:215], a[28:31], a[180:183], v[212:215]
    ds_read_b64_tr_b16 a[62:63], v14 offset:58368
    v_mfma_f32_16x16x32_bf16 v[216:219], a[16:19], a[136:139], v[216:219]
    v_mfma_f32_16x16x32_bf16 v[216:219], a[20:23], a[152:155], v[216:219]
    v_mfma_f32_16x16x32_bf16 v[216:219], a[24:27], a[168:171], v[216:219]
    v_mfma_f32_16x16x32_bf16 v[216:219], a[28:31], a[184:187], v[216:219]
    buffer_load_dwordx4 a[124:127], v6, s[20:23], s35 offen sc1
    v_mfma_f32_16x16x32_bf16 v[220:223], a[16:19], a[140:143], v[220:223]
    s_add_u32 s35, s35, 1024
    v_mfma_f32_16x16x32_bf16 v[220:223], a[20:23], a[156:159], v[220:223]
    v_mfma_f32_16x16x32_bf16 v[220:223], a[24:27], a[172:175], v[220:223]
    v_mfma_f32_16x16x32_bf16 v[220:223], a[28:31], a[188:191], v[220:223]
    s_waitcnt vmcnt(16) lgkmcnt(0)
    s_barrier
    v_mfma_f32_16x16x32_bf16 v[224:227], a[32:35], a[128:131], v[224:227]
    ds_read_b64_tr_b16 a[0:1], v8 offset:0
    v_mfma_f32_16x16x32_bf16 v[224:227], a[36:39], a[144:147], v[224:227]
    ds_read_b64_tr_b16 a[2:3], v8 offset:1024
    v_mfma_f32_16x16x32_bf16 v[224:227], a[40:43], a[160:163], v[224:227]
    ds_read_b64_tr_b16 a[4:5], v8 offset:16384
    v_mfma_f32_16x16x32_bf16 v[224:227], a[44:47], a[176:179], v[224:227]
    ds_read_b64_tr_b16 a[6:7], v8 offset:17408
    v_mfma_f32_16x16x32_bf16 v[228:231], a[32:35], a[132:135], v[228:231]
    ds_read_b64_tr_b16 a[8:9], v8 offset:32768
    v_mfma_f32_16x16x32_bf16 v[228:231], a[36:39], a[148:151], v[228:231]
    ds_read_b64_tr_b16 a[10:11], v8 offset:33792
    v_mfma_f32_16x16x32_bf16 v[228:231], a[40:43], a[164:167], v[228:231]
    ds_read_b64_tr_b16 a[12:13], v8 offset:49152
    v_mfma_f32_16x16x32_bf16 v[228:231], a[44:47], a[180:183], v[228:231]
    ds_read_b64_tr_b16 a[14:15], v8 offset:50176
    v_mfma_f32_16x16x32_bf16 v[232:235], a[32:35], a[136:139], v[232:235]
    v_xor_b32 v14, 0x10000, v14
    v_mfma_f32_16x16x32_bf16 v[232:235], a[36:39], a[152:155], v[232:235]
    v_mfma_f32_16x16x32_bf16 v[232:235], a[40:43], a[168:171], v[232:235]
    v_mfma_f32_16x16x32_bf16 v[232:235], a[44:47], a[184:187], v[232:235]
    v_mfma_f32_16x16x32_bf16 v[236:239], a[32:35], a[140:143], v[236:239]
    v_mfma_f32_16x16x32_bf16 v[236:239], a[36:39], a[156:159], v[236:239]
    v_mfma_f32_16x16x32_bf16 v[236:239], a[40:43], a[172:175], v[236:239]
    v_mfma_f32_16x16x32_bf16 v[236:239], a[44:47], a[188:191], v[236:239]
    s_waitcnt lgkmcnt(8)
    v_mfma_f32_16x16x32_bf16 v[240:243], a[48:51], a[128:131], v[240:243]
    ds_read_b64_tr_b16 a[16:17], v8 offset:8192
    v_mfma_f32_16x16x32_bf16 v[240:243], a[52:55], a[144:147], v[240:243]
    ds_read_b64_tr_b16 a[18:19], v8 offset:9216
    v_mfma_f32_16x16x32_bf16 v[240:243], a[56:59], a[160:163], v[240:243]
    ds_read_b64_tr_b16 a[20:21], v8 offset:24576
    v_mfma_f32_16x16x32_bf16 v[240:243], a[60:63], a[176:179], v[240:243]
    ds_read_b64_tr_b16 a[22:23], v8 offset:25600
    v_mfma_f32_16x16x32_bf16 v[244:247], a[48:51], a[132:135], v[244:247]
    ds_read_b64_tr_b16 a[24:25], v8 offset:40960
    v_mfma_f32_16x16x32_bf16 v[244:247], a[52:55], a[148:151], v[244:247]
    ds_read_b64_tr_b16 a[26:27], v8 offset:41984
    v_mfma_f32_16x16x32_bf16 v[244:247], a[56:59], a[164:167], v[244:247]
    ds_read_b64_tr_b16 a[28:29], v8 offset:57344
    v_mfma_f32_16x16x32_bf16 v[244:247], a[60:63], a[180:183], v[244:247]
    ds_read_b64_tr_b16 a[30:31], v8 offset:58368
    v_mfma_f32_16x16x32_bf16 v[248:251], a[48:51], a[136:139], v[248:251]
    v_mfma_f32_16x16x32_bf16 v[248:251], a[52:55], a[152:155], v[248:251]
    v_mfma_f32_16x16x32_bf16 v[248:251], a[56:59], a[168:171], v[248:251]
    v_mfma_f32_16x16x32_bf16 v[248:251], a[60:63], a[184:187], v[248:251]
    v_mfma_f32_16x16x32_bf16 v[252:255], a[48:51], a[140:143], v[252:255]
    v_mfma_f32_16x16x32_bf16 v[252:255], a[52:55], a[156:159], v[252:255]
    v_mfma_f32_16x16x32_bf16 v[252:255], a[56:59], a[172:175], v[252:255]
    v_mfma_f32_16x16x32_bf16 v[252:255], a[60:63], a[188:191], v[252:255]
    s_waitcnt vmcnt(0)
    s_waitcnt lgkmcnt(8)
    v_mfma_f32_16x16x32_bf16 v[32:35], a[0:3], a[64:67], v[32:35]
    ds_read_b64_tr_b16 a[32:33], v9 offset:0
    s_add_u32 m0, s33, 65536
    s_add_u32 s32, s31, 28672
    v_mfma_f32_16x16x32_bf16 v[32:35], a[4:7], a[80:83], v[32:35]
    ds_read_b64_tr_b16 a[34:35], v9 offset:1024
    buffer_load_dwordx4 v2, s[12:15], s31 offen lds
    v_mfma_f32_16x16x32_bf16 v[32:35], a[8:11], a[96:99], v[32:35]
    ds_read_b64_tr_b16 a[36:37], v9 offset:16384
    v_mfma_f32_16x16x32_bf16 v[32:35], a[12:15], a[112:115], v[32:35]
    ds_read_b64_tr_b16 a[38:39], v9 offset:17408
    v_mfma_f32_16x16x32_bf16 v[36:39], a[0:3], a[68:71], v[36:39]
    ds_read_b64_tr_b16 a[40:41], v9 offset:32768
    v_mfma_f32_16x16x32_bf16 v[36:39], a[4:7], a[84:87], v[36:39]
    ds_read_b64_tr_b16 a[42:43], v9 offset:33792
    v_mfma_f32_16x16x32_bf16 v[36:39], a[8:11], a[100:103], v[36:39]
    ds_read_b64_tr_b16 a[44:45], v9 offset:49152
    s_add_u32 m0, s33, 66560
    v_mfma_f32_16x16x32_bf16 v[36:39], a[12:15], a[116:119], v[36:39]
    ds_read_b64_tr_b16 a[46:47], v9 offset:50176
    buffer_load_dwordx4 v2, s[12:15], s32 offen lds
    v_mfma_f32_16x16x32_bf16 v[40:43], a[0:3], a[72:75], v[40:43]
    v_xor_b32 v8, 0x10000, v8
    v_mfma_f32_16x16x32_bf16 v[40:43], a[4:7], a[88:91], v[40:43]
    v_mfma_f32_16x16x32_bf16 v[40:43], a[8:11], a[104:107], v[40:43]
    v_mfma_f32_16x16x32_bf16 v[40:43], a[12:15], a[120:123], v[40:43]
    v_mfma_f32_16x16x32_bf16 v[44:47], a[0:3], a[76:79], v[44:47]
    s_add_u32 m0, s33, 73728
    v_mfma_f32_16x16x32_bf16 v[44:47], a[4:7], a[92:95], v[44:47]
    buffer_load_dwordx4 v2, s[16:19], s31 offen lds
    v_mfma_f32_16x16x32_bf16 v[44:47], a[8:11], a[108:111], v[44:47]
    v_mfma_f32_16x16x32_bf16 v[44:47], a[12:15], a[124:127], v[44:47]
    s_waitcnt lgkmcnt(8)
    v_mfma_f32_16x16x32_bf16 v[48:51], a[16:19], a[64:67], v[48:51]
    ds_read_b64_tr_b16 a[48:49], v9 offset:8192
    v_mfma_f32_16x16x32_bf16 v[48:51], a[20:23], a[80:83], v[48:51]
    ds_read_b64_tr_b16 a[50:51], v9 offset:9216
    v_mfma_f32_16x16x32_bf16 v[48:51], a[24:27], a[96:99], v[48:51]
    ds_read_b64_tr_b16 a[52:53], v9 offset:24576
    s_add_u32 m0, s33, 74752
    v_mfma_f32_16x16x32_bf16 v[48:51], a[28:31], a[112:115], v[48:51]
    ds_read_b64_tr_b16 a[54:55], v9 offset:25600
    buffer_load_dwordx4 v2, s[16:19], s32 offen lds
    v_mfma_f32_16x16x32_bf16 v[52:55], a[16:19], a[68:71], v[52:55]
    ds_read_b64_tr_b16 a[56:57], v9 offset:40960
    s_add_u32 s31, s31, 229376
    v_mfma_f32_16x16x32_bf16 v[52:55], a[20:23], a[84:87], v[52:55]
    ds_read_b64_tr_b16 a[58:59], v9 offset:41984
    v_mfma_f32_16x16x32_bf16 v[52:55], a[24:27], a[100:103], v[52:55]
    ds_read_b64_tr_b16 a[60:61], v9 offset:57344
    v_mfma_f32_16x16x32_bf16 v[52:55], a[28:31], a[116:119], v[52:55]
    ds_read_b64_tr_b16 a[62:63], v9 offset:58368
    v_mfma_f32_16x16x32_bf16 v[56:59], a[16:19], a[72:75], v[56:59]
    s_add_u32 m0, s33, 81920
    s_add_u32 s32, s31, 28672
    v_mfma_f32_16x16x32_bf16 v[56:59], a[20:23], a[88:91], v[56:59]
    buffer_load_dwordx4 v2, s[12:15], s31 offen lds
    v_mfma_f32_16x16x32_bf16 v[56:59], a[24:27], a[104:107], v[56:59]
    v_mfma_f32_16x16x32_bf16 v[56:59], a[28:31], a[120:123], v[56:59]
    v_mfma_f32_16x16x32_bf16 v[60:63], a[16:19], a[76:79], v[60:63]
    v_mfma_f32_16x16x32_bf16 v[60:63], a[20:23], a[92:95], v[60:63]
    v_mfma_f32_16x16x32_bf16 v[60:63], a[24:27], a[108:111], v[60:63]
    s_add_u32 m0, s33, 82944
    v_mfma_f32_16x16x32_bf16 v[60:63], a[28:31], a[124:127], v[60:63]
    buffer_load_dwordx4 v2, s[12:15], s32 offen lds
    s_waitcnt lgkmcnt(8)
    v_mfma_f32_16x16x32_bf16 v[64:67], a[32:35], a[64:67], v[64:67]
    ds_read_b64_tr_b16 a[0:1], v10 offset:0
    v_mfma_f32_16x16x32_bf16 v[64:67], a[36:39], a[80:83], v[64:67]
    ds_read_b64_tr_b16 a[2:3], v10 offset:1024
    v_mfma_f32_16x16x32_bf16 v[64:67], a[40:43], a[96:99], v[64:67]
    ds_read_b64_tr_b16 a[4:5], v10 offset:16384
    v_mfma_f32_16x16x32_bf16 v[64:67], a[44:47], a[112:115], v[64:67]
    ds_read_b64_tr_b16 a[6:7], v10 offset:17408
    v_mfma_f32_16x16x32_bf16 v[68:71], a[32:35], a[68:71], v[68:71]
    ds_read_b64_tr_b16 a[8:9], v10 offset:32768
    s_add_u32 m0, s33, 90112
    v_mfma_f32_16x16x32_bf16 v[68:71], a[36:39], a[84:87], v[68:71]
    ds_read_b64_tr_b16 a[10:11], v10 offset:33792
    buffer_load_dwordx4 v2, s[16:19], s31 offen lds
    v_mfma_f32_16x16x32_bf16 v[68:71], a[40:43], a[100:103], v[68:71]
    ds_read_b64_tr_b16 a[12:13], v10 offset:49152
    v_mfma_f32_16x16x32_bf16 v[68:71], a[44:47], a[116:119], v[68:71]
    ds_read_b64_tr_b16 a[14:15], v10 offset:50176
    v_mfma_f32_16x16x32_bf16 v[72:75], a[32:35], a[72:75], v[72:75]
    v_xor_b32 v9, 0x10000, v9
    v_mfma_f32_16x16x32_bf16 v[72:75], a[36:39], a[88:91], v[72:75]
    v_mfma_f32_16x16x32_bf16 v[72:75], a[40:43], a[104:107], v[72:75]
    s_add_u32 m0, s33, 91136
    v_mfma_f32_16x16x32_bf16 v[72:75], a[44:47], a[120:123], v[72:75]
    buffer_load_dwordx4 v2, s[16:19], s32 offen lds
    v_mfma_f32_16x16x32_bf16 v[76:79], a[32:35], a[76:79], v[76:79]
    s_add_u32 s31, s31, 229376
    v_mfma_f32_16x16x32_bf16 v[76:79], a[36:39], a[92:95], v[76:79]
    v_mfma_f32_16x16x32_bf16 v[76:79], a[40:43], a[108:111], v[76:79]
    v_mfma_f32_16x16x32_bf16 v[76:79], a[44:47], a[124:127], v[76:79]
    s_waitcnt lgkmcnt(8)
    v_mfma_f32_16x16x32_bf16 v[80:83], a[48:51], a[64:67], v[80:83]
    ds_read_b64_tr_b16 a[16:17], v10 offset:8192
    s_add_u32 m0, s33, 98304
    s_add_u32 s32, s31, 28672
    v_mfma_f32_16x16x32_bf16 v[80:83], a[52:55], a[80:83], v[80:83]
    ds_read_b64_tr_b16 a[18:19], v10 offset:9216
    buffer_load_dwordx4 v2, s[12:15], s31 offen lds
    v_mfma_f32_16x16x32_bf16 v[80:83], a[56:59], a[96:99], v[80:83]
    ds_read_b64_tr_b16 a[20:21], v10 offset:24576
    v_mfma_f32_16x16x32_bf16 v[80:83], a[60:63], a[112:115], v[80:83]
    ds_read_b64_tr_b16 a[22:23], v10 offset:25600
    v_mfma_f32_16x16x32_bf16 v[84:87], a[48:51], a[68:71], v[84:87]
    ds_read_b64_tr_b16 a[24:25], v10 offset:40960
    v_mfma_f32_16x16x32_bf16 v[84:87], a[52:55], a[84:87], v[84:87]
    ds_read_b64_tr_b16 a[26:27], v10 offset:41984
    v_mfma_f32_16x16x32_bf16 v[84:87], a[56:59], a[100:103], v[84:87]
    ds_read_b64_tr_b16 a[28:29], v10 offset:57344
    s_add_u32 m0, s33, 99328
    v_mfma_f32_16x16x32_bf16 v[84:87], a[60:63], a[116:119], v[84:87]
    ds_read_b64_tr_b16 a[30:31], v10 offset:58368
    buffer_load_dwordx4 v2, s[12:15], s32 offen lds
    v_mfma_f32_16x16x32_bf16 v[88:91], a[48:51], a[72:75], v[88:91]
    v_mfma_f32_16x16x32_bf16 v[88:91], a[52:55], a[88:91], v[88:91]
    v_mfma_f32_16x16x32_bf16 v[88:91], a[56:59], a[104:107], v[88:91]
    v_mfma_f32_16x16x32_bf16 v[88:91], a[60:63], a[120:123], v[88:91]
    v_mfma_f32_16x16x32_bf16 v[92:95], a[48:51], a[76:79], v[92:95]
    s_add_u32 m0, s33, 106496
    v_mfma_f32_16x16x32_bf16 v[92:95], a[52:55], a[92:95], v[92:95]
    buffer_load_dwordx4 v2, s[16:19], s31 offen lds
    v_mfma_f32_16x16x32_bf16 v[92:95], a[56:59], a[108:111], v[92:95]
    v_mfma_f32_16x16x32_bf16 v[92:95], a[60:63], a[124:127], v[92:95]
    s_waitcnt lgkmcnt(8)
    v_mfma_f32_16x16x32_bf16 v[96:99], a[0:3], a[64:67], v[96:99]
    ds_read_b64_tr_b16 a[32:33], v11 offset:0
    v_mfma_f32_16x16x32_bf16 v[96:99], a[4:7], a[80:83], v[96:99]
    ds_read_b64_tr_b16 a[34:35], v11 offset:1024
    v_mfma_f32_16x16x32_bf16 v[96:99], a[8:11], a[96:99], v[96:99]
    ds_read_b64_tr_b16 a[36:37], v11 offset:16384
    s_add_u32 m0, s33, 107520
    v_mfma_f32_16x16x32_bf16 v[96:99], a[12:15], a[112:115], v[96:99]
    ds_read_b64_tr_b16 a[38:39], v11 offset:17408
    buffer_load_dwordx4 v2, s[16:19], s32 offen lds
    v_mfma_f32_16x16x32_bf16 v[100:103], a[0:3], a[68:71], v[100:103]
    ds_read_b64_tr_b16 a[40:41], v11 offset:32768
    s_add_u32 s31, s31, 229376
    v_mfma_f32_16x16x32_bf16 v[100:103], a[4:7], a[84:87], v[100:103]
    ds_read_b64_tr_b16 a[42:43], v11 offset:33792
    v_mfma_f32_16x16x32_bf16 v[100:103], a[8:11], a[100:103], v[100:103]
    ds_read_b64_tr_b16 a[44:45], v11 offset:49152
    v_mfma_f32_16x16x32_bf16 v[100:103], a[12:15], a[116:119], v[100:103]
    ds_read_b64_tr_b16 a[46:47], v11 offset:50176
    v_mfma_f32_16x16x32_bf16 v[104:107], a[0:3], a[72:75], v[104:107]
    v_xor_b32 v10, 0x10000, v10
    s_add_u32 m0, s33, 114688
    s_add_u32 s32, s31, 28672
    v_mfma_f32_16x16x32_bf16 v[104:107], a[4:7], a[88:91], v[104:107]
    buffer_load_dwordx4 v2, s[12:15], s31 offen lds
    v_mfma_f32_16x16x32_bf16 v[104:107], a[8:11], a[104:107], v[104:107]
    v_mfma_f32_16x16x32_bf16 v[104:107], a[12:15], a[120:123], v[104:107]
    v_mfma_f32_16x16x32_bf16 v[108:111], a[0:3], a[76:79], v[108:111]
    v_mfma_f32_16x16x32_bf16 v[108:111], a[4:7], a[92:95], v[108:111]
    v_mfma_f32_16x16x32_bf16 v[108:111], a[8:11], a[108:111], v[108:111]
    s_add_u32 m0, s33, 115712
    v_mfma_f32_16x16x32_bf16 v[108:111], a[12:15], a[124:127], v[108:111]
    buffer_load_dwordx4 v2, s[12:15], s32 offen lds
    s_waitcnt lgkmcnt(8)
    v_mfma_f32_16x16x32_bf16 v[112:115], a[16:19], a[64:67], v[112:115]
    ds_read_b64_tr_b16 a[48:49], v11 offset:8192
    v_mfma_f32_16x16x32_bf16 v[112:115], a[20:23], a[80:83], v[112:115]
    ds_read_b64_tr_b16 a[50:51], v11 offset:9216
    v_mfma_f32_16x16x32_bf16 v[112:115], a[24:27], a[96:99], v[112:115]
    ds_read_b64_tr_b16 a[52:53], v11 offset:24576
    v_mfma_f32_16x16x32_bf16 v[112:115], a[28:31], a[112:115], v[112:115]
    ds_read_b64_tr_b16 a[54:55], v11 offset:25600
    v_mfma_f32_16x16x32_bf16 v[116:119], a[16:19], a[68:71], v[116:119]
    ds_read_b64_tr_b16 a[56:57], v11 offset:40960
    s_add_u32 m0, s33, 122880
    v_mfma_f32_16x16x32_bf16 v[116:119], a[20:23], a[84:87], v[116:119]
    ds_read_b64_tr_b16 a[58:59], v11 offset:41984
    buffer_load_dwordx4 v2, s[16:19], s31 offen lds
    v_mfma_f32_16x16x32_bf16 v[116:119], a[24:27], a[100:103], v[116:119]
    ds_read_b64_tr_b16 a[60:61], v11 offset:57344
    v_mfma_f32_16x16x32_bf16 v[116:119], a[28:31], a[116:119], v[116:119]
    ds_read_b64_tr_b16 a[62:63], v11 offset:58368
    v_mfma_f32_16x16x32_bf16 v[120:123], a[16:19], a[72:75], v[120:123]
    v_mfma_f32_16x16x32_bf16 v[120:123], a[20:23], a[88:91], v[120:123]
    v_mfma_f32_16x16x32_bf16 v[120:123], a[24:27], a[104:107], v[120:123]
    s_add_u32 m0, s33, 123904
    v_mfma_f32_16x16x32_bf16 v[120:123], a[28:31], a[120:123], v[120:123]
    buffer_load_dwordx4 v2, s[16:19], s32 offen lds
    v_mfma_f32_16x16x32_bf16 v[124:127], a[16:19], a[76:79], v[124:127]
    s_add_u32 s31, s31, 229376
    v_mfma_f32_16x16x32_bf16 v[124:127], a[20:23], a[92:95], v[124:127]
    v_mfma_f32_16x16x32_bf16 v[124:127], a[24:27], a[108:111], v[124:127]
    v_mfma_f32_16x16x32_bf16 v[124:127], a[28:31], a[124:127], v[124:127]
    s_waitcnt lgkmcnt(8)
    v_mfma_f32_16x16x32_bf16 v[128:131], a[32:35], a[64:67], v[128:131]
    ds_read_b64_tr_b16 a[0:1], v12 offset:0
    v_mfma_f32_16x16x32_bf16 v[128:131], a[36:39], a[80:83], v[128:131]
    ds_read_b64_tr_b16 a[2:3], v12 offset:1024
    buffer_load_dwordx4 a[128:131], v3, s[20:23], s35 offen sc1
    v_mfma_f32_16x16x32_bf16 v[128:131], a[40:43], a[96:99], v[128:131]
    ds_read_b64_tr_b16 a[4:5], v12 offset:16384
    v_mfma_f32_16x16x32_bf16 v[128:131], a[44:47], a[112:115], v[128:131]
    ds_read_b64_tr_b16 a[6:7], v12 offset:17408
    v_mfma_f32_16x16x32_bf16 v[132:135], a[32:35], a[68:71], v[132:135]
    ds_read_b64_tr_b16 a[8:9], v12 offset:32768
    v_mfma_f32_16x16x32_bf16 v[132:135], a[36:39], a[84:87], v[132:135]
    ds_read_b64_tr_b16 a[10:11], v12 offset:33792
    v_mfma_f32_16x16x32_bf16 v[132:135], a[40:43], a[100:103], v[132:135]
    ds_read_b64_tr_b16 a[12:13], v12 offset:49152
    v_mfma_f32_16x16x32_bf16 v[132:135], a[44:47], a[116:119], v[132:135]
    ds_read_b64_tr_b16 a[14:15], v12 offset:50176
    buffer_load_dwordx4 a[132:135], v4, s[20:23], s35 offen sc1
    v_mfma_f32_16x16x32_bf16 v[136:139], a[32:35], a[72:75], v[136:139]
    v_xor_b32 v11, 0x10000, v11
    v_mfma_f32_16x16x32_bf16 v[136:139], a[36:39], a[88:91], v[136:139]
    v_mfma_f32_16x16x32_bf16 v[136:139], a[40:43], a[104:107], v[136:139]
    v_mfma_f32_16x16x32_bf16 v[136:139], a[44:47], a[120:123], v[136:139]
    v_mfma_f32_16x16x32_bf16 v[140:143], a[32:35], a[76:79], v[140:143]
    v_mfma_f32_16x16x32_bf16 v[140:143], a[36:39], a[92:95], v[140:143]
    buffer_load_dwordx4 a[136:139], v5, s[20:23], s35 offen sc1
    v_mfma_f32_16x16x32_bf16 v[140:143], a[40:43], a[108:111], v[140:143]
    v_mfma_f32_16x16x32_bf16 v[140:143], a[44:47], a[124:127], v[140:143]
    s_waitcnt lgkmcnt(8)
    v_mfma_f32_16x16x32_bf16 v[144:147], a[48:51], a[64:67], v[144:147]
    ds_read_b64_tr_b16 a[16:17], v12 offset:8192
    v_mfma_f32_16x16x32_bf16 v[144:147], a[52:55], a[80:83], v[144:147]
    ds_read_b64_tr_b16 a[18:19], v12 offset:9216
    v_mfma_f32_16x16x32_bf16 v[144:147], a[56:59], a[96:99], v[144:147]
    ds_read_b64_tr_b16 a[20:21], v12 offset:24576
    v_mfma_f32_16x16x32_bf16 v[144:147], a[60:63], a[112:115], v[144:147]
    ds_read_b64_tr_b16 a[22:23], v12 offset:25600
    buffer_load_dwordx4 a[140:143], v6, s[20:23], s35 offen sc1
    v_mfma_f32_16x16x32_bf16 v[148:151], a[48:51], a[68:71], v[148:151]
    ds_read_b64_tr_b16 a[24:25], v12 offset:40960
    s_add_u32 s35, s35, 1024
    v_mfma_f32_16x16x32_bf16 v[148:151], a[52:55], a[84:87], v[148:151]
    ds_read_b64_tr_b16 a[26:27], v12 offset:41984
    v_mfma_f32_16x16x32_bf16 v[148:151], a[56:59], a[100:103], v[148:151]
    ds_read_b64_tr_b16 a[28:29], v12 offset:57344
    v_mfma_f32_16x16x32_bf16 v[148:151], a[60:63], a[116:119], v[148:151]
    ds_read_b64_tr_b16 a[30:31], v12 offset:58368
    v_mfma_f32_16x16x32_bf16 v[152:155], a[48:51], a[72:75], v[152:155]
    v_mfma_f32_16x16x32_bf16 v[152:155], a[52:55], a[88:91], v[152:155]
    buffer_load_dwordx4 a[144:147], v3, s[20:23], s35 offen sc1
    v_mfma_f32_16x16x32_bf16 v[152:155], a[56:59], a[104:107], v[152:155]
    v_mfma_f32_16x16x32_bf16 v[152:155], a[60:63], a[120:123], v[152:155]
    v_mfma_f32_16x16x32_bf16 v[156:159], a[48:51], a[76:79], v[156:159]
    v_mfma_f32_16x16x32_bf16 v[156:159], a[52:55], a[92:95], v[156:159]
    v_mfma_f32_16x16x32_bf16 v[156:159], a[56:59], a[108:111], v[156:159]
    v_mfma_f32_16x16x32_bf16 v[156:159], a[60:63], a[124:127], v[156:159]
    buffer_load_dwordx4 a[148:151], v4, s[20:23], s35 offen sc1
    s_waitcnt lgkmcnt(8)
    v_mfma_f32_16x16x32_bf16 v[160:163], a[0:3], a[64:67], v[160:163]
    ds_read_b64_tr_b16 a[32:33], v13 offset:0
    v_mfma_f32_16x16x32_bf16 v[160:163], a[4:7], a[80:83], v[160:163]
    ds_read_b64_tr_b16 a[34:35], v13 offset:1024
    v_mfma_f32_16x16x32_bf16 v[160:163], a[8:11], a[96:99], v[160:163]
    ds_read_b64_tr_b16 a[36:37], v13 offset:16384
    v_mfma_f32_16x16x32_bf16 v[160:163], a[12:15], a[112:115], v[160:163]
    ds_read_b64_tr_b16 a[38:39], v13 offset:17408
    v_mfma_f32_16x16x32_bf16 v[164:167], a[0:3], a[68:71], v[164:167]
    ds_read_b64_tr_b16 a[40:41], v13 offset:32768
    v_mfma_f32_16x16x32_bf16 v[164:167], a[4:7], a[84:87], v[164:167]
    ds_read_b64_tr_b16 a[42:43], v13 offset:33792
    buffer_load_dwordx4 a[152:155], v5, s[20:23], s35 offen sc1
    v_mfma_f32_16x16x32_bf16 v[164:167], a[8:11], a[100:103], v[164:167]
    ds_read_b64_tr_b16 a[44:45], v13 offset:49152
    v_mfma_f32_16x16x32_bf16 v[164:167], a[12:15], a[116:119], v[164:167]
    ds_read_b64_tr_b16 a[46:47], v13 offset:50176
    v_mfma_f32_16x16x32_bf16 v[168:171], a[0:3], a[72:75], v[168:171]
    v_xor_b32 v12, 0x10000, v12
    v_mfma_f32_16x16x32_bf16 v[168:171], a[4:7], a[88:91], v[168:171]
    v_mfma_f32_16x16x32_bf16 v[168:171], a[8:11], a[104:107], v[168:171]
    v_mfma_f32_16x16x32_bf16 v[168:171], a[12:15], a[120:123], v[168:171]
    buffer_load_dwordx4 a[156:159], v6, s[20:23], s35 offen sc1
    v_mfma_f32_16x16x32_bf16 v[172:175], a[0:3], a[76:79], v[172:175]
    s_add_u32 s35, s35, 1024
    v_mfma_f32_16x16x32_bf16 v[172:175], a[4:7], a[92:95], v[172:175]
    v_mfma_f32_16x16x32_bf16 v[172:175], a[8:11], a[108:111], v[172:175]
    v_mfma_f32_16x16x32_bf16 v[172:175], a[12:15], a[124:127], v[172:175]
    s_waitcnt lgkmcnt(8)
    v_mfma_f32_16x16x32_bf16 v[176:179], a[16:19], a[64:67], v[176:179]
    ds_read_b64_tr_b16 a[48:49], v13 offset:8192
    v_mfma_f32_16x16x32_bf16 v[176:179], a[20:23], a[80:83], v[176:179]
    ds_read_b64_tr_b16 a[50:51], v13 offset:9216
    buffer_load_dwordx4 a[160:163], v3, s[20:23], s35 offen sc1
    v_mfma_f32_16x16x32_bf16 v[176:179], a[24:27], a[96:99], v[176:179]
    ds_read_b64_tr_b16 a[52:53], v13 offset:24576
    v_mfma_f32_16x16x32_bf16 v[176:179], a[28:31], a[112:115], v[176:179]
    ds_read_b64_tr_b16 a[54:55], v13 offset:25600
    v_mfma_f32_16x16x32_bf16 v[180:183], a[16:19], a[68:71], v[180:183]
    ds_read_b64_tr_b16 a[56:57], v13 offset:40960
    v_mfma_f32_16x16x32_bf16 v[180:183], a[20:23], a[84:87], v[180:183]
    ds_read_b64_tr_b16 a[58:59], v13 offset:41984
    v_mfma_f32_16x16x32_bf16 v[180:183], a[24:27], a[100:103], v[180:183]
    ds_read_b64_tr_b16 a[60:61], v13 offset:57344
    v_mfma_f32_16x16x32_bf16 v[180:183], a[28:31], a[116:119], v[180:183]
    ds_read_b64_tr_b16 a[62:63], v13 offset:58368
    buffer_load_dwordx4 a[164:167], v4, s[20:23], s35 offen sc1
    v_mfma_f32_16x16x32_bf16 v[184:187], a[16:19], a[72:75], v[184:187]
    v_mfma_f32_16x16x32_bf16 v[184:187], a[20:23], a[88:91], v[184:187]
    v_mfma_f32_16x16x32_bf16 v[184:187], a[24:27], a[104:107], v[184:187]
    v_mfma_f32_16x16x32_bf16 v[184:187], a[28:31], a[120:123], v[184:187]
    v_mfma_f32_16x16x32_bf16 v[188:191], a[16:19], a[76:79], v[188:191]
    v_mfma_f32_16x16x32_bf16 v[188:191], a[20:23], a[92:95], v[188:191]
    buffer_load_dwordx4 a[168:171], v5, s[20:23], s35 offen sc1
    v_mfma_f32_16x16x32_bf16 v[188:191], a[24:27], a[108:111], v[188:191]
    v_mfma_f32_16x16x32_bf16 v[188:191], a[28:31], a[124:127], v[188:191]
    s_waitcnt lgkmcnt(8)
    v_mfma_f32_16x16x32_bf16 v[192:195], a[32:35], a[64:67], v[192:195]
    ds_read_b64_tr_b16 a[0:1], v14 offset:0
    v_mfma_f32_16x16x32_bf16 v[192:195], a[36:39], a[80:83], v[192:195]
    ds_read_b64_tr_b16 a[2:3], v14 offset:1024
    v_mfma_f32_16x16x32_bf16 v[192:195], a[40:43], a[96:99], v[192:195]
    ds_read_b64_tr_b16 a[4:5], v14 offset:16384
    v_mfma_f32_16x16x32_bf16 v[192:195], a[44:47], a[112:115], v[192:195]
    ds_read_b64_tr_b16 a[6:7], v14 offset:17408
    buffer_load_dwordx4 a[172:175], v6, s[20:23], s35 offen sc1
    v_mfma_f32_16x16x32_bf16 v[196:199], a[32:35], a[68:71], v[196:199]
    ds_read_b64_tr_b16 a[8:9], v14 offset:32768
    s_add_u32 s35, s35, 1024
    v_mfma_f32_16x16x32_bf16 v[196:199], a[36:39], a[84:87], v[196:199]
    ds_read_b64_tr_b16 a[10:11], v14 offset:33792
    v_mfma_f32_16x16x32_bf16 v[196:199], a[40:43], a[100:103], v[196:199]
    ds_read_b64_tr_b16 a[12:13], v14 offset:49152
    v_mfma_f32_16x16x32_bf16 v[196:199], a[44:47], a[116:119], v[196:199]
    ds_read_b64_tr_b16 a[14:15], v14 offset:50176
    v_mfma_f32_16x16x32_bf16 v[200:203], a[32:35], a[72:75], v[200:203]
    v_xor_b32 v13, 0x10000, v13
    v_mfma_f32_16x16x32_bf16 v[200:203], a[36:39], a[88:91], v[200:203]
    buffer_load_dwordx4 a[176:179], v3, s[20:23], s35 offen sc1
    v_mfma_f32_16x16x32_bf16 v[200:203], a[40:43], a[104:107], v[200:203]
    v_mfma_f32_16x16x32_bf16 v[200:203], a[44:47], a[120:123], v[200:203]
    v_mfma_f32_16x16x32_bf16 v[204:207], a[32:35], a[76:79], v[204:207]
    v_mfma_f32_16x16x32_bf16 v[204:207], a[36:39], a[92:95], v[204:207]
    v_mfma_f32_16x16x32_bf16 v[204:207], a[40:43], a[108:111], v[204:207]
    v_mfma_f32_16x16x32_bf16 v[204:207], a[44:47], a[124:127], v[204:207]
    buffer_load_dwordx4 a[180:183], v4, s[20:23], s35 offen sc1
    s_waitcnt lgkmcnt(8)
    v_mfma_f32_16x16x32_bf16 v[208:211], a[48:51], a[64:67], v[208:211]
    ds_read_b64_tr_b16 a[16:17], v14 offset:8192
    v_mfma_f32_16x16x32_bf16 v[208:211], a[52:55], a[80:83], v[208:211]
    ds_read_b64_tr_b16 a[18:19], v14 offset:9216
    v_mfma_f32_16x16x32_bf16 v[208:211], a[56:59], a[96:99], v[208:211]
    ds_read_b64_tr_b16 a[20:21], v14 offset:24576
    v_mfma_f32_16x16x32_bf16 v[208:211], a[60:63], a[112:115], v[208:211]
    ds_read_b64_tr_b16 a[22:23], v14 offset:25600
    v_mfma_f32_16x16x32_bf16 v[212:215], a[48:51], a[68:71], v[212:215]
    ds_read_b64_tr_b16 a[24:25], v14 offset:40960
    v_mfma_f32_16x16x32_bf16 v[212:215], a[52:55], a[84:87], v[212:215]
    ds_read_b64_tr_b16 a[26:27], v14 offset:41984
    buffer_load_dwordx4 a[184:187], v5, s[20:23], s35 offen sc1
    v_mfma_f32_16x16x32_bf16 v[212:215], a[56:59], a[100:103], v[212:215]
    ds_read_b64_tr_b16 a[28:29], v14 offset:57344
    v_mfma_f32_16x16x32_bf16 v[212:215], a[60:63], a[116:119], v[212:215]
    ds_read_b64_tr_b16 a[30:31], v14 offset:58368
    v_mfma_f32_16x16x32_bf16 v[216:219], a[48:51], a[72:75], v[216:219]
    v_mfma_f32_16x16x32_bf16 v[216:219], a[52:55], a[88:91], v[216:219]
    v_mfma_f32_16x16x32_bf16 v[216:219], a[56:59], a[104:107], v[216:219]
    v_mfma_f32_16x16x32_bf16 v[216:219], a[60:63], a[120:123], v[216:219]
    buffer_load_dwordx4 a[188:191], v6, s[20:23], s35 offen sc1
    v_mfma_f32_16x16x32_bf16 v[220:223], a[48:51], a[76:79], v[220:223]
    s_add_u32 s35, s35, 1024
    v_mfma_f32_16x16x32_bf16 v[220:223], a[52:55], a[92:95], v[220:223]
    v_mfma_f32_16x16x32_bf16 v[220:223], a[56:59], a[108:111], v[220:223]
    v_mfma_f32_16x16x32_bf16 v[220:223], a[60:63], a[124:127], v[220:223]
    s_waitcnt vmcnt(16) lgkmcnt(0)
    s_barrier
    v_mfma_f32_16x16x32_bf16 v[224:227], a[0:3], a[64:67], v[224:227]
    ds_read_b64_tr_b16 a[32:33], v8 offset:0
    v_mfma_f32_16x16x32_bf16 v[224:227], a[4:7], a[80:83], v[224:227]
    ds_read_b64_tr_b16 a[34:35], v8 offset:1024
    v_mfma_f32_16x16x32_bf16 v[224:227], a[8:11], a[96:99], v[224:227]
    ds_read_b64_tr_b16 a[36:37], v8 offset:16384
    v_mfma_f32_16x16x32_bf16 v[224:227], a[12:15], a[112:115], v[224:227]
    ds_read_b64_tr_b16 a[38:39], v8 offset:17408
    v_mfma_f32_16x16x32_bf16 v[228:231], a[0:3], a[68:71], v[228:231]
    ds_read_b64_tr_b16 a[40:41], v8 offset:32768
    v_mfma_f32_16x16x32_bf16 v[228:231], a[4:7], a[84:87], v[228:231]
    ds_read_b64_tr_b16 a[42:43], v8 offset:33792
    v_mfma_f32_16x16x32_bf16 v[228:231], a[8:11], a[100:103], v[228:231]
    ds_read_b64_tr_b16 a[44:45], v8 offset:49152
    v_mfma_f32_16x16x32_bf16 v[228:231], a[12:15], a[116:119], v[228:231]
    ds_read_b64_tr_b16 a[46:47], v8 offset:50176
    v_mfma_f32_16x16x32_bf16 v[232:235], a[0:3], a[72:75], v[232:235]
    v_xor_b32 v14, 0x10000, v14
    v_mfma_f32_16x16x32_bf16 v[232:235], a[4:7], a[88:91], v[232:235]
    v_mfma_f32_16x16x32_bf16 v[232:235], a[8:11], a[104:107], v[232:235]
    v_mfma_f32_16x16x32_bf16 v[232:235], a[12:15], a[120:123], v[232:235]
    v_mfma_f32_16x16x32_bf16 v[236:239], a[0:3], a[76:79], v[236:239]
    v_mfma_f32_16x16x32_bf16 v[236:239], a[4:7], a[92:95], v[236:239]
    v_mfma_f32_16x16x32_bf16 v[236:239], a[8:11], a[108:111], v[236:239]
    v_mfma_f32_16x16x32_bf16 v[236:239], a[12:15], a[124:127], v[236:239]
    s_waitcnt lgkmcnt(8)
    v_mfma_f32_16x16x32_bf16 v[240:243], a[16:19], a[64:67], v[240:243]
    ds_read_b64_tr_b16 a[48:49], v8 offset:8192
    v_mfma_f32_16x16x32_bf16 v[240:243], a[20:23], a[80:83], v[240:243]
    ds_read_b64_tr_b16 a[50:51], v8 offset:9216
    v_mfma_f32_16x16x32_bf16 v[240:243], a[24:27], a[96:99], v[240:243]
    ds_read_b64_tr_b16 a[52:53], v8 offset:24576
    v_mfma_f32_16x16x32_bf16 v[240:243], a[28:31], a[112:115], v[240:243]
    ds_read_b64_tr_b16 a[54:55], v8 offset:25600
    v_mfma_f32_16x16x32_bf16 v[244:247], a[16:19], a[68:71], v[244:247]
    ds_read_b64_tr_b16 a[56:57], v8 offset:40960
    v_mfma_f32_16x16x32_bf16 v[244:247], a[20:23], a[84:87], v[244:247]
    ds_read_b64_tr_b16 a[58:59], v8 offset:41984
    v_mfma_f32_16x16x32_bf16 v[244:247], a[24:27], a[100:103], v[244:247]
    ds_read_b64_tr_b16 a[60:61], v8 offset:57344
    v_mfma_f32_16x16x32_bf16 v[244:247], a[28:31], a[116:119], v[244:247]
    ds_read_b64_tr_b16 a[62:63], v8 offset:58368
    v_mfma_f32_16x16x32_bf16 v[248:251], a[16:19], a[72:75], v[248:251]
    v_mfma_f32_16x16x32_bf16 v[248:251], a[20:23], a[88:91], v[248:251]
    v_mfma_f32_16x16x32_bf16 v[248:251], a[24:27], a[104:107], v[248:251]
    v_mfma_f32_16x16x32_bf16 v[248:251], a[28:31], a[120:123], v[248:251]
    v_mfma_f32_16x16x32_bf16 v[252:255], a[16:19], a[76:79], v[252:255]
    v_mfma_f32_16x16x32_bf16 v[252:255], a[20:23], a[92:95], v[252:255]
    v_mfma_f32_16x16x32_bf16 v[252:255], a[24:27], a[108:111], v[252:255]
    v_mfma_f32_16x16x32_bf16 v[252:255], a[28:31], a[124:127], v[252:255]
    s_sub_u32 s36, s36, 1
    s_cmp_lg_u32 s36, 0
    s_cbranch_scc1 L_gup_k
    s_lshl_b32 s38, s29, 4
    s_lshl_b32 s39, s28, 2
    s_add_u32 s38, s38, s39
    s_mul_i32 s38, s38, 112
    s_mul_i32 s39, s30, 7
    s_lshr_b32 s39, s39, 1
    s_add_u32 s38, s38, s39
    s_lshl_b32 s41, s38, 10
    s_add_u32 s42, s41, 114688
    s_add_u32 s43, s42, 114688
    s_add_u32 s44, s43, 114688
    s_bitcmp1_b32 s30, 0
    s_cbranch_scc1 L_gup_odd
    s_waitcnt vmcnt(0)
    s_waitcnt lgkmcnt(8)
    v_mfma_f32_16x16x32_bf16 v[32:35], a[32:35], a[128:131], v[32:35]
    ds_read_b64_tr_b16 a[0:1], v9 offset:0
    v_mfma_f32_16x16x32_bf16 v[32:35], a[36:39], a[144:147], v[32:35]
    ds_read_b64_tr_b16 a[2:3], v9 offset:1024
    v_mfma_f32_16x16x32_bf16 v[32:35], a[40:43], a[160:163], v[32:35]
    ds_read_b64_tr_b16 a[4:5], v9 offset:16384
    v_mfma_f32_16x16x32_bf16 v[32:35], a[44:47], a[176:179], v[32:35]
    ds_read_b64_tr_b16 a[6:7], v9 offset:17408
    v_mfma_f32_16x16x32_bf16 v[36:39], a[32:35], a[132:135], v[36:39]
    ds_read_b64_tr_b16 a[8:9], v9 offset:32768
    v_mfma_f32_16x16x32_bf16 v[36:39], a[36:39], a[148:151], v[36:39]
    ds_read_b64_tr_b16 a[10:11], v9 offset:33792
    v_mfma_f32_16x16x32_bf16 v[36:39], a[40:43], a[164:167], v[36:39]
    ds_read_b64_tr_b16 a[12:13], v9 offset:49152
    v_mfma_f32_16x16x32_bf16 v[36:39], a[44:47], a[180:183], v[36:39]
    ds_read_b64_tr_b16 a[14:15], v9 offset:50176
    v_mfma_f32_16x16x32_bf16 v[40:43], a[32:35], a[136:139], v[40:43]
    v_exp_f32 v32, -v32
    v_mfma_f32_16x16x32_bf16 v[40:43], a[36:39], a[152:155], v[40:43]
    v_exp_f32 v33, -v33
    v_mfma_f32_16x16x32_bf16 v[40:43], a[40:43], a[168:171], v[40:43]
    v_exp_f32 v34, -v34
    v_mfma_f32_16x16x32_bf16 v[40:43], a[44:47], a[184:187], v[40:43]
    v_exp_f32 v35, -v35
    v_mfma_f32_16x16x32_bf16 v[44:47], a[32:35], a[140:143], v[44:47]
    v_add_f32 v32, 1.0, v32
    v_add_f32 v33, 1.0, v33
    v_mfma_f32_16x16x32_bf16 v[44:47], a[36:39], a[156:159], v[44:47]
    v_add_f32 v34, 1.0, v34
    v_add_f32 v35, 1.0, v35
    v_mfma_f32_16x16x32_bf16 v[44:47], a[40:43], a[172:175], v[44:47]
    v_rcp_f32 v32, v32
    v_mfma_f32_16x16x32_bf16 v[44:47], a[44:47], a[188:191], v[44:47]
    v_rcp_f32 v33, v33
    s_waitcnt lgkmcnt(8)
    v_mfma_f32_16x16x32_bf16 v[48:51], a[48:51], a[128:131], v[48:51]
    ds_read_b64_tr_b16 a[16:17], v9 offset:8192
    v_mfma_f32_16x16x32_bf16 v[48:51], a[52:55], a[144:147], v[48:51]
    ds_read_b64_tr_b16 a[18:19], v9 offset:9216
    v_mfma_f32_16x16x32_bf16 v[48:51], a[56:59], a[160:163], v[48:51]
    ds_read_b64_tr_b16 a[20:21], v9 offset:24576
    v_mfma_f32_16x16x32_bf16 v[48:51], a[60:63], a[176:179], v[48:51]
    ds_read_b64_tr_b16 a[22:23], v9 offset:25600
    v_mfma_f32_16x16x32_bf16 v[52:55], a[48:51], a[132:135], v[52:55]
    ds_read_b64_tr_b16 a[24:25], v9 offset:40960
    v_mfma_f32_16x16x32_bf16 v[52:55], a[52:55], a[148:151], v[52:55]
    ds_read_b64_tr_b16 a[26:27], v9 offset:41984
    v_mfma_f32_16x16x32_bf16 v[52:55], a[56:59], a[164:167], v[52:55]
    ds_read_b64_tr_b16 a[28:29], v9 offset:57344
    v_mfma_f32_16x16x32_bf16 v[52:55], a[60:63], a[180:183], v[52:55]
    ds_read_b64_tr_b16 a[30:31], v9 offset:58368
    v_mul_f32 v32, v48, v32
    v_mfma_f32_16x16x32_bf16 v[56:59], a[48:51], a[136:139], v[56:59]
    v_rcp_f32 v34, v34
    v_mfma_f32_16x16x32_bf16 v[56:59], a[52:55], a[152:155], v[56:59]
    v_rcp_f32 v35, v35
    v_mfma_f32_16x16x32_bf16 v[56:59], a[56:59], a[168:171], v[56:59]
    v_mul_f32 v33, v49, v33
    v_mul_f32 v34, v50, v34
    v_mfma_f32_16x16x32_bf16 v[56:59], a[60:63], a[184:187], v[56:59]
    v_mul_f32 v35, v51, v35
    v_cvt_pk_bf16_f32 v16, v32, v33
    v_mfma_f32_16x16x32_bf16 v[60:63], a[48:51], a[140:143], v[60:63]
    v_cvt_pk_bf16_f32 v17, v34, v35
    v_mfma_f32_16x16x32_bf16 v[60:63], a[52:55], a[156:159], v[60:63]
    v_exp_f32 v36, -v36
    v_mfma_f32_16x16x32_bf16 v[60:63], a[56:59], a[172:175], v[60:63]
    v_exp_f32 v37, -v37
    v_mfma_f32_16x16x32_bf16 v[60:63], a[60:63], a[188:191], v[60:63]
    v_exp_f32 v38, -v38
    s_waitcnt lgkmcnt(8)
    v_mfma_f32_16x16x32_bf16 v[64:67], a[0:3], a[128:131], v[64:67]
    ds_read_b64_tr_b16 a[32:33], v10 offset:0
    v_add_f32 v36, 1.0, v36
    v_mfma_f32_16x16x32_bf16 v[64:67], a[4:7], a[144:147], v[64:67]
    ds_read_b64_tr_b16 a[34:35], v10 offset:1024
    v_add_f32 v37, 1.0, v37
    v_mfma_f32_16x16x32_bf16 v[64:67], a[8:11], a[160:163], v[64:67]
    ds_read_b64_tr_b16 a[36:37], v10 offset:16384
    v_add_f32 v38, 1.0, v38
    v_mfma_f32_16x16x32_bf16 v[64:67], a[12:15], a[176:179], v[64:67]
    ds_read_b64_tr_b16 a[38:39], v10 offset:17408
    v_mfma_f32_16x16x32_bf16 v[68:71], a[0:3], a[132:135], v[68:71]
    ds_read_b64_tr_b16 a[40:41], v10 offset:32768
    v_mfma_f32_16x16x32_bf16 v[68:71], a[4:7], a[148:151], v[68:71]
    ds_read_b64_tr_b16 a[42:43], v10 offset:33792
    v_mfma_f32_16x16x32_bf16 v[68:71], a[8:11], a[164:167], v[68:71]
    ds_read_b64_tr_b16 a[44:45], v10 offset:49152
    v_mfma_f32_16x16x32_bf16 v[68:71], a[12:15], a[180:183], v[68:71]
    ds_read_b64_tr_b16 a[46:47], v10 offset:50176
    v_mfma_f32_16x16x32_bf16 v[72:75], a[0:3], a[136:139], v[72:75]
    v_exp_f32 v39, -v39
    v_mfma_f32_16x16x32_bf16 v[72:75], a[4:7], a[152:155], v[72:75]
    v_add_f32 v39, 1.0, v39
    v_mfma_f32_16x16x32_bf16 v[72:75], a[8:11], a[168:171], v[72:75]
    v_rcp_f32 v36, v36
    v_mfma_f32_16x16x32_bf16 v[72:75], a[12:15], a[184:187], v[72:75]
    v_rcp_f32 v37, v37
    v_mfma_f32_16x16x32_bf16 v[76:79], a[0:3], a[140:143], v[76:79]
    v_rcp_f32 v38, v38
    v_mfma_f32_16x16x32_bf16 v[76:79], a[4:7], a[156:159], v[76:79]
    v_rcp_f32 v39, v39
    v_mfma_f32_16x16x32_bf16 v[76:79], a[8:11], a[172:175], v[76:79]
    v_mul_f32 v36, v52, v36
    v_mul_f32 v37, v53, v37
    v_mfma_f32_16x16x32_bf16 v[76:79], a[12:15], a[188:191], v[76:79]
    v_mul_f32 v38, v54, v38
    v_mul_f32 v39, v55, v39
    s_waitcnt lgkmcnt(8)
    v_mfma_f32_16x16x32_bf16 v[80:83], a[16:19], a[128:131], v[80:83]
    ds_read_b64_tr_b16 a[48:49], v10 offset:8192
    v_cvt_pk_bf16_f32 v20, v36, v37
    v_mfma_f32_16x16x32_bf16 v[80:83], a[20:23], a[144:147], v[80:83]
    ds_read_b64_tr_b16 a[50:51], v10 offset:9216
    v_cvt_pk_bf16_f32 v21, v38, v39
    v_mfma_f32_16x16x32_bf16 v[80:83], a[24:27], a[160:163], v[80:83]
    ds_read_b64_tr_b16 a[52:53], v10 offset:24576
    v_mfma_f32_16x16x32_bf16 v[80:83], a[28:31], a[176:179], v[80:83]
    ds_read_b64_tr_b16 a[54:55], v10 offset:25600
    v_mfma_f32_16x16x32_bf16 v[84:87], a[16:19], a[132:135], v[84:87]
    ds_read_b64_tr_b16 a[56:57], v10 offset:40960
    v_mfma_f32_16x16x32_bf16 v[84:87], a[20:23], a[148:151], v[84:87]
    ds_read_b64_tr_b16 a[58:59], v10 offset:41984
    v_mfma_f32_16x16x32_bf16 v[84:87], a[24:27], a[164:167], v[84:87]
    ds_read_b64_tr_b16 a[60:61], v10 offset:57344
    v_mfma_f32_16x16x32_bf16 v[84:87], a[28:31], a[180:183], v[84:87]
    ds_read_b64_tr_b16 a[62:63], v10 offset:58368
    v_mfma_f32_16x16x32_bf16 v[88:91], a[16:19], a[136:139], v[88:91]
    v_exp_f32 v40, -v40
    v_mfma_f32_16x16x32_bf16 v[88:91], a[20:23], a[152:155], v[88:91]
    v_exp_f32 v41, -v41
    v_mfma_f32_16x16x32_bf16 v[88:91], a[24:27], a[168:171], v[88:91]
    v_exp_f32 v42, -v42
    v_mfma_f32_16x16x32_bf16 v[88:91], a[28:31], a[184:187], v[88:91]
    v_exp_f32 v43, -v43
    v_mfma_f32_16x16x32_bf16 v[92:95], a[16:19], a[140:143], v[92:95]
    v_add_f32 v40, 1.0, v40
    v_add_f32 v41, 1.0, v41
    v_mfma_f32_16x16x32_bf16 v[92:95], a[20:23], a[156:159], v[92:95]
    v_add_f32 v42, 1.0, v42
    v_add_f32 v43, 1.0, v43
    v_mfma_f32_16x16x32_bf16 v[92:95], a[24:27], a[172:175], v[92:95]
    v_rcp_f32 v40, v40
    v_mfma_f32_16x16x32_bf16 v[92:95], a[28:31], a[188:191], v[92:95]
    v_rcp_f32 v41, v41
    s_waitcnt lgkmcnt(8)
    v_mfma_f32_16x16x32_bf16 v[96:99], a[32:35], a[128:131], v[96:99]
    ds_read_b64_tr_b16 a[0:1], v11 offset:0
    v_mul_f32 v40, v56, v40
    v_mfma_f32_16x16x32_bf16 v[96:99], a[36:39], a[144:147], v[96:99]
    ds_read_b64_tr_b16 a[2:3], v11 offset:1024
    v_mul_f32 v41, v57, v41
    v_mfma_f32_16x16x32_bf16 v[96:99], a[40:43], a[160:163], v[96:99]
    ds_read_b64_tr_b16 a[4:5], v11 offset:16384
    v_cvt_pk_bf16_f32 v24, v40, v41
    v_mfma_f32_16x16x32_bf16 v[96:99], a[44:47], a[176:179], v[96:99]
    ds_read_b64_tr_b16 a[6:7], v11 offset:17408
    v_mfma_f32_16x16x32_bf16 v[100:103], a[32:35], a[132:135], v[100:103]
    ds_read_b64_tr_b16 a[8:9], v11 offset:32768
    v_mfma_f32_16x16x32_bf16 v[100:103], a[36:39], a[148:151], v[100:103]
    ds_read_b64_tr_b16 a[10:11], v11 offset:33792
    v_mfma_f32_16x16x32_bf16 v[100:103], a[40:43], a[164:167], v[100:103]
    ds_read_b64_tr_b16 a[12:13], v11 offset:49152
    v_mfma_f32_16x16x32_bf16 v[100:103], a[44:47], a[180:183], v[100:103]
    ds_read_b64_tr_b16 a[14:15], v11 offset:50176
    v_mfma_f32_16x16x32_bf16 v[104:107], a[32:35], a[136:139], v[104:107]
    v_rcp_f32 v42, v42
    v_mfma_f32_16x16x32_bf16 v[104:107], a[36:39], a[152:155], v[104:107]
    v_rcp_f32 v43, v43
    v_mfma_f32_16x16x32_bf16 v[104:107], a[40:43], a[168:171], v[104:107]
    v_mul_f32 v42, v58, v42
    v_mul_f32 v43, v59, v43
    v_mfma_f32_16x16x32_bf16 v[104:107], a[44:47], a[184:187], v[104:107]
    v_cvt_pk_bf16_f32 v25, v42, v43
    v_mfma_f32_16x16x32_bf16 v[108:111], a[32:35], a[140:143], v[108:111]
    v_exp_f32 v44, -v44
    v_mfma_f32_16x16x32_bf16 v[108:111], a[36:39], a[156:159], v[108:111]
    v_exp_f32 v45, -v45
    v_mfma_f32_16x16x32_bf16 v[108:111], a[40:43], a[172:175], v[108:111]
    v_exp_f32 v46, -v46
    v_mfma_f32_16x16x32_bf16 v[108:111], a[44:47], a[188:191], v[108:111]
    v_exp_f32 v47, -v47
    s_waitcnt lgkmcnt(8)
    v_mfma_f32_16x16x32_bf16 v[112:115], a[48:51], a[128:131], v[112:115]
    ds_read_b64_tr_b16 a[16:17], v11 offset:8192
    v_add_f32 v44, 1.0, v44
    v_mfma_f32_16x16x32_bf16 v[112:115], a[52:55], a[144:147], v[112:115]
    ds_read_b64_tr_b16 a[18:19], v11 offset:9216
    v_add_f32 v45, 1.0, v45
    v_mfma_f32_16x16x32_bf16 v[112:115], a[56:59], a[160:163], v[112:115]
    ds_read_b64_tr_b16 a[20:21], v11 offset:24576
    v_add_f32 v46, 1.0, v46
    v_mfma_f32_16x16x32_bf16 v[112:115], a[60:63], a[176:179], v[112:115]
    ds_read_b64_tr_b16 a[22:23], v11 offset:25600
    v_add_f32 v47, 1.0, v47
    v_mfma_f32_16x16x32_bf16 v[116:119], a[48:51], a[132:135], v[116:119]
    ds_read_b64_tr_b16 a[24:25], v11 offset:40960
    v_mfma_f32_16x16x32_bf16 v[116:119], a[52:55], a[148:151], v[116:119]
    ds_read_b64_tr_b16 a[26:27], v11 offset:41984
    v_mfma_f32_16x16x32_bf16 v[116:119], a[56:59], a[164:167], v[116:119]
    ds_read_b64_tr_b16 a[28:29], v11 offset:57344
    v_mfma_f32_16x16x32_bf16 v[116:119], a[60:63], a[180:183], v[116:119]
    ds_read_b64_tr_b16 a[30:31], v11 offset:58368
    v_mfma_f32_16x16x32_bf16 v[120:123], a[48:51], a[136:139], v[120:123]
    v_rcp_f32 v44, v44
    v_mfma_f32_16x16x32_bf16 v[120:123], a[52:55], a[152:155], v[120:123]
    v_rcp_f32 v45, v45
    v_mfma_f32_16x16x32_bf16 v[120:123], a[56:59], a[168:171], v[120:123]
    v_rcp_f32 v46, v46
    v_mfma_f32_16x16x32_bf16 v[120:123], a[60:63], a[184:187], v[120:123]
    v_rcp_f32 v47, v47
    v_mfma_f32_16x16x32_bf16 v[124:127], a[48:51], a[140:143], v[124:127]
    v_mul_f32 v44, v60, v44
    v_mul_f32 v45, v61, v45
    v_mfma_f32_16x16x32_bf16 v[124:127], a[52:55], a[156:159], v[124:127]
    v_mul_f32 v46, v62, v46
    v_mul_f32 v47, v63, v47
    v_mfma_f32_16x16x32_bf16 v[124:127], a[56:59], a[172:175], v[124:127]
    v_cvt_pk_bf16_f32 v28, v44, v45
    v_cvt_pk_bf16_f32 v29, v46, v47
    v_mfma_f32_16x16x32_bf16 v[124:127], a[60:63], a[188:191], v[124:127]
    v_exp_f32 v64, -v64
    s_waitcnt lgkmcnt(8)
    v_mfma_f32_16x16x32_bf16 v[128:131], a[0:3], a[128:131], v[128:131]
    ds_read_b64_tr_b16 a[32:33], v12 offset:0
    v_add_f32 v64, 1.0, v64
    v_mfma_f32_16x16x32_bf16 v[128:131], a[4:7], a[144:147], v[128:131]
    ds_read_b64_tr_b16 a[34:35], v12 offset:1024
    v_mfma_f32_16x16x32_bf16 v[128:131], a[8:11], a[160:163], v[128:131]
    ds_read_b64_tr_b16 a[36:37], v12 offset:16384
    v_mfma_f32_16x16x32_bf16 v[128:131], a[12:15], a[176:179], v[128:131]
    ds_read_b64_tr_b16 a[38:39], v12 offset:17408
    v_mfma_f32_16x16x32_bf16 v[132:135], a[0:3], a[132:135], v[132:135]
    ds_read_b64_tr_b16 a[40:41], v12 offset:32768
    v_mfma_f32_16x16x32_bf16 v[132:135], a[4:7], a[148:151], v[132:135]
    ds_read_b64_tr_b16 a[42:43], v12 offset:33792
    v_mfma_f32_16x16x32_bf16 v[132:135], a[8:11], a[164:167], v[132:135]
    ds_read_b64_tr_b16 a[44:45], v12 offset:49152
    v_mfma_f32_16x16x32_bf16 v[132:135], a[12:15], a[180:183], v[132:135]
    ds_read_b64_tr_b16 a[46:47], v12 offset:50176
    v_mfma_f32_16x16x32_bf16 v[136:139], a[0:3], a[136:139], v[136:139]
    v_exp_f32 v65, -v65
    v_mfma_f32_16x16x32_bf16 v[136:139], a[4:7], a[152:155], v[136:139]
    v_exp_f32 v66, -v66
    v_mfma_f32_16x16x32_bf16 v[136:139], a[8:11], a[168:171], v[136:139]
    v_exp_f32 v67, -v67
    v_mfma_f32_16x16x32_bf16 v[136:139], a[12:15], a[184:187], v[136:139]
    v_add_f32 v65, 1.0, v65
    v_add_f32 v66, 1.0, v66
    v_mfma_f32_16x16x32_bf16 v[140:143], a[0:3], a[140:143], v[140:143]
    v_add_f32 v67, 1.0, v67
    v_mfma_f32_16x16x32_bf16 v[140:143], a[4:7], a[156:159], v[140:143]
    v_rcp_f32 v64, v64
    v_mfma_f32_16x16x32_bf16 v[140:143], a[8:11], a[172:175], v[140:143]
    v_rcp_f32 v65, v65
    v_mfma_f32_16x16x32_bf16 v[140:143], a[12:15], a[188:191], v[140:143]
    v_rcp_f32 v66, v66
    s_waitcnt lgkmcnt(8)
    v_mfma_f32_16x16x32_bf16 v[144:147], a[16:19], a[128:131], v[144:147]
    ds_read_b64_tr_b16 a[48:49], v12 offset:8192
    v_mul_f32 v64, v80, v64
    v_mfma_f32_16x16x32_bf16 v[144:147], a[20:23], a[144:147], v[144:147]
    ds_read_b64_tr_b16 a[50:51], v12 offset:9216
    v_mul_f32 v65, v81, v65
    v_mfma_f32_16x16x32_bf16 v[144:147], a[24:27], a[160:163], v[144:147]
    ds_read_b64_tr_b16 a[52:53], v12 offset:24576
    v_mul_f32 v66, v82, v66
    v_mfma_f32_16x16x32_bf16 v[144:147], a[28:31], a[176:179], v[144:147]
    ds_read_b64_tr_b16 a[54:55], v12 offset:25600
    v_cvt_pk_bf16_f32 v18, v64, v65
    v_mfma_f32_16x16x32_bf16 v[148:151], a[16:19], a[132:135], v[148:151]
    ds_read_b64_tr_b16 a[56:57], v12 offset:40960
    v_mfma_f32_16x16x32_bf16 v[148:151], a[20:23], a[148:151], v[148:151]
    ds_read_b64_tr_b16 a[58:59], v12 offset:41984
    v_mfma_f32_16x16x32_bf16 v[148:151], a[24:27], a[164:167], v[148:151]
    ds_read_b64_tr_b16 a[60:61], v12 offset:57344
    v_mfma_f32_16x16x32_bf16 v[148:151], a[28:31], a[180:183], v[148:151]
    ds_read_b64_tr_b16 a[62:63], v12 offset:58368
    v_mfma_f32_16x16x32_bf16 v[152:155], a[16:19], a[136:139], v[152:155]
    v_rcp_f32 v67, v67
    v_mfma_f32_16x16x32_bf16 v[152:155], a[20:23], a[152:155], v[152:155]
    v_mul_f32 v67, v83, v67
    v_mfma_f32_16x16x32_bf16 v[152:155], a[24:27], a[168:171], v[152:155]
    v_cvt_pk_bf16_f32 v19, v66, v67
    v_mfma_f32_16x16x32_bf16 v[152:155], a[28:31], a[184:187], v[152:155]
    buffer_store_dwordx4 v[16:19], v1, s[24:27], s41 offen offset:0 sc1
    v_mfma_f32_16x16x32_bf16 v[156:159], a[16:19], a[140:143], v[156:159]
    v_exp_f32 v68, -v68
    v_mfma_f32_16x16x32_bf16 v[156:159], a[20:23], a[156:159], v[156:159]
    v_exp_f32 v69, -v69
    v_mfma_f32_16x16x32_bf16 v[156:159], a[24:27], a[172:175], v[156:159]
    v_exp_f32 v70, -v70
    v_mfma_f32_16x16x32_bf16 v[156:159], a[28:31], a[188:191], v[156:159]
    v_exp_f32 v71, -v71
    s_waitcnt lgkmcnt(8)
    v_mfma_f32_16x16x32_bf16 v[160:163], a[32:35], a[128:131], v[160:163]
    ds_read_b64_tr_b16 a[0:1], v13 offset:0
    v_add_f32 v68, 1.0, v68
    v_mfma_f32_16x16x32_bf16 v[160:163], a[36:39], a[144:147], v[160:163]
    ds_read_b64_tr_b16 a[2:3], v13 offset:1024
    v_add_f32 v69, 1.0, v69
    v_mfma_f32_16x16x32_bf16 v[160:163], a[40:43], a[160:163], v[160:163]
    ds_read_b64_tr_b16 a[4:5], v13 offset:16384
    v_add_f32 v70, 1.0, v70
    v_mfma_f32_16x16x32_bf16 v[160:163], a[44:47], a[176:179], v[160:163]
    ds_read_b64_tr_b16 a[6:7], v13 offset:17408
    v_add_f32 v71, 1.0, v71
    v_mfma_f32_16x16x32_bf16 v[164:167], a[32:35], a[132:135], v[164:167]
    ds_read_b64_tr_b16 a[8:9], v13 offset:32768
    v_mfma_f32_16x16x32_bf16 v[164:167], a[36:39], a[148:151], v[164:167]
    ds_read_b64_tr_b16 a[10:11], v13 offset:33792
    v_mfma_f32_16x16x32_bf16 v[164:167], a[40:43], a[164:167], v[164:167]
    ds_read_b64_tr_b16 a[12:13], v13 offset:49152
    v_mfma_f32_16x16x32_bf16 v[164:167], a[44:47], a[180:183], v[164:167]
    ds_read_b64_tr_b16 a[14:15], v13 offset:50176
    v_mfma_f32_16x16x32_bf16 v[168:171], a[32:35], a[136:139], v[168:171]
    v_rcp_f32 v68, v68
    v_mfma_f32_16x16x32_bf16 v[168:171], a[36:39], a[152:155], v[168:171]
    v_rcp_f32 v69, v69
    v_mfma_f32_16x16x32_bf16 v[168:171], a[40:43], a[168:171], v[168:171]
    v_rcp_f32 v70, v70
    v_mfma_f32_16x16x32_bf16 v[168:171], a[44:47], a[184:187], v[168:171]
    v_rcp_f32 v71, v71
    v_mfma_f32_16x16x32_bf16 v[172:175], a[32:35], a[140:143], v[172:175]
    v_mul_f32 v68, v84, v68
    v_mul_f32 v69, v85, v69
    v_mfma_f32_16x16x32_bf16 v[172:175], a[36:39], a[156:159], v[172:175]
    v_mul_f32 v70, v86, v70
    v_mul_f32 v71, v87, v71
    v_mfma_f32_16x16x32_bf16 v[172:175], a[40:43], a[172:175], v[172:175]
    v_cvt_pk_bf16_f32 v22, v68, v69
    v_cvt_pk_bf16_f32 v23, v70, v71
    v_mfma_f32_16x16x32_bf16 v[172:175], a[44:47], a[188:191], v[172:175]
    buffer_store_dwordx4 v[20:23], v1, s[24:27], s42 offen offset:0 sc1
    s_waitcnt lgkmcnt(8)
    v_mfma_f32_16x16x32_bf16 v[176:179], a[48:51], a[128:131], v[176:179]
    ds_read_b64_tr_b16 a[16:17], v13 offset:8192
    v_mfma_f32_16x16x32_bf16 v[176:179], a[52:55], a[144:147], v[176:179]
    ds_read_b64_tr_b16 a[18:19], v13 offset:9216
    v_mfma_f32_16x16x32_bf16 v[176:179], a[56:59], a[160:163], v[176:179]
    ds_read_b64_tr_b16 a[20:21], v13 offset:24576
    v_mfma_f32_16x16x32_bf16 v[176:179], a[60:63], a[176:179], v[176:179]
    ds_read_b64_tr_b16 a[22:23], v13 offset:25600
    v_mfma_f32_16x16x32_bf16 v[180:183], a[48:51], a[132:135], v[180:183]
    ds_read_b64_tr_b16 a[24:25], v13 offset:40960
    v_mfma_f32_16x16x32_bf16 v[180:183], a[52:55], a[148:151], v[180:183]
    ds_read_b64_tr_b16 a[26:27], v13 offset:41984
    v_mfma_f32_16x16x32_bf16 v[180:183], a[56:59], a[164:167], v[180:183]
    ds_read_b64_tr_b16 a[28:29], v13 offset:57344
    v_mfma_f32_16x16x32_bf16 v[180:183], a[60:63], a[180:183], v[180:183]
    ds_read_b64_tr_b16 a[30:31], v13 offset:58368
    v_mfma_f32_16x16x32_bf16 v[184:187], a[48:51], a[136:139], v[184:187]
    v_exp_f32 v72, -v72
    v_mfma_f32_16x16x32_bf16 v[184:187], a[52:55], a[152:155], v[184:187]
    v_exp_f32 v73, -v73
    v_mfma_f32_16x16x32_bf16 v[184:187], a[56:59], a[168:171], v[184:187]
    v_exp_f32 v74, -v74
    v_mfma_f32_16x16x32_bf16 v[184:187], a[60:63], a[184:187], v[184:187]
    v_exp_f32 v75, -v75
    v_mfma_f32_16x16x32_bf16 v[188:191], a[48:51], a[140:143], v[188:191]
    v_add_f32 v72, 1.0, v72
    v_add_f32 v73, 1.0, v73
    v_mfma_f32_16x16x32_bf16 v[188:191], a[52:55], a[156:159], v[188:191]
    v_add_f32 v74, 1.0, v74
    v_add_f32 v75, 1.0, v75
    v_mfma_f32_16x16x32_bf16 v[188:191], a[56:59], a[172:175], v[188:191]
    v_rcp_f32 v72, v72
    v_mfma_f32_16x16x32_bf16 v[188:191], a[60:63], a[188:191], v[188:191]
    v_rcp_f32 v73, v73
    s_waitcnt lgkmcnt(8)
    v_mfma_f32_16x16x32_bf16 v[192:195], a[0:3], a[128:131], v[192:195]
    ds_read_b64_tr_b16 a[32:33], v14 offset:0
    v_mul_f32 v72, v88, v72
    v_mfma_f32_16x16x32_bf16 v[192:195], a[4:7], a[144:147], v[192:195]
    ds_read_b64_tr_b16 a[34:35], v14 offset:1024
    v_mul_f32 v73, v89, v73
    v_mfma_f32_16x16x32_bf16 v[192:195], a[8:11], a[160:163], v[192:195]
    ds_read_b64_tr_b16 a[36:37], v14 offset:16384
    v_cvt_pk_bf16_f32 v26, v72, v73
    v_mfma_f32_16x16x32_bf16 v[192:195], a[12:15], a[176:179], v[192:195]
    ds_read_b64_tr_b16 a[38:39], v14 offset:17408
    v_mfma_f32_16x16x32_bf16 v[196:199], a[0:3], a[132:135], v[196:199]
    ds_read_b64_tr_b16 a[40:41], v14 offset:32768
    v_mfma_f32_16x16x32_bf16 v[196:199], a[4:7], a[148:151], v[196:199]
    ds_read_b64_tr_b16 a[42:43], v14 offset:33792
    v_mfma_f32_16x16x32_bf16 v[196:199], a[8:11], a[164:167], v[196:199]
    ds_read_b64_tr_b16 a[44:45], v14 offset:49152
    v_mfma_f32_16x16x32_bf16 v[196:199], a[12:15], a[180:183], v[196:199]
    ds_read_b64_tr_b16 a[46:47], v14 offset:50176
    v_mfma_f32_16x16x32_bf16 v[200:203], a[0:3], a[136:139], v[200:203]
    v_rcp_f32 v74, v74
    v_mfma_f32_16x16x32_bf16 v[200:203], a[4:7], a[152:155], v[200:203]
    v_rcp_f32 v75, v75
    v_mfma_f32_16x16x32_bf16 v[200:203], a[8:11], a[168:171], v[200:203]
    v_mul_f32 v74, v90, v74
    v_mul_f32 v75, v91, v75
    v_mfma_f32_16x16x32_bf16 v[200:203], a[12:15], a[184:187], v[200:203]
    v_cvt_pk_bf16_f32 v27, v74, v75
    v_mfma_f32_16x16x32_bf16 v[204:207], a[0:3], a[140:143], v[204:207]
    buffer_store_dwordx4 v[24:27], v1, s[24:27], s43 offen offset:0 sc1
    v_mfma_f32_16x16x32_bf16 v[204:207], a[4:7], a[156:159], v[204:207]
    v_exp_f32 v76, -v76
    v_mfma_f32_16x16x32_bf16 v[204:207], a[8:11], a[172:175], v[204:207]
    v_exp_f32 v77, -v77
    v_mfma_f32_16x16x32_bf16 v[204:207], a[12:15], a[188:191], v[204:207]
    v_exp_f32 v78, -v78
    s_waitcnt lgkmcnt(8)
    v_mfma_f32_16x16x32_bf16 v[208:211], a[16:19], a[128:131], v[208:211]
    ds_read_b64_tr_b16 a[48:49], v14 offset:8192
    v_add_f32 v76, 1.0, v76
    v_mfma_f32_16x16x32_bf16 v[208:211], a[20:23], a[144:147], v[208:211]
    ds_read_b64_tr_b16 a[50:51], v14 offset:9216
    v_add_f32 v77, 1.0, v77
    v_mfma_f32_16x16x32_bf16 v[208:211], a[24:27], a[160:163], v[208:211]
    ds_read_b64_tr_b16 a[52:53], v14 offset:24576
    v_add_f32 v78, 1.0, v78
    v_mfma_f32_16x16x32_bf16 v[208:211], a[28:31], a[176:179], v[208:211]
    ds_read_b64_tr_b16 a[54:55], v14 offset:25600
    v_mfma_f32_16x16x32_bf16 v[212:215], a[16:19], a[132:135], v[212:215]
    ds_read_b64_tr_b16 a[56:57], v14 offset:40960
    v_mfma_f32_16x16x32_bf16 v[212:215], a[20:23], a[148:151], v[212:215]
    ds_read_b64_tr_b16 a[58:59], v14 offset:41984
    v_mfma_f32_16x16x32_bf16 v[212:215], a[24:27], a[164:167], v[212:215]
    ds_read_b64_tr_b16 a[60:61], v14 offset:57344
    v_mfma_f32_16x16x32_bf16 v[212:215], a[28:31], a[180:183], v[212:215]
    ds_read_b64_tr_b16 a[62:63], v14 offset:58368
    v_mfma_f32_16x16x32_bf16 v[216:219], a[16:19], a[136:139], v[216:219]
    v_exp_f32 v79, -v79
    v_mfma_f32_16x16x32_bf16 v[216:219], a[20:23], a[152:155], v[216:219]
    v_add_f32 v79, 1.0, v79
    v_mfma_f32_16x16x32_bf16 v[216:219], a[24:27], a[168:171], v[216:219]
    v_rcp_f32 v76, v76
    v_mfma_f32_16x16x32_bf16 v[216:219], a[28:31], a[184:187], v[216:219]
    v_rcp_f32 v77, v77
    v_mfma_f32_16x16x32_bf16 v[220:223], a[16:19], a[140:143], v[220:223]
    v_rcp_f32 v78, v78
    v_mfma_f32_16x16x32_bf16 v[220:223], a[20:23], a[156:159], v[220:223]
    v_rcp_f32 v79, v79
    v_mfma_f32_16x16x32_bf16 v[220:223], a[24:27], a[172:175], v[220:223]
    v_mul_f32 v76, v92, v76
    v_mul_f32 v77, v93, v77
    v_mfma_f32_16x16x32_bf16 v[220:223], a[28:31], a[188:191], v[220:223]
    v_mul_f32 v78, v94, v78
    v_mul_f32 v79, v95, v79
    s_waitcnt lgkmcnt(8)
    v_mfma_f32_16x16x32_bf16 v[224:227], a[32:35], a[128:131], v[224:227]
    v_cvt_pk_bf16_f32 v30, v76, v77
    v_cvt_pk_bf16_f32 v31, v78, v79
    v_mfma_f32_16x16x32_bf16 v[224:227], a[36:39], a[144:147], v[224:227]
    buffer_store_dwordx4 v[28:31], v1, s[24:27], s44 offen offset:0 sc1
    v_mfma_f32_16x16x32_bf16 v[224:227], a[40:43], a[160:163], v[224:227]
    v_exp_f32 v96, -v96
    v_mfma_f32_16x16x32_bf16 v[224:227], a[44:47], a[176:179], v[224:227]
    v_exp_f32 v97, -v97
    v_mfma_f32_16x16x32_bf16 v[228:231], a[32:35], a[132:135], v[228:231]
    v_exp_f32 v98, -v98
    v_mfma_f32_16x16x32_bf16 v[228:231], a[36:39], a[148:151], v[228:231]
    v_exp_f32 v99, -v99
    v_mfma_f32_16x16x32_bf16 v[228:231], a[40:43], a[164:167], v[228:231]
    v_add_f32 v96, 1.0, v96
    v_add_f32 v97, 1.0, v97
    v_mfma_f32_16x16x32_bf16 v[228:231], a[44:47], a[180:183], v[228:231]
    v_add_f32 v98, 1.0, v98
    v_add_f32 v99, 1.0, v99
    v_mfma_f32_16x16x32_bf16 v[232:235], a[32:35], a[136:139], v[232:235]
    v_rcp_f32 v96, v96
    v_mfma_f32_16x16x32_bf16 v[232:235], a[36:39], a[152:155], v[232:235]
    v_rcp_f32 v97, v97
    v_mfma_f32_16x16x32_bf16 v[232:235], a[40:43], a[168:171], v[232:235]
    v_rcp_f32 v98, v98
    v_mfma_f32_16x16x32_bf16 v[232:235], a[44:47], a[184:187], v[232:235]
    v_rcp_f32 v99, v99
    v_mfma_f32_16x16x32_bf16 v[236:239], a[32:35], a[140:143], v[236:239]
    v_mul_f32 v96, v112, v96
    v_mul_f32 v97, v113, v97
    v_mfma_f32_16x16x32_bf16 v[236:239], a[36:39], a[156:159], v[236:239]
    v_mul_f32 v98, v114, v98
    v_mul_f32 v99, v115, v99
    v_mfma_f32_16x16x32_bf16 v[236:239], a[40:43], a[172:175], v[236:239]
    v_cvt_pk_bf16_f32 v16, v96, v97
    v_cvt_pk_bf16_f32 v17, v98, v99
    v_mfma_f32_16x16x32_bf16 v[236:239], a[44:47], a[188:191], v[236:239]
    v_exp_f32 v100, -v100
    s_waitcnt lgkmcnt(0)
    v_mfma_f32_16x16x32_bf16 v[240:243], a[48:51], a[128:131], v[240:243]
    v_exp_f32 v101, -v101
    v_mfma_f32_16x16x32_bf16 v[240:243], a[52:55], a[144:147], v[240:243]
    v_exp_f32 v102, -v102
    v_mfma_f32_16x16x32_bf16 v[240:243], a[56:59], a[160:163], v[240:243]
    v_exp_f32 v103, -v103
    v_mfma_f32_16x16x32_bf16 v[240:243], a[60:63], a[176:179], v[240:243]
    v_add_f32 v100, 1.0, v100
    v_add_f32 v101, 1.0, v101
    v_mfma_f32_16x16x32_bf16 v[244:247], a[48:51], a[132:135], v[244:247]
    v_add_f32 v102, 1.0, v102
    v_add_f32 v103, 1.0, v103
    v_mfma_f32_16x16x32_bf16 v[244:247], a[52:55], a[148:151], v[244:247]
    v_rcp_f32 v100, v100
    v_mfma_f32_16x16x32_bf16 v[244:247], a[56:59], a[164:167], v[244:247]
    v_rcp_f32 v101, v101
    v_mfma_f32_16x16x32_bf16 v[244:247], a[60:63], a[180:183], v[244:247]
    v_rcp_f32 v102, v102
    v_mfma_f32_16x16x32_bf16 v[248:251], a[48:51], a[136:139], v[248:251]
    v_rcp_f32 v103, v103
    v_mfma_f32_16x16x32_bf16 v[248:251], a[52:55], a[152:155], v[248:251]
    v_mul_f32 v100, v116, v100
    v_mul_f32 v101, v117, v101
    v_mfma_f32_16x16x32_bf16 v[248:251], a[56:59], a[168:171], v[248:251]
    v_mul_f32 v102, v118, v102
    v_mul_f32 v103, v119, v103
    v_mfma_f32_16x16x32_bf16 v[248:251], a[60:63], a[184:187], v[248:251]
    v_cvt_pk_bf16_f32 v20, v100, v101
    v_cvt_pk_bf16_f32 v21, v102, v103
    v_mfma_f32_16x16x32_bf16 v[252:255], a[48:51], a[140:143], v[252:255]
    v_exp_f32 v104, -v104
    v_mfma_f32_16x16x32_bf16 v[252:255], a[52:55], a[156:159], v[252:255]
    v_exp_f32 v105, -v105
    v_mfma_f32_16x16x32_bf16 v[252:255], a[56:59], a[172:175], v[252:255]
    v_exp_f32 v106, -v106
    v_mfma_f32_16x16x32_bf16 v[252:255], a[60:63], a[188:191], v[252:255]
    v_exp_f32 v107, -v107
    s_barrier
    s_nop 7
    v_add_f32 v104, 1.0, v104
    v_add_f32 v105, 1.0, v105
    v_add_f32 v106, 1.0, v106
    v_add_f32 v107, 1.0, v107
    v_rcp_f32 v104, v104
    s_nop 0
    v_rcp_f32 v105, v105
    s_nop 0
    v_rcp_f32 v106, v106
    s_nop 0
    v_rcp_f32 v107, v107
    s_nop 0
    v_mul_f32 v104, v120, v104
    v_mul_f32 v105, v121, v105
    v_mul_f32 v106, v122, v106
    v_mul_f32 v107, v123, v107
    v_cvt_pk_bf16_f32 v24, v104, v105
    v_cvt_pk_bf16_f32 v25, v106, v107
    v_exp_f32 v108, -v108
    s_nop 0
    v_exp_f32 v109, -v109
    s_nop 0
    v_exp_f32 v110, -v110
    s_nop 0
    v_exp_f32 v111, -v111
    s_nop 0
    v_add_f32 v108, 1.0, v108
    v_add_f32 v109, 1.0, v109
    v_add_f32 v110, 1.0, v110
    v_add_f32 v111, 1.0, v111
    v_rcp_f32 v108, v108
    s_nop 0
    v_rcp_f32 v109, v109
    s_nop 0
    v_rcp_f32 v110, v110
    s_nop 0
    v_rcp_f32 v111, v111
    s_nop 0
    v_mul_f32 v108, v124, v108
    v_mul_f32 v109, v125, v109
    v_mul_f32 v110, v126, v110
    v_mul_f32 v111, v127, v111
    v_cvt_pk_bf16_f32 v28, v108, v109
    v_cvt_pk_bf16_f32 v29, v110, v111
    v_exp_f32 v128, -v128
    v_exp_f32 v129, -v129
    v_exp_f32 v130, -v130
    v_exp_f32 v131, -v131
    v_pk_add_f32 v[128:129], v[128:129], 1.0 op_sel_hi:[1,0]
    v_pk_add_f32 v[130:131], v[130:131], 1.0 op_sel_hi:[1,0]
    v_rcp_f32 v128, v128
    v_rcp_f32 v129, v129
    v_rcp_f32 v130, v130
    v_rcp_f32 v131, v131
    s_nop 0
    v_pk_mul_f32 v[128:129], v[144:145], v[128:129]
    v_pk_mul_f32 v[130:131], v[146:147], v[130:131]
    v_cvt_pk_bf16_f32 v18, v128, v129
    v_cvt_pk_bf16_f32 v19, v130, v131
    buffer_store_dwordx4 v[16:19], v1, s[24:27], s41 offen offset:1024 sc1
    v_exp_f32 v132, -v132
    v_exp_f32 v133, -v133
    v_exp_f32 v134, -v134
    v_exp_f32 v135, -v135
    v_pk_add_f32 v[132:133], v[132:133], 1.0 op_sel_hi:[1,0]
    v_pk_add_f32 v[134:135], v[134:135], 1.0 op_sel_hi:[1,0]
    v_rcp_f32 v132, v132
    v_rcp_f32 v133, v133
    v_rcp_f32 v134, v134
    v_rcp_f32 v135, v135
    s_nop 0
    v_pk_mul_f32 v[132:133], v[148:149], v[132:133]
    v_pk_mul_f32 v[134:135], v[150:151], v[134:135]
    v_cvt_pk_bf16_f32 v22, v132, v133
    v_cvt_pk_bf16_f32 v23, v134, v135
    buffer_store_dwordx4 v[20:23], v1, s[24:27], s42 offen offset:1024 sc1
    v_exp_f32 v136, -v136
    v_exp_f32 v137, -v137
    v_exp_f32 v138, -v138
    v_exp_f32 v139, -v139
    v_pk_add_f32 v[136:137], v[136:137], 1.0 op_sel_hi:[1,0]
    v_pk_add_f32 v[138:139], v[138:139], 1.0 op_sel_hi:[1,0]
    v_rcp_f32 v136, v136
    v_rcp_f32 v137, v137
    v_rcp_f32 v138, v138
    v_rcp_f32 v139, v139
    s_nop 0
    v_pk_mul_f32 v[136:137], v[152:153], v[136:137]
    v_pk_mul_f32 v[138:139], v[154:155], v[138:139]
    v_cvt_pk_bf16_f32 v26, v136, v137
    v_cvt_pk_bf16_f32 v27, v138, v139
    buffer_store_dwordx4 v[24:27], v1, s[24:27], s43 offen offset:1024 sc1
    v_exp_f32 v140, -v140
    v_exp_f32 v141, -v141
    v_exp_f32 v142, -v142
    v_exp_f32 v143, -v143
    v_pk_add_f32 v[140:141], v[140:141], 1.0 op_sel_hi:[1,0]
    v_pk_add_f32 v[142:143], v[142:143], 1.0 op_sel_hi:[1,0]
    v_rcp_f32 v140, v140
    v_rcp_f32 v141, v141
    v_rcp_f32 v142, v142
    v_rcp_f32 v143, v143
    s_nop 0
    v_pk_mul_f32 v[140:141], v[156:157], v[140:141]
    v_pk_mul_f32 v[142:143], v[158:159], v[142:143]
    v_cvt_pk_bf16_f32 v30, v140, v141
    v_cvt_pk_bf16_f32 v31, v142, v143
    buffer_store_dwordx4 v[28:31], v1, s[24:27], s44 offen offset:1024 sc1
    v_exp_f32 v160, -v160
    v_exp_f32 v161, -v161
    v_exp_f32 v162, -v162
    v_exp_f32 v163, -v163
    v_pk_add_f32 v[160:161], v[160:161], 1.0 op_sel_hi:[1,0]
    v_pk_add_f32 v[162:163], v[162:163], 1.0 op_sel_hi:[1,0]
    v_rcp_f32 v160, v160
    v_rcp_f32 v161, v161
    v_rcp_f32 v162, v162
    v_rcp_f32 v163, v163
    s_nop 0
    v_pk_mul_f32 v[160:161], v[176:177], v[160:161]
    v_pk_mul_f32 v[162:163], v[178:179], v[162:163]
    v_cvt_pk_bf16_f32 v16, v160, v161
    v_cvt_pk_bf16_f32 v17, v162, v163
    v_exp_f32 v192, -v192
    v_exp_f32 v193, -v193
    v_exp_f32 v194, -v194
    v_exp_f32 v195, -v195
    v_pk_add_f32 v[192:193], v[192:193], 1.0 op_sel_hi:[1,0]
    v_pk_add_f32 v[194:195], v[194:195], 1.0 op_sel_hi:[1,0]
    v_rcp_f32 v192, v192
    v_rcp_f32 v193, v193
    v_rcp_f32 v194, v194
    v_rcp_f32 v195, v195
    s_nop 0
    v_pk_mul_f32 v[192:193], v[208:209], v[192:193]
    v_pk_mul_f32 v[194:195], v[210:211], v[194:195]
    v_cvt_pk_bf16_f32 v18, v192, v193
    v_cvt_pk_bf16_f32 v19, v194, v195
    buffer_store_dwordx4 v[16:19], v1, s[24:27], s41 offen offset:2048 sc1
    v_exp_f32 v224, -v224
    v_exp_f32 v225, -v225
    v_exp_f32 v226, -v226
    v_exp_f32 v227, -v227
    v_pk_add_f32 v[224:225], v[224:225], 1.0 op_sel_hi:[1,0]
    v_pk_add_f32 v[226:227], v[226:227], 1.0 op_sel_hi:[1,0]
    v_rcp_f32 v224, v224
    v_rcp_f32 v225, v225
    v_rcp_f32 v226, v226
    v_rcp_f32 v227, v227
    s_nop 0
    v_pk_mul_f32 v[224:225], v[240:241], v[224:225]
    v_pk_mul_f32 v[226:227], v[242:243], v[226:227]
    v_cvt_pk_bf16_f32 v20, v224, v225
    v_cvt_pk_bf16_f32 v21, v226, v227
    buffer_store_dwordx2 v[20:21], v1, s[24:27], s41 offen offset:3072 sc1
    v_exp_f32 v164, -v164
    v_exp_f32 v165, -v165
    v_exp_f32 v166, -v166
    v_exp_f32 v167, -v167
    v_pk_add_f32 v[164:165], v[164:165], 1.0 op_sel_hi:[1,0]
    v_pk_add_f32 v[166:167], v[166:167], 1.0 op_sel_hi:[1,0]
    v_rcp_f32 v164, v164
    v_rcp_f32 v165, v165
    v_rcp_f32 v166, v166
    v_rcp_f32 v167, v167
    s_nop 0
    v_pk_mul_f32 v[164:165], v[180:181], v[164:165]
    v_pk_mul_f32 v[166:167], v[182:183], v[166:167]
    v_cvt_pk_bf16_f32 v24, v164, v165
    v_cvt_pk_bf16_f32 v25, v166, v167
    v_exp_f32 v196, -v196
    v_exp_f32 v197, -v197
    v_exp_f32 v198, -v198
    v_exp_f32 v199, -v199
    v_pk_add_f32 v[196:197], v[196:197], 1.0 op_sel_hi:[1,0]
    v_pk_add_f32 v[198:199], v[198:199], 1.0 op_sel_hi:[1,0]
    v_rcp_f32 v196, v196
    v_rcp_f32 v197, v197
    v_rcp_f32 v198, v198
    v_rcp_f32 v199, v199
    s_nop 0
    v_pk_mul_f32 v[196:197], v[212:213], v[196:197]
    v_pk_mul_f32 v[198:199], v[214:215], v[198:199]
    v_cvt_pk_bf16_f32 v26, v196, v197
    v_cvt_pk_bf16_f32 v27, v198, v199
    buffer_store_dwordx4 v[24:27], v1, s[24:27], s42 offen offset:2048 sc1
    v_exp_f32 v228, -v228
    v_exp_f32 v229, -v229
    v_exp_f32 v230, -v230
    v_exp_f32 v231, -v231
    v_pk_add_f32 v[228:229], v[228:229], 1.0 op_sel_hi:[1,0]
    v_pk_add_f32 v[230:231], v[230:231], 1.0 op_sel_hi:[1,0]
    v_rcp_f32 v228, v228
    v_rcp_f32 v229, v229
    v_rcp_f32 v230, v230
    v_rcp_f32 v231, v231
    s_nop 0
    v_pk_mul_f32 v[228:229], v[244:245], v[228:229]
    v_pk_mul_f32 v[230:231], v[246:247], v[230:231]
    v_cvt_pk_bf16_f32 v28, v228, v229
    v_cvt_pk_bf16_f32 v29, v230, v231
    buffer_store_dwordx2 v[28:29], v1, s[24:27], s42 offen offset:3072 sc1
    v_exp_f32 v168, -v168
    v_exp_f32 v169, -v169
    v_exp_f32 v170, -v170
    v_exp_f32 v171, -v171
    v_pk_add_f32 v[168:169], v[168:169], 1.0 op_sel_hi:[1,0]
    v_pk_add_f32 v[170:171], v[170:171], 1.0 op_sel_hi:[1,0]
    v_rcp_f32 v168, v168
    v_rcp_f32 v169, v169
    v_rcp_f32 v170, v170
    v_rcp_f32 v171, v171
    s_nop 0
    v_pk_mul_f32 v[168:169], v[184:185], v[168:169]
    v_pk_mul_f32 v[170:171], v[186:187], v[170:171]
    v_cvt_pk_bf16_f32 v16, v168, v169
    v_cvt_pk_bf16_f32 v17, v170, v171
    v_exp_f32 v200, -v200
    v_exp_f32 v201, -v201
    v_exp_f32 v202, -v202
    v_exp_f32 v203, -v203
    v_pk_add_f32 v[200:201], v[200:201], 1.0 op_sel_hi:[1,0]
    v_pk_add_f32 v[202:203], v[202:203], 1.0 op_sel_hi:[1,0]
    v_rcp_f32 v200, v200
    v_rcp_f32 v201, v201
    v_rcp_f32 v202, v202
    v_rcp_f32 v203, v203
    s_nop 0
    v_pk_mul_f32 v[200:201], v[216:217], v[200:201]
    v_pk_mul_f32 v[202:203], v[218:219], v[202:203]
    v_cvt_pk_bf16_f32 v18, v200, v201
    v_cvt_pk_bf16_f32 v19, v202, v203
    buffer_store_dwordx4 v[16:19], v1, s[24:27], s43 offen offset:2048 sc1
    v_exp_f32 v232, -v232
    v_exp_f32 v233, -v233
    v_exp_f32 v234, -v234
    v_exp_f32 v235, -v235
    v_pk_add_f32 v[232:233], v[232:233], 1.0 op_sel_hi:[1,0]
    v_pk_add_f32 v[234:235], v[234:235], 1.0 op_sel_hi:[1,0]
    v_rcp_f32 v232, v232
    v_rcp_f32 v233, v233
    v_rcp_f32 v234, v234
    v_rcp_f32 v235, v235
    s_nop 0
    v_pk_mul_f32 v[232:233], v[248:249], v[232:233]
    v_pk_mul_f32 v[234:235], v[250:251], v[234:235]
    v_cvt_pk_bf16_f32 v20, v232, v233
    v_cvt_pk_bf16_f32 v21, v234, v235
    buffer_store_dwordx2 v[20:21], v1, s[24:27], s43 offen offset:3072 sc1
    v_exp_f32 v172, -v172
    v_exp_f32 v173, -v173
    v_exp_f32 v174, -v174
    v_exp_f32 v175, -v175
    v_pk_add_f32 v[172:173], v[172:173], 1.0 op_sel_hi:[1,0]
    v_pk_add_f32 v[174:175], v[174:175], 1.0 op_sel_hi:[1,0]
    v_rcp_f32 v172, v172
    v_rcp_f32 v173, v173
    v_rcp_f32 v174, v174
    v_rcp_f32 v175, v175
    s_nop 0
    v_pk_mul_f32 v[172:173], v[188:189], v[172:173]
    v_pk_mul_f32 v[174:175], v[190:191], v[174:175]
    v_cvt_pk_bf16_f32 v24, v172, v173
    v_cvt_pk_bf16_f32 v25, v174, v175
    v_exp_f32 v204, -v204
    v_exp_f32 v205, -v205
    v_exp_f32 v206, -v206
    v_exp_f32 v207, -v207
    v_pk_add_f32 v[204:205], v[204:205], 1.0 op_sel_hi:[1,0]
    v_pk_add_f32 v[206:207], v[206:207], 1.0 op_sel_hi:[1,0]
    v_rcp_f32 v204, v204
    v_rcp_f32 v205, v205
    v_rcp_f32 v206, v206
    v_rcp_f32 v207, v207
    s_nop 0
    v_pk_mul_f32 v[204:205], v[220:221], v[204:205]
    v_pk_mul_f32 v[206:207], v[222:223], v[206:207]
    v_cvt_pk_bf16_f32 v26, v204, v205
    v_cvt_pk_bf16_f32 v27, v206, v207
    buffer_store_dwordx4 v[24:27], v1, s[24:27], s44 offen offset:2048 sc1
    v_exp_f32 v236, -v236
    v_exp_f32 v237, -v237
    v_exp_f32 v238, -v238
    v_exp_f32 v239, -v239
    v_pk_add_f32 v[236:237], v[236:237], 1.0 op_sel_hi:[1,0]
    v_pk_add_f32 v[238:239], v[238:239], 1.0 op_sel_hi:[1,0]
    v_rcp_f32 v236, v236
    v_rcp_f32 v237, v237
    v_rcp_f32 v238, v238
    v_rcp_f32 v239, v239
    s_nop 0
    v_pk_mul_f32 v[236:237], v[252:253], v[236:237]
    v_pk_mul_f32 v[238:239], v[254:255], v[238:239]
    v_cvt_pk_bf16_f32 v28, v236, v237
    v_cvt_pk_bf16_f32 v29, v238, v239
    buffer_store_dwordx2 v[28:29], v1, s[24:27], s44 offen offset:3072 sc1
    s_branch L_gup_fin
L_gup_odd:
    s_waitcnt vmcnt(0)
    s_waitcnt lgkmcnt(8)
    v_mfma_f32_16x16x32_bf16 v[32:35], a[32:35], a[128:131], v[32:35]
    ds_read_b64_tr_b16 a[0:1], v9 offset:0
    v_mfma_f32_16x16x32_bf16 v[32:35], a[36:39], a[144:147], v[32:35]
    ds_read_b64_tr_b16 a[2:3], v9 offset:1024
    v_mfma_f32_16x16x32_bf16 v[32:35], a[40:43], a[160:163], v[32:35]
    ds_read_b64_tr_b16 a[4:5], v9 offset:16384
    v_mfma_f32_16x16x32_bf16 v[32:35], a[44:47], a[176:179], v[32:35]
    ds_read_b64_tr_b16 a[6:7], v9 offset:17408
    v_mfma_f32_16x16x32_bf16 v[36:39], a[32:35], a[132:135], v[36:39]
    ds_read_b64_tr_b16 a[8:9], v9 offset:32768
    v_mfma_f32_16x16x32_bf16 v[36:39], a[36:39], a[148:151], v[36:39]
    ds_read_b64_tr_b16 a[10:11], v9 offset:33792
    v_mfma_f32_16x16x32_bf16 v[36:39], a[40:43], a[164:167], v[36:39]
    ds_read_b64_tr_b16 a[12:13], v9 offset:49152
    v_mfma_f32_16x16x32_bf16 v[36:39], a[44:47], a[180:183], v[36:39]
    ds_read_b64_tr_b16 a[14:15], v9 offset:50176
    v_mfma_f32_16x16x32_bf16 v[40:43], a[32:35], a[136:139], v[40:43]
    v_exp_f32 v32, -v32
    v_mfma_f32_16x16x32_bf16 v[40:43], a[36:39], a[152:155], v[40:43]
    v_exp_f32 v33, -v33
    v_mfma_f32_16x16x32_bf16 v[40:43], a[40:43], a[168:171], v[40:43]
    v_exp_f32 v34, -v34
    v_mfma_f32_16x16x32_bf16 v[40:43], a[44:47], a[184:187], v[40:43]
    v_exp_f32 v35, -v35
    v_mfma_f32_16x16x32_bf16 v[44:47], a[32:35], a[140:143], v[44:47]
    v_add_f32 v32, 1.0, v32
    v_add_f32 v33, 1.0, v33
    v_mfma_f32_16x16x32_bf16 v[44:47], a[36:39], a[156:159], v[44:47]
    v_add_f32 v34, 1.0, v34
    v_add_f32 v35, 1.0, v35
    v_mfma_f32_16x16x32_bf16 v[44:47], a[40:43], a[172:175], v[44:47]
    v_rcp_f32 v32, v32
    v_mfma_f32_16x16x32_bf16 v[44:47], a[44:47], a[188:191], v[44:47]
    v_rcp_f32 v33, v33
    s_waitcnt lgkmcnt(8)
    v_mfma_f32_16x16x32_bf16 v[48:51], a[48:51], a[128:131], v[48:51]
    ds_read_b64_tr_b16 a[16:17], v9 offset:8192
    v_mfma_f32_16x16x32_bf16 v[48:51], a[52:55], a[144:147], v[48:51]
    ds_read_b64_tr_b16 a[18:19], v9 offset:9216
    v_mfma_f32_16x16x32_bf16 v[48:51], a[56:59], a[160:163], v[48:51]
    ds_read_b64_tr_b16 a[20:21], v9 offset:24576
    v_mfma_f32_16x16x32_bf16 v[48:51], a[60:63], a[176:179], v[48:51]
    ds_read_b64_tr_b16 a[22:23], v9 offset:25600
    v_mfma_f32_16x16x32_bf16 v[52:55], a[48:51], a[132:135], v[52:55]
    ds_read_b64_tr_b16 a[24:25], v9 offset:40960
    v_mfma_f32_16x16x32_bf16 v[52:55], a[52:55], a[148:151], v[52:55]
    ds_read_b64_tr_b16 a[26:27], v9 offset:41984
    v_mfma_f32_16x16x32_bf16 v[52:55], a[56:59], a[164:167], v[52:55]
    ds_read_b64_tr_b16 a[28:29], v9 offset:57344
    v_mfma_f32_16x16x32_bf16 v[52:55], a[60:63], a[180:183], v[52:55]
    ds_read_b64_tr_b16 a[30:31], v9 offset:58368
    v_mul_f32 v32, v48, v32
    v_mfma_f32_16x16x32_bf16 v[56:59], a[48:51], a[136:139], v[56:59]
    v_rcp_f32 v34, v34
    v_mfma_f32_16x16x32_bf16 v[56:59], a[52:55], a[152:155], v[56:59]
    v_rcp_f32 v35, v35
    v_mfma_f32_16x16x32_bf16 v[56:59], a[56:59], a[168:171], v[56:59]
    v_mul_f32 v33, v49, v33
    v_mul_f32 v34, v50, v34
    v_mfma_f32_16x16x32_bf16 v[56:59], a[60:63], a[184:187], v[56:59]
    v_mul_f32 v35, v51, v35
    v_cvt_pk_bf16_f32 v16, v32, v33
    v_mfma_f32_16x16x32_bf16 v[60:63], a[48:51], a[140:143], v[60:63]
    v_cvt_pk_bf16_f32 v17, v34, v35
    v_mfma_f32_16x16x32_bf16 v[60:63], a[52:55], a[156:159], v[60:63]
    buffer_store_dwordx2 v[16:17], v1, s[24:27], s41 offen offset:8 sc1
    v_mfma_f32_16x16x32_bf16 v[60:63], a[56:59], a[172:175], v[60:63]
    v_exp_f32 v36, -v36
    v_mfma_f32_16x16x32_bf16 v[60:63], a[60:63], a[188:191], v[60:63]
    v_exp_f32 v37, -v37
    s_waitcnt lgkmcnt(8)
    v_mfma_f32_16x16x32_bf16 v[64:67], a[0:3], a[128:131], v[64:67]
    ds_read_b64_tr_b16 a[32:33], v10 offset:0
    v_add_f32 v36, 1.0, v36
    v_mfma_f32_16x16x32_bf16 v[64:67], a[4:7], a[144:147], v[64:67]
    ds_read_b64_tr_b16 a[34:35], v10 offset:1024
    v_add_f32 v37, 1.0, v37
    v_mfma_f32_16x16x32_bf16 v[64:67], a[8:11], a[160:163], v[64:67]
    ds_read_b64_tr_b16 a[36:37], v10 offset:16384
    v_mfma_f32_16x16x32_bf16 v[64:67], a[12:15], a[176:179], v[64:67]
    ds_read_b64_tr_b16 a[38:39], v10 offset:17408
    v_mfma_f32_16x16x32_bf16 v[68:71], a[0:3], a[132:135], v[68:71]
    ds_read_b64_tr_b16 a[40:41], v10 offset:32768
    v_mfma_f32_16x16x32_bf16 v[68:71], a[4:7], a[148:151], v[68:71]
    ds_read_b64_tr_b16 a[42:43], v10 offset:33792
    v_mfma_f32_16x16x32_bf16 v[68:71], a[8:11], a[164:167], v[68:71]
    ds_read_b64_tr_b16 a[44:45], v10 offset:49152
    v_mfma_f32_16x16x32_bf16 v[68:71], a[12:15], a[180:183], v[68:71]
    ds_read_b64_tr_b16 a[46:47], v10 offset:50176
    v_mfma_f32_16x16x32_bf16 v[72:75], a[0:3], a[136:139], v[72:75]
    v_exp_f32 v38, -v38
    v_mfma_f32_16x16x32_bf16 v[72:75], a[4:7], a[152:155], v[72:75]
    v_exp_f32 v39, -v39
    v_mfma_f32_16x16x32_bf16 v[72:75], a[8:11], a[168:171], v[72:75]
    v_add_f32 v38, 1.0, v38
    v_add_f32 v39, 1.0, v39
    v_mfma_f32_16x16x32_bf16 v[72:75], a[12:15], a[184:187], v[72:75]
    v_rcp_f32 v36, v36
    v_mfma_f32_16x16x32_bf16 v[76:79], a[0:3], a[140:143], v[76:79]
    v_rcp_f32 v37, v37
    v_mfma_f32_16x16x32_bf16 v[76:79], a[4:7], a[156:159], v[76:79]
    v_rcp_f32 v38, v38
    v_mfma_f32_16x16x32_bf16 v[76:79], a[8:11], a[172:175], v[76:79]
    v_rcp_f32 v39, v39
    v_mfma_f32_16x16x32_bf16 v[76:79], a[12:15], a[188:191], v[76:79]
    v_mul_f32 v36, v52, v36
    v_mul_f32 v37, v53, v37
    s_waitcnt lgkmcnt(8)
    v_mfma_f32_16x16x32_bf16 v[80:83], a[16:19], a[128:131], v[80:83]
    ds_read_b64_tr_b16 a[48:49], v10 offset:8192
    v_mul_f32 v38, v54, v38
    v_mfma_f32_16x16x32_bf16 v[80:83], a[20:23], a[144:147], v[80:83]
    ds_read_b64_tr_b16 a[50:51], v10 offset:9216
    v_mul_f32 v39, v55, v39
    v_mfma_f32_16x16x32_bf16 v[80:83], a[24:27], a[160:163], v[80:83]
    ds_read_b64_tr_b16 a[52:53], v10 offset:24576
    v_cvt_pk_bf16_f32 v20, v36, v37
    v_mfma_f32_16x16x32_bf16 v[80:83], a[28:31], a[176:179], v[80:83]
    ds_read_b64_tr_b16 a[54:55], v10 offset:25600
    v_cvt_pk_bf16_f32 v21, v38, v39
    v_mfma_f32_16x16x32_bf16 v[84:87], a[16:19], a[132:135], v[84:87]
    ds_read_b64_tr_b16 a[56:57], v10 offset:40960
    v_mfma_f32_16x16x32_bf16 v[84:87], a[20:23], a[148:151], v[84:87]
    ds_read_b64_tr_b16 a[58:59], v10 offset:41984
    v_mfma_f32_16x16x32_bf16 v[84:87], a[24:27], a[164:167], v[84:87]
    ds_read_b64_tr_b16 a[60:61], v10 offset:57344
    v_mfma_f32_16x16x32_bf16 v[84:87], a[28:31], a[180:183], v[84:87]
    ds_read_b64_tr_b16 a[62:63], v10 offset:58368
    v_mfma_f32_16x16x32_bf16 v[88:91], a[16:19], a[136:139], v[88:91]
    buffer_store_dwordx2 v[20:21], v1, s[24:27], s42 offen offset:8 sc1
    v_mfma_f32_16x16x32_bf16 v[88:91], a[20:23], a[152:155], v[88:91]
    v_exp_f32 v40, -v40
    v_mfma_f32_16x16x32_bf16 v[88:91], a[24:27], a[168:171], v[88:91]
    v_exp_f32 v41, -v41
    v_mfma_f32_16x16x32_bf16 v[88:91], a[28:31], a[184:187], v[88:91]
    v_exp_f32 v42, -v42
    v_mfma_f32_16x16x32_bf16 v[92:95], a[16:19], a[140:143], v[92:95]
    v_exp_f32 v43, -v43
    v_mfma_f32_16x16x32_bf16 v[92:95], a[20:23], a[156:159], v[92:95]
    v_add_f32 v40, 1.0, v40
    v_add_f32 v41, 1.0, v41
    v_mfma_f32_16x16x32_bf16 v[92:95], a[24:27], a[172:175], v[92:95]
    v_add_f32 v42, 1.0, v42
    v_add_f32 v43, 1.0, v43
    v_mfma_f32_16x16x32_bf16 v[92:95], a[28:31], a[188:191], v[92:95]
    v_rcp_f32 v40, v40
    s_waitcnt lgkmcnt(8)
    v_mfma_f32_16x16x32_bf16 v[96:99], a[32:35], a[128:131], v[96:99]
    ds_read_b64_tr_b16 a[0:1], v11 offset:0
    v_mul_f32 v40, v56, v40
    v_mfma_f32_16x16x32_bf16 v[96:99], a[36:39], a[144:147], v[96:99]
    ds_read_b64_tr_b16 a[2:3], v11 offset:1024
    v_mfma_f32_16x16x32_bf16 v[96:99], a[40:43], a[160:163], v[96:99]
    ds_read_b64_tr_b16 a[4:5], v11 offset:16384
    v_mfma_f32_16x16x32_bf16 v[96:99], a[44:47], a[176:179], v[96:99]
    ds_read_b64_tr_b16 a[6:7], v11 offset:17408
    v_mfma_f32_16x16x32_bf16 v[100:103], a[32:35], a[132:135], v[100:103]
    ds_read_b64_tr_b16 a[8:9], v11 offset:32768
    v_mfma_f32_16x16x32_bf16 v[100:103], a[36:39], a[148:151], v[100:103]
    ds_read_b64_tr_b16 a[10:11], v11 offset:33792
    v_mfma_f32_16x16x32_bf16 v[100:103], a[40:43], a[164:167], v[100:103]
    ds_read_b64_tr_b16 a[12:13], v11 offset:49152
    v_mfma_f32_16x16x32_bf16 v[100:103], a[44:47], a[180:183], v[100:103]
    ds_read_b64_tr_b16 a[14:15], v11 offset:50176
    v_mfma_f32_16x16x32_bf16 v[104:107], a[32:35], a[136:139], v[104:107]
    v_rcp_f32 v41, v41
    v_mfma_f32_16x16x32_bf16 v[104:107], a[36:39], a[152:155], v[104:107]
    v_rcp_f32 v42, v42
    v_mfma_f32_16x16x32_bf16 v[104:107], a[40:43], a[168:171], v[104:107]
    v_rcp_f32 v43, v43
    v_mfma_f32_16x16x32_bf16 v[104:107], a[44:47], a[184:187], v[104:107]
    v_mul_f32 v41, v57, v41
    v_mul_f32 v42, v58, v42
    v_mfma_f32_16x16x32_bf16 v[108:111], a[32:35], a[140:143], v[108:111]
    v_mul_f32 v43, v59, v43
    v_cvt_pk_bf16_f32 v24, v40, v41
    v_mfma_f32_16x16x32_bf16 v[108:111], a[36:39], a[156:159], v[108:111]
    v_cvt_pk_bf16_f32 v25, v42, v43
    v_mfma_f32_16x16x32_bf16 v[108:111], a[40:43], a[172:175], v[108:111]
    buffer_store_dwordx2 v[24:25], v1, s[24:27], s43 offen offset:8 sc1
    v_mfma_f32_16x16x32_bf16 v[108:111], a[44:47], a[188:191], v[108:111]
    v_exp_f32 v44, -v44
    s_waitcnt lgkmcnt(8)
    v_mfma_f32_16x16x32_bf16 v[112:115], a[48:51], a[128:131], v[112:115]
    ds_read_b64_tr_b16 a[16:17], v11 offset:8192
    v_add_f32 v44, 1.0, v44
    v_mfma_f32_16x16x32_bf16 v[112:115], a[52:55], a[144:147], v[112:115]
    ds_read_b64_tr_b16 a[18:19], v11 offset:9216
    v_mfma_f32_16x16x32_bf16 v[112:115], a[56:59], a[160:163], v[112:115]
    ds_read_b64_tr_b16 a[20:21], v11 offset:24576
    v_mfma_f32_16x16x32_bf16 v[112:115], a[60:63], a[176:179], v[112:115]
    ds_read_b64_tr_b16 a[22:23], v11 offset:25600
    v_mfma_f32_16x16x32_bf16 v[116:119], a[48:51], a[132:135], v[116:119]
    ds_read_b64_tr_b16 a[24:25], v11 offset:40960
    v_mfma_f32_16x16x32_bf16 v[116:119], a[52:55], a[148:151], v[116:119]
    ds_read_b64_tr_b16 a[26:27], v11 offset:41984
    v_mfma_f32_16x16x32_bf16 v[116:119], a[56:59], a[164:167], v[116:119]
    ds_read_b64_tr_b16 a[28:29], v11 offset:57344
    v_mfma_f32_16x16x32_bf16 v[116:119], a[60:63], a[180:183], v[116:119]
    ds_read_b64_tr_b16 a[30:31], v11 offset:58368
    v_mfma_f32_16x16x32_bf16 v[120:123], a[48:51], a[136:139], v[120:123]
    v_exp_f32 v45, -v45
    v_mfma_f32_16x16x32_bf16 v[120:123], a[52:55], a[152:155], v[120:123]
    v_exp_f32 v46, -v46
    v_mfma_f32_16x16x32_bf16 v[120:123], a[56:59], a[168:171], v[120:123]
    v_exp_f32 v47, -v47
    v_mfma_f32_16x16x32_bf16 v[120:123], a[60:63], a[184:187], v[120:123]
    v_add_f32 v45, 1.0, v45
    v_add_f32 v46, 1.0, v46
    v_mfma_f32_16x16x32_bf16 v[124:127], a[48:51], a[140:143], v[124:127]
    v_add_f32 v47, 1.0, v47
    v_mfma_f32_16x16x32_bf16 v[124:127], a[52:55], a[156:159], v[124:127]
    v_rcp_f32 v44, v44
    v_mfma_f32_16x16x32_bf16 v[124:127], a[56:59], a[172:175], v[124:127]
    v_rcp_f32 v45, v45
    v_mfma_f32_16x16x32_bf16 v[124:127], a[60:63], a[188:191], v[124:127]
    v_rcp_f32 v46, v46
    s_waitcnt lgkmcnt(8)
    v_mfma_f32_16x16x32_bf16 v[128:131], a[0:3], a[128:131], v[128:131]
    ds_read_b64_tr_b16 a[32:33], v12 offset:0
    v_mul_f32 v44, v60, v44
    v_mfma_f32_16x16x32_bf16 v[128:131], a[4:7], a[144:147], v[128:131]
    ds_read_b64_tr_b16 a[34:35], v12 offset:1024
    v_mul_f32 v45, v61, v45
    v_mfma_f32_16x16x32_bf16 v[128:131], a[8:11], a[160:163], v[128:131]
    ds_read_b64_tr_b16 a[36:37], v12 offset:16384
    v_mul_f32 v46, v62, v46
    v_mfma_f32_16x16x32_bf16 v[128:131], a[12:15], a[176:179], v[128:131]
    ds_read_b64_tr_b16 a[38:39], v12 offset:17408
    v_cvt_pk_bf16_f32 v28, v44, v45
    v_mfma_f32_16x16x32_bf16 v[132:135], a[0:3], a[132:135], v[132:135]
    ds_read_b64_tr_b16 a[40:41], v12 offset:32768
    v_mfma_f32_16x16x32_bf16 v[132:135], a[4:7], a[148:151], v[132:135]
    ds_read_b64_tr_b16 a[42:43], v12 offset:33792
    v_mfma_f32_16x16x32_bf16 v[132:135], a[8:11], a[164:167], v[132:135]
    ds_read_b64_tr_b16 a[44:45], v12 offset:49152
    v_mfma_f32_16x16x32_bf16 v[132:135], a[12:15], a[180:183], v[132:135]
    ds_read_b64_tr_b16 a[46:47], v12 offset:50176
    v_mfma_f32_16x16x32_bf16 v[136:139], a[0:3], a[136:139], v[136:139]
    v_rcp_f32 v47, v47
    v_mfma_f32_16x16x32_bf16 v[136:139], a[4:7], a[152:155], v[136:139]
    v_mul_f32 v47, v63, v47
    v_mfma_f32_16x16x32_bf16 v[136:139], a[8:11], a[168:171], v[136:139]
    v_cvt_pk_bf16_f32 v29, v46, v47
    v_mfma_f32_16x16x32_bf16 v[136:139], a[12:15], a[184:187], v[136:139]
    buffer_store_dwordx2 v[28:29], v1, s[24:27], s44 offen offset:8 sc1
    v_mfma_f32_16x16x32_bf16 v[140:143], a[0:3], a[140:143], v[140:143]
    v_exp_f32 v64, -v64
    v_mfma_f32_16x16x32_bf16 v[140:143], a[4:7], a[156:159], v[140:143]
    v_exp_f32 v65, -v65
    v_mfma_f32_16x16x32_bf16 v[140:143], a[8:11], a[172:175], v[140:143]
    v_exp_f32 v66, -v66
    v_mfma_f32_16x16x32_bf16 v[140:143], a[12:15], a[188:191], v[140:143]
    v_exp_f32 v67, -v67
    s_waitcnt lgkmcnt(8)
    v_mfma_f32_16x16x32_bf16 v[144:147], a[16:19], a[128:131], v[144:147]
    ds_read_b64_tr_b16 a[48:49], v12 offset:8192
    v_add_f32 v64, 1.0, v64
    v_mfma_f32_16x16x32_bf16 v[144:147], a[20:23], a[144:147], v[144:147]
    ds_read_b64_tr_b16 a[50:51], v12 offset:9216
    v_add_f32 v65, 1.0, v65
    v_mfma_f32_16x16x32_bf16 v[144:147], a[24:27], a[160:163], v[144:147]
    ds_read_b64_tr_b16 a[52:53], v12 offset:24576
    v_add_f32 v66, 1.0, v66
    v_mfma_f32_16x16x32_bf16 v[144:147], a[28:31], a[176:179], v[144:147]
    ds_read_b64_tr_b16 a[54:55], v12 offset:25600
    v_add_f32 v67, 1.0, v67
    v_mfma_f32_16x16x32_bf16 v[148:151], a[16:19], a[132:135], v[148:151]
    ds_read_b64_tr_b16 a[56:57], v12 offset:40960
    v_mfma_f32_16x16x32_bf16 v[148:151], a[20:23], a[148:151], v[148:151]
    ds_read_b64_tr_b16 a[58:59], v12 offset:41984
    v_mfma_f32_16x16x32_bf16 v[148:151], a[24:27], a[164:167], v[148:151]
    ds_read_b64_tr_b16 a[60:61], v12 offset:57344
    v_mfma_f32_16x16x32_bf16 v[148:151], a[28:31], a[180:183], v[148:151]
    ds_read_b64_tr_b16 a[62:63], v12 offset:58368
    v_mfma_f32_16x16x32_bf16 v[152:155], a[16:19], a[136:139], v[152:155]
    v_rcp_f32 v64, v64
    v_mfma_f32_16x16x32_bf16 v[152:155], a[20:23], a[152:155], v[152:155]
    v_rcp_f32 v65, v65
    v_mfma_f32_16x16x32_bf16 v[152:155], a[24:27], a[168:171], v[152:155]
    v_rcp_f32 v66, v66
    v_mfma_f32_16x16x32_bf16 v[152:155], a[28:31], a[184:187], v[152:155]
    v_rcp_f32 v67, v67
    v_mfma_f32_16x16x32_bf16 v[156:159], a[16:19], a[140:143], v[156:159]
    v_mul_f32 v64, v80, v64
    v_mul_f32 v65, v81, v65
    v_mfma_f32_16x16x32_bf16 v[156:159], a[20:23], a[156:159], v[156:159]
    v_mul_f32 v66, v82, v66
    v_mul_f32 v67, v83, v67
    v_mfma_f32_16x16x32_bf16 v[156:159], a[24:27], a[172:175], v[156:159]
    v_cvt_pk_bf16_f32 v16, v64, v65
    v_cvt_pk_bf16_f32 v17, v66, v67
    v_mfma_f32_16x16x32_bf16 v[156:159], a[28:31], a[188:191], v[156:159]
    v_exp_f32 v68, -v68
    s_waitcnt lgkmcnt(8)
    v_mfma_f32_16x16x32_bf16 v[160:163], a[32:35], a[128:131], v[160:163]
    ds_read_b64_tr_b16 a[0:1], v13 offset:0
    v_add_f32 v68, 1.0, v68
    v_mfma_f32_16x16x32_bf16 v[160:163], a[36:39], a[144:147], v[160:163]
    ds_read_b64_tr_b16 a[2:3], v13 offset:1024
    v_mfma_f32_16x16x32_bf16 v[160:163], a[40:43], a[160:163], v[160:163]
    ds_read_b64_tr_b16 a[4:5], v13 offset:16384
    v_mfma_f32_16x16x32_bf16 v[160:163], a[44:47], a[176:179], v[160:163]
    ds_read_b64_tr_b16 a[6:7], v13 offset:17408
    v_mfma_f32_16x16x32_bf16 v[164:167], a[32:35], a[132:135], v[164:167]
    ds_read_b64_tr_b16 a[8:9], v13 offset:32768
    v_mfma_f32_16x16x32_bf16 v[164:167], a[36:39], a[148:151], v[164:167]
    ds_read_b64_tr_b16 a[10:11], v13 offset:33792
    v_mfma_f32_16x16x32_bf16 v[164:167], a[40:43], a[164:167], v[164:167]
    ds_read_b64_tr_b16 a[12:13], v13 offset:49152
    v_mfma_f32_16x16x32_bf16 v[164:167], a[44:47], a[180:183], v[164:167]
    ds_read_b64_tr_b16 a[14:15], v13 offset:50176
    v_mfma_f32_16x16x32_bf16 v[168:171], a[32:35], a[136:139], v[168:171]
    v_exp_f32 v69, -v69
    v_mfma_f32_16x16x32_bf16 v[168:171], a[36:39], a[152:155], v[168:171]
    v_exp_f32 v70, -v70
    v_mfma_f32_16x16x32_bf16 v[168:171], a[40:43], a[168:171], v[168:171]
    v_exp_f32 v71, -v71
    v_mfma_f32_16x16x32_bf16 v[168:171], a[44:47], a[184:187], v[168:171]
    v_add_f32 v69, 1.0, v69
    v_add_f32 v70, 1.0, v70
    v_mfma_f32_16x16x32_bf16 v[172:175], a[32:35], a[140:143], v[172:175]
    v_add_f32 v71, 1.0, v71
    v_mfma_f32_16x16x32_bf16 v[172:175], a[36:39], a[156:159], v[172:175]
    v_rcp_f32 v68, v68
    v_mfma_f32_16x16x32_bf16 v[172:175], a[40:43], a[172:175], v[172:175]
    v_rcp_f32 v69, v69
    v_mfma_f32_16x16x32_bf16 v[172:175], a[44:47], a[188:191], v[172:175]
    v_rcp_f32 v70, v70
    s_waitcnt lgkmcnt(8)
    v_mfma_f32_16x16x32_bf16 v[176:179], a[48:51], a[128:131], v[176:179]
    ds_read_b64_tr_b16 a[16:17], v13 offset:8192
    v_mul_f32 v68, v84, v68
    v_mfma_f32_16x16x32_bf16 v[176:179], a[52:55], a[144:147], v[176:179]
    ds_read_b64_tr_b16 a[18:19], v13 offset:9216
    v_mul_f32 v69, v85, v69
    v_mfma_f32_16x16x32_bf16 v[176:179], a[56:59], a[160:163], v[176:179]
    ds_read_b64_tr_b16 a[20:21], v13 offset:24576
    v_mul_f32 v70, v86, v70
    v_mfma_f32_16x16x32_bf16 v[176:179], a[60:63], a[176:179], v[176:179]
    ds_read_b64_tr_b16 a[22:23], v13 offset:25600
    v_cvt_pk_bf16_f32 v20, v68, v69
    v_mfma_f32_16x16x32_bf16 v[180:183], a[48:51], a[132:135], v[180:183]
    ds_read_b64_tr_b16 a[24:25], v13 offset:40960
    v_mfma_f32_16x16x32_bf16 v[180:183], a[52:55], a[148:151], v[180:183]
    ds_read_b64_tr_b16 a[26:27], v13 offset:41984
    v_mfma_f32_16x16x32_bf16 v[180:183], a[56:59], a[164:167], v[180:183]
    ds_read_b64_tr_b16 a[28:29], v13 offset:57344
    v_mfma_f32_16x16x32_bf16 v[180:183], a[60:63], a[180:183], v[180:183]
    ds_read_b64_tr_b16 a[30:31], v13 offset:58368
    v_mfma_f32_16x16x32_bf16 v[184:187], a[48:51], a[136:139], v[184:187]
    v_rcp_f32 v71, v71
    v_mfma_f32_16x16x32_bf16 v[184:187], a[52:55], a[152:155], v[184:187]
    v_mul_f32 v71, v87, v71
    v_mfma_f32_16x16x32_bf16 v[184:187], a[56:59], a[168:171], v[184:187]
    v_cvt_pk_bf16_f32 v21, v70, v71
    v_mfma_f32_16x16x32_bf16 v[184:187], a[60:63], a[184:187], v[184:187]
    v_exp_f32 v72, -v72
    v_mfma_f32_16x16x32_bf16 v[188:191], a[48:51], a[140:143], v[188:191]
    v_exp_f32 v73, -v73
    v_mfma_f32_16x16x32_bf16 v[188:191], a[52:55], a[156:159], v[188:191]
    v_exp_f32 v74, -v74
    v_mfma_f32_16x16x32_bf16 v[188:191], a[56:59], a[172:175], v[188:191]
    v_exp_f32 v75, -v75
    v_mfma_f32_16x16x32_bf16 v[188:191], a[60:63], a[188:191], v[188:191]
    v_add_f32 v72, 1.0, v72
    v_add_f32 v73, 1.0, v73
    s_waitcnt lgkmcnt(8)
    v_mfma_f32_16x16x32_bf16 v[192:195], a[0:3], a[128:131], v[192:195]
    ds_read_b64_tr_b16 a[32:33], v14 offset:0
    v_add_f32 v74, 1.0, v74
    v_mfma_f32_16x16x32_bf16 v[192:195], a[4:7], a[144:147], v[192:195]
    ds_read_b64_tr_b16 a[34:35], v14 offset:1024
    v_add_f32 v75, 1.0, v75
    v_mfma_f32_16x16x32_bf16 v[192:195], a[8:11], a[160:163], v[192:195]
    ds_read_b64_tr_b16 a[36:37], v14 offset:16384
    v_mfma_f32_16x16x32_bf16 v[192:195], a[12:15], a[176:179], v[192:195]
    ds_read_b64_tr_b16 a[38:39], v14 offset:17408
    v_mfma_f32_16x16x32_bf16 v[196:199], a[0:3], a[132:135], v[196:199]
    ds_read_b64_tr_b16 a[40:41], v14 offset:32768
    v_mfma_f32_16x16x32_bf16 v[196:199], a[4:7], a[148:151], v[196:199]
    ds_read_b64_tr_b16 a[42:43], v14 offset:33792
    v_mfma_f32_16x16x32_bf16 v[196:199], a[8:11], a[164:167], v[196:199]
    ds_read_b64_tr_b16 a[44:45], v14 offset:49152
    v_mfma_f32_16x16x32_bf16 v[196:199], a[12:15], a[180:183], v[196:199]
    ds_read_b64_tr_b16 a[46:47], v14 offset:50176
    v_mfma_f32_16x16x32_bf16 v[200:203], a[0:3], a[136:139], v[200:203]
    v_rcp_f32 v72, v72
    v_mfma_f32_16x16x32_bf16 v[200:203], a[4:7], a[152:155], v[200:203]
    v_rcp_f32 v73, v73
    v_mfma_f32_16x16x32_bf16 v[200:203], a[8:11], a[168:171], v[200:203]
    v_rcp_f32 v74, v74
    v_mfma_f32_16x16x32_bf16 v[200:203], a[12:15], a[184:187], v[200:203]
    v_rcp_f32 v75, v75
    v_mfma_f32_16x16x32_bf16 v[204:207], a[0:3], a[140:143], v[204:207]
    v_mul_f32 v72, v88, v72
    v_mul_f32 v73, v89, v73
    v_mfma_f32_16x16x32_bf16 v[204:207], a[4:7], a[156:159], v[204:207]
    v_mul_f32 v74, v90, v74
    v_mul_f32 v75, v91, v75
    v_mfma_f32_16x16x32_bf16 v[204:207], a[8:11], a[172:175], v[204:207]
    v_cvt_pk_bf16_f32 v24, v72, v73
    v_cvt_pk_bf16_f32 v25, v74, v75
    v_mfma_f32_16x16x32_bf16 v[204:207], a[12:15], a[188:191], v[204:207]
    v_exp_f32 v76, -v76
    s_waitcnt lgkmcnt(8)
    v_mfma_f32_16x16x32_bf16 v[208:211], a[16:19], a[128:131], v[208:211]
    ds_read_b64_tr_b16 a[48:49], v14 offset:8192
    v_add_f32 v76, 1.0, v76
    v_mfma_f32_16x16x32_bf16 v[208:211], a[20:23], a[144:147], v[208:211]
    ds_read_b64_tr_b16 a[50:51], v14 offset:9216
    v_mfma_f32_16x16x32_bf16 v[208:211], a[24:27], a[160:163], v[208:211]
    ds_read_b64_tr_b16 a[52:53], v14 offset:24576
    v_mfma_f32_16x16x32_bf16 v[208:211], a[28:31], a[176:179], v[208:211]
    ds_read_b64_tr_b16 a[54:55], v14 offset:25600
    v_mfma_f32_16x16x32_bf16 v[212:215], a[16:19], a[132:135], v[212:215]
    ds_read_b64_tr_b16 a[56:57], v14 offset:40960
    v_mfma_f32_16x16x32_bf16 v[212:215], a[20:23], a[148:151], v[212:215]
    ds_read_b64_tr_b16 a[58:59], v14 offset:41984
    v_mfma_f32_16x16x32_bf16 v[212:215], a[24:27], a[164:167], v[212:215]
    ds_read_b64_tr_b16 a[60:61], v14 offset:57344
    v_mfma_f32_16x16x32_bf16 v[212:215], a[28:31], a[180:183], v[212:215]
    ds_read_b64_tr_b16 a[62:63], v14 offset:58368
    v_mfma_f32_16x16x32_bf16 v[216:219], a[16:19], a[136:139], v[216:219]
    v_exp_f32 v77, -v77
    v_mfma_f32_16x16x32_bf16 v[216:219], a[20:23], a[152:155], v[216:219]
    v_exp_f32 v78, -v78
    v_mfma_f32_16x16x32_bf16 v[216:219], a[24:27], a[168:171], v[216:219]
    v_exp_f32 v79, -v79
    v_mfma_f32_16x16x32_bf16 v[216:219], a[28:31], a[184:187], v[216:219]
    v_add_f32 v77, 1.0, v77
    v_add_f32 v78, 1.0, v78
    v_mfma_f32_16x16x32_bf16 v[220:223], a[16:19], a[140:143], v[220:223]
    v_add_f32 v79, 1.0, v79
    v_mfma_f32_16x16x32_bf16 v[220:223], a[20:23], a[156:159], v[220:223]
    v_rcp_f32 v76, v76
    v_mfma_f32_16x16x32_bf16 v[220:223], a[24:27], a[172:175], v[220:223]
    v_rcp_f32 v77, v77
    v_mfma_f32_16x16x32_bf16 v[220:223], a[28:31], a[188:191], v[220:223]
    v_rcp_f32 v78, v78
    s_waitcnt lgkmcnt(8)
    v_mfma_f32_16x16x32_bf16 v[224:227], a[32:35], a[128:131], v[224:227]
    v_rcp_f32 v79, v79
    v_mfma_f32_16x16x32_bf16 v[224:227], a[36:39], a[144:147], v[224:227]
    v_mul_f32 v76, v92, v76
    v_mul_f32 v77, v93, v77
    v_mfma_f32_16x16x32_bf16 v[224:227], a[40:43], a[160:163], v[224:227]
    v_mul_f32 v78, v94, v78
    v_mul_f32 v79, v95, v79
    v_mfma_f32_16x16x32_bf16 v[224:227], a[44:47], a[176:179], v[224:227]
    v_cvt_pk_bf16_f32 v28, v76, v77
    v_cvt_pk_bf16_f32 v29, v78, v79
    v_mfma_f32_16x16x32_bf16 v[228:231], a[32:35], a[132:135], v[228:231]
    v_exp_f32 v96, -v96
    v_mfma_f32_16x16x32_bf16 v[228:231], a[36:39], a[148:151], v[228:231]
    v_exp_f32 v97, -v97
    v_mfma_f32_16x16x32_bf16 v[228:231], a[40:43], a[164:167], v[228:231]
    v_exp_f32 v98, -v98
    v_mfma_f32_16x16x32_bf16 v[228:231], a[44:47], a[180:183], v[228:231]
    v_exp_f32 v99, -v99
    v_mfma_f32_16x16x32_bf16 v[232:235], a[32:35], a[136:139], v[232:235]
    v_add_f32 v96, 1.0, v96
    v_add_f32 v97, 1.0, v97
    v_mfma_f32_16x16x32_bf16 v[232:235], a[36:39], a[152:155], v[232:235]
    v_add_f32 v98, 1.0, v98
    v_add_f32 v99, 1.0, v99
    v_mfma_f32_16x16x32_bf16 v[232:235], a[40:43], a[168:171], v[232:235]
    v_rcp_f32 v96, v96
    v_mfma_f32_16x16x32_bf16 v[232:235], a[44:47], a[184:187], v[232:235]
    v_rcp_f32 v97, v97
    v_mfma_f32_16x16x32_bf16 v[236:239], a[32:35], a[140:143], v[236:239]
    v_rcp_f32 v98, v98
    v_mfma_f32_16x16x32_bf16 v[236:239], a[36:39], a[156:159], v[236:239]
    v_rcp_f32 v99, v99
    v_mfma_f32_16x16x32_bf16 v[236:239], a[40:43], a[172:175], v[236:239]
    v_mul_f32 v96, v112, v96
    v_mul_f32 v97, v113, v97
    v_mfma_f32_16x16x32_bf16 v[236:239], a[44:47], a[188:191], v[236:239]
    v_mul_f32 v98, v114, v98
    v_mul_f32 v99, v115, v99
    s_waitcnt lgkmcnt(0)
    v_mfma_f32_16x16x32_bf16 v[240:243], a[48:51], a[128:131], v[240:243]
    v_cvt_pk_bf16_f32 v18, v96, v97
    v_cvt_pk_bf16_f32 v19, v98, v99
    v_mfma_f32_16x16x32_bf16 v[240:243], a[52:55], a[144:147], v[240:243]
    buffer_store_dwordx4 v[16:19], v1, s[24:27], s41 offen offset:1024 sc1
    v_mfma_f32_16x16x32_bf16 v[240:243], a[56:59], a[160:163], v[240:243]
    v_exp_f32 v100, -v100
    v_mfma_f32_16x16x32_bf16 v[240:243], a[60:63], a[176:179], v[240:243]
    v_exp_f32 v101, -v101
    v_mfma_f32_16x16x32_bf16 v[244:247], a[48:51], a[132:135], v[244:247]
    v_exp_f32 v102, -v102
    v_mfma_f32_16x16x32_bf16 v[244:247], a[52:55], a[148:151], v[244:247]
    v_exp_f32 v103, -v103
    v_mfma_f32_16x16x32_bf16 v[244:247], a[56:59], a[164:167], v[244:247]
    v_add_f32 v100, 1.0, v100
    v_add_f32 v101, 1.0, v101
    v_mfma_f32_16x16x32_bf16 v[244:247], a[60:63], a[180:183], v[244:247]
    v_add_f32 v102, 1.0, v102
    v_add_f32 v103, 1.0, v103
    v_mfma_f32_16x16x32_bf16 v[248:251], a[48:51], a[136:139], v[248:251]
    v_rcp_f32 v100, v100
    v_mfma_f32_16x16x32_bf16 v[248:251], a[52:55], a[152:155], v[248:251]
    v_rcp_f32 v101, v101
    v_mfma_f32_16x16x32_bf16 v[248:251], a[56:59], a[168:171], v[248:251]
    v_rcp_f32 v102, v102
    v_mfma_f32_16x16x32_bf16 v[248:251], a[60:63], a[184:187], v[248:251]
    v_rcp_f32 v103, v103
    v_mfma_f32_16x16x32_bf16 v[252:255], a[48:51], a[140:143], v[252:255]
    v_mul_f32 v100, v116, v100
    v_mul_f32 v101, v117, v101
    v_mfma_f32_16x16x32_bf16 v[252:255], a[52:55], a[156:159], v[252:255]
    v_mul_f32 v102, v118, v102
    v_mul_f32 v103, v119, v103
    v_mfma_f32_16x16x32_bf16 v[252:255], a[56:59], a[172:175], v[252:255]
    v_cvt_pk_bf16_f32 v22, v100, v101
    v_cvt_pk_bf16_f32 v23, v102, v103
    v_mfma_f32_16x16x32_bf16 v[252:255], a[60:63], a[188:191], v[252:255]
    buffer_store_dwordx4 v[20:23], v1, s[24:27], s42 offen offset:1024 sc1
    s_barrier
    s_nop 7
    v_exp_f32 v104, -v104
    s_nop 0
    v_exp_f32 v105, -v105
    s_nop 0
    v_exp_f32 v106, -v106
    s_nop 0
    v_exp_f32 v107, -v107
    s_nop 0
    v_add_f32 v104, 1.0, v104
    v_add_f32 v105, 1.0, v105
    v_add_f32 v106, 1.0, v106
    v_add_f32 v107, 1.0, v107
    v_rcp_f32 v104, v104
    s_nop 0
    v_rcp_f32 v105, v105
    s_nop 0
    v_rcp_f32 v106, v106
    s_nop 0
    v_rcp_f32 v107, v107
    s_nop 0
    v_mul_f32 v104, v120, v104
    v_mul_f32 v105, v121, v105
    v_mul_f32 v106, v122, v106
    v_mul_f32 v107, v123, v107
    v_cvt_pk_bf16_f32 v26, v104, v105
    v_cvt_pk_bf16_f32 v27, v106, v107
    buffer_store_dwordx4 v[24:27], v1, s[24:27], s43 offen offset:1024 sc1
    v_exp_f32 v108, -v108
    s_nop 0
    v_exp_f32 v109, -v109
    s_nop 0
    v_exp_f32 v110, -v110
    s_nop 0
    v_exp_f32 v111, -v111
    s_nop 0
    v_add_f32 v108, 1.0, v108
    v_add_f32 v109, 1.0, v109
    v_add_f32 v110, 1.0, v110
    v_add_f32 v111, 1.0, v111
    v_rcp_f32 v108, v108
    s_nop 0
    v_rcp_f32 v109, v109
    s_nop 0
    v_rcp_f32 v110, v110
    s_nop 0
    v_rcp_f32 v111, v111
    s_nop 0
    v_mul_f32 v108, v124, v108
    v_mul_f32 v109, v125, v109
    v_mul_f32 v110, v126, v110
    v_mul_f32 v111, v127, v111
    v_cvt_pk_bf16_f32 v30, v108, v109
    v_cvt_pk_bf16_f32 v31, v110, v111
    buffer_store_dwordx4 v[28:31], v1, s[24:27], s44 offen offset:1024 sc1
    v_exp_f32 v128, -v128
    v_exp_f32 v129, -v129
    v_exp_f32 v130, -v130
    v_exp_f32 v131, -v131
    v_pk_add_f32 v[128:129], v[128:129], 1.0 op_sel_hi:[1,0]
    v_pk_add_f32 v[130:131], v[130:131], 1.0 op_sel_hi:[1,0]
    v_rcp_f32 v128, v128
    v_rcp_f32 v129, v129
    v_rcp_f32 v130, v130
    v_rcp_f32 v131, v131
    s_nop 0
    v_pk_mul_f32 v[128:129], v[144:145], v[128:129]
    v_pk_mul_f32 v[130:131], v[146:147], v[130:131]
    v_cvt_pk_bf16_f32 v16, v128, v129
    v_cvt_pk_bf16_f32 v17, v130, v131
    v_exp_f32 v160, -v160
    v_exp_f32 v161, -v161
    v_exp_f32 v162, -v162
    v_exp_f32 v163, -v163
    v_pk_add_f32 v[160:161], v[160:161], 1.0 op_sel_hi:[1,0]
    v_pk_add_f32 v[162:163], v[162:163], 1.0 op_sel_hi:[1,0]
    v_rcp_f32 v160, v160
    v_rcp_f32 v161, v161
    v_rcp_f32 v162, v162
    v_rcp_f32 v163, v163
    s_nop 0
    v_pk_mul_f32 v[160:161], v[176:177], v[160:161]
    v_pk_mul_f32 v[162:163], v[178:179], v[162:163]
    v_cvt_pk_bf16_f32 v18, v160, v161
    v_cvt_pk_bf16_f32 v19, v162, v163
    buffer_store_dwordx4 v[16:19], v1, s[24:27], s41 offen offset:2048 sc1
    v_exp_f32 v192, -v192
    v_exp_f32 v193, -v193
    v_exp_f32 v194, -v194
    v_exp_f32 v195, -v195
    v_pk_add_f32 v[192:193], v[192:193], 1.0 op_sel_hi:[1,0]
    v_pk_add_f32 v[194:195], v[194:195], 1.0 op_sel_hi:[1,0]
    v_rcp_f32 v192, v192
    v_rcp_f32 v193, v193
    v_rcp_f32 v194, v194
    v_rcp_f32 v195, v195
    s_nop 0
    v_pk_mul_f32 v[192:193], v[208:209], v[192:193]
    v_pk_mul_f32 v[194:195], v[210:211], v[194:195]
    v_cvt_pk_bf16_f32 v20, v192, v193
    v_cvt_pk_bf16_f32 v21, v194, v195
    v_exp_f32 v224, -v224
    v_exp_f32 v225, -v225
    v_exp_f32 v226, -v226
    v_exp_f32 v227, -v227
    v_pk_add_f32 v[224:225], v[224:225], 1.0 op_sel_hi:[1,0]
    v_pk_add_f32 v[226:227], v[226:227], 1.0 op_sel_hi:[1,0]
    v_rcp_f32 v224, v224
    v_rcp_f32 v225, v225
    v_rcp_f32 v226, v226
    v_rcp_f32 v227, v227
    s_nop 0
    v_pk_mul_f32 v[224:225], v[240:241], v[224:225]
    v_pk_mul_f32 v[226:227], v[242:243], v[226:227]
    v_cvt_pk_bf16_f32 v22, v224, v225
    v_cvt_pk_bf16_f32 v23, v226, v227
    buffer_store_dwordx4 v[20:23], v1, s[24:27], s41 offen offset:3072 sc1
    v_exp_f32 v132, -v132
    v_exp_f32 v133, -v133
    v_exp_f32 v134, -v134
    v_exp_f32 v135, -v135
    v_pk_add_f32 v[132:133], v[132:133], 1.0 op_sel_hi:[1,0]
    v_pk_add_f32 v[134:135], v[134:135], 1.0 op_sel_hi:[1,0]
    v_rcp_f32 v132, v132
    v_rcp_f32 v133, v133
    v_rcp_f32 v134, v134
    v_rcp_f32 v135, v135
    s_nop 0
    v_pk_mul_f32 v[132:133], v[148:149], v[132:133]
    v_pk_mul_f32 v[134:135], v[150:151], v[134:135]
    v_cvt_pk_bf16_f32 v24, v132, v133
    v_cvt_pk_bf16_f32 v25, v134, v135
    v_exp_f32 v164, -v164
    v_exp_f32 v165, -v165
    v_exp_f32 v166, -v166
    v_exp_f32 v167, -v167
    v_pk_add_f32 v[164:165], v[164:165], 1.0 op_sel_hi:[1,0]
    v_pk_add_f32 v[166:167], v[166:167], 1.0 op_sel_hi:[1,0]
    v_rcp_f32 v164, v164
    v_rcp_f32 v165, v165
    v_rcp_f32 v166, v166
    v_rcp_f32 v167, v167
    s_nop 0
    v_pk_mul_f32 v[164:165], v[180:181], v[164:165]
    v_pk_mul_f32 v[166:167], v[182:183], v[166:167]
    v_cvt_pk_bf16_f32 v26, v164, v165
    v_cvt_pk_bf16_f32 v27, v166, v167
    buffer_store_dwordx4 v[24:27], v1, s[24:27], s42 offen offset:2048 sc1
    v_exp_f32 v196, -v196
    v_exp_f32 v197, -v197
    v_exp_f32 v198, -v198
    v_exp_f32 v199, -v199
    v_pk_add_f32 v[196:197], v[196:197], 1.0 op_sel_hi:[1,0]
    v_pk_add_f32 v[198:199], v[198:199], 1.0 op_sel_hi:[1,0]
    v_rcp_f32 v196, v196
    v_rcp_f32 v197, v197
    v_rcp_f32 v198, v198
    v_rcp_f32 v199, v199
    s_nop 0
    v_pk_mul_f32 v[196:197], v[212:213], v[196:197]
    v_pk_mul_f32 v[198:199], v[214:215], v[198:199]
    v_cvt_pk_bf16_f32 v28, v196, v197
    v_cvt_pk_bf16_f32 v29, v198, v199
    v_exp_f32 v228, -v228
    v_exp_f32 v229, -v229
    v_exp_f32 v230, -v230
    v_exp_f32 v231, -v231
    v_pk_add_f32 v[228:229], v[228:229], 1.0 op_sel_hi:[1,0]
    v_pk_add_f32 v[230:231], v[230:231], 1.0 op_sel_hi:[1,0]
    v_rcp_f32 v228, v228
    v_rcp_f32 v229, v229
    v_rcp_f32 v230, v230
    v_rcp_f32 v231, v231
    s_nop 0
    v_pk_mul_f32 v[228:229], v[244:245], v[228:229]
    v_pk_mul_f32 v[230:231], v[246:247], v[230:231]
    v_cvt_pk_bf16_f32 v30, v228, v229
    v_cvt_pk_bf16_f32 v31, v230, v231
    buffer_store_dwordx4 v[28:31], v1, s[24:27], s42 offen offset:3072 sc1
    v_exp_f32 v136, -v136
    v_exp_f32 v137, -v137
    v_exp_f32 v138, -v138
    v_exp_f32 v139, -v139
    v_pk_add_f32 v[136:137], v[136:137], 1.0 op_sel_hi:[1,0]
    v_pk_add_f32 v[138:139], v[138:139], 1.0 op_sel_hi:[1,0]
    v_rcp_f32 v136, v136
    v_rcp_f32 v137, v137
    v_rcp_f32 v138, v138
    v_rcp_f32 v139, v139
    s_nop 0
    v_pk_mul_f32 v[136:137], v[152:153], v[136:137]
    v_pk_mul_f32 v[138:139], v[154:155], v[138:139]
    v_cvt_pk_bf16_f32 v16, v136, v137
    v_cvt_pk_bf16_f32 v17, v138, v139
    v_exp_f32 v168, -v168
    v_exp_f32 v169, -v169
    v_exp_f32 v170, -v170
    v_exp_f32 v171, -v171
    v_pk_add_f32 v[168:169], v[168:169], 1.0 op_sel_hi:[1,0]
    v_pk_add_f32 v[170:171], v[170:171], 1.0 op_sel_hi:[1,0]
    v_rcp_f32 v168, v168
    v_rcp_f32 v169, v169
    v_rcp_f32 v170, v170
    v_rcp_f32 v171, v171
    s_nop 0
    v_pk_mul_f32 v[168:169], v[184:185], v[168:169]
    v_pk_mul_f32 v[170:171], v[186:187], v[170:171]
    v_cvt_pk_bf16_f32 v18, v168, v169
    v_cvt_pk_bf16_f32 v19, v170, v171
    buffer_store_dwordx4 v[16:19], v1, s[24:27], s43 offen offset:2048 sc1
    v_exp_f32 v200, -v200
    v_exp_f32 v201, -v201
    v_exp_f32 v202, -v202
    v_exp_f32 v203, -v203
    v_pk_add_f32 v[200:201], v[200:201], 1.0 op_sel_hi:[1,0]
    v_pk_add_f32 v[202:203], v[202:203], 1.0 op_sel_hi:[1,0]
    v_rcp_f32 v200, v200
    v_rcp_f32 v201, v201
    v_rcp_f32 v202, v202
    v_rcp_f32 v203, v203
    s_nop 0
    v_pk_mul_f32 v[200:201], v[216:217], v[200:201]
    v_pk_mul_f32 v[202:203], v[218:219], v[202:203]
    v_cvt_pk_bf16_f32 v20, v200, v201
    v_cvt_pk_bf16_f32 v21, v202, v203
    v_exp_f32 v232, -v232
    v_exp_f32 v233, -v233
    v_exp_f32 v234, -v234
    v_exp_f32 v235, -v235
    v_pk_add_f32 v[232:233], v[232:233], 1.0 op_sel_hi:[1,0]
    v_pk_add_f32 v[234:235], v[234:235], 1.0 op_sel_hi:[1,0]
    v_rcp_f32 v232, v232
    v_rcp_f32 v233, v233
    v_rcp_f32 v234, v234
    v_rcp_f32 v235, v235
    s_nop 0
    v_pk_mul_f32 v[232:233], v[248:249], v[232:233]
    v_pk_mul_f32 v[234:235], v[250:251], v[234:235]
    v_cvt_pk_bf16_f32 v22, v232, v233
    v_cvt_pk_bf16_f32 v23, v234, v235
    buffer_store_dwordx4 v[20:23], v1, s[24:27], s43 offen offset:3072 sc1
    v_exp_f32 v140, -v140
    v_exp_f32 v141, -v141
    v_exp_f32 v142, -v142
    v_exp_f32 v143, -v143
    v_pk_add_f32 v[140:141], v[140:141], 1.0 op_sel_hi:[1,0]
    v_pk_add_f32 v[142:143], v[142:143], 1.0 op_sel_hi:[1,0]
    v_rcp_f32 v140, v140
    v_rcp_f32 v141, v141
    v_rcp_f32 v142, v142
    v_rcp_f32 v143, v143
    s_nop 0
    v_pk_mul_f32 v[140:141], v[156:157], v[140:141]
    v_pk_mul_f32 v[142:143], v[158:159], v[142:143]
    v_cvt_pk_bf16_f32 v24, v140, v141
    v_cvt_pk_bf16_f32 v25, v142, v143
    v_exp_f32 v172, -v172
    v_exp_f32 v173, -v173
    v_exp_f32 v174, -v174
    v_exp_f32 v175, -v175
    v_pk_add_f32 v[172:173], v[172:173], 1.0 op_sel_hi:[1,0]
    v_pk_add_f32 v[174:175], v[174:175], 1.0 op_sel_hi:[1,0]
    v_rcp_f32 v172, v172
    v_rcp_f32 v173, v173
    v_rcp_f32 v174, v174
    v_rcp_f32 v175, v175
    s_nop 0
    v_pk_mul_f32 v[172:173], v[188:189], v[172:173]
    v_pk_mul_f32 v[174:175], v[190:191], v[174:175]
    v_cvt_pk_bf16_f32 v26, v172, v173
    v_cvt_pk_bf16_f32 v27, v174, v175
    buffer_store_dwordx4 v[24:27], v1, s[24:27], s44 offen offset:2048 sc1
    v_exp_f32 v204, -v204
    v_exp_f32 v205, -v205
    v_exp_f32 v206, -v206
    v_exp_f32 v207, -v207
    v_pk_add_f32 v[204:205], v[204:205], 1.0 op_sel_hi:[1,0]
    v_pk_add_f32 v[206:207], v[206:207], 1.0 op_sel_hi:[1,0]
    v_rcp_f32 v204, v204
    v_rcp_f32 v205, v205
    v_rcp_f32 v206, v206
    v_rcp_f32 v207, v207
    s_nop 0
    v_pk_mul_f32 v[204:205], v[220:221], v[204:205]
    v_pk_mul_f32 v[206:207], v[222:223], v[206:207]
    v_cvt_pk_bf16_f32 v28, v204, v205
    v_cvt_pk_bf16_f32 v29, v206, v207
    v_exp_f32 v236, -v236
    v_exp_f32 v237, -v237
    v_exp_f32 v238, -v238
    v_exp_f32 v239, -v239
    v_pk_add_f32 v[236:237], v[236:237], 1.0 op_sel_hi:[1,0]
    v_pk_add_f32 v[238:239], v[238:239], 1.0 op_sel_hi:[1,0]
    v_rcp_f32 v236, v236
    v_rcp_f32 v237, v237
    v_rcp_f32 v238, v238
    v_rcp_f32 v239, v239
    s_nop 0
    v_pk_mul_f32 v[236:237], v[252:253], v[236:237]
    v_pk_mul_f32 v[238:239], v[254:255], v[238:239]
    v_cvt_pk_bf16_f32 v30, v236, v237
    v_cvt_pk_bf16_f32 v31, v238, v239
    buffer_store_dwordx4 v[28:31], v1, s[24:27], s44 offen offset:3072 sc1
L_gup_fin:
    s_lshl_b32 s38, s29, 1
    s_lshr_b32 s39, s30, 4
    s_add_u32 s38, s38, s39
    s_add_u32 s38, s38, 296
    s_lshl_b32 s90, s38, 7
    s_and_b32 s38, s30, 15
    s_lshl_b32 s38, s38, 2
    s_add_u32 s90, s90, s38
    s_mov_b64 s[6:7], s[80:81]
    s_mov_b64 s[10:11], s[84:85]
    s_mov_b32 s40, s100
    s_and_b32 s52, s2, 7
    s_lshr_b32 s53, s2, 3
    s_and_b32 s43, s52, 1
    s_lshr_b32 s52, s52, 1
    s_lshl_b32 s52, s52, 2
    s_lshr_b32 s41, s53, 3
    s_add_u32 s41, s41, s52
    s_and_b32 s42, s53, 7
    s_mov_b32 s12, s6
    s_mov_b32 s13, s7
    s_mov_b32 s14, 0x700000
    s_mov_b32 s15, 0x20000
    s_add_u32 s16, s4, 0x2800000
    s_addc_u32 s17, s5, 0
    s_mov_b32 s18, 0xe00000
    s_mov_b32 s19, 0x20000
    s_add_u32 s20, s4, 0x2000000
    s_addc_u32 s21, s5, 0
    s_mov_b32 s22, 0x400000
    s_mov_b32 s23, 0x20000
    s_mov_b32 s24, s10
    s_mov_b32 s25, s11
    s_mov_b32 s26, 0x400000
    s_mov_b32 s27, 0x20000
    s_add_u32 s28, s4, 0x5000
    s_addc_u32 s29, s5, 0
    s_mov_b32 s30, 0x13000
    s_mov_b32 s31, 0x20000
    s_add_u32 s32, s4, 0x4800000
    s_addc_u32 s33, s5, 0
    s_mov_b32 s34, 0x800000
    s_mov_b32 s35, 0x20000
    s_add_u32 s36, s4, 0x5800000
    s_addc_u32 s37, s5, 0
    s_mov_b32 s38, 0xa800
    s_mov_b32 s39, 0x20000
    v_lshlrev_b32 v1, 4, v0
    v_lshrrev_b32 v19, 4, v0
    s_and_b32 s52, s40, 1
    s_lshl_b32 s52, s52, 2
    v_or_b32 v17, s52, v19
    v_bfe_u32 v18, v0, 1, 3
    v_xor_b32 v17, v17, v18
    v_lshlrev_b32 v17, 5, v17
    v_and_b32 v18, 1, v0
    v_lshl_add_u32 v17, v18, 4, v17
    v_lshl_add_u32 v17, v19, 11, v17
    s_lshl_b32 s52, s42, 8
    v_add_u32 v2, s52, v17
    v_add_u32 v16, 32768, v2
    s_mul_i32 s44, s43, 3670016
    s_lshl_b32 s52, s40, 13
    s_add_u32 s44, s44, s52
    s_lshl_b32 s46, s40, 10
    s_add_u32 s47, s46, 0x10000
    s_mov_b32 s51, s46
    s_lshl_b32 s52, s41, 3
    s_lshl_b32 s53, s40, 1
    s_add_u32 s52, s52, s53
    s_mul_i32 s52, s52, 114688
    v_add_u32 v3, s52, v1
    v_add_u32 v4, 114688, v3
    s_mul_i32 s48, s43, 57344
    v_lshrrev_b32 v19, 4, v0
    v_bfe_u32 v17, v0, 2, 2
    v_lshl_add_u32 v19, v19, 2, v17
    v_and_b32 v17, 7, v19
    s_lshl_b32 s52, s43, 2
    v_xor_b32 v17, s52, v17
    v_lshlrev_b32 v19, 8, v19
    v_and_b32 v18, 3, v0
    v_lshl_add_u32 v19, v18, 3, v19
    v_xor_b32 v18, 0, v17
    v_lshl_add_u32 v8, v18, 5, v19
    v_xor_b32 v18, 1, v17
    v_lshl_add_u32 v9, v18, 5, v19
    v_xor_b32 v18, 2, v17
    v_lshl_add_u32 v10, v18, 5, v19
    v_xor_b32 v18, 3, v17
    v_lshl_add_u32 v11, v18, 5, v19
    v_xor_b32 v18, 4, v17
    v_lshl_add_u32 v12, v18, 5, v19
    v_xor_b32 v18, 5, v17
    v_lshl_add_u32 v13, v18, 5, v19
    v_xor_b32 v18, 6, v17
    v_lshl_add_u32 v14, v18, 5, v19
    v_xor_b32 v18, 7, v17
    v_lshl_add_u32 v15, v18, 5, v19
    s_lshr_b32 s52, s41, 1
    s_lshl_b32 s52, s52, 1
    s_add_u32 s52, s52, s43
    s_add_u32 s52, s52, 296
    s_lshl_b32 s91, s52, 7
    s_waitcnt vmcnt(0)
    s_barrier
    s_cmp_lg_u32 s100, 0
    s_cbranch_scc1 L_fz_s12
    s_mov_b64 s[88:89], exec
    s_mov_b64 exec, 1
    v_mov_b32 v250, 1
    v_mov_b32 v251, s90
    buffer_store_dword v250, v251, s[92:95], 0 offen sc1
    s_mov_b64 exec, s[88:89]
L_fz_s12:
    s_cmp_lg_u32 s100, 0
    s_cbranch_scc1 L_fz_w13
    s_mov_b64 s[88:89], exec
    s_mov_b64 exec, 0xffff
    v_lshlrev_b32 v252, 2, v0
    v_add_u32 v252, s91, v252
    s_mov_b32 s87, 262144
L_fz_p13:
    buffer_load_dword v253, v252, s[92:95], 0 offen sc1
    s_waitcnt vmcnt(0)
    v_cmp_ne_u32 vcc, 1, v253
    s_cbranch_vccz L_fz_g13
    s_sub_u32 s87, s87, 1
    s_cmp_lg_u32 s87, 0
    s_cbranch_scc1 L_fz_p13
L_fz_g13:
    s_mov_b64 exec, s[88:89]
L_fz_w13:
    s_add_u32 m0, s46, 0
    s_nop 0
    buffer_load_dwordx4 v2, s[12:15], s44 offen lds
    s_add_u32 m0, s46, 4096
    s_nop 0
    buffer_load_dwordx4 v16, s[12:15], s44 offen lds
    s_add_u32 s44, s44, 65536
    s_add_u32 m0, s46, 8192
    s_nop 0
    buffer_load_dwordx4 v2, s[12:15], s44 offen lds
    s_add_u32 m0, s46, 12288
    s_nop 0
    buffer_load_dwordx4 v16, s[12:15], s44 offen lds
    s_add_u32 s44, s44, 65536
    s_add_u32 m0, s46, 16384
    s_nop 0
    buffer_load_dwordx4 v2, s[12:15], s44 offen lds
    s_add_u32 m0, s46, 20480
    s_nop 0
    buffer_load_dwordx4 v16, s[12:15], s44 offen lds
    s_add_u32 s44, s44, 65536
    s_add_u32 m0, s46, 24576
    s_nop 0
    buffer_load_dwordx4 v2, s[12:15], s44 offen lds
    s_add_u32 m0, s46, 28672
    s_nop 0
    buffer_load_dwordx4 v16, s[12:15], s44 offen lds
    s_add_u32 s44, s44, 65536
    s_add_u32 m0, s46, 32768
    s_nop 0
    buffer_load_dwordx4 v2, s[12:15], s44 offen lds
    s_add_u32 m0, s46, 36864
    s_nop 0
    buffer_load_dwordx4 v16, s[12:15], s44 offen lds
    s_add_u32 s44, s44, 65536
    s_add_u32 m0, s46, 40960
    s_nop 0
    buffer_load_dwordx4 v2, s[12:15], s44 offen lds
    s_add_u32 m0, s46, 45056
    s_nop 0
    buffer_load_dwordx4 v16, s[12:15], s44 offen lds
    s_add_u32 s44, s44, 65536
    s_add_u32 m0, s46, 49152
    s_nop 0
    buffer_load_dwordx4 v2, s[12:15], s44 offen lds
    s_add_u32 m0, s46, 53248
    s_nop 0
    buffer_load_dwordx4 v16, s[12:15], s44 offen lds
    s_add_u32 s44, s44, 65536
    s_add_u32 m0, s46, 57344
    s_nop 0
    buffer_load_dwordx4 v2, s[12:15], s44 offen lds
    s_add_u32 m0, s46, 61440
    s_nop 0
    buffer_load_dwordx4 v16, s[12:15], s44 offen lds
    s_add_u32 s44, s44, 65536
    s_add_u32 m0, s46, 65536
    s_nop 0
    buffer_load_dwordx4 v2, s[12:15], s44 offen lds
    s_add_u32 m0, s46, 69632
    s_nop 0
    buffer_load_dwordx4 v16, s[12:15], s44 offen lds
    s_add_u32 s44, s44, 65536
    s_add_u32 m0, s46, 73728
    s_nop 0
    buffer_load_dwordx4 v2, s[12:15], s44 offen lds
    s_add_u32 m0, s46, 77824
    s_nop 0
    buffer_load_dwordx4 v16, s[12:15], s44 offen lds
    s_add_u32 s44, s44, 65536
    s_add_u32 m0, s46, 81920
    s_nop 0
    buffer_load_dwordx4 v2, s[12:15], s44 offen lds
    s_add_u32 m0, s46, 86016
    s_nop 0
    buffer_load_dwordx4 v16, s[12:15], s44 offen lds
    s_add_u32 s44, s44, 65536
    s_add_u32 m0, s46, 90112
    s_nop 0
    buffer_load_dwordx4 v2, s[12:15], s44 offen lds
    s_add_u32 m0, s46, 94208
    s_nop 0
    buffer_load_dwordx4 v16, s[12:15], s44 offen lds
    s_add_u32 s44, s44, 65536
    s_barrier
    buffer_load_dwordx4 a[64:67], v3, s[16:19], s48 offen sc1
    buffer_load_dwordx4 a[68:71], v4, s[16:19], s48 offen sc1
    s_add_u32 s48, s48, 1024
    buffer_load_dwordx4 a[72:75], v3, s[16:19], s48 offen sc1
    buffer_load_dwordx4 a[76:79], v4, s[16:19], s48 offen sc1
    s_add_u32 s48, s48, 1024
    buffer_load_dwordx4 a[80:83], v3, s[16:19], s48 offen sc1
    buffer_load_dwordx4 a[84:87], v4, s[16:19], s48 offen sc1
    s_add_u32 s48, s48, 1024
    buffer_load_dwordx4 a[88:91], v3, s[16:19], s48 offen sc1
    buffer_load_dwordx4 a[92:95], v4, s[16:19], s48 offen sc1
    s_add_u32 s48, s48, 1024
    buffer_load_dwordx4 a[96:99], v3, s[16:19], s48 offen sc1
    buffer_load_dwordx4 a[100:103], v4, s[16:19], s48 offen sc1
    s_add_u32 s48, s48, 1024
    buffer_load_dwordx4 a[104:107], v3, s[16:19], s48 offen sc1
    buffer_load_dwordx4 a[108:111], v4, s[16:19], s48 offen sc1
    s_add_u32 s48, s48, 1024
    v_and_b32 v19, 15, v0
    s_lshl_b32 s52, s41, 7
    s_lshl_b32 s53, s40, 5
    s_add_u32 s52, s52, s53
    v_add_u32 v19, s52, v19
    v_lshlrev_b32 v19, 11, v19
    v_bfe_u32 v17, v0, 4, 1
    v_lshlrev_b32 v17, 4, v17
    v_bfe_u32 v18, v0, 5, 1
    v_lshl_or_b32 v17, v18, 3, v17
    s_lshl_b32 s52, s42, 7
    s_lshl_b32 s53, s43, 6
    s_add_u32 s52, s52, s53
    v_add_u32 v17, s52, v17
    v_lshl_add_u32 v5, v17, 1, v19
    v_lshlrev_b32 v6, 2, v17
    s_waitcnt vmcnt(12)
    s_barrier
    ds_read_b64_tr_b16 a[0:1], v8 offset:0
    ds_read_b64_tr_b16 a[2:3], v8 offset:4096
    ds_read_b64_tr_b16 a[128:129], v8 offset:8192
    ds_read_b64_tr_b16 a[130:131], v8 offset:12288
    ds_read_b64_tr_b16 a[4:5], v9 offset:0
    ds_read_b64_tr_b16 a[6:7], v9 offset:4096
    ds_read_b64_tr_b16 a[132:133], v9 offset:8192
    ds_read_b64_tr_b16 a[134:135], v9 offset:12288
    ds_read_b64_tr_b16 a[8:9], v10 offset:0
    ds_read_b64_tr_b16 a[10:11], v10 offset:4096
    ds_read_b64_tr_b16 a[136:137], v10 offset:8192
    ds_read_b64_tr_b16 a[138:139], v10 offset:12288
    s_waitcnt lgkmcnt(4)
    ds_read_b64_tr_b16 a[12:13], v11 offset:0
    ds_read_b64_tr_b16 a[14:15], v11 offset:4096
    ds_read_b64_tr_b16 a[140:141], v11 offset:8192
    ds_read_b64_tr_b16 a[142:143], v11 offset:12288
    ds_read_b64_tr_b16 a[16:17], v12 offset:0
    ds_read_b64_tr_b16 a[18:19], v12 offset:4096
    ds_read_b64_tr_b16 a[144:145], v12 offset:8192
    ds_read_b64_tr_b16 a[146:147], v12 offset:12288
    s_waitcnt lgkmcnt(4)
    ds_read_b64_tr_b16 a[20:21], v13 offset:0
    ds_read_b64_tr_b16 a[22:23], v13 offset:4096
    ds_read_b64_tr_b16 a[148:149], v13 offset:8192
    ds_read_b64_tr_b16 a[150:151], v13 offset:12288
    ds_read_b64_tr_b16 a[24:25], v14 offset:0
    ds_read_b64_tr_b16 a[26:27], v14 offset:4096
    ds_read_b64_tr_b16 a[152:153], v14 offset:8192
    ds_read_b64_tr_b16 a[154:155], v14 offset:12288
    s_waitcnt vmcnt(8)
    s_waitcnt lgkmcnt(12)
    v_mfma_f32_16x16x32_bf16 v[64:67], a[0:3], a[64:67], 0
    ds_read_b64_tr_b16 a[28:29], v15 offset:0
    s_add_u32 m0, s47, 32768
    v_mfma_f32_16x16x32_bf16 v[64:67], a[128:131], a[72:75], v[64:67]
    ds_read_b64_tr_b16 a[30:31], v15 offset:4096
    buffer_load_dwordx4 v2, s[12:15], s44 offen lds
    v_mfma_f32_16x16x32_bf16 v[68:71], a[0:3], a[68:71], 0
    ds_read_b64_tr_b16 a[156:157], v15 offset:8192
    v_mfma_f32_16x16x32_bf16 v[68:71], a[128:131], a[76:79], v[68:71]
    ds_read_b64_tr_b16 a[158:159], v15 offset:12288
    s_waitcnt lgkmcnt(12)
    v_mfma_f32_16x16x32_bf16 v[72:75], a[4:7], a[64:67], 0
    ds_read_b64_tr_b16 a[0:1], v8 offset:16384
    s_add_u32 m0, s47, 36864
    v_mfma_f32_16x16x32_bf16 v[72:75], a[132:135], a[72:75], v[72:75]
    ds_read_b64_tr_b16 a[2:3], v8 offset:20480
    buffer_load_dwordx4 v16, s[12:15], s44 offen lds
    v_mfma_f32_16x16x32_bf16 v[76:79], a[4:7], a[68:71], 0
    ds_read_b64_tr_b16 a[128:129], v8 offset:24576
    s_add_u32 s44, s44, 65536
    v_mfma_f32_16x16x32_bf16 v[76:79], a[132:135], a[76:79], v[76:79]
    ds_read_b64_tr_b16 a[130:131], v8 offset:28672
    s_waitcnt lgkmcnt(12)
    v_mfma_f32_16x16x32_bf16 v[80:83], a[8:11], a[64:67], 0
    ds_read_b64_tr_b16 a[4:5], v9 offset:16384
    v_mfma_f32_16x16x32_bf16 v[80:83], a[136:139], a[72:75], v[80:83]
    ds_read_b64_tr_b16 a[6:7], v9 offset:20480
    buffer_load_dwordx4 a[112:115], v3, s[16:19], s48 offen sc1
    v_mfma_f32_16x16x32_bf16 v[84:87], a[8:11], a[68:71], 0
    ds_read_b64_tr_b16 a[132:133], v9 offset:24576
    v_mfma_f32_16x16x32_bf16 v[84:87], a[136:139], a[76:79], v[84:87]
    ds_read_b64_tr_b16 a[134:135], v9 offset:28672
    s_waitcnt lgkmcnt(12)
    v_mfma_f32_16x16x32_bf16 v[88:91], a[12:15], a[64:67], 0
    ds_read_b64_tr_b16 a[8:9], v10 offset:16384
    v_mfma_f32_16x16x32_bf16 v[88:91], a[140:143], a[72:75], v[88:91]
    ds_read_b64_tr_b16 a[10:11], v10 offset:20480
    buffer_load_dwordx4 a[116:119], v4, s[16:19], s48 offen sc1
    v_mfma_f32_16x16x32_bf16 v[92:95], a[12:15], a[68:71], 0
    ds_read_b64_tr_b16 a[136:137], v10 offset:24576
    s_add_u32 s48, s48, 1024
    v_mfma_f32_16x16x32_bf16 v[92:95], a[140:143], a[76:79], v[92:95]
    ds_read_b64_tr_b16 a[138:139], v10 offset:28672
    s_waitcnt lgkmcnt(12)
    v_mfma_f32_16x16x32_bf16 v[96:99], a[16:19], a[64:67], 0
    ds_read_b64_tr_b16 a[12:13], v11 offset:16384
    s_add_u32 m0, s47, 40960
    v_mfma_f32_16x16x32_bf16 v[96:99], a[144:147], a[72:75], v[96:99]
    ds_read_b64_tr_b16 a[14:15], v11 offset:20480
    buffer_load_dwordx4 v2, s[12:15], s44 offen lds
    v_mfma_f32_16x16x32_bf16 v[100:103], a[16:19], a[68:71], 0
    ds_read_b64_tr_b16 a[140:141], v11 offset:24576
    v_mfma_f32_16x16x32_bf16 v[100:103], a[144:147], a[76:79], v[100:103]
    ds_read_b64_tr_b16 a[142:143], v11 offset:28672
    s_waitcnt lgkmcnt(12)
    v_mfma_f32_16x16x32_bf16 v[104:107], a[20:23], a[64:67], 0
    ds_read_b64_tr_b16 a[16:17], v12 offset:16384
    s_add_u32 m0, s47, 45056
    v_mfma_f32_16x16x32_bf16 v[104:107], a[148:151], a[72:75], v[104:107]
    ds_read_b64_tr_b16 a[18:19], v12 offset:20480
    buffer_load_dwordx4 v16, s[12:15], s44 offen lds
    v_mfma_f32_16x16x32_bf16 v[108:111], a[20:23], a[68:71], 0
    ds_read_b64_tr_b16 a[144:145], v12 offset:24576
    s_add_u32 s44, s44, 65536
    v_mfma_f32_16x16x32_bf16 v[108:111], a[148:151], a[76:79], v[108:111]
    ds_read_b64_tr_b16 a[146:147], v12 offset:28672
    s_waitcnt lgkmcnt(12)
    v_mfma_f32_16x16x32_bf16 v[112:115], a[24:27], a[64:67], 0
    ds_read_b64_tr_b16 a[20:21], v13 offset:16384
    v_mfma_f32_16x16x32_bf16 v[112:115], a[152:155], a[72:75], v[112:115]
    ds_read_b64_tr_b16 a[22:23], v13 offset:20480
    buffer_load_dwordx4 a[120:123], v3, s[16:19], s48 offen sc1
    v_mfma_f32_16x16x32_bf16 v[116:119], a[24:27], a[68:71], 0
    ds_read_b64_tr_b16 a[148:149], v13 offset:24576
    v_mfma_f32_16x16x32_bf16 v[116:119], a[152:155], a[76:79], v[116:119]
    ds_read_b64_tr_b16 a[150:151], v13 offset:28672
    s_waitcnt lgkmcnt(12)
    v_mfma_f32_16x16x32_bf16 v[120:123], a[28:31], a[64:67], 0
    ds_read_b64_tr_b16 a[24:25], v14 offset:16384
    v_mfma_f32_16x16x32_bf16 v[120:123], a[156:159], a[72:75], v[120:123]
    ds_read_b64_tr_b16 a[26:27], v14 offset:20480
    buffer_load_dwordx4 a[124:127], v4, s[16:19], s48 offen sc1
    v_mfma_f32_16x16x32_bf16 v[124:127], a[28:31], a[68:71], 0
    ds_read_b64_tr_b16 a[152:153], v14 offset:24576
    s_add_u32 s48, s48, 1024
    v_mfma_f32_16x16x32_bf16 v[124:127], a[156:159], a[76:79], v[124:127]
    ds_read_b64_tr_b16 a[154:155], v14 offset:28672
    s_waitcnt vmcnt(12)
    s_barrier
    s_waitcnt lgkmcnt(12)
    v_mfma_f32_16x16x32_bf16 v[64:67], a[0:3], a[80:83], v[64:67]
    ds_read_b64_tr_b16 a[28:29], v15 offset:16384
    s_add_u32 m0, s47, 49152
    v_mfma_f32_16x16x32_bf16 v[64:67], a[128:131], a[88:91], v[64:67]
    ds_read_b64_tr_b16 a[30:31], v15 offset:20480
    buffer_load_dwordx4 v2, s[12:15], s44 offen lds
    v_mfma_f32_16x16x32_bf16 v[68:71], a[0:3], a[84:87], v[68:71]
    ds_read_b64_tr_b16 a[156:157], v15 offset:24576
    v_mfma_f32_16x16x32_bf16 v[68:71], a[128:131], a[92:95], v[68:71]
    ds_read_b64_tr_b16 a[158:159], v15 offset:28672
    s_waitcnt lgkmcnt(12)
    v_mfma_f32_16x16x32_bf16 v[72:75], a[4:7], a[80:83], v[72:75]
    ds_read_b64_tr_b16 a[0:1], v8 offset:32768
    s_add_u32 m0, s47, 53248
    v_mfma_f32_16x16x32_bf16 v[72:75], a[132:135], a[88:91], v[72:75]
    ds_read_b64_tr_b16 a[2:3], v8 offset:36864
    buffer_load_dwordx4 v16, s[12:15], s44 offen lds
    v_mfma_f32_16x16x32_bf16 v[76:79], a[4:7], a[84:87], v[76:79]
    ds_read_b64_tr_b16 a[128:129], v8 offset:40960
    s_add_u32 s44, s44, 65536
    v_mfma_f32_16x16x32_bf16 v[76:79], a[132:135], a[92:95], v[76:79]
    ds_read_b64_tr_b16 a[130:131], v8 offset:45056
    s_waitcnt lgkmcnt(12)
    v_mfma_f32_16x16x32_bf16 v[80:83], a[8:11], a[80:83], v[80:83]
    ds_read_b64_tr_b16 a[4:5], v9 offset:32768
    v_mfma_f32_16x16x32_bf16 v[80:83], a[136:139], a[88:91], v[80:83]
    ds_read_b64_tr_b16 a[6:7], v9 offset:36864
    buffer_load_dwordx4 a[64:67], v3, s[16:19], s48 offen sc1
    v_mfma_f32_16x16x32_bf16 v[84:87], a[8:11], a[84:87], v[84:87]
    ds_read_b64_tr_b16 a[132:133], v9 offset:40960
    v_mfma_f32_16x16x32_bf16 v[84:87], a[136:139], a[92:95], v[84:87]
    ds_read_b64_tr_b16 a[134:135], v9 offset:45056
    s_waitcnt lgkmcnt(12)
    v_mfma_f32_16x16x32_bf16 v[88:91], a[12:15], a[80:83], v[88:91]
    ds_read_b64_tr_b16 a[8:9], v10 offset:32768
    v_mfma_f32_16x16x32_bf16 v[88:91], a[140:143], a[88:91], v[88:91]
    ds_read_b64_tr_b16 a[10:11], v10 offset:36864
    buffer_load_dwordx4 a[68:71], v4, s[16:19], s48 offen sc1
    v_mfma_f32_16x16x32_bf16 v[92:95], a[12:15], a[84:87], v[92:95]
    ds_read_b64_tr_b16 a[136:137], v10 offset:40960
    s_add_u32 s48, s48, 1024
    v_mfma_f32_16x16x32_bf16 v[92:95], a[140:143], a[92:95], v[92:95]
    ds_read_b64_tr_b16 a[138:139], v10 offset:45056
    s_waitcnt lgkmcnt(12)
    v_mfma_f32_16x16x32_bf16 v[96:99], a[16:19], a[80:83], v[96:99]
    ds_read_b64_tr_b16 a[12:13], v11 offset:32768
    s_add_u32 m0, s47, 57344
    v_mfma_f32_16x16x32_bf16 v[96:99], a[144:147], a[88:91], v[96:99]
    ds_read_b64_tr_b16 a[14:15], v11 offset:36864
    buffer_load_dwordx4 v2, s[12:15], s44 offen lds
    v_mfma_f32_16x16x32_bf16 v[100:103], a[16:19], a[84:87], v[100:103]
    ds_read_b64_tr_b16 a[140:141], v11 offset:40960
    v_mfma_f32_16x16x32_bf16 v[100:103], a[144:147], a[92:95], v[100:103]
    ds_read_b64_tr_b16 a[142:143], v11 offset:45056
    s_waitcnt lgkmcnt(12)
    v_mfma_f32_16x16x32_bf16 v[104:107], a[20:23], a[80:83], v[104:107]
    ds_read_b64_tr_b16 a[16:17], v12 offset:32768
    s_add_u32 m0, s47, 61440
    v_mfma_f32_16x16x32_bf16 v[104:107], a[148:151], a[88:91], v[104:107]
    ds_read_b64_tr_b16 a[18:19], v12 offset:36864
    buffer_load_dwordx4 v16, s[12:15], s44 offen lds
    v_mfma_f32_16x16x32_bf16 v[108:111], a[20:23], a[84:87], v[108:111]
    ds_read_b64_tr_b16 a[144:145], v12 offset:40960
    s_add_u32 s44, s44, 65536
    v_mfma_f32_16x16x32_bf16 v[108:111], a[148:151], a[92:95], v[108:111]
    ds_read_b64_tr_b16 a[146:147], v12 offset:45056
    s_waitcnt lgkmcnt(12)
    v_mfma_f32_16x16x32_bf16 v[112:115], a[24:27], a[80:83], v[112:115]
    ds_read_b64_tr_b16 a[20:21], v13 offset:32768
    v_mfma_f32_16x16x32_bf16 v[112:115], a[152:155], a[88:91], v[112:115]
    ds_read_b64_tr_b16 a[22:23], v13 offset:36864
    buffer_load_dwordx4 a[72:75], v3, s[16:19], s48 offen sc1
    v_mfma_f32_16x16x32_bf16 v[116:119], a[24:27], a[84:87], v[116:119]
    ds_read_b64_tr_b16 a[148:149], v13 offset:40960
    v_mfma_f32_16x16x32_bf16 v[116:119], a[152:155], a[92:95], v[116:119]
    ds_read_b64_tr_b16 a[150:151], v13 offset:45056
    s_waitcnt lgkmcnt(12)
    v_mfma_f32_16x16x32_bf16 v[120:123], a[28:31], a[80:83], v[120:123]
    ds_read_b64_tr_b16 a[24:25], v14 offset:32768
    v_mfma_f32_16x16x32_bf16 v[120:123], a[156:159], a[88:91], v[120:123]
    ds_read_b64_tr_b16 a[26:27], v14 offset:36864
    buffer_load_dwordx4 a[76:79], v4, s[16:19], s48 offen sc1
    v_mfma_f32_16x16x32_bf16 v[124:127], a[28:31], a[84:87], v[124:127]
    ds_read_b64_tr_b16 a[152:153], v14 offset:40960
    s_add_u32 s48, s48, 1024
    v_mfma_f32_16x16x32_bf16 v[124:127], a[156:159], a[92:95], v[124:127]
    ds_read_b64_tr_b16 a[154:155], v14 offset:45056
    s_waitcnt vmcnt(16)
    s_waitcnt lgkmcnt(12)
    v_mfma_f32_16x16x32_bf16 v[64:67], a[0:3], a[96:99], v[64:67]
    ds_read_b64_tr_b16 a[28:29], v15 offset:32768
    s_add_u32 m0, s51, 0
    v_mfma_f32_16x16x32_bf16 v[64:67], a[128:131], a[104:107], v[64:67]
    ds_read_b64_tr_b16 a[30:31], v15 offset:36864
    buffer_load_dwordx4 v2, s[12:15], s44 offen lds
    v_mfma_f32_16x16x32_bf16 v[68:71], a[0:3], a[100:103], v[68:71]
    ds_read_b64_tr_b16 a[156:157], v15 offset:40960
    v_mfma_f32_16x16x32_bf16 v[68:71], a[128:131], a[108:111], v[68:71]
    ds_read_b64_tr_b16 a[158:159], v15 offset:45056
    s_waitcnt lgkmcnt(12)
    v_mfma_f32_16x16x32_bf16 v[72:75], a[4:7], a[96:99], v[72:75]
    ds_read_b64_tr_b16 a[0:1], v8 offset:49152
    s_add_u32 m0, s51, 4096
    v_mfma_f32_16x16x32_bf16 v[72:75], a[132:135], a[104:107], v[72:75]
    ds_read_b64_tr_b16 a[2:3], v8 offset:53248
    buffer_load_dwordx4 v16, s[12:15], s44 offen lds
    v_mfma_f32_16x16x32_bf16 v[76:79], a[4:7], a[100:103], v[76:79]
    ds_read_b64_tr_b16 a[128:129], v8 offset:57344
    s_add_u32 s44, s44, 65536
    v_mfma_f32_16x16x32_bf16 v[76:79], a[132:135], a[108:111], v[76:79]
    ds_read_b64_tr_b16 a[130:131], v8 offset:61440
    s_waitcnt lgkmcnt(12)
    v_mfma_f32_16x16x32_bf16 v[80:83], a[8:11], a[96:99], v[80:83]
    ds_read_b64_tr_b16 a[4:5], v9 offset:49152
    v_mfma_f32_16x16x32_bf16 v[80:83], a[136:139], a[104:107], v[80:83]
    ds_read_b64_tr_b16 a[6:7], v9 offset:53248
    buffer_load_dwordx4 a[80:83], v3, s[16:19], s48 offen sc1
    v_mfma_f32_16x16x32_bf16 v[84:87], a[8:11], a[100:103], v[84:87]
    ds_read_b64_tr_b16 a[132:133], v9 offset:57344
    v_mfma_f32_16x16x32_bf16 v[84:87], a[136:139], a[108:111], v[84:87]
    ds_read_b64_tr_b16 a[134:135], v9 offset:61440
    s_waitcnt lgkmcnt(12)
    v_mfma_f32_16x16x32_bf16 v[88:91], a[12:15], a[96:99], v[88:91]
    ds_read_b64_tr_b16 a[8:9], v10 offset:49152
    v_mfma_f32_16x16x32_bf16 v[88:91], a[140:143], a[104:107], v[88:91]
    ds_read_b64_tr_b16 a[10:11], v10 offset:53248
    buffer_load_dwordx4 a[84:87], v4, s[16:19], s48 offen sc1
    v_mfma_f32_16x16x32_bf16 v[92:95], a[12:15], a[100:103], v[92:95]
    ds_read_b64_tr_b16 a[136:137], v10 offset:57344
    s_add_u32 s48, s48, 1024
    v_mfma_f32_16x16x32_bf16 v[92:95], a[140:143], a[108:111], v[92:95]
    ds_read_b64_tr_b16 a[138:139], v10 offset:61440
    s_waitcnt lgkmcnt(12)
    v_mfma_f32_16x16x32_bf16 v[96:99], a[16:19], a[96:99], v[96:99]
    ds_read_b64_tr_b16 a[12:13], v11 offset:49152
    s_add_u32 m0, s51, 8192
    v_mfma_f32_16x16x32_bf16 v[96:99], a[144:147], a[104:107], v[96:99]
    ds_read_b64_tr_b16 a[14:15], v11 offset:53248
    buffer_load_dwordx4 v2, s[12:15], s44 offen lds
    v_mfma_f32_16x16x32_bf16 v[100:103], a[16:19], a[100:103], v[100:103]
    ds_read_b64_tr_b16 a[140:141], v11 offset:57344
    v_mfma_f32_16x16x32_bf16 v[100:103], a[144:147], a[108:111], v[100:103]
    ds_read_b64_tr_b16 a[142:143], v11 offset:61440
    s_waitcnt lgkmcnt(12)
    v_mfma_f32_16x16x32_bf16 v[104:107], a[20:23], a[96:99], v[104:107]
    ds_read_b64_tr_b16 a[16:17], v12 offset:49152
    s_add_u32 m0, s51, 12288
    v_mfma_f32_16x16x32_bf16 v[104:107], a[148:151], a[104:107], v[104:107]
    ds_read_b64_tr_b16 a[18:19], v12 offset:53248
    buffer_load_dwordx4 v16, s[12:15], s44 offen lds
    v_mfma_f32_16x16x32_bf16 v[108:111], a[20:23], a[100:103], v[108:111]
    ds_read_b64_tr_b16 a[144:145], v12 offset:57344
    s_add_u32 s44, s44, 65536
    v_mfma_f32_16x16x32_bf16 v[108:111], a[148:151], a[108:111], v[108:111]
    ds_read_b64_tr_b16 a[146:147], v12 offset:61440
    s_waitcnt lgkmcnt(12)
    v_mfma_f32_16x16x32_bf16 v[112:115], a[24:27], a[96:99], v[112:115]
    ds_read_b64_tr_b16 a[20:21], v13 offset:49152
    v_mfma_f32_16x16x32_bf16 v[112:115], a[152:155], a[104:107], v[112:115]
    ds_read_b64_tr_b16 a[22:23], v13 offset:53248
    buffer_load_dwordx4 a[88:91], v3, s[16:19], s48 offen sc1
    v_mfma_f32_16x16x32_bf16 v[116:119], a[24:27], a[100:103], v[116:119]
    ds_read_b64_tr_b16 a[148:149], v13 offset:57344
    v_mfma_f32_16x16x32_bf16 v[116:119], a[152:155], a[108:111], v[116:119]
    ds_read_b64_tr_b16 a[150:151], v13 offset:61440
    s_waitcnt lgkmcnt(12)
    v_mfma_f32_16x16x32_bf16 v[120:123], a[28:31], a[96:99], v[120:123]
    ds_read_b64_tr_b16 a[24:25], v14 offset:49152
    v_mfma_f32_16x16x32_bf16 v[120:123], a[156:159], a[104:107], v[120:123]
    ds_read_b64_tr_b16 a[26:27], v14 offset:53248
    buffer_load_dwordx4 a[92:95], v4, s[16:19], s48 offen sc1
    v_mfma_f32_16x16x32_bf16 v[124:127], a[28:31], a[100:103], v[124:127]
    ds_read_b64_tr_b16 a[152:153], v14 offset:57344
    s_add_u32 s48, s48, 1024
    v_mfma_f32_16x16x32_bf16 v[124:127], a[156:159], a[108:111], v[124:127]
    ds_read_b64_tr_b16 a[154:155], v14 offset:61440
    s_waitcnt vmcnt(16)
    s_barrier
    s_waitcnt lgkmcnt(12)
    v_mfma_f32_16x16x32_bf16 v[64:67], a[0:3], a[112:115], v[64:67]
    ds_read_b64_tr_b16 a[28:29], v15 offset:49152
    s_add_u32 m0, s51, 16384
    v_mfma_f32_16x16x32_bf16 v[64:67], a[128:131], a[120:123], v[64:67]
    ds_read_b64_tr_b16 a[30:31], v15 offset:53248
    buffer_load_dwordx4 v2, s[12:15], s44 offen lds
    v_mfma_f32_16x16x32_bf16 v[68:71], a[0:3], a[116:119], v[68:71]
    ds_read_b64_tr_b16 a[156:157], v15 offset:57344
    v_mfma_f32_16x16x32_bf16 v[68:71], a[128:131], a[124:127], v[68:71]
    ds_read_b64_tr_b16 a[158:159], v15 offset:61440
    v_xor_b32 v8, 0x10000, v8
    s_waitcnt lgkmcnt(12)
    v_mfma_f32_16x16x32_bf16 v[72:75], a[4:7], a[112:115], v[72:75]
    ds_read_b64_tr_b16 a[0:1], v8 offset:0
    s_add_u32 m0, s51, 20480
    v_mfma_f32_16x16x32_bf16 v[72:75], a[132:135], a[120:123], v[72:75]
    ds_read_b64_tr_b16 a[2:3], v8 offset:4096
    buffer_load_dwordx4 v16, s[12:15], s44 offen lds
    v_mfma_f32_16x16x32_bf16 v[76:79], a[4:7], a[116:119], v[76:79]
    ds_read_b64_tr_b16 a[128:129], v8 offset:8192
    s_add_u32 s44, s44, 65536
    v_mfma_f32_16x16x32_bf16 v[76:79], a[132:135], a[124:127], v[76:79]
    ds_read_b64_tr_b16 a[130:131], v8 offset:12288
    v_xor_b32 v9, 0x10000, v9
    s_waitcnt lgkmcnt(12)
    v_mfma_f32_16x16x32_bf16 v[80:83], a[8:11], a[112:115], v[80:83]
    ds_read_b64_tr_b16 a[4:5], v9 offset:0
    v_mfma_f32_16x16x32_bf16 v[80:83], a[136:139], a[120:123], v[80:83]
    ds_read_b64_tr_b16 a[6:7], v9 offset:4096
    buffer_load_dwordx4 a[96:99], v3, s[16:19], s48 offen sc1
    v_mfma_f32_16x16x32_bf16 v[84:87], a[8:11], a[116:119], v[84:87]
    ds_read_b64_tr_b16 a[132:133], v9 offset:8192
    v_mfma_f32_16x16x32_bf16 v[84:87], a[136:139], a[124:127], v[84:87]
    ds_read_b64_tr_b16 a[134:135], v9 offset:12288
    v_xor_b32 v10, 0x10000, v10
    s_waitcnt lgkmcnt(12)
    v_mfma_f32_16x16x32_bf16 v[88:91], a[12:15], a[112:115], v[88:91]
    ds_read_b64_tr_b16 a[8:9], v10 offset:0
    v_mfma_f32_16x16x32_bf16 v[88:91], a[140:143], a[120:123], v[88:91]
    ds_read_b64_tr_b16 a[10:11], v10 offset:4096
    buffer_load_dwordx4 a[100:103], v4, s[16:19], s48 offen sc1
    v_mfma_f32_16x16x32_bf16 v[92:95], a[12:15], a[116:119], v[92:95]
    ds_read_b64_tr_b16 a[136:137], v10 offset:8192
    s_add_u32 s48, s48, 1024
    v_mfma_f32_16x16x32_bf16 v[92:95], a[140:143], a[124:127], v[92:95]
    ds_read_b64_tr_b16 a[138:139], v10 offset:12288
    v_xor_b32 v11, 0x10000, v11
    s_waitcnt lgkmcnt(12)
    v_mfma_f32_16x16x32_bf16 v[96:99], a[16:19], a[112:115], v[96:99]
    ds_read_b64_tr_b16 a[12:13], v11 offset:0
    s_add_u32 m0, s51, 24576
    v_mfma_f32_16x16x32_bf16 v[96:99], a[144:147], a[120:123], v[96:99]
    ds_read_b64_tr_b16 a[14:15], v11 offset:4096
    buffer_load_dwordx4 v2, s[12:15], s44 offen lds
    v_mfma_f32_16x16x32_bf16 v[100:103], a[16:19], a[116:119], v[100:103]
    ds_read_b64_tr_b16 a[140:141], v11 offset:8192
    v_mfma_f32_16x16x32_bf16 v[100:103], a[144:147], a[124:127], v[100:103]
    ds_read_b64_tr_b16 a[142:143], v11 offset:12288
    v_xor_b32 v12, 0x10000, v12
    s_waitcnt lgkmcnt(12)
    v_mfma_f32_16x16x32_bf16 v[104:107], a[20:23], a[112:115], v[104:107]
    ds_read_b64_tr_b16 a[16:17], v12 offset:0
    s_add_u32 m0, s51, 28672
    v_mfma_f32_16x16x32_bf16 v[104:107], a[148:151], a[120:123], v[104:107]
    ds_read_b64_tr_b16 a[18:19], v12 offset:4096
    buffer_load_dwordx4 v16, s[12:15], s44 offen lds
    v_mfma_f32_16x16x32_bf16 v[108:111], a[20:23], a[116:119], v[108:111]
    ds_read_b64_tr_b16 a[144:145], v12 offset:8192
    s_add_u32 s44, s44, 65536
    v_mfma_f32_16x16x32_bf16 v[108:111], a[148:151], a[124:127], v[108:111]
    ds_read_b64_tr_b16 a[146:147], v12 offset:12288
    v_xor_b32 v13, 0x10000, v13
    s_waitcnt lgkmcnt(12)
    v_mfma_f32_16x16x32_bf16 v[112:115], a[24:27], a[112:115], v[112:115]
    ds_read_b64_tr_b16 a[20:21], v13 offset:0
    v_mfma_f32_16x16x32_bf16 v[112:115], a[152:155], a[120:123], v[112:115]
    ds_read_b64_tr_b16 a[22:23], v13 offset:4096
    buffer_load_dwordx4 a[104:107], v3, s[16:19], s48 offen sc1
    v_mfma_f32_16x16x32_bf16 v[116:119], a[24:27], a[116:119], v[116:119]
    ds_read_b64_tr_b16 a[148:149], v13 offset:8192
    v_mfma_f32_16x16x32_bf16 v[116:119], a[152:155], a[124:127], v[116:119]
    ds_read_b64_tr_b16 a[150:151], v13 offset:12288
    v_xor_b32 v14, 0x10000, v14
    s_xor_b32 s47, s47, 0x10000
    s_waitcnt lgkmcnt(12)
    v_mfma_f32_16x16x32_bf16 v[120:123], a[28:31], a[112:115], v[120:123]
    ds_read_b64_tr_b16 a[24:25], v14 offset:0
    s_xor_b32 s51, s51, 0x10000
    v_mfma_f32_16x16x32_bf16 v[120:123], a[156:159], a[120:123], v[120:123]
    ds_read_b64_tr_b16 a[26:27], v14 offset:4096
    buffer_load_dwordx4 a[108:111], v4, s[16:19], s48 offen sc1
    v_mfma_f32_16x16x32_bf16 v[124:127], a[28:31], a[116:119], v[124:127]
    ds_read_b64_tr_b16 a[152:153], v14 offset:8192
    s_add_u32 s48, s48, 1024
    v_mfma_f32_16x16x32_bf16 v[124:127], a[156:159], a[124:127], v[124:127]
    ds_read_b64_tr_b16 a[154:155], v14 offset:12288
    v_xor_b32 v15, 0x10000, v15
    s_mov_b32 s49, 4
.p2align 6
L_down_kernel_k:
    s_waitcnt vmcnt(16)
    s_waitcnt lgkmcnt(12)
    v_mfma_f32_16x16x32_bf16 v[64:67], a[0:3], a[64:67], v[64:67]
    ds_read_b64_tr_b16 a[28:29], v15 offset:0
    s_add_u32 m0, s47, 32768
    v_mfma_f32_16x16x32_bf16 v[64:67], a[128:131], a[72:75], v[64:67]
    ds_read_b64_tr_b16 a[30:31], v15 offset:4096
    buffer_load_dwordx4 v2, s[12:15], s44 offen lds
    v_mfma_f32_16x16x32_bf16 v[68:71], a[0:3], a[68:71], v[68:71]
    ds_read_b64_tr_b16 a[156:157], v15 offset:8192
    v_mfma_f32_16x16x32_bf16 v[68:71], a[128:131], a[76:79], v[68:71]
    ds_read_b64_tr_b16 a[158:159], v15 offset:12288
    s_waitcnt lgkmcnt(12)
    v_mfma_f32_16x16x32_bf16 v[72:75], a[4:7], a[64:67], v[72:75]
    ds_read_b64_tr_b16 a[0:1], v8 offset:16384
    s_add_u32 m0, s47, 36864
    v_mfma_f32_16x16x32_bf16 v[72:75], a[132:135], a[72:75], v[72:75]
    ds_read_b64_tr_b16 a[2:3], v8 offset:20480
    buffer_load_dwordx4 v16, s[12:15], s44 offen lds
    v_mfma_f32_16x16x32_bf16 v[76:79], a[4:7], a[68:71], v[76:79]
    ds_read_b64_tr_b16 a[128:129], v8 offset:24576
    s_add_u32 s44, s44, 65536
    v_mfma_f32_16x16x32_bf16 v[76:79], a[132:135], a[76:79], v[76:79]
    ds_read_b64_tr_b16 a[130:131], v8 offset:28672
    s_waitcnt lgkmcnt(12)
    v_mfma_f32_16x16x32_bf16 v[80:83], a[8:11], a[64:67], v[80:83]
    ds_read_b64_tr_b16 a[4:5], v9 offset:16384
    v_mfma_f32_16x16x32_bf16 v[80:83], a[136:139], a[72:75], v[80:83]
    ds_read_b64_tr_b16 a[6:7], v9 offset:20480
    buffer_load_dwordx4 a[112:115], v3, s[16:19], s48 offen sc1
    v_mfma_f32_16x16x32_bf16 v[84:87], a[8:11], a[68:71], v[84:87]
    ds_read_b64_tr_b16 a[132:133], v9 offset:24576
    v_mfma_f32_16x16x32_bf16 v[84:87], a[136:139], a[76:79], v[84:87]
    ds_read_b64_tr_b16 a[134:135], v9 offset:28672
    s_waitcnt lgkmcnt(12)
    v_mfma_f32_16x16x32_bf16 v[88:91], a[12:15], a[64:67], v[88:91]
    ds_read_b64_tr_b16 a[8:9], v10 offset:16384
    v_mfma_f32_16x16x32_bf16 v[88:91], a[140:143], a[72:75], v[88:91]
    ds_read_b64_tr_b16 a[10:11], v10 offset:20480
    buffer_load_dwordx4 a[116:119], v4, s[16:19], s48 offen sc1
    v_mfma_f32_16x16x32_bf16 v[92:95], a[12:15], a[68:71], v[92:95]
    ds_read_b64_tr_b16 a[136:137], v10 offset:24576
    s_add_u32 s48, s48, 1024
    v_mfma_f32_16x16x32_bf16 v[92:95], a[140:143], a[76:79], v[92:95]
    ds_read_b64_tr_b16 a[138:139], v10 offset:28672
    s_waitcnt lgkmcnt(12)
    v_mfma_f32_16x16x32_bf16 v[96:99], a[16:19], a[64:67], v[96:99]
    ds_read_b64_tr_b16 a[12:13], v11 offset:16384
    s_add_u32 m0, s47, 40960
    v_mfma_f32_16x16x32_bf16 v[96:99], a[144:147], a[72:75], v[96:99]
    ds_read_b64_tr_b16 a[14:15], v11 offset:20480
    buffer_load_dwordx4 v2, s[12:15], s44 offen lds
    v_mfma_f32_16x16x32_bf16 v[100:103], a[16:19], a[68:71], v[100:103]
    ds_read_b64_tr_b16 a[140:141], v11 offset:24576
    v_mfma_f32_16x16x32_bf16 v[100:103], a[144:147], a[76:79], v[100:103]
    ds_read_b64_tr_b16 a[142:143], v11 offset:28672
    s_waitcnt lgkmcnt(12)
    v_mfma_f32_16x16x32_bf16 v[104:107], a[20:23], a[64:67], v[104:107]
    ds_read_b64_tr_b16 a[16:17], v12 offset:16384
    s_add_u32 m0, s47, 45056
    v_mfma_f32_16x16x32_bf16 v[104:107], a[148:151], a[72:75], v[104:107]
    ds_read_b64_tr_b16 a[18:19], v12 offset:20480
    buffer_load_dwordx4 v16, s[12:15], s44 offen lds
    v_mfma_f32_16x16x32_bf16 v[108:111], a[20:23], a[68:71], v[108:111]
    ds_read_b64_tr_b16 a[144:145], v12 offset:24576
    s_add_u32 s44, s44, 65536
    v_mfma_f32_16x16x32_bf16 v[108:111], a[148:151], a[76:79], v[108:111]
    ds_read_b64_tr_b16 a[146:147], v12 offset:28672
    s_waitcnt lgkmcnt(12)
    v_mfma_f32_16x16x32_bf16 v[112:115], a[24:27], a[64:67], v[112:115]
    ds_read_b64_tr_b16 a[20:21], v13 offset:16384
    v_mfma_f32_16x16x32_bf16 v[112:115], a[152:155], a[72:75], v[112:115]
    ds_read_b64_tr_b16 a[22:23], v13 offset:20480
    buffer_load_dwordx4 a[120:123], v3, s[16:19], s48 offen sc1
    v_mfma_f32_16x16x32_bf16 v[116:119], a[24:27], a[68:71], v[116:119]
    ds_read_b64_tr_b16 a[148:149], v13 offset:24576
    v_mfma_f32_16x16x32_bf16 v[116:119], a[152:155], a[76:79], v[116:119]
    ds_read_b64_tr_b16 a[150:151], v13 offset:28672
    s_waitcnt lgkmcnt(12)
    v_mfma_f32_16x16x32_bf16 v[120:123], a[28:31], a[64:67], v[120:123]
    ds_read_b64_tr_b16 a[24:25], v14 offset:16384
    v_mfma_f32_16x16x32_bf16 v[120:123], a[156:159], a[72:75], v[120:123]
    ds_read_b64_tr_b16 a[26:27], v14 offset:20480
    buffer_load_dwordx4 a[124:127], v4, s[16:19], s48 offen sc1
    v_mfma_f32_16x16x32_bf16 v[124:127], a[28:31], a[68:71], v[124:127]
    ds_read_b64_tr_b16 a[152:153], v14 offset:24576
    s_add_u32 s48, s48, 1024
    v_mfma_f32_16x16x32_bf16 v[124:127], a[156:159], a[76:79], v[124:127]
    ds_read_b64_tr_b16 a[154:155], v14 offset:28672
    s_waitcnt vmcnt(16)
    s_barrier
    s_waitcnt lgkmcnt(12)
    v_mfma_f32_16x16x32_bf16 v[64:67], a[0:3], a[80:83], v[64:67]
    ds_read_b64_tr_b16 a[28:29], v15 offset:16384
    s_add_u32 m0, s47, 49152
    v_mfma_f32_16x16x32_bf16 v[64:67], a[128:131], a[88:91], v[64:67]
    ds_read_b64_tr_b16 a[30:31], v15 offset:20480
    buffer_load_dwordx4 v2, s[12:15], s44 offen lds
    v_mfma_f32_16x16x32_bf16 v[68:71], a[0:3], a[84:87], v[68:71]
    ds_read_b64_tr_b16 a[156:157], v15 offset:24576
    v_mfma_f32_16x16x32_bf16 v[68:71], a[128:131], a[92:95], v[68:71]
    ds_read_b64_tr_b16 a[158:159], v15 offset:28672
    s_waitcnt lgkmcnt(12)
    v_mfma_f32_16x16x32_bf16 v[72:75], a[4:7], a[80:83], v[72:75]
    ds_read_b64_tr_b16 a[0:1], v8 offset:32768
    s_add_u32 m0, s47, 53248
    v_mfma_f32_16x16x32_bf16 v[72:75], a[132:135], a[88:91], v[72:75]
    ds_read_b64_tr_b16 a[2:3], v8 offset:36864
    buffer_load_dwordx4 v16, s[12:15], s44 offen lds
    v_mfma_f32_16x16x32_bf16 v[76:79], a[4:7], a[84:87], v[76:79]
    ds_read_b64_tr_b16 a[128:129], v8 offset:40960
    s_add_u32 s44, s44, 65536
    v_mfma_f32_16x16x32_bf16 v[76:79], a[132:135], a[92:95], v[76:79]
    ds_read_b64_tr_b16 a[130:131], v8 offset:45056
    s_waitcnt lgkmcnt(12)
    v_mfma_f32_16x16x32_bf16 v[80:83], a[8:11], a[80:83], v[80:83]
    ds_read_b64_tr_b16 a[4:5], v9 offset:32768
    v_mfma_f32_16x16x32_bf16 v[80:83], a[136:139], a[88:91], v[80:83]
    ds_read_b64_tr_b16 a[6:7], v9 offset:36864
    buffer_load_dwordx4 a[64:67], v3, s[16:19], s48 offen sc1
    v_mfma_f32_16x16x32_bf16 v[84:87], a[8:11], a[84:87], v[84:87]
    ds_read_b64_tr_b16 a[132:133], v9 offset:40960
    v_mfma_f32_16x16x32_bf16 v[84:87], a[136:139], a[92:95], v[84:87]
    ds_read_b64_tr_b16 a[134:135], v9 offset:45056
    s_waitcnt lgkmcnt(12)
    v_mfma_f32_16x16x32_bf16 v[88:91], a[12:15], a[80:83], v[88:91]
    ds_read_b64_tr_b16 a[8:9], v10 offset:32768
    v_mfma_f32_16x16x32_bf16 v[88:91], a[140:143], a[88:91], v[88:91]
    ds_read_b64_tr_b16 a[10:11], v10 offset:36864
    buffer_load_dwordx4 a[68:71], v4, s[16:19], s48 offen sc1
    v_mfma_f32_16x16x32_bf16 v[92:95], a[12:15], a[84:87], v[92:95]
    ds_read_b64_tr_b16 a[136:137], v10 offset:40960
    s_add_u32 s48, s48, 1024
    v_mfma_f32_16x16x32_bf16 v[92:95], a[140:143], a[92:95], v[92:95]
    ds_read_b64_tr_b16 a[138:139], v10 offset:45056
    s_waitcnt lgkmcnt(12)
    v_mfma_f32_16x16x32_bf16 v[96:99], a[16:19], a[80:83], v[96:99]
    ds_read_b64_tr_b16 a[12:13], v11 offset:32768
    s_add_u32 m0, s47, 57344
    v_mfma_f32_16x16x32_bf16 v[96:99], a[144:147], a[88:91], v[96:99]
    ds_read_b64_tr_b16 a[14:15], v11 offset:36864
    buffer_load_dwordx4 v2, s[12:15], s44 offen lds
    v_mfma_f32_16x16x32_bf16 v[100:103], a[16:19], a[84:87], v[100:103]
    ds_read_b64_tr_b16 a[140:141], v11 offset:40960
    v_mfma_f32_16x16x32_bf16 v[100:103], a[144:147], a[92:95], v[100:103]
    ds_read_b64_tr_b16 a[142:143], v11 offset:45056
    s_waitcnt lgkmcnt(12)
    v_mfma_f32_16x16x32_bf16 v[104:107], a[20:23], a[80:83], v[104:107]
    ds_read_b64_tr_b16 a[16:17], v12 offset:32768
    s_add_u32 m0, s47, 61440
    v_mfma_f32_16x16x32_bf16 v[104:107], a[148:151], a[88:91], v[104:107]
    ds_read_b64_tr_b16 a[18:19], v12 offset:36864
    buffer_load_dwordx4 v16, s[12:15], s44 offen lds
    v_mfma_f32_16x16x32_bf16 v[108:111], a[20:23], a[84:87], v[108:111]
    ds_read_b64_tr_b16 a[144:145], v12 offset:40960
    s_add_u32 s44, s44, 65536
    v_mfma_f32_16x16x32_bf16 v[108:111], a[148:151], a[92:95], v[108:111]
    ds_read_b64_tr_b16 a[146:147], v12 offset:45056
    s_waitcnt lgkmcnt(12)
    v_mfma_f32_16x16x32_bf16 v[112:115], a[24:27], a[80:83], v[112:115]
    ds_read_b64_tr_b16 a[20:21], v13 offset:32768
    v_mfma_f32_16x16x32_bf16 v[112:115], a[152:155], a[88:91], v[112:115]
    ds_read_b64_tr_b16 a[22:23], v13 offset:36864
    buffer_load_dwordx4 a[72:75], v3, s[16:19], s48 offen sc1
    v_mfma_f32_16x16x32_bf16 v[116:119], a[24:27], a[84:87], v[116:119]
    ds_read_b64_tr_b16 a[148:149], v13 offset:40960
    v_mfma_f32_16x16x32_bf16 v[116:119], a[152:155], a[92:95], v[116:119]
    ds_read_b64_tr_b16 a[150:151], v13 offset:45056
    s_waitcnt lgkmcnt(12)
    v_mfma_f32_16x16x32_bf16 v[120:123], a[28:31], a[80:83], v[120:123]
    ds_read_b64_tr_b16 a[24:25], v14 offset:32768
    v_mfma_f32_16x16x32_bf16 v[120:123], a[156:159], a[88:91], v[120:123]
    ds_read_b64_tr_b16 a[26:27], v14 offset:36864
    buffer_load_dwordx4 a[76:79], v4, s[16:19], s48 offen sc1
    v_mfma_f32_16x16x32_bf16 v[124:127], a[28:31], a[84:87], v[124:127]
    ds_read_b64_tr_b16 a[152:153], v14 offset:40960
    s_add_u32 s48, s48, 1024
    v_mfma_f32_16x16x32_bf16 v[124:127], a[156:159], a[92:95], v[124:127]
    ds_read_b64_tr_b16 a[154:155], v14 offset:45056
    s_waitcnt vmcnt(16)
    s_waitcnt lgkmcnt(12)
    v_mfma_f32_16x16x32_bf16 v[64:67], a[0:3], a[96:99], v[64:67]
    ds_read_b64_tr_b16 a[28:29], v15 offset:32768
    s_add_u32 m0, s51, 0
    v_mfma_f32_16x16x32_bf16 v[64:67], a[128:131], a[104:107], v[64:67]
    ds_read_b64_tr_b16 a[30:31], v15 offset:36864
    buffer_load_dwordx4 v2, s[12:15], s44 offen lds
    v_mfma_f32_16x16x32_bf16 v[68:71], a[0:3], a[100:103], v[68:71]
    ds_read_b64_tr_b16 a[156:157], v15 offset:40960
    v_mfma_f32_16x16x32_bf16 v[68:71], a[128:131], a[108:111], v[68:71]
    ds_read_b64_tr_b16 a[158:159], v15 offset:45056
    s_waitcnt lgkmcnt(12)
    v_mfma_f32_16x16x32_bf16 v[72:75], a[4:7], a[96:99], v[72:75]
    ds_read_b64_tr_b16 a[0:1], v8 offset:49152
    s_add_u32 m0, s51, 4096
    v_mfma_f32_16x16x32_bf16 v[72:75], a[132:135], a[104:107], v[72:75]
    ds_read_b64_tr_b16 a[2:3], v8 offset:53248
    buffer_load_dwordx4 v16, s[12:15], s44 offen lds
    v_mfma_f32_16x16x32_bf16 v[76:79], a[4:7], a[100:103], v[76:79]
    ds_read_b64_tr_b16 a[128:129], v8 offset:57344
    s_add_u32 s44, s44, 65536
    v_mfma_f32_16x16x32_bf16 v[76:79], a[132:135], a[108:111], v[76:79]
    ds_read_b64_tr_b16 a[130:131], v8 offset:61440
    s_waitcnt lgkmcnt(12)
    v_mfma_f32_16x16x32_bf16 v[80:83], a[8:11], a[96:99], v[80:83]
    ds_read_b64_tr_b16 a[4:5], v9 offset:49152
    v_mfma_f32_16x16x32_bf16 v[80:83], a[136:139], a[104:107], v[80:83]
    ds_read_b64_tr_b16 a[6:7], v9 offset:53248
    buffer_load_dwordx4 a[80:83], v3, s[16:19], s48 offen sc1
    v_mfma_f32_16x16x32_bf16 v[84:87], a[8:11], a[100:103], v[84:87]
    ds_read_b64_tr_b16 a[132:133], v9 offset:57344
    v_mfma_f32_16x16x32_bf16 v[84:87], a[136:139], a[108:111], v[84:87]
    ds_read_b64_tr_b16 a[134:135], v9 offset:61440
    s_waitcnt lgkmcnt(12)
    v_mfma_f32_16x16x32_bf16 v[88:91], a[12:15], a[96:99], v[88:91]
    ds_read_b64_tr_b16 a[8:9], v10 offset:49152
    v_mfma_f32_16x16x32_bf16 v[88:91], a[140:143], a[104:107], v[88:91]
    ds_read_b64_tr_b16 a[10:11], v10 offset:53248
    buffer_load_dwordx4 a[84:87], v4, s[16:19], s48 offen sc1
    v_mfma_f32_16x16x32_bf16 v[92:95], a[12:15], a[100:103], v[92:95]
    ds_read_b64_tr_b16 a[136:137], v10 offset:57344
    s_add_u32 s48, s48, 1024
    v_mfma_f32_16x16x32_bf16 v[92:95], a[140:143], a[108:111], v[92:95]
    ds_read_b64_tr_b16 a[138:139], v10 offset:61440
    s_waitcnt lgkmcnt(12)
    v_mfma_f32_16x16x32_bf16 v[96:99], a[16:19], a[96:99], v[96:99]
    ds_read_b64_tr_b16 a[12:13], v11 offset:49152
    s_add_u32 m0, s51, 8192
    v_mfma_f32_16x16x32_bf16 v[96:99], a[144:147], a[104:107], v[96:99]
    ds_read_b64_tr_b16 a[14:15], v11 offset:53248
    buffer_load_dwordx4 v2, s[12:15], s44 offen lds
    v_mfma_f32_16x16x32_bf16 v[100:103], a[16:19], a[100:103], v[100:103]
    ds_read_b64_tr_b16 a[140:141], v11 offset:57344
    v_mfma_f32_16x16x32_bf16 v[100:103], a[144:147], a[108:111], v[100:103]
    ds_read_b64_tr_b16 a[142:143], v11 offset:61440
    s_waitcnt lgkmcnt(12)
    v_mfma_f32_16x16x32_bf16 v[104:107], a[20:23], a[96:99], v[104:107]
    ds_read_b64_tr_b16 a[16:17], v12 offset:49152
    s_add_u32 m0, s51, 12288
    v_mfma_f32_16x16x32_bf16 v[104:107], a[148:151], a[104:107], v[104:107]
    ds_read_b64_tr_b16 a[18:19], v12 offset:53248
    buffer_load_dwordx4 v16, s[12:15], s44 offen lds
    v_mfma_f32_16x16x32_bf16 v[108:111], a[20:23], a[100:103], v[108:111]
    ds_read_b64_tr_b16 a[144:145], v12 offset:57344
    s_add_u32 s44, s44, 65536
    v_mfma_f32_16x16x32_bf16 v[108:111], a[148:151], a[108:111], v[108:111]
    ds_read_b64_tr_b16 a[146:147], v12 offset:61440
    s_waitcnt lgkmcnt(12)
    v_mfma_f32_16x16x32_bf16 v[112:115], a[24:27], a[96:99], v[112:115]
    ds_read_b64_tr_b16 a[20:21], v13 offset:49152
    v_mfma_f32_16x16x32_bf16 v[112:115], a[152:155], a[104:107], v[112:115]
    ds_read_b64_tr_b16 a[22:23], v13 offset:53248
    buffer_load_dwordx4 a[88:91], v3, s[16:19], s48 offen sc1
    v_mfma_f32_16x16x32_bf16 v[116:119], a[24:27], a[100:103], v[116:119]
    ds_read_b64_tr_b16 a[148:149], v13 offset:57344
    v_mfma_f32_16x16x32_bf16 v[116:119], a[152:155], a[108:111], v[116:119]
    ds_read_b64_tr_b16 a[150:151], v13 offset:61440
    s_waitcnt lgkmcnt(12)
    v_mfma_f32_16x16x32_bf16 v[120:123], a[28:31], a[96:99], v[120:123]
    ds_read_b64_tr_b16 a[24:25], v14 offset:49152
    v_mfma_f32_16x16x32_bf16 v[120:123], a[156:159], a[104:107], v[120:123]
    ds_read_b64_tr_b16 a[26:27], v14 offset:53248
    buffer_load_dwordx4 a[92:95], v4, s[16:19], s48 offen sc1
    v_mfma_f32_16x16x32_bf16 v[124:127], a[28:31], a[100:103], v[124:127]
    ds_read_b64_tr_b16 a[152:153], v14 offset:57344
    s_add_u32 s48, s48, 1024
    v_mfma_f32_16x16x32_bf16 v[124:127], a[156:159], a[108:111], v[124:127]
    ds_read_b64_tr_b16 a[154:155], v14 offset:61440
    s_waitcnt vmcnt(16)
    s_barrier
    s_waitcnt lgkmcnt(12)
    v_mfma_f32_16x16x32_bf16 v[64:67], a[0:3], a[112:115], v[64:67]
    ds_read_b64_tr_b16 a[28:29], v15 offset:49152
    s_add_u32 m0, s51, 16384
    v_mfma_f32_16x16x32_bf16 v[64:67], a[128:131], a[120:123], v[64:67]
    ds_read_b64_tr_b16 a[30:31], v15 offset:53248
    buffer_load_dwordx4 v2, s[12:15], s44 offen lds
    v_mfma_f32_16x16x32_bf16 v[68:71], a[0:3], a[116:119], v[68:71]
    ds_read_b64_tr_b16 a[156:157], v15 offset:57344
    v_mfma_f32_16x16x32_bf16 v[68:71], a[128:131], a[124:127], v[68:71]
    ds_read_b64_tr_b16 a[158:159], v15 offset:61440
    v_xor_b32 v8, 0x10000, v8
    s_waitcnt lgkmcnt(12)
    v_mfma_f32_16x16x32_bf16 v[72:75], a[4:7], a[112:115], v[72:75]
    ds_read_b64_tr_b16 a[0:1], v8 offset:0
    s_add_u32 m0, s51, 20480
    v_mfma_f32_16x16x32_bf16 v[72:75], a[132:135], a[120:123], v[72:75]
    ds_read_b64_tr_b16 a[2:3], v8 offset:4096
    buffer_load_dwordx4 v16, s[12:15], s44 offen lds
    v_mfma_f32_16x16x32_bf16 v[76:79], a[4:7], a[116:119], v[76:79]
    ds_read_b64_tr_b16 a[128:129], v8 offset:8192
    s_add_u32 s44, s44, 65536
    v_mfma_f32_16x16x32_bf16 v[76:79], a[132:135], a[124:127], v[76:79]
    ds_read_b64_tr_b16 a[130:131], v8 offset:12288
    v_xor_b32 v9, 0x10000, v9
    s_waitcnt lgkmcnt(12)
    v_mfma_f32_16x16x32_bf16 v[80:83], a[8:11], a[112:115], v[80:83]
    ds_read_b64_tr_b16 a[4:5], v9 offset:0
    v_mfma_f32_16x16x32_bf16 v[80:83], a[136:139], a[120:123], v[80:83]
    ds_read_b64_tr_b16 a[6:7], v9 offset:4096
    buffer_load_dwordx4 a[96:99], v3, s[16:19], s48 offen sc1
    v_mfma_f32_16x16x32_bf16 v[84:87], a[8:11], a[116:119], v[84:87]
    ds_read_b64_tr_b16 a[132:133], v9 offset:8192
    v_mfma_f32_16x16x32_bf16 v[84:87], a[136:139], a[124:127], v[84:87]
    ds_read_b64_tr_b16 a[134:135], v9 offset:12288
    v_xor_b32 v10, 0x10000, v10
    s_waitcnt lgkmcnt(12)
    v_mfma_f32_16x16x32_bf16 v[88:91], a[12:15], a[112:115], v[88:91]
    ds_read_b64_tr_b16 a[8:9], v10 offset:0
    v_mfma_f32_16x16x32_bf16 v[88:91], a[140:143], a[120:123], v[88:91]
    ds_read_b64_tr_b16 a[10:11], v10 offset:4096
    buffer_load_dwordx4 a[100:103], v4, s[16:19], s48 offen sc1
    v_mfma_f32_16x16x32_bf16 v[92:95], a[12:15], a[116:119], v[92:95]
    ds_read_b64_tr_b16 a[136:137], v10 offset:8192
    s_add_u32 s48, s48, 1024
    v_mfma_f32_16x16x32_bf16 v[92:95], a[140:143], a[124:127], v[92:95]
    ds_read_b64_tr_b16 a[138:139], v10 offset:12288
    v_xor_b32 v11, 0x10000, v11
    s_waitcnt lgkmcnt(12)
    v_mfma_f32_16x16x32_bf16 v[96:99], a[16:19], a[112:115], v[96:99]
    ds_read_b64_tr_b16 a[12:13], v11 offset:0
    s_add_u32 m0, s51, 24576
    v_mfma_f32_16x16x32_bf16 v[96:99], a[144:147], a[120:123], v[96:99]
    ds_read_b64_tr_b16 a[14:15], v11 offset:4096
    buffer_load_dwordx4 v2, s[12:15], s44 offen lds
    v_mfma_f32_16x16x32_bf16 v[100:103], a[16:19], a[116:119], v[100:103]
    ds_read_b64_tr_b16 a[140:141], v11 offset:8192
    v_mfma_f32_16x16x32_bf16 v[100:103], a[144:147], a[124:127], v[100:103]
    ds_read_b64_tr_b16 a[142:143], v11 offset:12288
    v_xor_b32 v12, 0x10000, v12
    s_waitcnt lgkmcnt(12)
    v_mfma_f32_16x16x32_bf16 v[104:107], a[20:23], a[112:115], v[104:107]
    ds_read_b64_tr_b16 a[16:17], v12 offset:0
    s_add_u32 m0, s51, 28672
    v_mfma_f32_16x16x32_bf16 v[104:107], a[148:151], a[120:123], v[104:107]
    ds_read_b64_tr_b16 a[18:19], v12 offset:4096
    buffer_load_dwordx4 v16, s[12:15], s44 offen lds
    v_mfma_f32_16x16x32_bf16 v[108:111], a[20:23], a[116:119], v[108:111]
    ds_read_b64_tr_b16 a[144:145], v12 offset:8192
    s_add_u32 s44, s44, 65536
    v_mfma_f32_16x16x32_bf16 v[108:111], a[148:151], a[124:127], v[108:111]
    ds_read_b64_tr_b16 a[146:147], v12 offset:12288
    v_xor_b32 v13, 0x10000, v13
    s_waitcnt lgkmcnt(12)
    v_mfma_f32_16x16x32_bf16 v[112:115], a[24:27], a[112:115], v[112:115]
    ds_read_b64_tr_b16 a[20:21], v13 offset:0
    v_mfma_f32_16x16x32_bf16 v[112:115], a[152:155], a[120:123], v[112:115]
    ds_read_b64_tr_b16 a[22:23], v13 offset:4096
    buffer_load_dwordx4 a[104:107], v3, s[16:19], s48 offen sc1
    v_mfma_f32_16x16x32_bf16 v[116:119], a[24:27], a[116:119], v[116:119]
    ds_read_b64_tr_b16 a[148:149], v13 offset:8192
    v_mfma_f32_16x16x32_bf16 v[116:119], a[152:155], a[124:127], v[116:119]
    ds_read_b64_tr_b16 a[150:151], v13 offset:12288
    v_xor_b32 v14, 0x10000, v14
    s_xor_b32 s47, s47, 0x10000
    s_waitcnt lgkmcnt(12)
    v_mfma_f32_16x16x32_bf16 v[120:123], a[28:31], a[112:115], v[120:123]
    ds_read_b64_tr_b16 a[24:25], v14 offset:0
    s_xor_b32 s51, s51, 0x10000
    v_mfma_f32_16x16x32_bf16 v[120:123], a[156:159], a[120:123], v[120:123]
    ds_read_b64_tr_b16 a[26:27], v14 offset:4096
    buffer_load_dwordx4 a[108:111], v4, s[16:19], s48 offen sc1
    v_mfma_f32_16x16x32_bf16 v[124:127], a[28:31], a[116:119], v[124:127]
    ds_read_b64_tr_b16 a[152:153], v14 offset:8192
    s_add_u32 s48, s48, 1024
    v_mfma_f32_16x16x32_bf16 v[124:127], a[156:159], a[124:127], v[124:127]
    ds_read_b64_tr_b16 a[154:155], v14 offset:12288
    v_xor_b32 v15, 0x10000, v15
    s_sub_u32 s49, s49, 1
    s_cmp_lg_u32 s49, 0
    s_cbranch_scc1 L_down_kernel_k
    s_waitcnt vmcnt(16)
    s_waitcnt lgkmcnt(12)
    v_mfma_f32_16x16x32_bf16 v[64:67], a[0:3], a[64:67], v[64:67]
    ds_read_b64_tr_b16 a[28:29], v15 offset:0
    s_add_u32 m0, s47, 32768
    v_mfma_f32_16x16x32_bf16 v[64:67], a[128:131], a[72:75], v[64:67]
    ds_read_b64_tr_b16 a[30:31], v15 offset:4096
    buffer_load_dwordx4 v2, s[12:15], s44 offen lds
    v_mfma_f32_16x16x32_bf16 v[68:71], a[0:3], a[68:71], v[68:71]
    ds_read_b64_tr_b16 a[156:157], v15 offset:8192
    v_mfma_f32_16x16x32_bf16 v[68:71], a[128:131], a[76:79], v[68:71]
    ds_read_b64_tr_b16 a[158:159], v15 offset:12288
    s_waitcnt lgkmcnt(12)
    v_mfma_f32_16x16x32_bf16 v[72:75], a[4:7], a[64:67], v[72:75]
    ds_read_b64_tr_b16 a[0:1], v8 offset:16384
    s_add_u32 m0, s47, 36864
    v_mfma_f32_16x16x32_bf16 v[72:75], a[132:135], a[72:75], v[72:75]
    ds_read_b64_tr_b16 a[2:3], v8 offset:20480
    buffer_load_dwordx4 v16, s[12:15], s44 offen lds
    v_mfma_f32_16x16x32_bf16 v[76:79], a[4:7], a[68:71], v[76:79]
    ds_read_b64_tr_b16 a[128:129], v8 offset:24576
    s_add_u32 s44, s44, 65536
    v_mfma_f32_16x16x32_bf16 v[76:79], a[132:135], a[76:79], v[76:79]
    ds_read_b64_tr_b16 a[130:131], v8 offset:28672
    s_waitcnt lgkmcnt(12)
    v_mfma_f32_16x16x32_bf16 v[80:83], a[8:11], a[64:67], v[80:83]
    ds_read_b64_tr_b16 a[4:5], v9 offset:16384
    v_mfma_f32_16x16x32_bf16 v[80:83], a[136:139], a[72:75], v[80:83]
    ds_read_b64_tr_b16 a[6:7], v9 offset:20480
    buffer_load_dwordx4 a[112:115], v3, s[16:19], s48 offen sc1
    v_mfma_f32_16x16x32_bf16 v[84:87], a[8:11], a[68:71], v[84:87]
    ds_read_b64_tr_b16 a[132:133], v9 offset:24576
    v_mfma_f32_16x16x32_bf16 v[84:87], a[136:139], a[76:79], v[84:87]
    ds_read_b64_tr_b16 a[134:135], v9 offset:28672
    s_waitcnt lgkmcnt(12)
    v_mfma_f32_16x16x32_bf16 v[88:91], a[12:15], a[64:67], v[88:91]
    ds_read_b64_tr_b16 a[8:9], v10 offset:16384
    v_mfma_f32_16x16x32_bf16 v[88:91], a[140:143], a[72:75], v[88:91]
    ds_read_b64_tr_b16 a[10:11], v10 offset:20480
    buffer_load_dwordx4 a[116:119], v4, s[16:19], s48 offen sc1
    v_mfma_f32_16x16x32_bf16 v[92:95], a[12:15], a[68:71], v[92:95]
    ds_read_b64_tr_b16 a[136:137], v10 offset:24576
    s_add_u32 s48, s48, 1024
    v_mfma_f32_16x16x32_bf16 v[92:95], a[140:143], a[76:79], v[92:95]
    ds_read_b64_tr_b16 a[138:139], v10 offset:28672
    s_waitcnt lgkmcnt(12)
    v_mfma_f32_16x16x32_bf16 v[96:99], a[16:19], a[64:67], v[96:99]
    ds_read_b64_tr_b16 a[12:13], v11 offset:16384
    s_add_u32 m0, s47, 40960
    v_mfma_f32_16x16x32_bf16 v[96:99], a[144:147], a[72:75], v[96:99]
    ds_read_b64_tr_b16 a[14:15], v11 offset:20480
    buffer_load_dwordx4 v2, s[12:15], s44 offen lds
    v_mfma_f32_16x16x32_bf16 v[100:103], a[16:19], a[68:71], v[100:103]
    ds_read_b64_tr_b16 a[140:141], v11 offset:24576
    v_mfma_f32_16x16x32_bf16 v[100:103], a[144:147], a[76:79], v[100:103]
    ds_read_b64_tr_b16 a[142:143], v11 offset:28672
    s_waitcnt lgkmcnt(12)
    v_mfma_f32_16x16x32_bf16 v[104:107], a[20:23], a[64:67], v[104:107]
    ds_read_b64_tr_b16 a[16:17], v12 offset:16384
    s_add_u32 m0, s47, 45056
    v_mfma_f32_16x16x32_bf16 v[104:107], a[148:151], a[72:75], v[104:107]
    ds_read_b64_tr_b16 a[18:19], v12 offset:20480
    buffer_load_dwordx4 v16, s[12:15], s44 offen lds
    v_mfma_f32_16x16x32_bf16 v[108:111], a[20:23], a[68:71], v[108:111]
    ds_read_b64_tr_b16 a[144:145], v12 offset:24576
    s_add_u32 s44, s44, 65536
    v_mfma_f32_16x16x32_bf16 v[108:111], a[148:151], a[76:79], v[108:111]
    ds_read_b64_tr_b16 a[146:147], v12 offset:28672
    s_waitcnt lgkmcnt(12)
    v_mfma_f32_16x16x32_bf16 v[112:115], a[24:27], a[64:67], v[112:115]
    ds_read_b64_tr_b16 a[20:21], v13 offset:16384
    v_mfma_f32_16x16x32_bf16 v[112:115], a[152:155], a[72:75], v[112:115]
    ds_read_b64_tr_b16 a[22:23], v13 offset:20480
    buffer_load_dwordx4 a[120:123], v3, s[16:19], s48 offen sc1
    v_mfma_f32_16x16x32_bf16 v[116:119], a[24:27], a[68:71], v[116:119]
    ds_read_b64_tr_b16 a[148:149], v13 offset:24576
    v_mfma_f32_16x16x32_bf16 v[116:119], a[152:155], a[76:79], v[116:119]
    ds_read_b64_tr_b16 a[150:151], v13 offset:28672
    s_waitcnt lgkmcnt(12)
    v_mfma_f32_16x16x32_bf16 v[120:123], a[28:31], a[64:67], v[120:123]
    ds_read_b64_tr_b16 a[24:25], v14 offset:16384
    v_mfma_f32_16x16x32_bf16 v[120:123], a[156:159], a[72:75], v[120:123]
    ds_read_b64_tr_b16 a[26:27], v14 offset:20480
    buffer_load_dwordx4 a[124:127], v4, s[16:19], s48 offen sc1
    v_mfma_f32_16x16x32_bf16 v[124:127], a[28:31], a[68:71], v[124:127]
    ds_read_b64_tr_b16 a[152:153], v14 offset:24576
    s_add_u32 s48, s48, 1024
    v_mfma_f32_16x16x32_bf16 v[124:127], a[156:159], a[76:79], v[124:127]
    ds_read_b64_tr_b16 a[154:155], v14 offset:28672
    s_waitcnt vmcnt(16)
    s_barrier
    s_waitcnt lgkmcnt(12)
    v_mfma_f32_16x16x32_bf16 v[64:67], a[0:3], a[80:83], v[64:67]
    ds_read_b64_tr_b16 a[28:29], v15 offset:16384
    s_add_u32 m0, s47, 49152
    v_mfma_f32_16x16x32_bf16 v[64:67], a[128:131], a[88:91], v[64:67]
    ds_read_b64_tr_b16 a[30:31], v15 offset:20480
    buffer_load_dwordx4 v2, s[12:15], s44 offen lds
    v_mfma_f32_16x16x32_bf16 v[68:71], a[0:3], a[84:87], v[68:71]
    ds_read_b64_tr_b16 a[156:157], v15 offset:24576
    v_mfma_f32_16x16x32_bf16 v[68:71], a[128:131], a[92:95], v[68:71]
    ds_read_b64_tr_b16 a[158:159], v15 offset:28672
    s_waitcnt lgkmcnt(12)
    v_mfma_f32_16x16x32_bf16 v[72:75], a[4:7], a[80:83], v[72:75]
    ds_read_b64_tr_b16 a[0:1], v8 offset:32768
    s_add_u32 m0, s47, 53248
    v_mfma_f32_16x16x32_bf16 v[72:75], a[132:135], a[88:91], v[72:75]
    ds_read_b64_tr_b16 a[2:3], v8 offset:36864
    buffer_load_dwordx4 v16, s[12:15], s44 offen lds
    v_mfma_f32_16x16x32_bf16 v[76:79], a[4:7], a[84:87], v[76:79]
    ds_read_b64_tr_b16 a[128:129], v8 offset:40960
    s_add_u32 s44, s44, 65536
    v_mfma_f32_16x16x32_bf16 v[76:79], a[132:135], a[92:95], v[76:79]
    ds_read_b64_tr_b16 a[130:131], v8 offset:45056
    s_waitcnt lgkmcnt(12)
    v_mfma_f32_16x16x32_bf16 v[80:83], a[8:11], a[80:83], v[80:83]
    ds_read_b64_tr_b16 a[4:5], v9 offset:32768
    v_mfma_f32_16x16x32_bf16 v[80:83], a[136:139], a[88:91], v[80:83]
    ds_read_b64_tr_b16 a[6:7], v9 offset:36864
    buffer_load_dwordx4 a[64:67], v3, s[16:19], s48 offen sc1
    v_mfma_f32_16x16x32_bf16 v[84:87], a[8:11], a[84:87], v[84:87]
    ds_read_b64_tr_b16 a[132:133], v9 offset:40960
    v_mfma_f32_16x16x32_bf16 v[84:87], a[136:139], a[92:95], v[84:87]
    ds_read_b64_tr_b16 a[134:135], v9 offset:45056
    s_waitcnt lgkmcnt(12)
    v_mfma_f32_16x16x32_bf16 v[88:91], a[12:15], a[80:83], v[88:91]
    ds_read_b64_tr_b16 a[8:9], v10 offset:32768
    v_mfma_f32_16x16x32_bf16 v[88:91], a[140:143], a[88:91], v[88:91]
    ds_read_b64_tr_b16 a[10:11], v10 offset:36864
    buffer_load_dwordx4 a[68:71], v4, s[16:19], s48 offen sc1
    v_mfma_f32_16x16x32_bf16 v[92:95], a[12:15], a[84:87], v[92:95]
    ds_read_b64_tr_b16 a[136:137], v10 offset:40960
    s_add_u32 s48, s48, 1024
    v_mfma_f32_16x16x32_bf16 v[92:95], a[140:143], a[92:95], v[92:95]
    ds_read_b64_tr_b16 a[138:139], v10 offset:45056
    s_waitcnt lgkmcnt(12)
    v_mfma_f32_16x16x32_bf16 v[96:99], a[16:19], a[80:83], v[96:99]
    ds_read_b64_tr_b16 a[12:13], v11 offset:32768
    s_add_u32 m0, s47, 57344
    v_mfma_f32_16x16x32_bf16 v[96:99], a[144:147], a[88:91], v[96:99]
    ds_read_b64_tr_b16 a[14:15], v11 offset:36864
    buffer_load_dwordx4 v2, s[12:15], s44 offen lds
    v_mfma_f32_16x16x32_bf16 v[100:103], a[16:19], a[84:87], v[100:103]
    ds_read_b64_tr_b16 a[140:141], v11 offset:40960
    v_mfma_f32_16x16x32_bf16 v[100:103], a[144:147], a[92:95], v[100:103]
    ds_read_b64_tr_b16 a[142:143], v11 offset:45056
    s_waitcnt lgkmcnt(12)
    v_mfma_f32_16x16x32_bf16 v[104:107], a[20:23], a[80:83], v[104:107]
    ds_read_b64_tr_b16 a[16:17], v12 offset:32768
    s_add_u32 m0, s47, 61440
    v_mfma_f32_16x16x32_bf16 v[104:107], a[148:151], a[88:91], v[104:107]
    ds_read_b64_tr_b16 a[18:19], v12 offset:36864
    buffer_load_dwordx4 v16, s[12:15], s44 offen lds
    v_mfma_f32_16x16x32_bf16 v[108:111], a[20:23], a[84:87], v[108:111]
    ds_read_b64_tr_b16 a[144:145], v12 offset:40960
    s_add_u32 s44, s44, 65536
    v_mfma_f32_16x16x32_bf16 v[108:111], a[148:151], a[92:95], v[108:111]
    ds_read_b64_tr_b16 a[146:147], v12 offset:45056
    s_waitcnt lgkmcnt(12)
    v_mfma_f32_16x16x32_bf16 v[112:115], a[24:27], a[80:83], v[112:115]
    ds_read_b64_tr_b16 a[20:21], v13 offset:32768
    v_mfma_f32_16x16x32_bf16 v[112:115], a[152:155], a[88:91], v[112:115]
    ds_read_b64_tr_b16 a[22:23], v13 offset:36864
    buffer_load_dwordx4 a[72:75], v3, s[16:19], s48 offen sc1
    v_mfma_f32_16x16x32_bf16 v[116:119], a[24:27], a[84:87], v[116:119]
    ds_read_b64_tr_b16 a[148:149], v13 offset:40960
    v_mfma_f32_16x16x32_bf16 v[116:119], a[152:155], a[92:95], v[116:119]
    ds_read_b64_tr_b16 a[150:151], v13 offset:45056
    s_waitcnt lgkmcnt(12)
    v_mfma_f32_16x16x32_bf16 v[120:123], a[28:31], a[80:83], v[120:123]
    ds_read_b64_tr_b16 a[24:25], v14 offset:32768
    v_mfma_f32_16x16x32_bf16 v[120:123], a[156:159], a[88:91], v[120:123]
    ds_read_b64_tr_b16 a[26:27], v14 offset:36864
    buffer_load_dwordx4 a[76:79], v4, s[16:19], s48 offen sc1
    v_mfma_f32_16x16x32_bf16 v[124:127], a[28:31], a[84:87], v[124:127]
    ds_read_b64_tr_b16 a[152:153], v14 offset:40960
    s_add_u32 s48, s48, 1024
    v_mfma_f32_16x16x32_bf16 v[124:127], a[156:159], a[92:95], v[124:127]
    ds_read_b64_tr_b16 a[154:155], v14 offset:45056
    s_waitcnt vmcnt(16)
    s_waitcnt lgkmcnt(12)
    v_mfma_f32_16x16x32_bf16 v[64:67], a[0:3], a[96:99], v[64:67]
    ds_read_b64_tr_b16 a[28:29], v15 offset:32768
    v_mfma_f32_16x16x32_bf16 v[64:67], a[128:131], a[104:107], v[64:67]
    ds_read_b64_tr_b16 a[30:31], v15 offset:36864
    v_mfma_f32_16x16x32_bf16 v[68:71], a[0:3], a[100:103], v[68:71]
    ds_read_b64_tr_b16 a[156:157], v15 offset:40960
    v_mfma_f32_16x16x32_bf16 v[68:71], a[128:131], a[108:111], v[68:71]
    ds_read_b64_tr_b16 a[158:159], v15 offset:45056
    s_waitcnt lgkmcnt(12)
    v_mfma_f32_16x16x32_bf16 v[72:75], a[4:7], a[96:99], v[72:75]
    ds_read_b64_tr_b16 a[0:1], v8 offset:49152
    v_mfma_f32_16x16x32_bf16 v[72:75], a[132:135], a[104:107], v[72:75]
    ds_read_b64_tr_b16 a[2:3], v8 offset:53248
    v_mfma_f32_16x16x32_bf16 v[76:79], a[4:7], a[100:103], v[76:79]
    ds_read_b64_tr_b16 a[128:129], v8 offset:57344
    v_mfma_f32_16x16x32_bf16 v[76:79], a[132:135], a[108:111], v[76:79]
    ds_read_b64_tr_b16 a[130:131], v8 offset:61440
    s_waitcnt lgkmcnt(12)
    v_mfma_f32_16x16x32_bf16 v[80:83], a[8:11], a[96:99], v[80:83]
    ds_read_b64_tr_b16 a[4:5], v9 offset:49152
    v_mfma_f32_16x16x32_bf16 v[80:83], a[136:139], a[104:107], v[80:83]
    ds_read_b64_tr_b16 a[6:7], v9 offset:53248
    buffer_load_dwordx4 a[80:83], v3, s[16:19], s48 offen sc1
    v_mfma_f32_16x16x32_bf16 v[84:87], a[8:11], a[100:103], v[84:87]
    ds_read_b64_tr_b16 a[132:133], v9 offset:57344
    v_mfma_f32_16x16x32_bf16 v[84:87], a[136:139], a[108:111], v[84:87]
    ds_read_b64_tr_b16 a[134:135], v9 offset:61440
    s_waitcnt lgkmcnt(12)
    v_mfma_f32_16x16x32_bf16 v[88:91], a[12:15], a[96:99], v[88:91]
    ds_read_b64_tr_b16 a[8:9], v10 offset:49152
    v_mfma_f32_16x16x32_bf16 v[88:91], a[140:143], a[104:107], v[88:91]
    ds_read_b64_tr_b16 a[10:11], v10 offset:53248
    buffer_load_dwordx4 a[84:87], v4, s[16:19], s48 offen sc1
    v_mfma_f32_16x16x32_bf16 v[92:95], a[12:15], a[100:103], v[92:95]
    ds_read_b64_tr_b16 a[136:137], v10 offset:57344
    s_add_u32 s48, s48, 1024
    v_mfma_f32_16x16x32_bf16 v[92:95], a[140:143], a[108:111], v[92:95]
    ds_read_b64_tr_b16 a[138:139], v10 offset:61440
    s_waitcnt lgkmcnt(12)
    v_mfma_f32_16x16x32_bf16 v[96:99], a[16:19], a[96:99], v[96:99]
    ds_read_b64_tr_b16 a[12:13], v11 offset:49152
    v_mfma_f32_16x16x32_bf16 v[96:99], a[144:147], a[104:107], v[96:99]
    ds_read_b64_tr_b16 a[14:15], v11 offset:53248
    v_mfma_f32_16x16x32_bf16 v[100:103], a[16:19], a[100:103], v[100:103]
    ds_read_b64_tr_b16 a[140:141], v11 offset:57344
    v_mfma_f32_16x16x32_bf16 v[100:103], a[144:147], a[108:111], v[100:103]
    ds_read_b64_tr_b16 a[142:143], v11 offset:61440
    s_waitcnt lgkmcnt(12)
    v_mfma_f32_16x16x32_bf16 v[104:107], a[20:23], a[96:99], v[104:107]
    ds_read_b64_tr_b16 a[16:17], v12 offset:49152
    v_mfma_f32_16x16x32_bf16 v[104:107], a[148:151], a[104:107], v[104:107]
    ds_read_b64_tr_b16 a[18:19], v12 offset:53248
    v_mfma_f32_16x16x32_bf16 v[108:111], a[20:23], a[100:103], v[108:111]
    ds_read_b64_tr_b16 a[144:145], v12 offset:57344
    v_mfma_f32_16x16x32_bf16 v[108:111], a[148:151], a[108:111], v[108:111]
    ds_read_b64_tr_b16 a[146:147], v12 offset:61440
    s_waitcnt lgkmcnt(12)
    v_mfma_f32_16x16x32_bf16 v[112:115], a[24:27], a[96:99], v[112:115]
    ds_read_b64_tr_b16 a[20:21], v13 offset:49152
    v_mfma_f32_16x16x32_bf16 v[112:115], a[152:155], a[104:107], v[112:115]
    ds_read_b64_tr_b16 a[22:23], v13 offset:53248
    buffer_load_dwordx4 a[88:91], v3, s[16:19], s48 offen sc1
    v_mfma_f32_16x16x32_bf16 v[116:119], a[24:27], a[100:103], v[116:119]
    ds_read_b64_tr_b16 a[148:149], v13 offset:57344
    v_mfma_f32_16x16x32_bf16 v[116:119], a[152:155], a[108:111], v[116:119]
    ds_read_b64_tr_b16 a[150:151], v13 offset:61440
    s_waitcnt lgkmcnt(12)
    v_mfma_f32_16x16x32_bf16 v[120:123], a[28:31], a[96:99], v[120:123]
    ds_read_b64_tr_b16 a[24:25], v14 offset:49152
    v_mfma_f32_16x16x32_bf16 v[120:123], a[156:159], a[104:107], v[120:123]
    ds_read_b64_tr_b16 a[26:27], v14 offset:53248
    buffer_load_dwordx4 a[92:95], v4, s[16:19], s48 offen sc1
    v_mfma_f32_16x16x32_bf16 v[124:127], a[28:31], a[100:103], v[124:127]
    ds_read_b64_tr_b16 a[152:153], v14 offset:57344
    s_add_u32 s48, s48, 1024
    v_mfma_f32_16x16x32_bf16 v[124:127], a[156:159], a[108:111], v[124:127]
    ds_read_b64_tr_b16 a[154:155], v14 offset:61440
    s_waitcnt vmcnt(12)
    s_barrier
    s_waitcnt lgkmcnt(12)
    v_mfma_f32_16x16x32_bf16 v[64:67], a[0:3], a[112:115], v[64:67]
    ds_read_b64_tr_b16 a[28:29], v15 offset:49152
    v_mfma_f32_16x16x32_bf16 v[64:67], a[128:131], a[120:123], v[64:67]
    ds_read_b64_tr_b16 a[30:31], v15 offset:53248
    v_mfma_f32_16x16x32_bf16 v[68:71], a[0:3], a[116:119], v[68:71]
    ds_read_b64_tr_b16 a[156:157], v15 offset:57344
    v_mfma_f32_16x16x32_bf16 v[68:71], a[128:131], a[124:127], v[68:71]
    ds_read_b64_tr_b16 a[158:159], v15 offset:61440
    v_xor_b32 v8, 0x10000, v8
    s_waitcnt lgkmcnt(12)
    v_mfma_f32_16x16x32_bf16 v[72:75], a[4:7], a[112:115], v[72:75]
    ds_read_b64_tr_b16 a[0:1], v8 offset:0
    v_mfma_f32_16x16x32_bf16 v[72:75], a[132:135], a[120:123], v[72:75]
    ds_read_b64_tr_b16 a[2:3], v8 offset:4096
    v_mfma_f32_16x16x32_bf16 v[76:79], a[4:7], a[116:119], v[76:79]
    v_mfma_f32_16x16x32_bf16 v[76:79], a[132:135], a[124:127], v[76:79]
    v_xor_b32 v9, 0x10000, v9
    s_waitcnt lgkmcnt(12)
    v_mfma_f32_16x16x32_bf16 v[80:83], a[8:11], a[112:115], v[80:83]
    ds_read_b64_tr_b16 a[4:5], v9 offset:0
    v_mfma_f32_16x16x32_bf16 v[80:83], a[136:139], a[120:123], v[80:83]
    ds_read_b64_tr_b16 a[6:7], v9 offset:4096
    buffer_load_dwordx4 a[96:99], v3, s[16:19], s48 offen sc1
    v_mfma_f32_16x16x32_bf16 v[84:87], a[8:11], a[116:119], v[84:87]
    v_mfma_f32_16x16x32_bf16 v[84:87], a[136:139], a[124:127], v[84:87]
    v_xor_b32 v10, 0x10000, v10
    s_waitcnt lgkmcnt(12)
    v_mfma_f32_16x16x32_bf16 v[88:91], a[12:15], a[112:115], v[88:91]
    ds_read_b64_tr_b16 a[8:9], v10 offset:0
    v_mfma_f32_16x16x32_bf16 v[88:91], a[140:143], a[120:123], v[88:91]
    ds_read_b64_tr_b16 a[10:11], v10 offset:4096
    buffer_load_dwordx4 a[100:103], v4, s[16:19], s48 offen sc1
    v_mfma_f32_16x16x32_bf16 v[92:95], a[12:15], a[116:119], v[92:95]
    s_add_u32 s48, s48, 1024
    v_mfma_f32_16x16x32_bf16 v[92:95], a[140:143], a[124:127], v[92:95]
    v_xor_b32 v11, 0x10000, v11
    s_waitcnt lgkmcnt(6)
    v_mfma_f32_16x16x32_bf16 v[96:99], a[16:19], a[112:115], v[96:99]
    ds_read_b64_tr_b16 a[12:13], v11 offset:0
    v_mfma_f32_16x16x32_bf16 v[96:99], a[144:147], a[120:123], v[96:99]
    ds_read_b64_tr_b16 a[14:15], v11 offset:4096
    v_mfma_f32_16x16x32_bf16 v[100:103], a[16:19], a[116:119], v[100:103]
    v_mfma_f32_16x16x32_bf16 v[100:103], a[144:147], a[124:127], v[100:103]
    v_xor_b32 v12, 0x10000, v12
    s_waitcnt lgkmcnt(6)
    v_mfma_f32_16x16x32_bf16 v[104:107], a[20:23], a[112:115], v[104:107]
    ds_read_b64_tr_b16 a[16:17], v12 offset:0
    v_mfma_f32_16x16x32_bf16 v[104:107], a[148:151], a[120:123], v[104:107]
    ds_read_b64_tr_b16 a[18:19], v12 offset:4096
    v_mfma_f32_16x16x32_bf16 v[108:111], a[20:23], a[116:119], v[108:111]
    v_mfma_f32_16x16x32_bf16 v[108:111], a[148:151], a[124:127], v[108:111]
    v_xor_b32 v13, 0x10000, v13
    s_waitcnt lgkmcnt(6)
    v_mfma_f32_16x16x32_bf16 v[112:115], a[24:27], a[112:115], v[112:115]
    ds_read_b64_tr_b16 a[20:21], v13 offset:0
    v_mfma_f32_16x16x32_bf16 v[112:115], a[152:155], a[120:123], v[112:115]
    ds_read_b64_tr_b16 a[22:23], v13 offset:4096
    buffer_load_dwordx4 a[104:107], v3, s[16:19], s48 offen sc1
    v_mfma_f32_16x16x32_bf16 v[116:119], a[24:27], a[116:119], v[116:119]
    v_mfma_f32_16x16x32_bf16 v[116:119], a[152:155], a[124:127], v[116:119]
    v_xor_b32 v14, 0x10000, v14
    s_xor_b32 s47, s47, 0x10000
    s_waitcnt lgkmcnt(6)
    v_mfma_f32_16x16x32_bf16 v[120:123], a[28:31], a[112:115], v[120:123]
    ds_read_b64_tr_b16 a[24:25], v14 offset:0
    s_xor_b32 s51, s51, 0x10000
    v_mfma_f32_16x16x32_bf16 v[120:123], a[156:159], a[120:123], v[120:123]
    ds_read_b64_tr_b16 a[26:27], v14 offset:4096
    buffer_load_dwordx4 a[108:111], v4, s[16:19], s48 offen sc1
    v_mfma_f32_16x16x32_bf16 v[124:127], a[28:31], a[116:119], v[124:127]
    s_add_u32 s48, s48, 1024
    v_mfma_f32_16x16x32_bf16 v[124:127], a[156:159], a[124:127], v[124:127]
    v_xor_b32 v15, 0x10000, v15
    s_lshl_b32 s52, s2, 15
    s_lshl_b32 s53, s40, 13
    s_add_u32 s52, s52, s53
    s_add_u32 s55, s52, 4096
    s_xor_b32 s54, s2, 1
    s_lshl_b32 s54, s54, 15
    s_add_u32 s54, s54, s53
    s_waitcnt vmcnt(12)
    ds_read_b64_tr_b16 a[28:29], v15 offset:0
    ds_read_b64_tr_b16 a[30:31], v15 offset:4096
    s_waitcnt lgkmcnt(6)
    v_mfma_f32_16x16x32_bf16 v[96:99], a[16:19], a[64:67], v[96:99]
    ds_read_b64_tr_b16 a[144:145], v12 offset:8192
    v_mfma_f32_16x16x32_bf16 v[100:103], a[16:19], a[68:71], v[100:103]
    ds_read_b64_tr_b16 a[146:147], v12 offset:12288
    buffer_load_dwordx4 a[112:115], v3, s[16:19], s48 offen sc1
    s_waitcnt lgkmcnt(6)
    v_mfma_f32_16x16x32_bf16 v[104:107], a[20:23], a[64:67], v[104:107]
    ds_read_b64_tr_b16 a[148:149], v13 offset:8192
    v_mfma_f32_16x16x32_bf16 v[108:111], a[20:23], a[68:71], v[108:111]
    ds_read_b64_tr_b16 a[150:151], v13 offset:12288
    s_waitcnt lgkmcnt(6)
    v_mfma_f32_16x16x32_bf16 v[112:115], a[24:27], a[64:67], v[112:115]
    ds_read_b64_tr_b16 a[152:153], v14 offset:8192
    v_mfma_f32_16x16x32_bf16 v[116:119], a[24:27], a[68:71], v[116:119]
    ds_read_b64_tr_b16 a[154:155], v14 offset:12288
    buffer_load_dwordx4 a[116:119], v4, s[16:19], s48 offen sc1
    s_waitcnt lgkmcnt(6)
    v_mfma_f32_16x16x32_bf16 v[120:123], a[28:31], a[64:67], v[120:123]
    ds_read_b64_tr_b16 a[156:157], v15 offset:8192
    s_add_u32 s48, s48, 1024
    v_mfma_f32_16x16x32_bf16 v[124:127], a[28:31], a[68:71], v[124:127]
    ds_read_b64_tr_b16 a[158:159], v15 offset:12288
    s_waitcnt vmcnt(10)
    s_waitcnt lgkmcnt(6)
    v_mfma_f32_16x16x32_bf16 v[96:99], a[144:147], a[72:75], v[96:99]
    ds_read_b64_tr_b16 a[16:17], v12 offset:16384
    v_mfma_f32_16x16x32_bf16 v[100:103], a[144:147], a[76:79], v[100:103]
    ds_read_b64_tr_b16 a[18:19], v12 offset:20480
    buffer_load_dwordx4 a[120:123], v3, s[16:19], s48 offen sc1
    s_waitcnt lgkmcnt(6)
    v_mfma_f32_16x16x32_bf16 v[104:107], a[148:151], a[72:75], v[104:107]
    ds_read_b64_tr_b16 a[20:21], v13 offset:16384
    v_mfma_f32_16x16x32_bf16 v[108:111], a[148:151], a[76:79], v[108:111]
    ds_read_b64_tr_b16 a[22:23], v13 offset:20480
    s_waitcnt lgkmcnt(6)
    v_mfma_f32_16x16x32_bf16 v[112:115], a[152:155], a[72:75], v[112:115]
    ds_read_b64_tr_b16 a[24:25], v14 offset:16384
    v_mfma_f32_16x16x32_bf16 v[116:119], a[152:155], a[76:79], v[116:119]
    ds_read_b64_tr_b16 a[26:27], v14 offset:20480
    buffer_load_dwordx4 a[124:127], v4, s[16:19], s48 offen sc1
    s_waitcnt lgkmcnt(6)
    v_mfma_f32_16x16x32_bf16 v[120:123], a[156:159], a[72:75], v[120:123]
    ds_read_b64_tr_b16 a[28:29], v15 offset:16384
    s_add_u32 s48, s48, 1024
    v_mfma_f32_16x16x32_bf16 v[124:127], a[156:159], a[76:79], v[124:127]
    ds_read_b64_tr_b16 a[30:31], v15 offset:20480
    s_waitcnt vmcnt(10)
    s_waitcnt lgkmcnt(6)
    v_mfma_f32_16x16x32_bf16 v[96:99], a[16:19], a[80:83], v[96:99]
    ds_read_b64_tr_b16 a[144:145], v12 offset:24576
    v_mfma_f32_16x16x32_bf16 v[100:103], a[16:19], a[84:87], v[100:103]
    ds_read_b64_tr_b16 a[146:147], v12 offset:28672
    s_waitcnt lgkmcnt(6)
    v_mfma_f32_16x16x32_bf16 v[104:107], a[20:23], a[80:83], v[104:107]
    ds_read_b64_tr_b16 a[148:149], v13 offset:24576
    v_mfma_f32_16x16x32_bf16 v[108:111], a[20:23], a[84:87], v[108:111]
    ds_read_b64_tr_b16 a[150:151], v13 offset:28672
    s_waitcnt lgkmcnt(6)
    v_mfma_f32_16x16x32_bf16 v[112:115], a[24:27], a[80:83], v[112:115]
    ds_read_b64_tr_b16 a[152:153], v14 offset:24576
    v_mfma_f32_16x16x32_bf16 v[116:119], a[24:27], a[84:87], v[116:119]
    ds_read_b64_tr_b16 a[154:155], v14 offset:28672
    s_waitcnt lgkmcnt(6)
    v_mfma_f32_16x16x32_bf16 v[120:123], a[28:31], a[80:83], v[120:123]
    ds_read_b64_tr_b16 a[156:157], v15 offset:24576
    v_mfma_f32_16x16x32_bf16 v[124:127], a[28:31], a[84:87], v[124:127]
    ds_read_b64_tr_b16 a[158:159], v15 offset:28672
    s_waitcnt vmcnt(8)
    s_barrier
    s_waitcnt lgkmcnt(6)
    v_mfma_f32_16x16x32_bf16 v[96:99], a[144:147], a[88:91], v[96:99]
    ds_read_b64_tr_b16 a[16:17], v12 offset:32768
    v_mfma_f32_16x16x32_bf16 v[100:103], a[144:147], a[92:95], v[100:103]
    ds_read_b64_tr_b16 a[18:19], v12 offset:36864
    s_waitcnt lgkmcnt(6)
    v_mfma_f32_16x16x32_bf16 v[104:107], a[148:151], a[88:91], v[104:107]
    ds_read_b64_tr_b16 a[20:21], v13 offset:32768
    v_mfma_f32_16x16x32_bf16 v[108:111], a[148:151], a[92:95], v[108:111]
    ds_read_b64_tr_b16 a[22:23], v13 offset:36864
    s_waitcnt lgkmcnt(6)
    v_mfma_f32_16x16x32_bf16 v[112:115], a[152:155], a[88:91], v[112:115]
    ds_read_b64_tr_b16 a[24:25], v14 offset:32768
    v_mfma_f32_16x16x32_bf16 v[116:119], a[152:155], a[92:95], v[116:119]
    ds_read_b64_tr_b16 a[26:27], v14 offset:36864
    s_waitcnt lgkmcnt(6)
    v_mfma_f32_16x16x32_bf16 v[120:123], a[156:159], a[88:91], v[120:123]
    ds_read_b64_tr_b16 a[28:29], v15 offset:32768
    v_mfma_f32_16x16x32_bf16 v[124:127], a[156:159], a[92:95], v[124:127]
    ds_read_b64_tr_b16 a[30:31], v15 offset:36864
    s_waitcnt vmcnt(6)
    s_waitcnt lgkmcnt(6)
    v_mfma_f32_16x16x32_bf16 v[96:99], a[16:19], a[96:99], v[96:99]
    ds_read_b64_tr_b16 a[144:145], v12 offset:40960
    v_mfma_f32_16x16x32_bf16 v[100:103], a[16:19], a[100:103], v[100:103]
    ds_read_b64_tr_b16 a[146:147], v12 offset:45056
    s_waitcnt lgkmcnt(6)
    v_mfma_f32_16x16x32_bf16 v[104:107], a[20:23], a[96:99], v[104:107]
    ds_read_b64_tr_b16 a[148:149], v13 offset:40960
    v_mfma_f32_16x16x32_bf16 v[108:111], a[20:23], a[100:103], v[108:111]
    ds_read_b64_tr_b16 a[150:151], v13 offset:45056
    s_waitcnt lgkmcnt(6)
    v_mfma_f32_16x16x32_bf16 v[112:115], a[24:27], a[96:99], v[112:115]
    ds_read_b64_tr_b16 a[152:153], v14 offset:40960
    v_mfma_f32_16x16x32_bf16 v[116:119], a[24:27], a[100:103], v[116:119]
    ds_read_b64_tr_b16 a[154:155], v14 offset:45056
    s_waitcnt lgkmcnt(6)
    v_mfma_f32_16x16x32_bf16 v[120:123], a[28:31], a[96:99], v[120:123]
    ds_read_b64_tr_b16 a[156:157], v15 offset:40960
    v_mfma_f32_16x16x32_bf16 v[124:127], a[28:31], a[100:103], v[124:127]
    ds_read_b64_tr_b16 a[158:159], v15 offset:45056
    s_waitcnt vmcnt(4)
    s_waitcnt lgkmcnt(6)
    v_mfma_f32_16x16x32_bf16 v[96:99], a[144:147], a[104:107], v[96:99]
    ds_read_b64_tr_b16 a[16:17], v12 offset:49152
    v_mfma_f32_16x16x32_bf16 v[100:103], a[144:147], a[108:111], v[100:103]
    ds_read_b64_tr_b16 a[18:19], v12 offset:53248
    s_waitcnt lgkmcnt(6)
    v_mfma_f32_16x16x32_bf16 v[104:107], a[148:151], a[104:107], v[104:107]
    ds_read_b64_tr_b16 a[20:21], v13 offset:49152
    v_mfma_f32_16x16x32_bf16 v[108:111], a[148:151], a[108:111], v[108:111]
    ds_read_b64_tr_b16 a[22:23], v13 offset:53248
    s_waitcnt lgkmcnt(6)
    v_mfma_f32_16x16x32_bf16 v[112:115], a[152:155], a[104:107], v[112:115]
    ds_read_b64_tr_b16 a[24:25], v14 offset:49152
    v_mfma_f32_16x16x32_bf16 v[116:119], a[152:155], a[108:111], v[116:119]
    ds_read_b64_tr_b16 a[26:27], v14 offset:53248
    s_waitcnt lgkmcnt(6)
    v_mfma_f32_16x16x32_bf16 v[120:123], a[156:159], a[104:107], v[120:123]
    ds_read_b64_tr_b16 a[28:29], v15 offset:49152
    v_mfma_f32_16x16x32_bf16 v[124:127], a[156:159], a[108:111], v[124:127]
    ds_read_b64_tr_b16 a[30:31], v15 offset:53248
    s_waitcnt vmcnt(2)
    s_waitcnt lgkmcnt(6)
    v_mfma_f32_16x16x32_bf16 v[96:99], a[16:19], a[112:115], v[96:99]
    ds_read_b64_tr_b16 a[144:145], v12 offset:57344
    v_mfma_f32_16x16x32_bf16 v[100:103], a[16:19], a[116:119], v[100:103]
    ds_read_b64_tr_b16 a[146:147], v12 offset:61440
    s_waitcnt lgkmcnt(6)
    v_mfma_f32_16x16x32_bf16 v[104:107], a[20:23], a[112:115], v[104:107]
    ds_read_b64_tr_b16 a[148:149], v13 offset:57344
    v_mfma_f32_16x16x32_bf16 v[108:111], a[20:23], a[116:119], v[108:111]
    ds_read_b64_tr_b16 a[150:151], v13 offset:61440
    s_waitcnt lgkmcnt(6)
    v_mfma_f32_16x16x32_bf16 v[112:115], a[24:27], a[112:115], v[112:115]
    ds_read_b64_tr_b16 a[152:153], v14 offset:57344
    v_mfma_f32_16x16x32_bf16 v[116:119], a[24:27], a[116:119], v[116:119]
    ds_read_b64_tr_b16 a[154:155], v14 offset:61440
    s_waitcnt lgkmcnt(6)
    v_mfma_f32_16x16x32_bf16 v[120:123], a[28:31], a[112:115], v[120:123]
    ds_read_b64_tr_b16 a[156:157], v15 offset:57344
    v_mfma_f32_16x16x32_bf16 v[124:127], a[28:31], a[116:119], v[124:127]
    ds_read_b64_tr_b16 a[158:159], v15 offset:61440
    s_waitcnt vmcnt(0)
    s_waitcnt lgkmcnt(6)
    v_mfma_f32_16x16x32_bf16 v[96:99], a[144:147], a[120:123], v[96:99]
    v_mfma_f32_16x16x32_bf16 v[100:103], a[144:147], a[124:127], v[100:103]
    s_waitcnt lgkmcnt(4)
    v_mfma_f32_16x16x32_bf16 v[104:107], a[148:151], a[120:123], v[104:107]
    v_mfma_f32_16x16x32_bf16 v[108:111], a[148:151], a[124:127], v[108:111]
    s_waitcnt lgkmcnt(2)
    v_mfma_f32_16x16x32_bf16 v[112:115], a[152:155], a[120:123], v[112:115]
    v_mfma_f32_16x16x32_bf16 v[116:119], a[152:155], a[124:127], v[116:119]
    s_waitcnt lgkmcnt(0)
    v_mfma_f32_16x16x32_bf16 v[120:123], a[156:159], a[120:123], v[120:123]
    v_mfma_f32_16x16x32_bf16 v[124:127], a[156:159], a[124:127], v[124:127]
    v_mfma_f32_16x16x32_bf16 v[64:67], a[0:3], a[64:67], v[64:67]
    ds_read_b64_tr_b16 a[128:129], v8 offset:8192
    v_mfma_f32_16x16x32_bf16 v[68:71], a[0:3], a[68:71], v[68:71]
    ds_read_b64_tr_b16 a[130:131], v8 offset:12288
    buffer_store_dwordx4 v[96:99], v1, s[32:35], s52 offen offset:0 sc1
    v_mfma_f32_16x16x32_bf16 v[72:75], a[4:7], a[64:67], v[72:75]
    ds_read_b64_tr_b16 a[132:133], v9 offset:8192
    v_mfma_f32_16x16x32_bf16 v[76:79], a[4:7], a[68:71], v[76:79]
    ds_read_b64_tr_b16 a[134:135], v9 offset:12288
    buffer_store_dwordx4 v[100:103], v1, s[32:35], s52 offen offset:1024 sc1
    v_mfma_f32_16x16x32_bf16 v[80:83], a[8:11], a[64:67], v[80:83]
    ds_read_b64_tr_b16 a[136:137], v10 offset:8192
    v_mfma_f32_16x16x32_bf16 v[84:87], a[8:11], a[68:71], v[84:87]
    ds_read_b64_tr_b16 a[138:139], v10 offset:12288
    buffer_store_dwordx4 v[104:107], v1, s[32:35], s52 offen offset:2048 sc1
    v_mfma_f32_16x16x32_bf16 v[88:91], a[12:15], a[64:67], v[88:91]
    ds_read_b64_tr_b16 a[140:141], v11 offset:8192
    v_mfma_f32_16x16x32_bf16 v[92:95], a[12:15], a[68:71], v[92:95]
    ds_read_b64_tr_b16 a[142:143], v11 offset:12288
    buffer_store_dwordx4 v[108:111], v1, s[32:35], s52 offen offset:3072 sc1
    s_waitcnt lgkmcnt(6)
    v_mfma_f32_16x16x32_bf16 v[64:67], a[128:131], a[72:75], v[64:67]
    ds_read_b64_tr_b16 a[0:1], v8 offset:16384
    v_mfma_f32_16x16x32_bf16 v[68:71], a[128:131], a[76:79], v[68:71]
    ds_read_b64_tr_b16 a[2:3], v8 offset:20480
    buffer_store_dwordx4 v[112:115], v1, s[32:35], s55 offen offset:0 sc1
    s_waitcnt lgkmcnt(6)
    v_mfma_f32_16x16x32_bf16 v[72:75], a[132:135], a[72:75], v[72:75]
    ds_read_b64_tr_b16 a[4:5], v9 offset:16384
    v_mfma_f32_16x16x32_bf16 v[76:79], a[132:135], a[76:79], v[76:79]
    ds_read_b64_tr_b16 a[6:7], v9 offset:20480
    buffer_store_dwordx4 v[116:119], v1, s[32:35], s55 offen offset:1024 sc1
    s_waitcnt lgkmcnt(6)
    v_mfma_f32_16x16x32_bf16 v[80:83], a[136:139], a[72:75], v[80:83]
    ds_read_b64_tr_b16 a[8:9], v10 offset:16384
    v_mfma_f32_16x16x32_bf16 v[84:87], a[136:139], a[76:79], v[84:87]
    ds_read_b64_tr_b16 a[10:11], v10 offset:20480
    buffer_store_dwordx4 v[120:123], v1, s[32:35], s55 offen offset:2048 sc1
    s_waitcnt lgkmcnt(6)
    v_mfma_f32_16x16x32_bf16 v[88:91], a[140:143], a[72:75], v[88:91]
    ds_read_b64_tr_b16 a[12:13], v11 offset:16384
    v_mfma_f32_16x16x32_bf16 v[92:95], a[140:143], a[76:79], v[92:95]
    ds_read_b64_tr_b16 a[14:15], v11 offset:20480
    buffer_store_dwordx4 v[124:127], v1, s[32:35], s55 offen offset:3072 sc1
    s_waitcnt lgkmcnt(6)
    v_mfma_f32_16x16x32_bf16 v[64:67], a[0:3], a[80:83], v[64:67]
    ds_read_b64_tr_b16 a[128:129], v8 offset:24576
    v_mfma_f32_16x16x32_bf16 v[68:71], a[0:3], a[84:87], v[68:71]
    ds_read_b64_tr_b16 a[130:131], v8 offset:28672
    s_waitcnt lgkmcnt(6)
    v_mfma_f32_16x16x32_bf16 v[72:75], a[4:7], a[80:83], v[72:75]
    ds_read_b64_tr_b16 a[132:133], v9 offset:24576
    v_mfma_f32_16x16x32_bf16 v[76:79], a[4:7], a[84:87], v[76:79]
    ds_read_b64_tr_b16 a[134:135], v9 offset:28672
    s_waitcnt lgkmcnt(6)
    v_mfma_f32_16x16x32_bf16 v[80:83], a[8:11], a[80:83], v[80:83]
    ds_read_b64_tr_b16 a[136:137], v10 offset:24576
    v_mfma_f32_16x16x32_bf16 v[84:87], a[8:11], a[84:87], v[84:87]
    ds_read_b64_tr_b16 a[138:139], v10 offset:28672
    s_waitcnt lgkmcnt(6)
    v_mfma_f32_16x16x32_bf16 v[88:91], a[12:15], a[80:83], v[88:91]
    ds_read_b64_tr_b16 a[140:141], v11 offset:24576
    v_mfma_f32_16x16x32_bf16 v[92:95], a[12:15], a[84:87], v[92:95]
    ds_read_b64_tr_b16 a[142:143], v11 offset:28672
    s_waitcnt lgkmcnt(6)
    v_mfma_f32_16x16x32_bf16 v[64:67], a[128:131], a[88:91], v[64:67]
    ds_read_b64_tr_b16 a[0:1], v8 offset:32768
    v_mfma_f32_16x16x32_bf16 v[68:71], a[128:131], a[92:95], v[68:71]
    ds_read_b64_tr_b16 a[2:3], v8 offset:36864
    s_waitcnt lgkmcnt(6)
    v_mfma_f32_16x16x32_bf16 v[72:75], a[132:135], a[88:91], v[72:75]
    ds_read_b64_tr_b16 a[4:5], v9 offset:32768
    v_mfma_f32_16x16x32_bf16 v[76:79], a[132:135], a[92:95], v[76:79]
    ds_read_b64_tr_b16 a[6:7], v9 offset:36864
    s_waitcnt lgkmcnt(6)
    v_mfma_f32_16x16x32_bf16 v[80:83], a[136:139], a[88:91], v[80:83]
    ds_read_b64_tr_b16 a[8:9], v10 offset:32768
    v_mfma_f32_16x16x32_bf16 v[84:87], a[136:139], a[92:95], v[84:87]
    ds_read_b64_tr_b16 a[10:11], v10 offset:36864
    s_waitcnt lgkmcnt(6)
    v_mfma_f32_16x16x32_bf16 v[88:91], a[140:143], a[88:91], v[88:91]
    ds_read_b64_tr_b16 a[12:13], v11 offset:32768
    v_mfma_f32_16x16x32_bf16 v[92:95], a[140:143], a[92:95], v[92:95]
    ds_read_b64_tr_b16 a[14:15], v11 offset:36864
    s_waitcnt lgkmcnt(6)
    v_mfma_f32_16x16x32_bf16 v[64:67], a[0:3], a[96:99], v[64:67]
    ds_read_b64_tr_b16 a[128:129], v8 offset:40960
    v_mfma_f32_16x16x32_bf16 v[68:71], a[0:3], a[100:103], v[68:71]
    ds_read_b64_tr_b16 a[130:131], v8 offset:45056
    s_waitcnt lgkmcnt(6)
    v_mfma_f32_16x16x32_bf16 v[72:75], a[4:7], a[96:99], v[72:75]
    ds_read_b64_tr_b16 a[132:133], v9 offset:40960
    v_mfma_f32_16x16x32_bf16 v[76:79], a[4:7], a[100:103], v[76:79]
    ds_read_b64_tr_b16 a[134:135], v9 offset:45056
    s_waitcnt lgkmcnt(6)
    v_mfma_f32_16x16x32_bf16 v[80:83], a[8:11], a[96:99], v[80:83]
    ds_read_b64_tr_b16 a[136:137], v10 offset:40960
    v_mfma_f32_16x16x32_bf16 v[84:87], a[8:11], a[100:103], v[84:87]
    ds_read_b64_tr_b16 a[138:139], v10 offset:45056
    s_waitcnt lgkmcnt(6)
    v_mfma_f32_16x16x32_bf16 v[88:91], a[12:15], a[96:99], v[88:91]
    ds_read_b64_tr_b16 a[140:141], v11 offset:40960
    v_mfma_f32_16x16x32_bf16 v[92:95], a[12:15], a[100:103], v[92:95]
    ds_read_b64_tr_b16 a[142:143], v11 offset:45056
    s_waitcnt lgkmcnt(6)
    v_mfma_f32_16x16x32_bf16 v[64:67], a[128:131], a[104:107], v[64:67]
    ds_read_b64_tr_b16 a[0:1], v8 offset:49152
    v_mfma_f32_16x16x32_bf16 v[68:71], a[128:131], a[108:111], v[68:71]
    ds_read_b64_tr_b16 a[2:3], v8 offset:53248
    s_waitcnt lgkmcnt(6)
    v_mfma_f32_16x16x32_bf16 v[72:75], a[132:135], a[104:107], v[72:75]
    ds_read_b64_tr_b16 a[4:5], v9 offset:49152
    v_mfma_f32_16x16x32_bf16 v[76:79], a[132:135], a[108:111], v[76:79]
    ds_read_b64_tr_b16 a[6:7], v9 offset:53248
    s_waitcnt lgkmcnt(6)
    v_mfma_f32_16x16x32_bf16 v[80:83], a[136:139], a[104:107], v[80:83]
    ds_read_b64_tr_b16 a[8:9], v10 offset:49152
    v_mfma_f32_16x16x32_bf16 v[84:87], a[136:139], a[108:111], v[84:87]
    ds_read_b64_tr_b16 a[10:11], v10 offset:53248
    s_waitcnt lgkmcnt(6)
    v_mfma_f32_16x16x32_bf16 v[88:91], a[140:143], a[104:107], v[88:91]
    ds_read_b64_tr_b16 a[12:13], v11 offset:49152
    v_mfma_f32_16x16x32_bf16 v[92:95], a[140:143], a[108:111], v[92:95]
    ds_read_b64_tr_b16 a[14:15], v11 offset:53248
    s_waitcnt lgkmcnt(6)
    v_mfma_f32_16x16x32_bf16 v[64:67], a[0:3], a[112:115], v[64:67]
    ds_read_b64_tr_b16 a[128:129], v8 offset:57344
    v_mfma_f32_16x16x32_bf16 v[68:71], a[0:3], a[116:119], v[68:71]
    ds_read_b64_tr_b16 a[130:131], v8 offset:61440
    s_waitcnt lgkmcnt(6)
    v_mfma_f32_16x16x32_bf16 v[72:75], a[4:7], a[112:115], v[72:75]
    ds_read_b64_tr_b16 a[132:133], v9 offset:57344
    v_mfma_f32_16x16x32_bf16 v[76:79], a[4:7], a[116:119], v[76:79]
    ds_read_b64_tr_b16 a[134:135], v9 offset:61440
    s_waitcnt lgkmcnt(6)
    v_mfma_f32_16x16x32_bf16 v[80:83], a[8:11], a[112:115], v[80:83]
    ds_read_b64_tr_b16 a[136:137], v10 offset:57344
    v_mfma_f32_16x16x32_bf16 v[84:87], a[8:11], a[116:119], v[84:87]
    ds_read_b64_tr_b16 a[138:139], v10 offset:61440
    s_waitcnt lgkmcnt(6)
    v_mfma_f32_16x16x32_bf16 v[88:91], a[12:15], a[112:115], v[88:91]
    ds_read_b64_tr_b16 a[140:141], v11 offset:57344
    v_mfma_f32_16x16x32_bf16 v[92:95], a[12:15], a[116:119], v[92:95]
    ds_read_b64_tr_b16 a[142:143], v11 offset:61440
    s_waitcnt lgkmcnt(6)
    v_mfma_f32_16x16x32_bf16 v[64:67], a[128:131], a[120:123], v[64:67]
    v_mfma_f32_16x16x32_bf16 v[68:71], a[128:131], a[124:127], v[68:71]
    s_waitcnt lgkmcnt(4)
    v_mfma_f32_16x16x32_bf16 v[72:75], a[132:135], a[120:123], v[72:75]
    v_mfma_f32_16x16x32_bf16 v[76:79], a[132:135], a[124:127], v[76:79]
    s_waitcnt lgkmcnt(2)
    v_mfma_f32_16x16x32_bf16 v[80:83], a[136:139], a[120:123], v[80:83]
    v_mfma_f32_16x16x32_bf16 v[84:87], a[136:139], a[124:127], v[84:87]
    s_waitcnt lgkmcnt(0)
    v_mfma_f32_16x16x32_bf16 v[88:91], a[140:143], a[120:123], v[88:91]
    v_mfma_f32_16x16x32_bf16 v[92:95], a[140:143], a[124:127], v[92:95]
    s_barrier
    s_mov_b32 s53, 0
    buffer_load_dwordx4 v[16:19], v5, s[20:23], s53 offen sc1
    s_mov_b32 s53, 32768
    buffer_load_dwordx4 v[20:23], v5, s[20:23], s53 offen sc1
    s_mov_b32 s53, 0
    buffer_load_dwordx4 v[32:35], v6, s[28:31], s53 offen offset:0
    buffer_load_dwordx4 v[36:39], v6, s[28:31], s53 offen offset:16
    s_mov_b32 s53, 24576
    buffer_load_dwordx4 v[160:163], v6, s[28:31], s53 offen offset:0
    buffer_load_dwordx4 v[164:167], v6, s[28:31], s53 offen offset:16
    s_mov_b32 s53, 49152
    buffer_load_dwordx4 v[176:179], v6, s[28:31], s53 offen offset:0
    buffer_load_dwordx4 v[180:183], v6, s[28:31], s53 offen offset:16
    s_mov_b32 s53, 73728
    buffer_load_dwordx4 v[192:195], v6, s[28:31], s53 offen offset:0
    buffer_load_dwordx4 v[196:199], v6, s[28:31], s53 offen offset:16
    s_mov_b32 s53, 64
    buffer_load_dwordx4 v[24:27], v5, s[20:23], s53 offen sc1
    s_mov_b32 s53, 32832
    buffer_load_dwordx4 v[28:31], v5, s[20:23], s53 offen sc1
    s_mov_b32 s53, 0
    buffer_load_dwordx4 v[40:43], v6, s[28:31], s53 offen offset:128
    buffer_load_dwordx4 v[44:47], v6, s[28:31], s53 offen offset:144
    s_mov_b32 s53, 24576
    buffer_load_dwordx4 v[168:171], v6, s[28:31], s53 offen offset:128
    buffer_load_dwordx4 v[172:175], v6, s[28:31], s53 offen offset:144
    s_mov_b32 s53, 49152
    buffer_load_dwordx4 v[184:187], v6, s[28:31], s53 offen offset:128
    buffer_load_dwordx4 v[188:191], v6, s[28:31], s53 offen offset:144
    s_mov_b32 s53, 73728
    buffer_load_dwordx4 v[200:203], v6, s[28:31], s53 offen offset:128
    buffer_load_dwordx4 v[204:207], v6, s[28:31], s53 offen offset:144
    s_waitcnt vmcnt(20)
    s_barrier
    s_cmp_lg_u32 s40, 0
    s_cbranch_scc1 L_down_kernel_wait
    s_lshl_b32 s52, s2, 7
    s_xor_b32 s53, s52, 128
    v_mov_b32 v48, 1
    v_mov_b32 v49, s52
    v_mov_b32 v51, s53
    s_mov_b64 s[58:59], exec
    s_mov_b64 exec, 1
    buffer_store_dword v48, v49, s[36:39], 0 offen sc1
    s_mov_b32 s57, 262144
L_down_kernel_poll:
    buffer_load_dword v50, v51, s[36:39], 0 offen sc1
    s_waitcnt vmcnt(0)
    v_readfirstlane_b32 s53, v50
    s_cmp_eq_u32 s53, 1
    s_cbranch_scc1 L_down_kernel_got
    s_sleep 1
    s_sub_u32 s57, s57, 1
    s_cmp_lg_u32 s57, 0
    s_cbranch_scc1 L_down_kernel_poll
L_down_kernel_got:
    s_mov_b64 exec, s[58:59]
L_down_kernel_wait:
    s_barrier
    buffer_load_dwordx4 v[128:131], v1, s[32:35], s54 offen offset:0 sc1
    buffer_load_dwordx4 v[132:135], v1, s[32:35], s54 offen offset:1024 sc1
    buffer_load_dwordx4 v[136:139], v1, s[32:35], s54 offen offset:2048 sc1
    buffer_load_dwordx4 v[140:143], v1, s[32:35], s54 offen offset:3072 sc1
    s_add_u32 s54, s54, 4096
    buffer_load_dwordx4 v[144:147], v1, s[32:35], s54 offen offset:0 sc1
    buffer_load_dwordx4 v[148:151], v1, s[32:35], s54 offen offset:1024 sc1
    buffer_load_dwordx4 v[152:155], v1, s[32:35], s54 offen offset:2048 sc1
    buffer_load_dwordx4 v[156:159], v1, s[32:35], s54 offen offset:3072 sc1
    s_waitcnt vmcnt(8)
    v_add_f32 v32, v32, v160
    v_add_f32 v176, v176, v192
    v_add_f32 v32, v32, v176
    v_add_f32 v33, v33, v161
    v_add_f32 v177, v177, v193
    v_add_f32 v33, v33, v177
    v_add_f32 v34, v34, v162
    v_add_f32 v178, v178, v194
    v_add_f32 v34, v34, v178
    v_add_f32 v35, v35, v163
    v_add_f32 v179, v179, v195
    v_add_f32 v35, v35, v179
    v_add_f32 v36, v36, v164
    v_add_f32 v180, v180, v196
    v_add_f32 v36, v36, v180
    v_add_f32 v37, v37, v165
    v_add_f32 v181, v181, v197
    v_add_f32 v37, v37, v181
    v_add_f32 v38, v38, v166
    v_add_f32 v182, v182, v198
    v_add_f32 v38, v38, v182
    v_add_f32 v39, v39, v167
    v_add_f32 v183, v183, v199
    v_add_f32 v39, v39, v183
    v_add_f32 v40, v40, v168
    v_add_f32 v184, v184, v200
    v_add_f32 v40, v40, v184
    v_add_f32 v41, v41, v169
    v_add_f32 v185, v185, v201
    v_add_f32 v41, v41, v185
    v_add_f32 v42, v42, v170
    v_add_f32 v186, v186, v202
    v_add_f32 v42, v42, v186
    v_add_f32 v43, v43, v171
    v_add_f32 v187, v187, v203
    v_add_f32 v43, v43, v187
    v_add_f32 v44, v44, v172
    v_add_f32 v188, v188, v204
    v_add_f32 v44, v44, v188
    v_add_f32 v45, v45, v173
    v_add_f32 v189, v189, v205
    v_add_f32 v45, v45, v189
    v_add_f32 v46, v46, v174
    v_add_f32 v190, v190, v206
    v_add_f32 v46, v46, v190
    v_add_f32 v47, v47, v175
    v_add_f32 v191, v191, v207
    v_add_f32 v47, v47, v191
    v_cvt_pk_bf16_f32 v160, v32, v33
    v_cvt_pk_bf16_f32 v161, v34, v35
    v_cvt_pk_bf16_f32 v162, v36, v37
    v_cvt_pk_bf16_f32 v163, v38, v39
    v_cvt_pk_bf16_f32 v164, v40, v41
    v_cvt_pk_bf16_f32 v165, v42, v43
    v_cvt_pk_bf16_f32 v166, v44, v45
    v_cvt_pk_bf16_f32 v167, v46, v47
    v_lshlrev_b32 v32, 16, v160
    v_and_b32 v33, 0xffff0000, v160
    v_lshlrev_b32 v34, 16, v161
    v_and_b32 v35, 0xffff0000, v161
    v_lshlrev_b32 v36, 16, v162
    v_and_b32 v37, 0xffff0000, v162
    v_lshlrev_b32 v38, 16, v163
    v_and_b32 v39, 0xffff0000, v163
    v_lshlrev_b32 v40, 16, v164
    v_and_b32 v41, 0xffff0000, v164
    v_lshlrev_b32 v42, 16, v165
    v_and_b32 v43, 0xffff0000, v165
    v_lshlrev_b32 v44, 16, v166
    v_and_b32 v45, 0xffff0000, v166
    v_lshlrev_b32 v46, 16, v167
    v_and_b32 v47, 0xffff0000, v167
    s_mov_b32 s52, 0x3f317218
    v_mul_f32 v32, s52, v32
    v_mul_f32 v33, s52, v33
    v_mul_f32 v34, s52, v34
    v_mul_f32 v35, s52, v35
    v_mul_f32 v36, s52, v36
    v_mul_f32 v37, s52, v37
    v_mul_f32 v38, s52, v38
    v_mul_f32 v39, s52, v39
    v_mul_f32 v40, s52, v40
    v_mul_f32 v41, s52, v41
    v_mul_f32 v42, s52, v42
    v_mul_f32 v43, s52, v43
    v_mul_f32 v44, s52, v44
    v_mul_f32 v45, s52, v45
    v_mul_f32 v46, s52, v46
    v_mul_f32 v47, s52, v47
    s_waitcnt vmcnt(7)
    v_add_f32 v64, v64, v128
    v_add_f32 v65, v65, v129
    v_add_f32 v66, v66, v130
    v_add_f32 v67, v67, v131
    s_waitcnt vmcnt(6)
    v_add_f32 v68, v68, v132
    v_add_f32 v69, v69, v133
    v_add_f32 v70, v70, v134
    v_add_f32 v71, v71, v135
    s_waitcnt vmcnt(5)
    v_add_f32 v72, v72, v136
    v_add_f32 v73, v73, v137
    v_add_f32 v74, v74, v138
    v_add_f32 v75, v75, v139
    s_waitcnt vmcnt(4)
    v_add_f32 v76, v76, v140
    v_add_f32 v77, v77, v141
    v_add_f32 v78, v78, v142
    v_add_f32 v79, v79, v143
    s_waitcnt vmcnt(3)
    v_add_f32 v80, v80, v144
    v_add_f32 v81, v81, v145
    v_add_f32 v82, v82, v146
    v_add_f32 v83, v83, v147
    s_waitcnt vmcnt(2)
    v_add_f32 v84, v84, v148
    v_add_f32 v85, v85, v149
    v_add_f32 v86, v86, v150
    v_add_f32 v87, v87, v151
    s_waitcnt vmcnt(1)
    v_add_f32 v88, v88, v152
    v_add_f32 v89, v89, v153
    v_add_f32 v90, v90, v154
    v_add_f32 v91, v91, v155
    s_waitcnt vmcnt(0)
    v_add_f32 v92, v92, v156
    v_add_f32 v93, v93, v157
    v_add_f32 v94, v94, v158
    v_add_f32 v95, v95, v159
    s_nop 1
    v_permlane16_swap_b32 v64, v72
    v_permlane16_swap_b32 v65, v73
    v_permlane16_swap_b32 v66, v74
    v_permlane16_swap_b32 v67, v75
    v_lshlrev_b32 v52, 16, v16
    v_and_b32 v53, 0xffff0000, v16
    v_lshlrev_b32 v54, 16, v17
    v_and_b32 v55, 0xffff0000, v17
    v_lshlrev_b32 v56, 16, v18
    v_and_b32 v57, 0xffff0000, v18
    v_lshlrev_b32 v58, 16, v19
    v_and_b32 v59, 0xffff0000, v19
    v_fmac_f32 v52, v64, v32
    v_fmac_f32 v56, v72, v36
    v_fmac_f32 v53, v65, v33
    v_fmac_f32 v57, v73, v37
    v_fmac_f32 v54, v66, v34
    v_fmac_f32 v58, v74, v38
    v_fmac_f32 v55, v67, v35
    v_fmac_f32 v59, v75, v39
    v_cvt_pk_bf16_f32 v16, v52, v53
    v_cvt_pk_bf16_f32 v17, v54, v55
    v_cvt_pk_bf16_f32 v18, v56, v57
    v_cvt_pk_bf16_f32 v19, v58, v59
    s_mov_b32 s53, 0
    buffer_store_dwordx4 v[16:19], v5, s[24:27], s53 offen
    s_nop 1
    v_permlane16_swap_b32 v68, v76
    v_permlane16_swap_b32 v69, v77
    v_permlane16_swap_b32 v70, v78
    v_permlane16_swap_b32 v71, v79
    v_lshlrev_b32 v52, 16, v20
    v_and_b32 v53, 0xffff0000, v20
    v_lshlrev_b32 v54, 16, v21
    v_and_b32 v55, 0xffff0000, v21
    v_lshlrev_b32 v56, 16, v22
    v_and_b32 v57, 0xffff0000, v22
    v_lshlrev_b32 v58, 16, v23
    v_and_b32 v59, 0xffff0000, v23
    v_fmac_f32 v52, v68, v32
    v_fmac_f32 v56, v76, v36
    v_fmac_f32 v53, v69, v33
    v_fmac_f32 v57, v77, v37
    v_fmac_f32 v54, v70, v34
    v_fmac_f32 v58, v78, v38
    v_fmac_f32 v55, v71, v35
    v_fmac_f32 v59, v79, v39
    v_cvt_pk_bf16_f32 v20, v52, v53
    v_cvt_pk_bf16_f32 v21, v54, v55
    v_cvt_pk_bf16_f32 v22, v56, v57
    v_cvt_pk_bf16_f32 v23, v58, v59
    s_mov_b32 s53, 32768
    buffer_store_dwordx4 v[20:23], v5, s[24:27], s53 offen
    s_nop 1
    v_permlane16_swap_b32 v80, v88
    v_permlane16_swap_b32 v81, v89
    v_permlane16_swap_b32 v82, v90
    v_permlane16_swap_b32 v83, v91
    v_lshlrev_b32 v52, 16, v24
    v_and_b32 v53, 0xffff0000, v24
    v_lshlrev_b32 v54, 16, v25
    v_and_b32 v55, 0xffff0000, v25
    v_lshlrev_b32 v56, 16, v26
    v_and_b32 v57, 0xffff0000, v26
    v_lshlrev_b32 v58, 16, v27
    v_and_b32 v59, 0xffff0000, v27
    v_fmac_f32 v52, v80, v40
    v_fmac_f32 v56, v88, v44
    v_fmac_f32 v53, v81, v41
    v_fmac_f32 v57, v89, v45
    v_fmac_f32 v54, v82, v42
    v_fmac_f32 v58, v90, v46
    v_fmac_f32 v55, v83, v43
    v_fmac_f32 v59, v91, v47
    v_cvt_pk_bf16_f32 v24, v52, v53
    v_cvt_pk_bf16_f32 v25, v54, v55
    v_cvt_pk_bf16_f32 v26, v56, v57
    v_cvt_pk_bf16_f32 v27, v58, v59
    s_mov_b32 s53, 64
    buffer_store_dwordx4 v[24:27], v5, s[24:27], s53 offen
    s_nop 1
    v_permlane16_swap_b32 v84, v92
    v_permlane16_swap_b32 v85, v93
    v_permlane16_swap_b32 v86, v94
    v_permlane16_swap_b32 v87, v95
    v_lshlrev_b32 v52, 16, v28
    v_and_b32 v53, 0xffff0000, v28
    v_lshlrev_b32 v54, 16, v29
    v_and_b32 v55, 0xffff0000, v29
    v_lshlrev_b32 v56, 16, v30
    v_and_b32 v57, 0xffff0000, v30
    v_lshlrev_b32 v58, 16, v31
    v_and_b32 v59, 0xffff0000, v31
    v_fmac_f32 v52, v84, v40
    v_fmac_f32 v56, v92, v44
    v_fmac_f32 v53, v85, v41
    v_fmac_f32 v57, v93, v45
    v_fmac_f32 v54, v86, v42
    v_fmac_f32 v58, v94, v46
    v_fmac_f32 v55, v87, v43
    v_fmac_f32 v59, v95, v47
    v_cvt_pk_bf16_f32 v28, v52, v53
    v_cvt_pk_bf16_f32 v29, v54, v55
    v_cvt_pk_bf16_f32 v30, v56, v57
    v_cvt_pk_bf16_f32 v31, v58, v59
    s_mov_b32 s53, 32832
    buffer_store_dwordx4 v[28:31], v5, s[24:27], s53 offen
L_down_kernel_end:
    s_endpgm
mega_kernel_codeend:
.section .rodata,"a"
.p2align 6
.amdhsa_kernel prep_kernel
  .amdhsa_next_free_vgpr 128
  .amdhsa_next_free_sgpr 102
  .amdhsa_accum_offset 128
  .amdhsa_group_segment_fixed_size 0
  .amdhsa_kernarg_size 112
  .amdhsa_user_sgpr_count 2
  .amdhsa_user_sgpr_kernarg_segment_ptr 1
  .amdhsa_system_sgpr_workgroup_id_x 1
.end_amdhsa_kernel
.p2align 6
.amdhsa_kernel mega_kernel
  .amdhsa_next_free_vgpr 512
  .amdhsa_next_free_sgpr 102
  .amdhsa_accum_offset 256
  .amdhsa_group_segment_fixed_size 0
  .amdhsa_kernarg_size 112
  .amdhsa_user_sgpr_count 2
  .amdhsa_user_sgpr_kernarg_segment_ptr 1
  .amdhsa_system_sgpr_workgroup_id_x 1
.end_amdhsa_kernel
```
